```python
import torch

def _softmax(x, axis=-1):
    return torch.softmax(x, dim=axis)
def _gelu(x):
    return torch.nn.functional.gelu(x, approximate="tanh")
def _silu(x):
    return torch.nn.functional.silu(x)
def _sigmoid(x):
    return torch.sigmoid(x)
def _layernorm(x, axis=-1, eps=1e-5):
    m = x.mean(dim=axis, keepdim=True)
    v = x.var(dim=axis, keepdim=True, unbiased=False)
    return (x - m) / torch.sqrt(v + eps)
def _scatter_add(tgt, idx, src, axis=0):
    return tgt.clone().index_add_(axis, idx, src)
def _segment_sum(src, seg, n):
    out = torch.zeros((n,) + src.shape[1:], dtype=src.dtype)
    return out.index_add_(0, seg, src)
def _pad(x, pw):
    flat = tuple(v for pair in reversed(pw) for v in pair)
    return torch.nn.functional.pad(x, flat)

kernel_name = 'standalone__mha_softmax__near_ridge'

def setup_inputs():

    _w = (lambda a: (lambda t: t.to(torch.bfloat16) if t.is_floating_point() else t)(torch.as_tensor(a)))
    B, H, Sq, Sk, D = 32, 32, 256, 512, 128
    return {
        "q": _w((lambda *s: torch.randn(*s, dtype=torch.bfloat16) * 0.8)(B, H, Sq, D)),
        "k": _w((lambda *s: torch.randn(*s, dtype=torch.bfloat16) * 0.8)(B, H, Sk, D)),
        "v": _w((lambda *s: torch.randn(*s, dtype=torch.bfloat16) * 0.05)(B, H, Sk, D)),
    }

def reference(q, k, v):
    scale = q.shape[-1] ** -0.5
    scores = torch.einsum("bhqd,bhkd->bhqk", q, k) * scale
    p = _softmax(scores, axis=-1)
    return torch.einsum("bhqk,bhkd->bhqd", p, v)
```

```asm
; @launch grid=(256,1,1) block=(256,1,1) lds=163840
.amdgcn_target "amdgcn-amd-amdhsa--gfx950"
.text
.globl standalone__mha_softmax__near_ridge_kernel
.p2align 8
.type standalone__mha_softmax__near_ridge_kernel,@function
standalone__mha_softmax__near_ridge_kernel:
    s_cmp_ge_u32 s2, 256
    s_cbranch_scc1 L_end
    s_load_dwordx4 s[40:43], s[0:1], 0
    s_load_dwordx4 s[44:47], s[0:1], 16
    s_bfe_u32 s31, s2, 196611
    s_getreg_b32 s30, hwreg(HW_REG_XCC_ID)
    s_and_b32 s30, s30, 1
    s_mul_i32 s32, s2, 1
    s_bfe_u32 s32, s32, 131075
    s_lshl_b32 s32, s32, 17
    s_and_b32 s3, s2, 7
    s_lshl_b32 s3, s3, 5
    s_lshr_b32 s2, s2, 3
    s_or_b32 s2, s2, s3
    v_lshrrev_b32 v1, 6, v0
    v_and_b32 v2, 63, v0
    v_readfirstlane_b32 s28, v1
    v_lshrrev_b32 v3, 4, v2
    v_and_b32 v4, 15, v2
    v_lshl_add_u32 v5, v1, 3, v3
    v_and_b32 v9, 1, v1
    v_lshrrev_b32 v8, 1, v1
    v_lshlrev_b32 v7, 11, v9
    v_lshl_add_u32 v7, v8, 16, v7
    v_lshl_add_u32 v7, v3, 8, v7
    v_and_b32 v6, 15, v5
    v_xor_b32 v6, v6, v4
    v_lshl_add_u32 v232, v6, 4, v7
    v_xor_b32 v233, 64, v232
    v_lshlrev_b32 v6, 1, v3
    v_xor_b32 v6, v6, v4
    v_lshl_add_u32 v234, v6, 4, v7
    v_xor_b32 v235, 128, v234
    v_lshlrev_b32 v5, 13, v9
    v_lshl_add_u32 v5, v8, 15, v5
    v_lshl_add_u32 v5, v3, 8, v5
    v_xor_b32 v6, v3, v4
    v_lshl_add_u32 v236, v6, 4, v5
    v_xor_b32 v237, 64, v236
    v_xor_b32 v238, 128, v236
    v_xor_b32 v239, 192, v236
    s_lshl_b32 s25, s28, 11
    s_mul_i32 s29, s28, 24576
    s_add_u32 s29, s29, 65536
    s_lshl_b32 s20, s2, 19
    s_add_u32 s10, s20, 524288
    s_mov_b32 s14, s10
    s_lshr_b32 s6, s10, 1
    s_mov_b32 s18, s6
    s_xor_b32 s21, s20, s32
    s_add_u32 s22, s20, 131072
    s_xor_b32 s22, s22, s32
    s_lshr_b32 s23, s21, 1
    s_mov_b32 s7, 0x20000
    s_mov_b32 s11, 0x20000
    s_mov_b32 s15, 0x20000
    s_mov_b32 s19, 0x20000
    s_getpc_b64 s[36:37]
L_pc:
    v_lshl_add_u32 v12, s31, 2, v1
    v_min_u32 v12, (L_codeend - L_pc) / 1024 - 1, v12
    v_lshlrev_b32 v12, 10, v12
    v_lshl_add_u32 v12, v2, 4, v12
    v_mov_b32 v13, s37
    v_add_co_u32 v12, vcc, s36, v12
    s_nop 1
    v_addc_co_u32 v13, vcc, 0, v13, vcc
    global_load_dwordx4 v[16:19], v[12:13], off
    v_lshl_add_u32 v252, s31, 2, v1
    v_min_u32 v252, (L_codeend - L_head) / 1024 - 1, v252
    v_lshlrev_b32 v252, 10, v252
    v_lshl_add_u32 v252, v2, 4, v252
    v_add_u32 v252, L_head - L_pc, v252
    v_mov_b32 v253, s37
    v_add_co_u32 v252, vcc, s36, v252
    s_nop 1
    v_addc_co_u32 v253, vcc, 0, v253, vcc
    v_lshl_add_u32 v254, s31, 2, v1
    v_min_u32 v254, (L_codeend - L_lastpass) / 1024 - 1, v254
    v_lshlrev_b32 v254, 10, v254
    v_lshl_add_u32 v254, v2, 4, v254
    v_add_u32 v254, L_lastpass - L_pc, v254
    v_mov_b32 v255, s37
    v_add_co_u32 v254, vcc, s36, v254
    s_nop 1
    v_addc_co_u32 v255, vcc, 0, v255, vcc
    s_waitcnt lgkmcnt(0)
    s_mov_b32 s8, s42
    s_and_b32 s9, s43, 0xffff
    s_mov_b32 s4, s40
    s_and_b32 s5, s41, 0xffff
    s_mov_b32 s12, s44
    s_and_b32 s13, s45, 0xffff
    s_mov_b32 s16, s46
    s_and_b32 s17, s47, 0xffff
    s_add_u32 m0, s25, 0
    s_add_u32 s35, s21, 0
    buffer_load_dwordx4 v232, s[8:11], s35 offen nt lds
    buffer_load_dwordx4 v233, s[8:11], s35 offen offset:1024 nt lds
    s_cmp_lg_u32 s30, 0
    s_cbranch_scc1 L_ser0
    s_waitcnt vmcnt(0)
L_ser0:
    s_add_u32 m0, s29, 8192
    s_add_u32 s35, s23, 0
    buffer_load_dwordx4 v236, s[4:7], s35 offen nt lds
    buffer_load_dwordx4 v237, s[4:7], s35 offen offset:1024 nt lds
    s_cmp_lg_u32 s30, 0
    s_cbranch_scc1 L_ser1
    s_waitcnt vmcnt(0)
L_ser1:
    s_add_u32 m0, s29, 10240
    s_add_u32 s35, s23, 2048
    buffer_load_dwordx4 v238, s[4:7], s35 offen nt lds
    buffer_load_dwordx4 v239, s[4:7], s35 offen offset:1024 nt lds
    s_cmp_lg_u32 s30, 0
    s_cbranch_scc1 L_ser2
    s_waitcnt vmcnt(0)
L_ser2:
    s_add_u32 m0, s29, 12288
    s_add_u32 s35, s23, 4096
    buffer_load_dwordx4 v236, s[4:7], s35 offen nt lds
    buffer_load_dwordx4 v237, s[4:7], s35 offen offset:1024 nt lds
    s_cmp_lg_u32 s30, 0
    s_cbranch_scc1 L_ser3
    s_waitcnt vmcnt(0)
L_ser3:
    s_add_u32 m0, s29, 14336
    s_add_u32 s35, s23, 6144
    buffer_load_dwordx4 v238, s[4:7], s35 offen nt lds
    buffer_load_dwordx4 v239, s[4:7], s35 offen offset:1024 nt lds
    s_cmp_lg_u32 s30, 0
    s_cbranch_scc1 L_ser4
    s_waitcnt vmcnt(0)
L_ser4:
    s_add_u32 m0, s29, 0
    s_add_u32 s35, s23, 16384
    buffer_load_dwordx4 v236, s[4:7], s35 offen nt lds
    buffer_load_dwordx4 v237, s[4:7], s35 offen offset:1024 nt lds
    s_add_u32 m0, s29, 2048
    s_add_u32 s35, s23, 18432
    buffer_load_dwordx4 v238, s[4:7], s35 offen nt lds
    buffer_load_dwordx4 v239, s[4:7], s35 offen offset:1024 nt lds
    s_add_u32 m0, s29, 4096
    s_add_u32 s35, s23, 20480
    buffer_load_dwordx4 v236, s[4:7], s35 offen nt lds
    buffer_load_dwordx4 v237, s[4:7], s35 offen offset:1024 nt lds
    s_add_u32 m0, s29, 6144
    s_add_u32 s35, s23, 22528
    buffer_load_dwordx4 v238, s[4:7], s35 offen nt lds
    buffer_load_dwordx4 v239, s[4:7], s35 offen offset:1024 nt lds
    s_add_u32 m0, s25, 8192
    s_add_u32 s35, s21, 4096
    buffer_load_dwordx4 v232, s[8:11], s35 offen nt lds
    buffer_load_dwordx4 v233, s[8:11], s35 offen offset:1024 nt lds
    v_xor_b32 v9, v3, v4
    v_lshlrev_b32 v9, 4, v9
    v_lshl_add_u32 v216, v4, 8, v9
    v_xor_b32 v217, 64, v216
    v_xor_b32 v218, 128, v216
    v_xor_b32 v219, 192, v216
    v_lshrrev_b32 v9, 2, v2
    v_and_b32 v10, 7, v9
    v_lshlrev_b32 v10, 1, v10
    v_bfe_u32 v11, v2, 1, 1
    v_xor_b32 v10, v10, v11
    v_lshlrev_b32 v10, 4, v10
    v_lshl_add_u32 v10, v9, 8, v10
    v_and_b32 v11, 1, v2
    v_lshl_add_u32 v10, v11, 3, v10
    v_add_u32 v224, 32768, v10
    v_xor_b32 v225, 32, v224
    v_xor_b32 v226, 64, v224
    v_xor_b32 v227, 96, v224
    v_xor_b32 v228, 128, v224
    v_xor_b32 v229, 160, v224
    v_xor_b32 v230, 192, v224
    v_xor_b32 v231, 224, v224
    v_and_b32 v9, 7, v4
    v_lshrrev_b32 v10, 1, v3
    v_xor_b32 v9, v9, v10
    v_lshlrev_b32 v9, 4, v9
    v_lshl_add_u32 v9, v4, 8, v9
    v_and_b32 v10, 1, v3
    v_lshl_add_u32 v9, v10, 3, v9
    v_add_u32 v240, s29, v9
    v_xor_b32 v241, 32, v240
    v_xor_b32 v242, 64, v240
    v_xor_b32 v243, 96, v240
    v_lshlrev_b32 v9, 4, v2
    v_add_u32 v215, s29, v9
    s_mov_b32 s26, 0x3e0293ee
    s_mov_b32 s27, 0xc1c00000
    s_mov_b32 s33, 0
    s_mov_b32 s38, 0
    s_mov_b32 s40, 0
    s_mov_b32 s39, 0x4b800000
    v_mov_b32 v9, 0x3f803f80
    v_and_b32 v10, 3, v2
    v_cmp_eq_u32 vcc, 0, v10
    s_nop 1
    v_cndmask_b32 v9, 0, v9, vcc
    v_accvgpr_write_b32 a240, v9
    v_accvgpr_write_b32 a241, v9
    v_accvgpr_write_b32 a242, v9
    v_accvgpr_write_b32 a243, v9
    s_lshr_b32 s23, s22, 1
    s_add_u32 m0, s25, 16384
    s_add_u32 s35, s21, 8192
    buffer_load_dwordx4 v232, s[8:11], s35 offen nt lds
    buffer_load_dwordx4 v233, s[8:11], s35 offen offset:1024 nt lds
    s_add_u32 m0, s25, 32768
    s_add_u32 s35, s21, 0
    buffer_load_dwordx4 v234, s[12:15], s35 offen nt lds
    buffer_load_dwordx4 v235, s[12:15], s35 offen offset:1024 nt lds
    s_add_u32 m0, s29, 16384
    s_add_u32 s35, s23, 0
    buffer_load_dwordx4 v236, s[4:7], s35 offen nt lds
    buffer_load_dwordx4 v237, s[4:7], s35 offen offset:1024 nt lds
    s_add_u32 m0, s29, 18432
    s_add_u32 s35, s23, 2048
    buffer_load_dwordx4 v238, s[4:7], s35 offen nt lds
    buffer_load_dwordx4 v239, s[4:7], s35 offen offset:1024 nt lds
    v_add_u32 v200, s29, v216
    v_add_u32 v201, s29, v217
    v_add_u32 v202, s29, v218
    v_add_u32 v203, s29, v219
    s_waitcnt vmcnt(8)
    s_barrier
    ds_read_b128 v[160:163], v216 offset:0
    ds_read_b128 v[164:167], v217 offset:0
    ds_read_b128 v[168:171], v218 offset:0
    ds_read_b128 v[172:175], v219 offset:0
    ds_read_b128 a[128:131], v200 offset:8192
    ds_read_b128 a[132:135], v201 offset:8192
    ds_read_b128 a[136:139], v202 offset:8192
    ds_read_b128 a[140:143], v203 offset:8192
    ds_read_b128 v[176:179], v216 offset:4096
    ds_read_b128 v[180:183], v217 offset:4096
    ds_read_b128 v[184:187], v218 offset:4096
    ds_read_b128 v[188:191], v219 offset:4096
    ds_read_b128 a[144:147], v200 offset:12288
    ds_read_b128 a[148:151], v201 offset:12288
    ds_read_b128 a[152:155], v202 offset:12288
    ds_read_b128 a[156:159], v203 offset:12288
    ds_read_b128 a[160:163], v200 offset:0
    ds_read_b128 a[164:167], v201 offset:0
    ds_read_b128 a[168:171], v202 offset:0
    ds_read_b128 a[172:175], v203 offset:0
    ds_read_b128 a[176:179], v200 offset:4096
    ds_read_b128 a[180:183], v201 offset:4096
    ds_read_b128 a[184:187], v202 offset:4096
    ds_read_b128 a[188:191], v203 offset:4096
    s_waitcnt lgkmcnt(0)
    v_mfma_f32_16x16x32_bf16 v[64:67], v[160:163], a[128:131], 0
    s_add_u32 m0, s25, 40960
    s_add_u32 s35, s21, 4096
    buffer_load_dwordx4 v234, s[12:15], s35 offen nt lds
    buffer_load_dwordx4 v235, s[12:15], s35 offen offset:1024 nt lds
    v_mfma_f32_16x16x32_bf16 v[72:75], v[160:163], a[144:147], 0
    v_mfma_f32_16x16x32_bf16 v[80:83], v[160:163], a[160:163], 0
    v_mfma_f32_16x16x32_bf16 v[88:91], v[160:163], a[176:179], 0
    v_mfma_f32_16x16x32_bf16 v[64:67], v[164:167], a[132:135], v[64:67]
    v_mfma_f32_16x16x32_bf16 v[72:75], v[164:167], a[148:151], v[72:75]
    v_mfma_f32_16x16x32_bf16 v[80:83], v[164:167], a[164:167], v[80:83]
    v_mfma_f32_16x16x32_bf16 v[88:91], v[164:167], a[180:183], v[88:91]
    v_mfma_f32_16x16x32_bf16 v[64:67], v[168:171], a[136:139], v[64:67]
    v_mfma_f32_16x16x32_bf16 v[72:75], v[168:171], a[152:155], v[72:75]
    v_mfma_f32_16x16x32_bf16 v[80:83], v[168:171], a[168:171], v[80:83]
    v_mfma_f32_16x16x32_bf16 v[88:91], v[168:171], a[184:187], v[88:91]
    v_mfma_f32_16x16x32_bf16 v[64:67], v[172:175], a[140:143], v[64:67]
    v_mfma_f32_16x16x32_bf16 v[72:75], v[172:175], a[156:159], v[72:75]
    v_mfma_f32_16x16x32_bf16 v[80:83], v[172:175], a[172:175], v[80:83]
    v_mfma_f32_16x16x32_bf16 v[88:91], v[172:175], a[188:191], v[88:91]
    v_mfma_f32_16x16x32_bf16 v[68:71], v[176:179], a[128:131], 0
    v_mfma_f32_16x16x32_bf16 v[76:79], v[176:179], a[144:147], 0
    v_mfma_f32_16x16x32_bf16 v[84:87], v[176:179], a[160:163], 0
    v_mfma_f32_16x16x32_bf16 v[92:95], v[176:179], a[176:179], 0
    v_mfma_f32_16x16x32_bf16 v[68:71], v[180:183], a[132:135], v[68:71]
    v_mfma_f32_16x16x32_bf16 v[76:79], v[180:183], a[148:151], v[76:79]
    v_mfma_f32_16x16x32_bf16 v[84:87], v[180:183], a[164:167], v[84:87]
    v_mfma_f32_16x16x32_bf16 v[92:95], v[180:183], a[180:183], v[92:95]
    v_mfma_f32_16x16x32_bf16 v[68:71], v[184:187], a[136:139], v[68:71]
    v_mfma_f32_16x16x32_bf16 v[76:79], v[184:187], a[152:155], v[76:79]
    v_mfma_f32_16x16x32_bf16 v[84:87], v[184:187], a[168:171], v[84:87]
    v_mfma_f32_16x16x32_bf16 v[92:95], v[184:187], a[184:187], v[92:95]
    v_mfma_f32_16x16x32_bf16 v[68:71], v[188:191], a[140:143], v[68:71]
    v_mfma_f32_16x16x32_bf16 v[76:79], v[188:191], a[156:159], v[76:79]
    v_mfma_f32_16x16x32_bf16 v[84:87], v[188:191], a[172:175], v[84:87]
    v_mfma_f32_16x16x32_bf16 v[92:95], v[188:191], a[188:191], v[92:95]
    ds_read_b128 v[160:163], v216 offset:8192
    ds_read_b128 v[164:167], v217 offset:8192
    ds_read_b128 v[168:171], v218 offset:8192
    ds_read_b128 v[172:175], v219 offset:8192
    ds_read_b128 v[176:179], v216 offset:12288
    ds_read_b128 v[180:183], v217 offset:12288
    ds_read_b128 v[184:187], v218 offset:12288
    ds_read_b128 v[188:191], v219 offset:12288
    s_nop 3
    v_max3_f32 v220, v64, v65, v66
    v_max3_f32 v221, v72, v73, v74
    v_max3_f32 v222, v80, v81, v82
    v_max3_f32 v223, v88, v89, v90
    v_max3_f32 v220, v220, v67, v68
    v_max3_f32 v221, v221, v75, v76
    v_max3_f32 v222, v222, v83, v84
    v_max3_f32 v223, v223, v91, v92
    v_max3_f32 v220, v220, v69, v70
    v_max3_f32 v221, v221, v77, v78
    v_max3_f32 v222, v222, v85, v86
    v_max3_f32 v223, v223, v93, v94
    v_max3_f32 v220, v220, v71, v71
    v_max3_f32 v221, v221, v79, v79
    v_max3_f32 v222, v222, v87, v87
    v_max3_f32 v223, v223, v95, v95
    s_nop 0
    v_permlane32_swap_b32 v220, v221
    v_permlane32_swap_b32 v222, v223
    v_max_f32 v220, v220, v221
    v_max_f32 v222, v222, v223
    s_nop 1
    v_permlane16_swap_b32 v220, v222
    v_max_f32 v220, v220, v222
    v_mul_f32 v220, s26, v220
    v_sub_f32 v244, s27, v220
    v_sub_f32 v246, s27, v220
    s_nop 1
    v_permlane16_swap_b32 v244, v246
    v_mov_b32 v245, v244
    v_mov_b32 v247, v246
    s_nop 0
    v_permlane32_swap_b32 v244, v245
    v_permlane32_swap_b32 v246, v247
    s_waitcnt lgkmcnt(0)
    v_pk_fma_f32 v[64:65], v[64:65], s[26:27], v[244:245] op_sel:[0,0,0] op_sel_hi:[1,0,0]
    v_pk_fma_f32 v[66:67], v[66:67], s[26:27], v[244:245] op_sel:[0,0,0] op_sel_hi:[1,0,0]
    v_pk_fma_f32 v[68:69], v[68:69], s[26:27], v[244:245] op_sel:[0,0,0] op_sel_hi:[1,0,0]
    v_pk_fma_f32 v[70:71], v[70:71], s[26:27], v[244:245] op_sel:[0,0,0] op_sel_hi:[1,0,0]
    v_pk_fma_f32 v[72:73], v[72:73], s[26:27], v[244:245] op_sel:[0,0,1] op_sel_hi:[1,0,1]
    v_pk_fma_f32 v[74:75], v[74:75], s[26:27], v[244:245] op_sel:[0,0,1] op_sel_hi:[1,0,1]
    v_pk_fma_f32 v[76:77], v[76:77], s[26:27], v[244:245] op_sel:[0,0,1] op_sel_hi:[1,0,1]
    v_pk_fma_f32 v[78:79], v[78:79], s[26:27], v[244:245] op_sel:[0,0,1] op_sel_hi:[1,0,1]
    v_pk_fma_f32 v[80:81], v[80:81], s[26:27], v[246:247] op_sel:[0,0,0] op_sel_hi:[1,0,0]
    v_pk_fma_f32 v[82:83], v[82:83], s[26:27], v[246:247] op_sel:[0,0,0] op_sel_hi:[1,0,0]
    v_pk_fma_f32 v[84:85], v[84:85], s[26:27], v[246:247] op_sel:[0,0,0] op_sel_hi:[1,0,0]
    v_pk_fma_f32 v[86:87], v[86:87], s[26:27], v[246:247] op_sel:[0,0,0] op_sel_hi:[1,0,0]
    v_pk_fma_f32 v[88:89], v[88:89], s[26:27], v[246:247] op_sel:[0,0,1] op_sel_hi:[1,0,1]
    v_pk_fma_f32 v[90:91], v[90:91], s[26:27], v[246:247] op_sel:[0,0,1] op_sel_hi:[1,0,1]
    v_pk_fma_f32 v[92:93], v[92:93], s[26:27], v[246:247] op_sel:[0,0,1] op_sel_hi:[1,0,1]
    v_pk_fma_f32 v[94:95], v[94:95], s[26:27], v[246:247] op_sel:[0,0,1] op_sel_hi:[1,0,1]
    s_nop 1
    v_mfma_f32_16x16x32_bf16 v[96:99], v[160:163], a[128:131], 0
    v_exp_f32 v64, v64
    v_mfma_f32_16x16x32_bf16 v[104:107], v[160:163], a[144:147], 0
    v_mfma_f32_16x16x32_bf16 v[112:115], v[160:163], a[160:163], 0
    v_exp_f32 v65, v65
    v_mfma_f32_16x16x32_bf16 v[120:123], v[160:163], a[176:179], 0
    s_add_u32 m0, s25, 24576
    v_cvt_pk_bf16_f32 v128, v64, v65
    v_mfma_f32_16x16x32_bf16 v[96:99], v[164:167], a[132:135], v[96:99]
    s_add_u32 s35, s21, 12288
    v_exp_f32 v66, v66
    v_mfma_f32_16x16x32_bf16 v[104:107], v[164:167], a[148:151], v[104:107]
    buffer_load_dwordx4 v232, s[8:11], s35 offen nt lds
    v_mfma_f32_16x16x32_bf16 v[112:115], v[164:167], a[164:167], v[112:115]
    v_exp_f32 v67, v67
    v_mfma_f32_16x16x32_bf16 v[120:123], v[164:167], a[180:183], v[120:123]
    v_cvt_pk_bf16_f32 v129, v66, v67
    v_mfma_f32_16x16x32_bf16 v[96:99], v[168:171], a[136:139], v[96:99]
    v_exp_f32 v68, v68
    v_mfma_f32_16x16x32_bf16 v[104:107], v[168:171], a[152:155], v[104:107]
    v_mfma_f32_16x16x32_bf16 v[112:115], v[168:171], a[168:171], v[112:115]
    v_exp_f32 v69, v69
    v_mfma_f32_16x16x32_bf16 v[120:123], v[168:171], a[184:187], v[120:123]
    v_cvt_pk_bf16_f32 v130, v68, v69
    v_mfma_f32_16x16x32_bf16 v[96:99], v[172:175], a[140:143], v[96:99]
    v_exp_f32 v70, v70
    v_mfma_f32_16x16x32_bf16 v[104:107], v[172:175], a[156:159], v[104:107]
    v_mfma_f32_16x16x32_bf16 v[112:115], v[172:175], a[172:175], v[112:115]
    v_exp_f32 v71, v71
    v_mfma_f32_16x16x32_bf16 v[120:123], v[172:175], a[188:191], v[120:123]
    v_cvt_pk_bf16_f32 v131, v70, v71
    v_mfma_f32_16x16x32_bf16 v[100:103], v[176:179], a[128:131], 0
    v_exp_f32 v72, v72
    v_mfma_f32_16x16x32_bf16 v[108:111], v[176:179], a[144:147], 0
    v_mfma_f32_16x16x32_bf16 v[116:119], v[176:179], a[160:163], 0
    v_exp_f32 v73, v73
    v_mfma_f32_16x16x32_bf16 v[124:127], v[176:179], a[176:179], 0
    buffer_load_dwordx4 v233, s[8:11], s35 offen offset:1024 nt lds
    v_cvt_pk_bf16_f32 v132, v72, v73
    v_mfma_f32_16x16x32_bf16 v[100:103], v[180:183], a[132:135], v[100:103]
    v_exp_f32 v74, v74
    v_mfma_f32_16x16x32_bf16 v[108:111], v[180:183], a[148:151], v[108:111]
    v_mfma_f32_16x16x32_bf16 v[116:119], v[180:183], a[164:167], v[116:119]
    v_exp_f32 v75, v75
    v_mfma_f32_16x16x32_bf16 v[124:127], v[180:183], a[180:183], v[124:127]
    v_cvt_pk_bf16_f32 v133, v74, v75
    v_mfma_f32_16x16x32_bf16 v[100:103], v[184:187], a[136:139], v[100:103]
    v_exp_f32 v76, v76
    v_mfma_f32_16x16x32_bf16 v[108:111], v[184:187], a[152:155], v[108:111]
    v_mfma_f32_16x16x32_bf16 v[116:119], v[184:187], a[168:171], v[116:119]
    v_exp_f32 v77, v77
    v_mfma_f32_16x16x32_bf16 v[124:127], v[184:187], a[184:187], v[124:127]
    v_cvt_pk_bf16_f32 v134, v76, v77
    v_mfma_f32_16x16x32_bf16 v[100:103], v[188:191], a[140:143], v[100:103]
    v_exp_f32 v78, v78
    v_mfma_f32_16x16x32_bf16 v[108:111], v[188:191], a[156:159], v[108:111]
    v_mfma_f32_16x16x32_bf16 v[116:119], v[188:191], a[172:175], v[116:119]
    v_exp_f32 v79, v79
    v_mfma_f32_16x16x32_bf16 v[124:127], v[188:191], a[188:191], v[124:127]
    v_cvt_pk_bf16_f32 v135, v78, v79
    s_waitcnt vmcnt(8) lgkmcnt(0)
    s_barrier
    v_exp_f32 v80, v80
    s_nop 0
    s_add_u32 m0, s25, 49152
    ds_read_b128 v[160:163], v216 offset:16384
    s_add_u32 s35, s21, 8192
    v_exp_f32 v81, v81
    s_nop 0
    buffer_load_dwordx4 v234, s[12:15], s35 offen nt lds
    v_cvt_pk_bf16_f32 v136, v80, v81
    v_exp_f32 v82, v82
    s_nop 0
    ds_read_b128 v[164:167], v217 offset:16384
    v_exp_f32 v83, v83
    s_nop 0
    v_cvt_pk_bf16_f32 v137, v82, v83
    v_exp_f32 v84, v84
    s_nop 0
    ds_read_b128 v[168:171], v218 offset:16384
    v_exp_f32 v85, v85
    s_nop 0
    v_cvt_pk_bf16_f32 v138, v84, v85
    v_exp_f32 v86, v86
    s_nop 0
    ds_read_b128 v[172:175], v219 offset:16384
    v_exp_f32 v87, v87
    s_nop 0
    v_cvt_pk_bf16_f32 v139, v86, v87
    v_exp_f32 v88, v88
    s_nop 0
    ds_read_b128 v[176:179], v216 offset:20480
    v_exp_f32 v89, v89
    s_nop 0
    buffer_load_dwordx4 v235, s[12:15], s35 offen offset:1024 nt lds
    v_cvt_pk_bf16_f32 v140, v88, v89
    v_exp_f32 v90, v90
    s_nop 0
    ds_read_b128 v[180:183], v217 offset:20480
    v_exp_f32 v91, v91
    s_nop 0
    v_cvt_pk_bf16_f32 v141, v90, v91
    ds_read_b128 v[184:187], v218 offset:20480
    v_exp_f32 v92, v92
    s_nop 0
    ds_read_b128 v[188:191], v219 offset:20480
    v_exp_f32 v93, v93
    s_nop 0
    v_cvt_pk_bf16_f32 v142, v92, v93
    v_exp_f32 v94, v94
    v_exp_f32 v95, v95
    s_nop 0
    v_cvt_pk_bf16_f32 v143, v94, v95
    s_waitcnt lgkmcnt(0)
    v_pk_fma_f32 v[96:97], v[96:97], s[26:27], v[244:245] op_sel:[0,0,0] op_sel_hi:[1,0,0]
    v_pk_fma_f32 v[98:99], v[98:99], s[26:27], v[244:245] op_sel:[0,0,0] op_sel_hi:[1,0,0]
    v_pk_fma_f32 v[100:101], v[100:101], s[26:27], v[244:245] op_sel:[0,0,0] op_sel_hi:[1,0,0]
    v_pk_fma_f32 v[102:103], v[102:103], s[26:27], v[244:245] op_sel:[0,0,0] op_sel_hi:[1,0,0]
    v_pk_fma_f32 v[104:105], v[104:105], s[26:27], v[244:245] op_sel:[0,0,1] op_sel_hi:[1,0,1]
    v_pk_fma_f32 v[106:107], v[106:107], s[26:27], v[244:245] op_sel:[0,0,1] op_sel_hi:[1,0,1]
    v_pk_fma_f32 v[108:109], v[108:109], s[26:27], v[244:245] op_sel:[0,0,1] op_sel_hi:[1,0,1]
    v_pk_fma_f32 v[110:111], v[110:111], s[26:27], v[244:245] op_sel:[0,0,1] op_sel_hi:[1,0,1]
    v_pk_fma_f32 v[112:113], v[112:113], s[26:27], v[246:247] op_sel:[0,0,0] op_sel_hi:[1,0,0]
    v_pk_fma_f32 v[114:115], v[114:115], s[26:27], v[246:247] op_sel:[0,0,0] op_sel_hi:[1,0,0]
    v_pk_fma_f32 v[116:117], v[116:117], s[26:27], v[246:247] op_sel:[0,0,0] op_sel_hi:[1,0,0]
    v_pk_fma_f32 v[118:119], v[118:119], s[26:27], v[246:247] op_sel:[0,0,0] op_sel_hi:[1,0,0]
    v_pk_fma_f32 v[120:121], v[120:121], s[26:27], v[246:247] op_sel:[0,0,1] op_sel_hi:[1,0,1]
    v_pk_fma_f32 v[122:123], v[122:123], s[26:27], v[246:247] op_sel:[0,0,1] op_sel_hi:[1,0,1]
    v_pk_fma_f32 v[124:125], v[124:125], s[26:27], v[246:247] op_sel:[0,0,1] op_sel_hi:[1,0,1]
    v_pk_fma_f32 v[126:127], v[126:127], s[26:27], v[246:247] op_sel:[0,0,1] op_sel_hi:[1,0,1]
    s_nop 1
    v_mfma_f32_16x16x32_bf16 v[64:67], v[160:163], a[128:131], 0
    v_mfma_f32_16x16x32_bf16 v[72:75], v[160:163], a[144:147], 0
    v_exp_f32 v96, v96
    ds_read_b64_tr_b16 a[192:193], v224 offset:0
    v_mfma_f32_16x16x32_bf16 v[80:83], v[160:163], a[160:163], 0
    v_exp_f32 v97, v97
    v_mfma_f32_16x16x32_bf16 v[88:91], v[160:163], a[176:179], 0
    s_add_u32 m0, s25, 0
    v_cvt_pk_bf16_f32 v144, v96, v97
    ds_read_b64_tr_b16 a[194:195], v224 offset:4096
    v_mfma_f32_16x16x32_bf16 v[64:67], v[164:167], a[132:135], v[64:67]
    s_add_u32 s35, s21, 16384
    v_exp_f32 v98, v98
    ds_read_b64_tr_b16 a[196:197], v225 offset:0
    v_mfma_f32_16x16x32_bf16 v[72:75], v[164:167], a[148:151], v[72:75]
    ds_read_b64_tr_b16 a[198:199], v225 offset:4096
    buffer_load_dwordx4 v232, s[8:11], s35 offen nt lds
    v_mfma_f32_16x16x32_bf16 v[80:83], v[164:167], a[164:167], v[80:83]
    v_exp_f32 v99, v99
    v_mfma_f32_16x16x32_bf16 v[88:91], v[164:167], a[180:183], v[88:91]
    v_cvt_pk_bf16_f32 v145, v98, v99
    ds_read_b64_tr_b16 a[200:201], v226 offset:0
    v_mfma_f32_16x16x32_bf16 v[64:67], v[168:171], a[136:139], v[64:67]
    v_mfma_f32_16x16x32_bf16 v[72:75], v[168:171], a[152:155], v[72:75]
    v_exp_f32 v100, v100
    ds_read_b64_tr_b16 a[202:203], v226 offset:4096
    v_mfma_f32_16x16x32_bf16 v[80:83], v[168:171], a[168:171], v[80:83]
    v_exp_f32 v101, v101
    v_mfma_f32_16x16x32_bf16 v[88:91], v[168:171], a[184:187], v[88:91]
    v_cvt_pk_bf16_f32 v146, v100, v101
    ds_read_b64_tr_b16 a[204:205], v227 offset:0
    v_mfma_f32_16x16x32_bf16 v[64:67], v[172:175], a[140:143], v[64:67]
    v_mfma_f32_16x16x32_bf16 v[72:75], v[172:175], a[156:159], v[72:75]
    v_exp_f32 v102, v102
    ds_read_b64_tr_b16 a[206:207], v227 offset:4096
    v_mfma_f32_16x16x32_bf16 v[80:83], v[172:175], a[172:175], v[80:83]
    v_exp_f32 v103, v103
    ds_read_b64_tr_b16 a[208:209], v228 offset:0
    v_mfma_f32_16x16x32_bf16 v[88:91], v[172:175], a[188:191], v[88:91]
    v_cvt_pk_bf16_f32 v147, v102, v103
    ds_read_b64_tr_b16 a[210:211], v228 offset:4096
    v_mfma_f32_16x16x32_bf16 v[68:71], v[176:179], a[128:131], 0
    v_mfma_f32_16x16x32_bf16 v[76:79], v[176:179], a[144:147], 0
    v_exp_f32 v104, v104
    ds_read_b64_tr_b16 a[212:213], v229 offset:0
    v_mfma_f32_16x16x32_bf16 v[84:87], v[176:179], a[160:163], 0
    buffer_load_dwordx4 v233, s[8:11], s35 offen offset:1024 nt lds
    v_exp_f32 v105, v105
    v_mfma_f32_16x16x32_bf16 v[92:95], v[176:179], a[176:179], 0
    v_cvt_pk_bf16_f32 v148, v104, v105
    ds_read_b64_tr_b16 a[214:215], v229 offset:4096
    v_mfma_f32_16x16x32_bf16 v[68:71], v[180:183], a[132:135], v[68:71]
    v_mfma_f32_16x16x32_bf16 v[76:79], v[180:183], a[148:151], v[76:79]
    v_exp_f32 v106, v106
    ds_read_b64_tr_b16 a[216:217], v230 offset:0
    v_mfma_f32_16x16x32_bf16 v[84:87], v[180:183], a[164:167], v[84:87]
    v_exp_f32 v107, v107
    ds_read_b64_tr_b16 a[218:219], v230 offset:4096
    v_mfma_f32_16x16x32_bf16 v[92:95], v[180:183], a[180:183], v[92:95]
    v_cvt_pk_bf16_f32 v149, v106, v107
    ds_read_b64_tr_b16 a[220:221], v231 offset:0
    v_mfma_f32_16x16x32_bf16 v[68:71], v[184:187], a[136:139], v[68:71]
    v_mfma_f32_16x16x32_bf16 v[76:79], v[184:187], a[152:155], v[76:79]
    v_exp_f32 v108, v108
    ds_read_b64_tr_b16 a[222:223], v231 offset:4096
    v_mfma_f32_16x16x32_bf16 v[84:87], v[184:187], a[168:171], v[84:87]
    v_exp_f32 v109, v109
    v_mfma_f32_16x16x32_bf16 v[92:95], v[184:187], a[184:187], v[92:95]
    v_mfma_f32_16x16x32_bf16 v[68:71], v[188:191], a[140:143], v[68:71]
    v_cvt_pk_bf16_f32 v150, v108, v109
    v_mfma_f32_16x16x32_bf16 v[76:79], v[188:191], a[156:159], v[76:79]
    v_mfma_f32_16x16x32_bf16 v[84:87], v[188:191], a[172:175], v[84:87]
    v_exp_f32 v110, v110
    v_exp_f32 v111, v111
    v_mfma_f32_16x16x32_bf16 v[92:95], v[188:191], a[188:191], v[92:95]
    v_cvt_pk_bf16_f32 v151, v110, v111
    s_waitcnt vmcnt(4) lgkmcnt(0)
    s_barrier
    v_mfma_f32_16x16x32_bf16 a[224:227], a[240:243], v[128:131], 0
    v_mfma_f32_16x16x32_bf16 a[228:231], a[240:243], v[132:135], 0
    s_add_u32 m0, s25, 57344
    v_exp_f32 v112, v112
    ds_read_b128 v[160:163], v216 offset:24576
    v_mfma_f32_16x16x32_bf16 a[232:235], a[240:243], v[136:139], 0
    s_add_u32 s35, s21, 12288
    v_exp_f32 v113, v113
    v_mfma_f32_16x16x32_bf16 a[236:239], a[240:243], v[140:143], 0
    buffer_load_dwordx4 v234, s[12:15], s35 offen nt lds
    v_cvt_pk_bf16_f32 v152, v112, v113
    v_mfma_f32_16x16x32_bf16 v[0:3], a[192:195], v[128:131], 0
    v_mfma_f32_16x16x32_bf16 v[4:7], a[192:195], v[132:135], 0
    v_exp_f32 v114, v114
    ds_read_b128 v[164:167], v217 offset:24576
    v_mfma_f32_16x16x32_bf16 a[0:3], a[192:195], v[136:139], 0
    v_exp_f32 v115, v115
    v_mfma_f32_16x16x32_bf16 a[4:7], a[192:195], v[140:143], 0
    v_mfma_f32_16x16x32_bf16 v[8:11], a[196:199], v[128:131], 0
    v_mfma_f32_16x16x32_bf16 v[12:15], a[196:199], v[132:135], 0
    v_cvt_pk_bf16_f32 v153, v114, v115
    v_exp_f32 v116, v116
    ds_read_b128 v[168:171], v218 offset:24576
    v_mfma_f32_16x16x32_bf16 a[8:11], a[196:199], v[136:139], 0
    v_exp_f32 v117, v117
    v_mfma_f32_16x16x32_bf16 a[12:15], a[196:199], v[140:143], 0
    v_mfma_f32_16x16x32_bf16 v[16:19], a[200:203], v[128:131], 0
    v_mfma_f32_16x16x32_bf16 v[20:23], a[200:203], v[132:135], 0
    v_cvt_pk_bf16_f32 v154, v116, v117
    v_exp_f32 v118, v118
    ds_read_b128 v[172:175], v219 offset:24576
    v_mfma_f32_16x16x32_bf16 a[16:19], a[200:203], v[136:139], 0
    v_exp_f32 v119, v119
    v_mfma_f32_16x16x32_bf16 a[20:23], a[200:203], v[140:143], 0
    v_mfma_f32_16x16x32_bf16 v[24:27], a[204:207], v[128:131], 0
    v_mfma_f32_16x16x32_bf16 v[28:31], a[204:207], v[132:135], 0
    v_cvt_pk_bf16_f32 v155, v118, v119
    v_exp_f32 v120, v120
    ds_read_b128 v[176:179], v216 offset:28672
    v_mfma_f32_16x16x32_bf16 a[24:27], a[204:207], v[136:139], 0
    v_exp_f32 v121, v121
    v_mfma_f32_16x16x32_bf16 a[28:31], a[204:207], v[140:143], 0
    buffer_load_dwordx4 v235, s[12:15], s35 offen offset:1024 nt lds
    v_cvt_pk_bf16_f32 v156, v120, v121
    v_mfma_f32_16x16x32_bf16 v[32:35], a[208:211], v[128:131], 0
    v_mfma_f32_16x16x32_bf16 v[36:39], a[208:211], v[132:135], 0
    v_exp_f32 v122, v122
    ds_read_b128 v[180:183], v217 offset:28672
    v_mfma_f32_16x16x32_bf16 a[32:35], a[208:211], v[136:139], 0
    v_exp_f32 v123, v123
    v_mfma_f32_16x16x32_bf16 a[36:39], a[208:211], v[140:143], 0
    v_cvt_pk_bf16_f32 v157, v122, v123
    ds_read_b128 v[184:187], v218 offset:28672
    v_mfma_f32_16x16x32_bf16 v[40:43], a[212:215], v[128:131], 0
    v_mfma_f32_16x16x32_bf16 v[44:47], a[212:215], v[132:135], 0
    v_exp_f32 v124, v124
    ds_read_b128 v[188:191], v219 offset:28672
    v_mfma_f32_16x16x32_bf16 a[40:43], a[212:215], v[136:139], 0
    v_exp_f32 v125, v125
    v_mfma_f32_16x16x32_bf16 a[44:47], a[212:215], v[140:143], 0
    v_mfma_f32_16x16x32_bf16 v[48:51], a[216:219], v[128:131], 0
    v_mfma_f32_16x16x32_bf16 v[52:55], a[216:219], v[132:135], 0
    v_cvt_pk_bf16_f32 v158, v124, v125
    v_exp_f32 v126, v126
    v_mfma_f32_16x16x32_bf16 a[48:51], a[216:219], v[136:139], 0
    v_exp_f32 v127, v127
    v_mfma_f32_16x16x32_bf16 a[52:55], a[216:219], v[140:143], 0
    v_cvt_pk_bf16_f32 v159, v126, v127
    v_mfma_f32_16x16x32_bf16 v[56:59], a[220:223], v[128:131], 0
    v_mfma_f32_16x16x32_bf16 v[60:63], a[220:223], v[132:135], 0
    v_mfma_f32_16x16x32_bf16 a[56:59], a[220:223], v[136:139], 0
    v_mfma_f32_16x16x32_bf16 a[60:63], a[220:223], v[140:143], 0
    s_waitcnt lgkmcnt(0)
    v_pk_fma_f32 v[64:65], v[64:65], s[26:27], v[244:245] op_sel:[0,0,0] op_sel_hi:[1,0,0]
    v_pk_fma_f32 v[66:67], v[66:67], s[26:27], v[244:245] op_sel:[0,0,0] op_sel_hi:[1,0,0]
    v_pk_fma_f32 v[68:69], v[68:69], s[26:27], v[244:245] op_sel:[0,0,0] op_sel_hi:[1,0,0]
    v_pk_fma_f32 v[70:71], v[70:71], s[26:27], v[244:245] op_sel:[0,0,0] op_sel_hi:[1,0,0]
    v_pk_fma_f32 v[72:73], v[72:73], s[26:27], v[244:245] op_sel:[0,0,1] op_sel_hi:[1,0,1]
    v_pk_fma_f32 v[74:75], v[74:75], s[26:27], v[244:245] op_sel:[0,0,1] op_sel_hi:[1,0,1]
    v_pk_fma_f32 v[76:77], v[76:77], s[26:27], v[244:245] op_sel:[0,0,1] op_sel_hi:[1,0,1]
    v_pk_fma_f32 v[78:79], v[78:79], s[26:27], v[244:245] op_sel:[0,0,1] op_sel_hi:[1,0,1]
    v_pk_fma_f32 v[80:81], v[80:81], s[26:27], v[246:247] op_sel:[0,0,0] op_sel_hi:[1,0,0]
    v_pk_fma_f32 v[82:83], v[82:83], s[26:27], v[246:247] op_sel:[0,0,0] op_sel_hi:[1,0,0]
    v_pk_fma_f32 v[84:85], v[84:85], s[26:27], v[246:247] op_sel:[0,0,0] op_sel_hi:[1,0,0]
    v_pk_fma_f32 v[86:87], v[86:87], s[26:27], v[246:247] op_sel:[0,0,0] op_sel_hi:[1,0,0]
    v_pk_fma_f32 v[88:89], v[88:89], s[26:27], v[246:247] op_sel:[0,0,1] op_sel_hi:[1,0,1]
    v_pk_fma_f32 v[90:91], v[90:91], s[26:27], v[246:247] op_sel:[0,0,1] op_sel_hi:[1,0,1]
    v_pk_fma_f32 v[92:93], v[92:93], s[26:27], v[246:247] op_sel:[0,0,1] op_sel_hi:[1,0,1]
    v_pk_fma_f32 v[94:95], v[94:95], s[26:27], v[246:247] op_sel:[0,0,1] op_sel_hi:[1,0,1]
    s_nop 1
    v_mfma_f32_16x16x32_bf16 v[96:99], v[160:163], a[128:131], 0
    v_mfma_f32_16x16x32_bf16 v[104:107], v[160:163], a[144:147], 0
    v_exp_f32 v64, v64
    ds_read_b64_tr_b16 a[192:193], v224 offset:8192
    v_mfma_f32_16x16x32_bf16 v[112:115], v[160:163], a[160:163], 0
    v_exp_f32 v65, v65
    v_mfma_f32_16x16x32_bf16 v[120:123], v[160:163], a[176:179], 0
    s_add_u32 m0, s25, 8192
    v_cvt_pk_bf16_f32 v128, v64, v65
    ds_read_b64_tr_b16 a[194:195], v224 offset:12288
    v_mfma_f32_16x16x32_bf16 v[96:99], v[164:167], a[132:135], v[96:99]
    s_add_u32 s35, s21, 20480
    v_exp_f32 v66, v66
    ds_read_b64_tr_b16 a[196:197], v225 offset:8192
    v_mfma_f32_16x16x32_bf16 v[104:107], v[164:167], a[148:151], v[104:107]
    ds_read_b64_tr_b16 a[198:199], v225 offset:12288
    buffer_load_dwordx4 v232, s[8:11], s35 offen nt lds
    v_mfma_f32_16x16x32_bf16 v[112:115], v[164:167], a[164:167], v[112:115]
    v_exp_f32 v67, v67
    v_mfma_f32_16x16x32_bf16 v[120:123], v[164:167], a[180:183], v[120:123]
    v_cvt_pk_bf16_f32 v129, v66, v67
    ds_read_b64_tr_b16 a[200:201], v226 offset:8192
    v_mfma_f32_16x16x32_bf16 v[96:99], v[168:171], a[136:139], v[96:99]
    v_mfma_f32_16x16x32_bf16 v[104:107], v[168:171], a[152:155], v[104:107]
    v_exp_f32 v68, v68
    ds_read_b64_tr_b16 a[202:203], v226 offset:12288
    v_mfma_f32_16x16x32_bf16 v[112:115], v[168:171], a[168:171], v[112:115]
    v_exp_f32 v69, v69
    v_mfma_f32_16x16x32_bf16 v[120:123], v[168:171], a[184:187], v[120:123]
    v_cvt_pk_bf16_f32 v130, v68, v69
    ds_read_b64_tr_b16 a[204:205], v227 offset:8192
    v_mfma_f32_16x16x32_bf16 v[96:99], v[172:175], a[140:143], v[96:99]
    v_mfma_f32_16x16x32_bf16 v[104:107], v[172:175], a[156:159], v[104:107]
    v_exp_f32 v70, v70
    ds_read_b64_tr_b16 a[206:207], v227 offset:12288
    v_mfma_f32_16x16x32_bf16 v[112:115], v[172:175], a[172:175], v[112:115]
    v_exp_f32 v71, v71
    ds_read_b64_tr_b16 a[208:209], v228 offset:8192
    v_mfma_f32_16x16x32_bf16 v[120:123], v[172:175], a[188:191], v[120:123]
    v_cvt_pk_bf16_f32 v131, v70, v71
    ds_read_b64_tr_b16 a[210:211], v228 offset:12288
    v_mfma_f32_16x16x32_bf16 v[100:103], v[176:179], a[128:131], 0
    v_mfma_f32_16x16x32_bf16 v[108:111], v[176:179], a[144:147], 0
    v_exp_f32 v72, v72
    ds_read_b64_tr_b16 a[212:213], v229 offset:8192
    v_mfma_f32_16x16x32_bf16 v[116:119], v[176:179], a[160:163], 0
    buffer_load_dwordx4 v233, s[8:11], s35 offen offset:1024 nt lds
    v_exp_f32 v73, v73
    v_mfma_f32_16x16x32_bf16 v[124:127], v[176:179], a[176:179], 0
    v_cvt_pk_bf16_f32 v132, v72, v73
    ds_read_b64_tr_b16 a[214:215], v229 offset:12288
    v_mfma_f32_16x16x32_bf16 v[100:103], v[180:183], a[132:135], v[100:103]
    v_exp_f32 v74, v74
    v_mfma_f32_16x16x32_bf16 v[108:111], v[180:183], a[148:151], v[108:111]
    ds_read_b64_tr_b16 a[216:217], v230 offset:8192
    v_mfma_f32_16x16x32_bf16 v[116:119], v[180:183], a[164:167], v[116:119]
    v_exp_f32 v75, v75
    ds_read_b64_tr_b16 a[218:219], v230 offset:12288
    v_mfma_f32_16x16x32_bf16 v[124:127], v[180:183], a[180:183], v[124:127]
    v_cvt_pk_bf16_f32 v133, v74, v75
    ds_read_b64_tr_b16 a[220:221], v231 offset:8192
    v_mfma_f32_16x16x32_bf16 v[100:103], v[184:187], a[136:139], v[100:103]
    v_mfma_f32_16x16x32_bf16 v[108:111], v[184:187], a[152:155], v[108:111]
    v_exp_f32 v76, v76
    ds_read_b64_tr_b16 a[222:223], v231 offset:12288
    v_mfma_f32_16x16x32_bf16 v[116:119], v[184:187], a[168:171], v[116:119]
    v_exp_f32 v77, v77
    v_mfma_f32_16x16x32_bf16 v[124:127], v[184:187], a[184:187], v[124:127]
    v_cvt_pk_bf16_f32 v134, v76, v77
    v_mfma_f32_16x16x32_bf16 v[100:103], v[188:191], a[140:143], v[100:103]
    v_mfma_f32_16x16x32_bf16 v[108:111], v[188:191], a[156:159], v[108:111]
    v_mfma_f32_16x16x32_bf16 v[116:119], v[188:191], a[172:175], v[116:119]
    v_exp_f32 v78, v78
    v_exp_f32 v79, v79
    v_mfma_f32_16x16x32_bf16 v[124:127], v[188:191], a[188:191], v[124:127]
    v_cvt_pk_bf16_f32 v135, v78, v79
    s_waitcnt vmcnt(4) lgkmcnt(0)
    s_barrier
    v_mfma_f32_16x16x32_bf16 a[224:227], a[240:243], v[144:147], a[224:227]
    v_mfma_f32_16x16x32_bf16 a[228:231], a[240:243], v[148:151], a[228:231]
    s_add_u32 m0, s25, 32768
    v_exp_f32 v80, v80
    ds_read_b128 v[160:163], v216 offset:0
    v_mfma_f32_16x16x32_bf16 a[232:235], a[240:243], v[152:155], a[232:235]
    s_add_u32 s35, s21, 16384
    v_exp_f32 v81, v81
    v_mfma_f32_16x16x32_bf16 a[236:239], a[240:243], v[156:159], a[236:239]
    buffer_load_dwordx4 v234, s[12:15], s35 offen nt lds
    v_cvt_pk_bf16_f32 v136, v80, v81
    v_mfma_f32_16x16x32_bf16 v[0:3], a[192:195], v[144:147], v[0:3]
    v_mfma_f32_16x16x32_bf16 v[4:7], a[192:195], v[148:151], v[4:7]
    v_exp_f32 v82, v82
    ds_read_b128 v[164:167], v217 offset:0
    v_mfma_f32_16x16x32_bf16 a[0:3], a[192:195], v[152:155], a[0:3]
    v_exp_f32 v83, v83
    v_mfma_f32_16x16x32_bf16 a[4:7], a[192:195], v[156:159], a[4:7]
    v_mfma_f32_16x16x32_bf16 v[8:11], a[196:199], v[144:147], v[8:11]
    v_mfma_f32_16x16x32_bf16 v[12:15], a[196:199], v[148:151], v[12:15]
    v_cvt_pk_bf16_f32 v137, v82, v83
    v_exp_f32 v84, v84
    ds_read_b128 v[168:171], v218 offset:0
    v_mfma_f32_16x16x32_bf16 a[8:11], a[196:199], v[152:155], a[8:11]
    v_exp_f32 v85, v85
    v_mfma_f32_16x16x32_bf16 a[12:15], a[196:199], v[156:159], a[12:15]
    v_mfma_f32_16x16x32_bf16 v[16:19], a[200:203], v[144:147], v[16:19]
    v_mfma_f32_16x16x32_bf16 v[20:23], a[200:203], v[148:151], v[20:23]
    v_cvt_pk_bf16_f32 v138, v84, v85
    v_exp_f32 v86, v86
    ds_read_b128 v[172:175], v219 offset:0
    v_mfma_f32_16x16x32_bf16 a[16:19], a[200:203], v[152:155], a[16:19]
    v_exp_f32 v87, v87
    v_mfma_f32_16x16x32_bf16 a[20:23], a[200:203], v[156:159], a[20:23]
    v_mfma_f32_16x16x32_bf16 v[24:27], a[204:207], v[144:147], v[24:27]
    v_cvt_pk_bf16_f32 v139, v86, v87
    v_exp_f32 v88, v88
    v_mfma_f32_16x16x32_bf16 v[28:31], a[204:207], v[148:151], v[28:31]
    ds_read_b128 v[176:179], v216 offset:4096
    v_mfma_f32_16x16x32_bf16 a[24:27], a[204:207], v[152:155], a[24:27]
    v_exp_f32 v89, v89
    v_mfma_f32_16x16x32_bf16 a[28:31], a[204:207], v[156:159], a[28:31]
    buffer_load_dwordx4 v235, s[12:15], s35 offen offset:1024 nt lds
    v_cvt_pk_bf16_f32 v140, v88, v89
    v_mfma_f32_16x16x32_bf16 v[32:35], a[208:211], v[144:147], v[32:35]
    v_mfma_f32_16x16x32_bf16 v[36:39], a[208:211], v[148:151], v[36:39]
    v_exp_f32 v90, v90
    ds_read_b128 v[180:183], v217 offset:4096
    v_mfma_f32_16x16x32_bf16 a[32:35], a[208:211], v[152:155], a[32:35]
    v_exp_f32 v91, v91
    v_mfma_f32_16x16x32_bf16 a[36:39], a[208:211], v[156:159], a[36:39]
    v_cvt_pk_bf16_f32 v141, v90, v91
    ds_read_b128 v[184:187], v218 offset:4096
    v_mfma_f32_16x16x32_bf16 v[40:43], a[212:215], v[144:147], v[40:43]
    v_mfma_f32_16x16x32_bf16 v[44:47], a[212:215], v[148:151], v[44:47]
    v_exp_f32 v92, v92
    ds_read_b128 v[188:191], v219 offset:4096
    v_mfma_f32_16x16x32_bf16 a[40:43], a[212:215], v[152:155], a[40:43]
    v_exp_f32 v93, v93
    v_mfma_f32_16x16x32_bf16 a[44:47], a[212:215], v[156:159], a[44:47]
    v_mfma_f32_16x16x32_bf16 v[48:51], a[216:219], v[144:147], v[48:51]
    v_mfma_f32_16x16x32_bf16 v[52:55], a[216:219], v[148:151], v[52:55]
    v_cvt_pk_bf16_f32 v142, v92, v93
    v_exp_f32 v94, v94
    v_mfma_f32_16x16x32_bf16 a[48:51], a[216:219], v[152:155], a[48:51]
    v_exp_f32 v95, v95
    v_mfma_f32_16x16x32_bf16 a[52:55], a[216:219], v[156:159], a[52:55]
    v_cvt_pk_bf16_f32 v143, v94, v95
    v_mfma_f32_16x16x32_bf16 v[56:59], a[220:223], v[144:147], v[56:59]
    v_mfma_f32_16x16x32_bf16 v[60:63], a[220:223], v[148:151], v[60:63]
    v_mfma_f32_16x16x32_bf16 a[56:59], a[220:223], v[152:155], a[56:59]
    v_mfma_f32_16x16x32_bf16 a[60:63], a[220:223], v[156:159], a[60:63]
    s_waitcnt lgkmcnt(0)
    v_pk_fma_f32 v[96:97], v[96:97], s[26:27], v[244:245] op_sel:[0,0,0] op_sel_hi:[1,0,0]
    v_pk_fma_f32 v[98:99], v[98:99], s[26:27], v[244:245] op_sel:[0,0,0] op_sel_hi:[1,0,0]
    v_pk_fma_f32 v[100:101], v[100:101], s[26:27], v[244:245] op_sel:[0,0,0] op_sel_hi:[1,0,0]
    v_pk_fma_f32 v[102:103], v[102:103], s[26:27], v[244:245] op_sel:[0,0,0] op_sel_hi:[1,0,0]
    v_pk_fma_f32 v[104:105], v[104:105], s[26:27], v[244:245] op_sel:[0,0,1] op_sel_hi:[1,0,1]
    v_pk_fma_f32 v[106:107], v[106:107], s[26:27], v[244:245] op_sel:[0,0,1] op_sel_hi:[1,0,1]
    v_pk_fma_f32 v[108:109], v[108:109], s[26:27], v[244:245] op_sel:[0,0,1] op_sel_hi:[1,0,1]
    v_pk_fma_f32 v[110:111], v[110:111], s[26:27], v[244:245] op_sel:[0,0,1] op_sel_hi:[1,0,1]
    v_pk_fma_f32 v[112:113], v[112:113], s[26:27], v[246:247] op_sel:[0,0,0] op_sel_hi:[1,0,0]
    v_pk_fma_f32 v[114:115], v[114:115], s[26:27], v[246:247] op_sel:[0,0,0] op_sel_hi:[1,0,0]
    v_pk_fma_f32 v[116:117], v[116:117], s[26:27], v[246:247] op_sel:[0,0,0] op_sel_hi:[1,0,0]
    v_pk_fma_f32 v[118:119], v[118:119], s[26:27], v[246:247] op_sel:[0,0,0] op_sel_hi:[1,0,0]
    v_pk_fma_f32 v[120:121], v[120:121], s[26:27], v[246:247] op_sel:[0,0,1] op_sel_hi:[1,0,1]
    v_pk_fma_f32 v[122:123], v[122:123], s[26:27], v[246:247] op_sel:[0,0,1] op_sel_hi:[1,0,1]
    v_pk_fma_f32 v[124:125], v[124:125], s[26:27], v[246:247] op_sel:[0,0,1] op_sel_hi:[1,0,1]
    v_pk_fma_f32 v[126:127], v[126:127], s[26:27], v[246:247] op_sel:[0,0,1] op_sel_hi:[1,0,1]
    s_nop 1
    v_mfma_f32_16x16x32_bf16 v[64:67], v[160:163], a[128:131], 0
    v_mfma_f32_16x16x32_bf16 v[72:75], v[160:163], a[144:147], 0
    v_exp_f32 v96, v96
    ds_read_b64_tr_b16 a[192:193], v224 offset:16384
    v_mfma_f32_16x16x32_bf16 v[80:83], v[160:163], a[160:163], 0
    v_exp_f32 v97, v97
    v_mfma_f32_16x16x32_bf16 v[88:91], v[160:163], a[176:179], 0
    s_add_u32 m0, s25, 16384
    v_cvt_pk_bf16_f32 v144, v96, v97
    ds_read_b64_tr_b16 a[194:195], v224 offset:20480
    v_mfma_f32_16x16x32_bf16 v[64:67], v[164:167], a[132:135], v[64:67]
    s_add_u32 s35, s21, 24576
    v_exp_f32 v98, v98
    ds_read_b64_tr_b16 a[196:197], v225 offset:16384
    v_mfma_f32_16x16x32_bf16 v[72:75], v[164:167], a[148:151], v[72:75]
    ds_read_b64_tr_b16 a[198:199], v225 offset:20480
    buffer_load_dwordx4 v232, s[8:11], s35 offen nt lds
    v_mfma_f32_16x16x32_bf16 v[80:83], v[164:167], a[164:167], v[80:83]
    v_exp_f32 v99, v99
    v_mfma_f32_16x16x32_bf16 v[88:91], v[164:167], a[180:183], v[88:91]
    v_cvt_pk_bf16_f32 v145, v98, v99
    ds_read_b64_tr_b16 a[200:201], v226 offset:16384
    v_mfma_f32_16x16x32_bf16 v[64:67], v[168:171], a[136:139], v[64:67]
    v_mfma_f32_16x16x32_bf16 v[72:75], v[168:171], a[152:155], v[72:75]
    v_exp_f32 v100, v100
    ds_read_b64_tr_b16 a[202:203], v226 offset:20480
    v_mfma_f32_16x16x32_bf16 v[80:83], v[168:171], a[168:171], v[80:83]
    v_exp_f32 v101, v101
    v_mfma_f32_16x16x32_bf16 v[88:91], v[168:171], a[184:187], v[88:91]
    v_cvt_pk_bf16_f32 v146, v100, v101
    ds_read_b64_tr_b16 a[204:205], v227 offset:16384
    v_mfma_f32_16x16x32_bf16 v[64:67], v[172:175], a[140:143], v[64:67]
    v_exp_f32 v102, v102
    v_mfma_f32_16x16x32_bf16 v[72:75], v[172:175], a[156:159], v[72:75]
    ds_read_b64_tr_b16 a[206:207], v227 offset:20480
    v_mfma_f32_16x16x32_bf16 v[80:83], v[172:175], a[172:175], v[80:83]
    v_exp_f32 v103, v103
    ds_read_b64_tr_b16 a[208:209], v228 offset:16384
    v_mfma_f32_16x16x32_bf16 v[88:91], v[172:175], a[188:191], v[88:91]
    v_cvt_pk_bf16_f32 v147, v102, v103
    ds_read_b64_tr_b16 a[210:211], v228 offset:20480
    v_mfma_f32_16x16x32_bf16 v[68:71], v[176:179], a[128:131], 0
    v_mfma_f32_16x16x32_bf16 v[76:79], v[176:179], a[144:147], 0
    v_exp_f32 v104, v104
    ds_read_b64_tr_b16 a[212:213], v229 offset:16384
    v_mfma_f32_16x16x32_bf16 v[84:87], v[176:179], a[160:163], 0
    buffer_load_dwordx4 v233, s[8:11], s35 offen offset:1024 nt lds
    v_exp_f32 v105, v105
    v_mfma_f32_16x16x32_bf16 v[92:95], v[176:179], a[176:179], 0
    v_cvt_pk_bf16_f32 v148, v104, v105
    ds_read_b64_tr_b16 a[214:215], v229 offset:20480
    v_mfma_f32_16x16x32_bf16 v[68:71], v[180:183], a[132:135], v[68:71]
    v_exp_f32 v106, v106
    v_mfma_f32_16x16x32_bf16 v[76:79], v[180:183], a[148:151], v[76:79]
    ds_read_b64_tr_b16 a[216:217], v230 offset:16384
    v_mfma_f32_16x16x32_bf16 v[84:87], v[180:183], a[164:167], v[84:87]
    v_exp_f32 v107, v107
    ds_read_b64_tr_b16 a[218:219], v230 offset:20480
    v_mfma_f32_16x16x32_bf16 v[92:95], v[180:183], a[180:183], v[92:95]
    v_cvt_pk_bf16_f32 v149, v106, v107
    ds_read_b64_tr_b16 a[220:221], v231 offset:16384
    v_mfma_f32_16x16x32_bf16 v[68:71], v[184:187], a[136:139], v[68:71]
    v_mfma_f32_16x16x32_bf16 v[76:79], v[184:187], a[152:155], v[76:79]
    v_exp_f32 v108, v108
    ds_read_b64_tr_b16 a[222:223], v231 offset:20480
    v_mfma_f32_16x16x32_bf16 v[84:87], v[184:187], a[168:171], v[84:87]
    v_exp_f32 v109, v109
    v_mfma_f32_16x16x32_bf16 v[92:95], v[184:187], a[184:187], v[92:95]
    v_cvt_pk_bf16_f32 v150, v108, v109
    v_mfma_f32_16x16x32_bf16 v[68:71], v[188:191], a[140:143], v[68:71]
    v_mfma_f32_16x16x32_bf16 v[76:79], v[188:191], a[156:159], v[76:79]
    v_mfma_f32_16x16x32_bf16 v[84:87], v[188:191], a[172:175], v[84:87]
    v_exp_f32 v110, v110
    v_exp_f32 v111, v111
    v_mfma_f32_16x16x32_bf16 v[92:95], v[188:191], a[188:191], v[92:95]
    v_cvt_pk_bf16_f32 v151, v110, v111
    s_waitcnt vmcnt(4) lgkmcnt(0)
    s_barrier
    v_mfma_f32_16x16x32_bf16 a[224:227], a[240:243], v[128:131], a[224:227]
    v_mfma_f32_16x16x32_bf16 a[228:231], a[240:243], v[132:135], a[228:231]
    s_add_u32 m0, s29, 20480
    v_exp_f32 v112, v112
    ds_read_b128 v[160:163], v216 offset:8192
    v_mfma_f32_16x16x32_bf16 a[232:235], a[240:243], v[136:139], a[232:235]
    s_add_u32 s35, s23, 4096
    v_exp_f32 v113, v113
    v_mfma_f32_16x16x32_bf16 a[236:239], a[240:243], v[140:143], a[236:239]
    buffer_load_dwordx4 v236, s[4:7], s35 offen nt lds
    v_cvt_pk_bf16_f32 v152, v112, v113
    v_mfma_f32_16x16x32_bf16 v[0:3], a[192:195], v[128:131], v[0:3]
    v_mfma_f32_16x16x32_bf16 v[4:7], a[192:195], v[132:135], v[4:7]
    v_exp_f32 v114, v114
    ds_read_b128 v[164:167], v217 offset:8192
    v_mfma_f32_16x16x32_bf16 a[0:3], a[192:195], v[136:139], a[0:3]
    v_exp_f32 v115, v115
    v_mfma_f32_16x16x32_bf16 a[4:7], a[192:195], v[140:143], a[4:7]
    v_cvt_pk_bf16_f32 v153, v114, v115
    v_mfma_f32_16x16x32_bf16 v[8:11], a[196:199], v[128:131], v[8:11]
    v_exp_f32 v116, v116
    v_mfma_f32_16x16x32_bf16 v[12:15], a[196:199], v[132:135], v[12:15]
    ds_read_b128 v[168:171], v218 offset:8192
    v_mfma_f32_16x16x32_bf16 a[8:11], a[196:199], v[136:139], a[8:11]
    v_exp_f32 v117, v117
    v_mfma_f32_16x16x32_bf16 a[12:15], a[196:199], v[140:143], a[12:15]
    buffer_load_dwordx4 v237, s[4:7], s35 offen offset:1024 nt lds
    v_cvt_pk_bf16_f32 v154, v116, v117
    v_mfma_f32_16x16x32_bf16 v[16:19], a[200:203], v[128:131], v[16:19]
    v_mfma_f32_16x16x32_bf16 v[20:23], a[200:203], v[132:135], v[20:23]
    v_exp_f32 v118, v118
    ds_read_b128 v[172:175], v219 offset:8192
    v_mfma_f32_16x16x32_bf16 a[16:19], a[200:203], v[136:139], a[16:19]
    v_exp_f32 v119, v119
    v_mfma_f32_16x16x32_bf16 a[20:23], a[200:203], v[140:143], a[20:23]
    v_cvt_pk_bf16_f32 v155, v118, v119
    v_mfma_f32_16x16x32_bf16 v[24:27], a[204:207], v[128:131], v[24:27]
    v_exp_f32 v120, v120
    v_mfma_f32_16x16x32_bf16 v[28:31], a[204:207], v[132:135], v[28:31]
    s_add_u32 m0, s25, 40960
    ds_read_b128 v[176:179], v216 offset:12288
    v_mfma_f32_16x16x32_bf16 a[24:27], a[204:207], v[136:139], a[24:27]
    s_add_u32 s35, s21, 20480
    v_exp_f32 v121, v121
    v_mfma_f32_16x16x32_bf16 a[28:31], a[204:207], v[140:143], a[28:31]
    buffer_load_dwordx4 v234, s[12:15], s35 offen nt lds
    v_cvt_pk_bf16_f32 v156, v120, v121
    v_mfma_f32_16x16x32_bf16 v[32:35], a[208:211], v[128:131], v[32:35]
    v_mfma_f32_16x16x32_bf16 v[36:39], a[208:211], v[132:135], v[36:39]
    v_exp_f32 v122, v122
    ds_read_b128 v[180:183], v217 offset:12288
    v_mfma_f32_16x16x32_bf16 a[32:35], a[208:211], v[136:139], a[32:35]
    v_exp_f32 v123, v123
    v_mfma_f32_16x16x32_bf16 a[36:39], a[208:211], v[140:143], a[36:39]
    v_cvt_pk_bf16_f32 v157, v122, v123
    ds_read_b128 v[184:187], v218 offset:12288
    v_mfma_f32_16x16x32_bf16 v[40:43], a[212:215], v[128:131], v[40:43]
    v_mfma_f32_16x16x32_bf16 v[44:47], a[212:215], v[132:135], v[44:47]
    v_exp_f32 v124, v124
    ds_read_b128 v[188:191], v219 offset:12288
    v_mfma_f32_16x16x32_bf16 a[40:43], a[212:215], v[136:139], a[40:43]
    v_exp_f32 v125, v125
    v_mfma_f32_16x16x32_bf16 a[44:47], a[212:215], v[140:143], a[44:47]
    buffer_load_dwordx4 v235, s[12:15], s35 offen offset:1024 nt lds
    v_cvt_pk_bf16_f32 v158, v124, v125
    v_mfma_f32_16x16x32_bf16 v[48:51], a[216:219], v[128:131], v[48:51]
    v_exp_f32 v126, v126
    v_mfma_f32_16x16x32_bf16 v[52:55], a[216:219], v[132:135], v[52:55]
    v_mfma_f32_16x16x32_bf16 a[48:51], a[216:219], v[136:139], a[48:51]
    v_exp_f32 v127, v127
    v_mfma_f32_16x16x32_bf16 a[52:55], a[216:219], v[140:143], a[52:55]
    v_cvt_pk_bf16_f32 v159, v126, v127
    v_mfma_f32_16x16x32_bf16 v[56:59], a[220:223], v[128:131], v[56:59]
    v_mfma_f32_16x16x32_bf16 v[60:63], a[220:223], v[132:135], v[60:63]
    v_mfma_f32_16x16x32_bf16 a[56:59], a[220:223], v[136:139], a[56:59]
    v_mfma_f32_16x16x32_bf16 a[60:63], a[220:223], v[140:143], a[60:63]
    s_waitcnt lgkmcnt(0)
    v_pk_fma_f32 v[64:65], v[64:65], s[26:27], v[244:245] op_sel:[0,0,0] op_sel_hi:[1,0,0]
    v_pk_fma_f32 v[66:67], v[66:67], s[26:27], v[244:245] op_sel:[0,0,0] op_sel_hi:[1,0,0]
    v_pk_fma_f32 v[68:69], v[68:69], s[26:27], v[244:245] op_sel:[0,0,0] op_sel_hi:[1,0,0]
    v_pk_fma_f32 v[70:71], v[70:71], s[26:27], v[244:245] op_sel:[0,0,0] op_sel_hi:[1,0,0]
    v_pk_fma_f32 v[72:73], v[72:73], s[26:27], v[244:245] op_sel:[0,0,1] op_sel_hi:[1,0,1]
    v_pk_fma_f32 v[74:75], v[74:75], s[26:27], v[244:245] op_sel:[0,0,1] op_sel_hi:[1,0,1]
    v_pk_fma_f32 v[76:77], v[76:77], s[26:27], v[244:245] op_sel:[0,0,1] op_sel_hi:[1,0,1]
    v_pk_fma_f32 v[78:79], v[78:79], s[26:27], v[244:245] op_sel:[0,0,1] op_sel_hi:[1,0,1]
    v_pk_fma_f32 v[80:81], v[80:81], s[26:27], v[246:247] op_sel:[0,0,0] op_sel_hi:[1,0,0]
    v_pk_fma_f32 v[82:83], v[82:83], s[26:27], v[246:247] op_sel:[0,0,0] op_sel_hi:[1,0,0]
    v_pk_fma_f32 v[84:85], v[84:85], s[26:27], v[246:247] op_sel:[0,0,0] op_sel_hi:[1,0,0]
    v_pk_fma_f32 v[86:87], v[86:87], s[26:27], v[246:247] op_sel:[0,0,0] op_sel_hi:[1,0,0]
    v_pk_fma_f32 v[88:89], v[88:89], s[26:27], v[246:247] op_sel:[0,0,1] op_sel_hi:[1,0,1]
    v_pk_fma_f32 v[90:91], v[90:91], s[26:27], v[246:247] op_sel:[0,0,1] op_sel_hi:[1,0,1]
    v_pk_fma_f32 v[92:93], v[92:93], s[26:27], v[246:247] op_sel:[0,0,1] op_sel_hi:[1,0,1]
    v_pk_fma_f32 v[94:95], v[94:95], s[26:27], v[246:247] op_sel:[0,0,1] op_sel_hi:[1,0,1]
    s_nop 1
    v_mfma_f32_16x16x32_bf16 v[96:99], v[160:163], a[128:131], 0
    v_mfma_f32_16x16x32_bf16 v[104:107], v[160:163], a[144:147], 0
    v_exp_f32 v64, v64
    ds_read_b64_tr_b16 a[192:193], v224 offset:24576
    v_mfma_f32_16x16x32_bf16 v[112:115], v[160:163], a[160:163], 0
    v_exp_f32 v65, v65
    v_mfma_f32_16x16x32_bf16 v[120:123], v[160:163], a[176:179], 0
    s_add_u32 m0, s25, 24576
    v_cvt_pk_bf16_f32 v128, v64, v65
    ds_read_b64_tr_b16 a[194:195], v224 offset:28672
    v_mfma_f32_16x16x32_bf16 v[96:99], v[164:167], a[132:135], v[96:99]
    s_add_u32 s35, s21, 28672
    v_exp_f32 v66, v66
    ds_read_b64_tr_b16 a[196:197], v225 offset:24576
    v_mfma_f32_16x16x32_bf16 v[104:107], v[164:167], a[148:151], v[104:107]
    ds_read_b64_tr_b16 a[198:199], v225 offset:28672
    buffer_load_dwordx4 v232, s[8:11], s35 offen nt lds
    v_mfma_f32_16x16x32_bf16 v[112:115], v[164:167], a[164:167], v[112:115]
    v_exp_f32 v67, v67
    v_mfma_f32_16x16x32_bf16 v[120:123], v[164:167], a[180:183], v[120:123]
    v_cvt_pk_bf16_f32 v129, v66, v67
    ds_read_b64_tr_b16 a[200:201], v226 offset:24576
    v_mfma_f32_16x16x32_bf16 v[96:99], v[168:171], a[136:139], v[96:99]
    v_mfma_f32_16x16x32_bf16 v[104:107], v[168:171], a[152:155], v[104:107]
    v_exp_f32 v68, v68
    ds_read_b64_tr_b16 a[202:203], v226 offset:28672
    v_mfma_f32_16x16x32_bf16 v[112:115], v[168:171], a[168:171], v[112:115]
    v_exp_f32 v69, v69
    v_mfma_f32_16x16x32_bf16 v[120:123], v[168:171], a[184:187], v[120:123]
    v_cvt_pk_bf16_f32 v130, v68, v69
    ds_read_b64_tr_b16 a[204:205], v227 offset:24576
    v_mfma_f32_16x16x32_bf16 v[96:99], v[172:175], a[140:143], v[96:99]
    v_exp_f32 v70, v70
    v_mfma_f32_16x16x32_bf16 v[104:107], v[172:175], a[156:159], v[104:107]
    ds_read_b64_tr_b16 a[206:207], v227 offset:28672
    v_mfma_f32_16x16x32_bf16 v[112:115], v[172:175], a[172:175], v[112:115]
    v_exp_f32 v71, v71
    ds_read_b64_tr_b16 a[208:209], v228 offset:24576
    v_mfma_f32_16x16x32_bf16 v[120:123], v[172:175], a[188:191], v[120:123]
    v_cvt_pk_bf16_f32 v131, v70, v71
    ds_read_b64_tr_b16 a[210:211], v228 offset:28672
    v_mfma_f32_16x16x32_bf16 v[100:103], v[176:179], a[128:131], 0
    v_mfma_f32_16x16x32_bf16 v[108:111], v[176:179], a[144:147], 0
    v_exp_f32 v72, v72
    ds_read_b64_tr_b16 a[212:213], v229 offset:24576
    v_mfma_f32_16x16x32_bf16 v[116:119], v[176:179], a[160:163], 0
    buffer_load_dwordx4 v233, s[8:11], s35 offen offset:1024 nt lds
    v_exp_f32 v73, v73
    v_mfma_f32_16x16x32_bf16 v[124:127], v[176:179], a[176:179], 0
    v_cvt_pk_bf16_f32 v132, v72, v73
    ds_read_b64_tr_b16 a[214:215], v229 offset:28672
    v_mfma_f32_16x16x32_bf16 v[100:103], v[180:183], a[132:135], v[100:103]
    v_exp_f32 v74, v74
    v_mfma_f32_16x16x32_bf16 v[108:111], v[180:183], a[148:151], v[108:111]
    ds_read_b64_tr_b16 a[216:217], v230 offset:24576
    v_mfma_f32_16x16x32_bf16 v[116:119], v[180:183], a[164:167], v[116:119]
    v_exp_f32 v75, v75
    ds_read_b64_tr_b16 a[218:219], v230 offset:28672
    v_mfma_f32_16x16x32_bf16 v[124:127], v[180:183], a[180:183], v[124:127]
    v_cvt_pk_bf16_f32 v133, v74, v75
    ds_read_b64_tr_b16 a[220:221], v231 offset:24576
    v_mfma_f32_16x16x32_bf16 v[100:103], v[184:187], a[136:139], v[100:103]
    v_mfma_f32_16x16x32_bf16 v[108:111], v[184:187], a[152:155], v[108:111]
    v_exp_f32 v76, v76
    ds_read_b64_tr_b16 a[222:223], v231 offset:28672
    v_mfma_f32_16x16x32_bf16 v[116:119], v[184:187], a[168:171], v[116:119]
    v_exp_f32 v77, v77
    v_mfma_f32_16x16x32_bf16 v[124:127], v[184:187], a[184:187], v[124:127]
    v_cvt_pk_bf16_f32 v134, v76, v77
    v_mfma_f32_16x16x32_bf16 v[100:103], v[188:191], a[140:143], v[100:103]
    v_mfma_f32_16x16x32_bf16 v[108:111], v[188:191], a[156:159], v[108:111]
    v_mfma_f32_16x16x32_bf16 v[116:119], v[188:191], a[172:175], v[116:119]
    v_exp_f32 v78, v78
    v_exp_f32 v79, v79
    v_mfma_f32_16x16x32_bf16 v[124:127], v[188:191], a[188:191], v[124:127]
    v_cvt_pk_bf16_f32 v135, v78, v79
    s_waitcnt vmcnt(6) lgkmcnt(0)
    s_barrier
    v_mfma_f32_16x16x32_bf16 a[224:227], a[240:243], v[144:147], a[224:227]
    v_exp_f32 v80, v80
    v_mfma_f32_16x16x32_bf16 a[228:231], a[240:243], v[148:151], a[228:231]
    ds_read_b128 v[160:163], v216 offset:16384
    v_mfma_f32_16x16x32_bf16 a[232:235], a[240:243], v[152:155], a[232:235]
    v_exp_f32 v81, v81
    v_mfma_f32_16x16x32_bf16 a[236:239], a[240:243], v[156:159], a[236:239]
    global_load_dwordx4 a[248:251], v[252:253], off
    v_cvt_pk_bf16_f32 v136, v80, v81
    v_mfma_f32_16x16x32_bf16 v[0:3], a[192:195], v[144:147], v[0:3]
    v_mfma_f32_16x16x32_bf16 v[4:7], a[192:195], v[148:151], v[4:7]
    v_exp_f32 v82, v82
    ds_read_b128 v[164:167], v217 offset:16384
    v_mfma_f32_16x16x32_bf16 a[0:3], a[192:195], v[152:155], a[0:3]
    v_exp_f32 v83, v83
    v_mfma_f32_16x16x32_bf16 a[4:7], a[192:195], v[156:159], a[4:7]
    v_cvt_pk_bf16_f32 v137, v82, v83
    v_mfma_f32_16x16x32_bf16 v[8:11], a[196:199], v[144:147], v[8:11]
    v_exp_f32 v84, v84
    v_mfma_f32_16x16x32_bf16 v[12:15], a[196:199], v[148:151], v[12:15]
    ds_read_b128 v[168:171], v218 offset:16384
    v_mfma_f32_16x16x32_bf16 a[8:11], a[196:199], v[152:155], a[8:11]
    v_exp_f32 v85, v85
    v_mfma_f32_16x16x32_bf16 a[12:15], a[196:199], v[156:159], a[12:15]
    s_add_u32 m0, s25, 49152
    v_cvt_pk_bf16_f32 v138, v84, v85
    ds_read_b128 v[172:175], v219 offset:16384
    v_mfma_f32_16x16x32_bf16 v[16:19], a[200:203], v[144:147], v[16:19]
    s_add_u32 s35, s21, 24576
    v_exp_f32 v86, v86
    v_mfma_f32_16x16x32_bf16 v[20:23], a[200:203], v[148:151], v[20:23]
    buffer_load_dwordx4 v234, s[12:15], s35 offen nt lds
    v_mfma_f32_16x16x32_bf16 a[16:19], a[200:203], v[152:155], a[16:19]
    v_exp_f32 v87, v87
    v_mfma_f32_16x16x32_bf16 a[20:23], a[200:203], v[156:159], a[20:23]
    v_cvt_pk_bf16_f32 v139, v86, v87
    v_mfma_f32_16x16x32_bf16 v[24:27], a[204:207], v[144:147], v[24:27]
    v_exp_f32 v88, v88
    v_mfma_f32_16x16x32_bf16 v[28:31], a[204:207], v[148:151], v[28:31]
    ds_read_b128 v[176:179], v216 offset:20480
    v_mfma_f32_16x16x32_bf16 a[24:27], a[204:207], v[152:155], a[24:27]
    v_exp_f32 v89, v89
    v_mfma_f32_16x16x32_bf16 a[28:31], a[204:207], v[156:159], a[28:31]
    v_mfma_f32_16x16x32_bf16 v[32:35], a[208:211], v[144:147], v[32:35]
    v_mfma_f32_16x16x32_bf16 v[36:39], a[208:211], v[148:151], v[36:39]
    v_cvt_pk_bf16_f32 v140, v88, v89
    v_exp_f32 v90, v90
    ds_read_b128 v[180:183], v217 offset:20480
    v_mfma_f32_16x16x32_bf16 a[32:35], a[208:211], v[152:155], a[32:35]
    v_exp_f32 v91, v91
    v_mfma_f32_16x16x32_bf16 a[36:39], a[208:211], v[156:159], a[36:39]
    v_cvt_pk_bf16_f32 v141, v90, v91
    ds_read_b128 v[184:187], v218 offset:20480
    v_mfma_f32_16x16x32_bf16 v[40:43], a[212:215], v[144:147], v[40:43]
    v_exp_f32 v92, v92
    v_mfma_f32_16x16x32_bf16 v[44:47], a[212:215], v[148:151], v[44:47]
    buffer_load_dwordx4 v235, s[12:15], s35 offen offset:1024 nt lds
    v_mfma_f32_16x16x32_bf16 a[40:43], a[212:215], v[152:155], a[40:43]
    v_exp_f32 v93, v93
    v_mfma_f32_16x16x32_bf16 a[44:47], a[212:215], v[156:159], a[44:47]
    v_cvt_pk_bf16_f32 v142, v92, v93
    ds_read_b128 v[188:191], v219 offset:20480
    v_mfma_f32_16x16x32_bf16 v[48:51], a[216:219], v[144:147], v[48:51]
    v_exp_f32 v94, v94
    v_mfma_f32_16x16x32_bf16 v[52:55], a[216:219], v[148:151], v[52:55]
    v_mfma_f32_16x16x32_bf16 a[48:51], a[216:219], v[152:155], a[48:51]
    v_exp_f32 v95, v95
    v_mfma_f32_16x16x32_bf16 a[52:55], a[216:219], v[156:159], a[52:55]
    v_cvt_pk_bf16_f32 v143, v94, v95
    v_mfma_f32_16x16x32_bf16 v[56:59], a[220:223], v[144:147], v[56:59]
    v_mfma_f32_16x16x32_bf16 v[60:63], a[220:223], v[148:151], v[60:63]
    v_mfma_f32_16x16x32_bf16 a[56:59], a[220:223], v[152:155], a[56:59]
    v_mfma_f32_16x16x32_bf16 a[60:63], a[220:223], v[156:159], a[60:63]
    s_waitcnt lgkmcnt(0)
    v_pk_fma_f32 v[96:97], v[96:97], s[26:27], v[244:245] op_sel:[0,0,0] op_sel_hi:[1,0,0]
    v_pk_fma_f32 v[98:99], v[98:99], s[26:27], v[244:245] op_sel:[0,0,0] op_sel_hi:[1,0,0]
    v_pk_fma_f32 v[100:101], v[100:101], s[26:27], v[244:245] op_sel:[0,0,0] op_sel_hi:[1,0,0]
    v_pk_fma_f32 v[102:103], v[102:103], s[26:27], v[244:245] op_sel:[0,0,0] op_sel_hi:[1,0,0]
    v_pk_fma_f32 v[104:105], v[104:105], s[26:27], v[244:245] op_sel:[0,0,1] op_sel_hi:[1,0,1]
    v_pk_fma_f32 v[106:107], v[106:107], s[26:27], v[244:245] op_sel:[0,0,1] op_sel_hi:[1,0,1]
    v_pk_fma_f32 v[108:109], v[108:109], s[26:27], v[244:245] op_sel:[0,0,1] op_sel_hi:[1,0,1]
    v_pk_fma_f32 v[110:111], v[110:111], s[26:27], v[244:245] op_sel:[0,0,1] op_sel_hi:[1,0,1]
    v_pk_fma_f32 v[112:113], v[112:113], s[26:27], v[246:247] op_sel:[0,0,0] op_sel_hi:[1,0,0]
    v_pk_fma_f32 v[114:115], v[114:115], s[26:27], v[246:247] op_sel:[0,0,0] op_sel_hi:[1,0,0]
    v_pk_fma_f32 v[116:117], v[116:117], s[26:27], v[246:247] op_sel:[0,0,0] op_sel_hi:[1,0,0]
    v_pk_fma_f32 v[118:119], v[118:119], s[26:27], v[246:247] op_sel:[0,0,0] op_sel_hi:[1,0,0]
    v_pk_fma_f32 v[120:121], v[120:121], s[26:27], v[246:247] op_sel:[0,0,1] op_sel_hi:[1,0,1]
    v_pk_fma_f32 v[122:123], v[122:123], s[26:27], v[246:247] op_sel:[0,0,1] op_sel_hi:[1,0,1]
    v_pk_fma_f32 v[124:125], v[124:125], s[26:27], v[246:247] op_sel:[0,0,1] op_sel_hi:[1,0,1]
    v_pk_fma_f32 v[126:127], v[126:127], s[26:27], v[246:247] op_sel:[0,0,1] op_sel_hi:[1,0,1]
    s_nop 1
    v_mfma_f32_16x16x32_bf16 v[64:67], v[160:163], a[128:131], 0
    v_mfma_f32_16x16x32_bf16 v[72:75], v[160:163], a[144:147], 0
    v_exp_f32 v96, v96
    ds_read_b64_tr_b16 a[192:193], v224 offset:0
    v_mfma_f32_16x16x32_bf16 v[80:83], v[160:163], a[160:163], 0
    v_exp_f32 v97, v97
    v_mfma_f32_16x16x32_bf16 v[88:91], v[160:163], a[176:179], 0
    s_add_u32 m0, s25, 0
    v_cvt_pk_bf16_f32 v144, v96, v97
    ds_read_b64_tr_b16 a[194:195], v224 offset:4096
    v_mfma_f32_16x16x32_bf16 v[64:67], v[164:167], a[132:135], v[64:67]
    s_add_u32 s35, s21, 32768
    v_exp_f32 v98, v98
    ds_read_b64_tr_b16 a[196:197], v225 offset:0
    v_mfma_f32_16x16x32_bf16 v[72:75], v[164:167], a[148:151], v[72:75]
    ds_read_b64_tr_b16 a[198:199], v225 offset:4096
    buffer_load_dwordx4 v232, s[8:11], s35 offen nt lds
    v_mfma_f32_16x16x32_bf16 v[80:83], v[164:167], a[164:167], v[80:83]
    v_exp_f32 v99, v99
    v_mfma_f32_16x16x32_bf16 v[88:91], v[164:167], a[180:183], v[88:91]
    v_cvt_pk_bf16_f32 v145, v98, v99
    ds_read_b64_tr_b16 a[200:201], v226 offset:0
    v_mfma_f32_16x16x32_bf16 v[64:67], v[168:171], a[136:139], v[64:67]
    v_mfma_f32_16x16x32_bf16 v[72:75], v[168:171], a[152:155], v[72:75]
    v_exp_f32 v100, v100
    ds_read_b64_tr_b16 a[202:203], v226 offset:4096
    v_mfma_f32_16x16x32_bf16 v[80:83], v[168:171], a[168:171], v[80:83]
    v_exp_f32 v101, v101
    v_mfma_f32_16x16x32_bf16 v[88:91], v[168:171], a[184:187], v[88:91]
    v_cvt_pk_bf16_f32 v146, v100, v101
    ds_read_b64_tr_b16 a[204:205], v227 offset:0
    v_mfma_f32_16x16x32_bf16 v[64:67], v[172:175], a[140:143], v[64:67]
    v_exp_f32 v102, v102
    v_mfma_f32_16x16x32_bf16 v[72:75], v[172:175], a[156:159], v[72:75]
    ds_read_b64_tr_b16 a[206:207], v227 offset:4096
    v_mfma_f32_16x16x32_bf16 v[80:83], v[172:175], a[172:175], v[80:83]
    v_exp_f32 v103, v103
    ds_read_b64_tr_b16 a[208:209], v228 offset:0
    v_mfma_f32_16x16x32_bf16 v[88:91], v[172:175], a[188:191], v[88:91]
    v_cvt_pk_bf16_f32 v147, v102, v103
    ds_read_b64_tr_b16 a[210:211], v228 offset:4096
    v_mfma_f32_16x16x32_bf16 v[68:71], v[176:179], a[128:131], 0
    v_exp_f32 v104, v104
    v_mfma_f32_16x16x32_bf16 v[76:79], v[176:179], a[144:147], 0
    ds_read_b64_tr_b16 a[212:213], v229 offset:0
    v_mfma_f32_16x16x32_bf16 v[84:87], v[176:179], a[160:163], 0
    buffer_load_dwordx4 v233, s[8:11], s35 offen offset:1024 nt lds
    v_exp_f32 v105, v105
    v_mfma_f32_16x16x32_bf16 v[92:95], v[176:179], a[176:179], 0
    v_cvt_pk_bf16_f32 v148, v104, v105
    ds_read_b64_tr_b16 a[214:215], v229 offset:4096
    v_mfma_f32_16x16x32_bf16 v[68:71], v[180:183], a[132:135], v[68:71]
    v_exp_f32 v106, v106
    v_mfma_f32_16x16x32_bf16 v[76:79], v[180:183], a[148:151], v[76:79]
    ds_read_b64_tr_b16 a[216:217], v230 offset:0
    v_mfma_f32_16x16x32_bf16 v[84:87], v[180:183], a[164:167], v[84:87]
    v_exp_f32 v107, v107
    ds_read_b64_tr_b16 a[218:219], v230 offset:4096
    v_mfma_f32_16x16x32_bf16 v[92:95], v[180:183], a[180:183], v[92:95]
    v_cvt_pk_bf16_f32 v149, v106, v107
    ds_read_b64_tr_b16 a[220:221], v231 offset:0
    v_mfma_f32_16x16x32_bf16 v[68:71], v[184:187], a[136:139], v[68:71]
    v_exp_f32 v108, v108
    v_mfma_f32_16x16x32_bf16 v[76:79], v[184:187], a[152:155], v[76:79]
    ds_read_b64_tr_b16 a[222:223], v231 offset:4096
    v_mfma_f32_16x16x32_bf16 v[84:87], v[184:187], a[168:171], v[84:87]
    v_exp_f32 v109, v109
    v_mfma_f32_16x16x32_bf16 v[92:95], v[184:187], a[184:187], v[92:95]
    v_cvt_pk_bf16_f32 v150, v108, v109
    v_mfma_f32_16x16x32_bf16 v[68:71], v[188:191], a[140:143], v[68:71]
    v_mfma_f32_16x16x32_bf16 v[76:79], v[188:191], a[156:159], v[76:79]
    v_mfma_f32_16x16x32_bf16 v[84:87], v[188:191], a[172:175], v[84:87]
    v_exp_f32 v110, v110
    v_exp_f32 v111, v111
    v_mfma_f32_16x16x32_bf16 v[92:95], v[188:191], a[188:191], v[92:95]
    v_cvt_pk_bf16_f32 v151, v110, v111
    s_waitcnt vmcnt(5) lgkmcnt(0)
    s_barrier
    v_mfma_f32_16x16x32_bf16 a[224:227], a[240:243], v[128:131], a[224:227]
    v_exp_f32 v112, v112
    v_mfma_f32_16x16x32_bf16 a[228:231], a[240:243], v[132:135], a[228:231]
    s_add_u32 m0, s29, 22528
    ds_read_b128 v[160:163], v216 offset:24576
    v_mfma_f32_16x16x32_bf16 a[232:235], a[240:243], v[136:139], a[232:235]
    s_add_u32 s35, s23, 6144
    v_exp_f32 v113, v113
    v_mfma_f32_16x16x32_bf16 a[236:239], a[240:243], v[140:143], a[236:239]
    buffer_load_dwordx4 v238, s[4:7], s35 offen nt lds
    v_cvt_pk_bf16_f32 v152, v112, v113
    v_mfma_f32_16x16x32_bf16 v[0:3], a[192:195], v[128:131], v[0:3]
    v_mfma_f32_16x16x32_bf16 v[4:7], a[192:195], v[132:135], v[4:7]
    v_exp_f32 v114, v114
    ds_read_b128 v[164:167], v217 offset:24576
    v_mfma_f32_16x16x32_bf16 a[0:3], a[192:195], v[136:139], a[0:3]
    v_exp_f32 v115, v115
    v_mfma_f32_16x16x32_bf16 a[4:7], a[192:195], v[140:143], a[4:7]
    v_cvt_pk_bf16_f32 v153, v114, v115
    v_mfma_f32_16x16x32_bf16 v[8:11], a[196:199], v[128:131], v[8:11]
    v_exp_f32 v116, v116
    v_mfma_f32_16x16x32_bf16 v[12:15], a[196:199], v[132:135], v[12:15]
    ds_read_b128 v[168:171], v218 offset:24576
    v_mfma_f32_16x16x32_bf16 a[8:11], a[196:199], v[136:139], a[8:11]
    v_exp_f32 v117, v117
    v_mfma_f32_16x16x32_bf16 a[12:15], a[196:199], v[140:143], a[12:15]
    buffer_load_dwordx4 v239, s[4:7], s35 offen offset:1024 nt lds
    v_cvt_pk_bf16_f32 v154, v116, v117
    v_mfma_f32_16x16x32_bf16 v[16:19], a[200:203], v[128:131], v[16:19]
    v_exp_f32 v118, v118
    v_mfma_f32_16x16x32_bf16 v[20:23], a[200:203], v[132:135], v[20:23]
    ds_read_b128 v[172:175], v219 offset:24576
    v_mfma_f32_16x16x32_bf16 a[16:19], a[200:203], v[136:139], a[16:19]
    v_exp_f32 v119, v119
    v_mfma_f32_16x16x32_bf16 a[20:23], a[200:203], v[140:143], a[20:23]
    v_cvt_pk_bf16_f32 v155, v118, v119
    v_mfma_f32_16x16x32_bf16 v[24:27], a[204:207], v[128:131], v[24:27]
    v_exp_f32 v120, v120
    v_mfma_f32_16x16x32_bf16 v[28:31], a[204:207], v[132:135], v[28:31]
    s_add_u32 m0, s25, 57344
    ds_read_b128 v[176:179], v216 offset:28672
    v_mfma_f32_16x16x32_bf16 a[24:27], a[204:207], v[136:139], a[24:27]
    s_add_u32 s35, s21, 28672
    v_exp_f32 v121, v121
    v_mfma_f32_16x16x32_bf16 a[28:31], a[204:207], v[140:143], a[28:31]
    buffer_load_dwordx4 v234, s[12:15], s35 offen nt lds
    v_cvt_pk_bf16_f32 v156, v120, v121
    v_mfma_f32_16x16x32_bf16 v[32:35], a[208:211], v[128:131], v[32:35]
    v_exp_f32 v122, v122
    v_mfma_f32_16x16x32_bf16 v[36:39], a[208:211], v[132:135], v[36:39]
    ds_read_b128 v[180:183], v217 offset:28672
    v_mfma_f32_16x16x32_bf16 a[32:35], a[208:211], v[136:139], a[32:35]
    v_exp_f32 v123, v123
    v_mfma_f32_16x16x32_bf16 a[36:39], a[208:211], v[140:143], a[36:39]
    v_cvt_pk_bf16_f32 v157, v122, v123
    ds_read_b128 v[184:187], v218 offset:28672
    v_mfma_f32_16x16x32_bf16 v[40:43], a[212:215], v[128:131], v[40:43]
    v_mfma_f32_16x16x32_bf16 v[44:47], a[212:215], v[132:135], v[44:47]
    v_exp_f32 v124, v124
    ds_read_b128 v[188:191], v219 offset:28672
    v_mfma_f32_16x16x32_bf16 a[40:43], a[212:215], v[136:139], a[40:43]
    v_exp_f32 v125, v125
    v_mfma_f32_16x16x32_bf16 a[44:47], a[212:215], v[140:143], a[44:47]
    buffer_load_dwordx4 v235, s[12:15], s35 offen offset:1024 nt lds
    v_cvt_pk_bf16_f32 v158, v124, v125
    v_mfma_f32_16x16x32_bf16 v[48:51], a[216:219], v[128:131], v[48:51]
    v_exp_f32 v126, v126
    v_mfma_f32_16x16x32_bf16 v[52:55], a[216:219], v[132:135], v[52:55]
    v_mfma_f32_16x16x32_bf16 a[48:51], a[216:219], v[136:139], a[48:51]
    v_exp_f32 v127, v127
    v_mfma_f32_16x16x32_bf16 a[52:55], a[216:219], v[140:143], a[52:55]
    v_cvt_pk_bf16_f32 v159, v126, v127
    v_mfma_f32_16x16x32_bf16 v[56:59], a[220:223], v[128:131], v[56:59]
    v_mfma_f32_16x16x32_bf16 v[60:63], a[220:223], v[132:135], v[60:63]
    v_mfma_f32_16x16x32_bf16 a[56:59], a[220:223], v[136:139], a[56:59]
    v_mfma_f32_16x16x32_bf16 a[60:63], a[220:223], v[140:143], a[60:63]
    s_waitcnt lgkmcnt(0)
    v_pk_fma_f32 v[64:65], v[64:65], s[26:27], v[244:245] op_sel:[0,0,0] op_sel_hi:[1,0,0]
    v_pk_fma_f32 v[66:67], v[66:67], s[26:27], v[244:245] op_sel:[0,0,0] op_sel_hi:[1,0,0]
    v_pk_fma_f32 v[68:69], v[68:69], s[26:27], v[244:245] op_sel:[0,0,0] op_sel_hi:[1,0,0]
    v_pk_fma_f32 v[70:71], v[70:71], s[26:27], v[244:245] op_sel:[0,0,0] op_sel_hi:[1,0,0]
    v_pk_fma_f32 v[72:73], v[72:73], s[26:27], v[244:245] op_sel:[0,0,1] op_sel_hi:[1,0,1]
    v_pk_fma_f32 v[74:75], v[74:75], s[26:27], v[244:245] op_sel:[0,0,1] op_sel_hi:[1,0,1]
    v_pk_fma_f32 v[76:77], v[76:77], s[26:27], v[244:245] op_sel:[0,0,1] op_sel_hi:[1,0,1]
    v_pk_fma_f32 v[78:79], v[78:79], s[26:27], v[244:245] op_sel:[0,0,1] op_sel_hi:[1,0,1]
    v_pk_fma_f32 v[80:81], v[80:81], s[26:27], v[246:247] op_sel:[0,0,0] op_sel_hi:[1,0,0]
    v_pk_fma_f32 v[82:83], v[82:83], s[26:27], v[246:247] op_sel:[0,0,0] op_sel_hi:[1,0,0]
    v_pk_fma_f32 v[84:85], v[84:85], s[26:27], v[246:247] op_sel:[0,0,0] op_sel_hi:[1,0,0]
    v_pk_fma_f32 v[86:87], v[86:87], s[26:27], v[246:247] op_sel:[0,0,0] op_sel_hi:[1,0,0]
    v_pk_fma_f32 v[88:89], v[88:89], s[26:27], v[246:247] op_sel:[0,0,1] op_sel_hi:[1,0,1]
    v_pk_fma_f32 v[90:91], v[90:91], s[26:27], v[246:247] op_sel:[0,0,1] op_sel_hi:[1,0,1]
    v_pk_fma_f32 v[92:93], v[92:93], s[26:27], v[246:247] op_sel:[0,0,1] op_sel_hi:[1,0,1]
    v_pk_fma_f32 v[94:95], v[94:95], s[26:27], v[246:247] op_sel:[0,0,1] op_sel_hi:[1,0,1]
    s_nop 1
    v_mfma_f32_16x16x32_bf16 v[96:99], v[160:163], a[128:131], 0
    v_mfma_f32_16x16x32_bf16 v[104:107], v[160:163], a[144:147], 0
    v_exp_f32 v64, v64
    ds_read_b64_tr_b16 a[192:193], v224 offset:8192
    v_mfma_f32_16x16x32_bf16 v[112:115], v[160:163], a[160:163], 0
    v_exp_f32 v65, v65
    v_mfma_f32_16x16x32_bf16 v[120:123], v[160:163], a[176:179], 0
    s_add_u32 m0, s25, 8192
    v_cvt_pk_bf16_f32 v128, v64, v65
    ds_read_b64_tr_b16 a[194:195], v224 offset:12288
    v_mfma_f32_16x16x32_bf16 v[96:99], v[164:167], a[132:135], v[96:99]
    s_add_u32 s35, s21, 36864
    v_exp_f32 v66, v66
    ds_read_b64_tr_b16 a[196:197], v225 offset:8192
    v_mfma_f32_16x16x32_bf16 v[104:107], v[164:167], a[148:151], v[104:107]
    ds_read_b64_tr_b16 a[198:199], v225 offset:12288
    buffer_load_dwordx4 v232, s[8:11], s35 offen nt lds
    v_mfma_f32_16x16x32_bf16 v[112:115], v[164:167], a[164:167], v[112:115]
    v_exp_f32 v67, v67
    v_mfma_f32_16x16x32_bf16 v[120:123], v[164:167], a[180:183], v[120:123]
    v_cvt_pk_bf16_f32 v129, v66, v67
    ds_read_b64_tr_b16 a[200:201], v226 offset:8192
    v_mfma_f32_16x16x32_bf16 v[96:99], v[168:171], a[136:139], v[96:99]
    v_mfma_f32_16x16x32_bf16 v[104:107], v[168:171], a[152:155], v[104:107]
    v_exp_f32 v68, v68
    ds_read_b64_tr_b16 a[202:203], v226 offset:12288
    v_mfma_f32_16x16x32_bf16 v[112:115], v[168:171], a[168:171], v[112:115]
    v_exp_f32 v69, v69
    v_mfma_f32_16x16x32_bf16 v[120:123], v[168:171], a[184:187], v[120:123]
    v_cvt_pk_bf16_f32 v130, v68, v69
    ds_read_b64_tr_b16 a[204:205], v227 offset:8192
    v_mfma_f32_16x16x32_bf16 v[96:99], v[172:175], a[140:143], v[96:99]
    v_exp_f32 v70, v70
    v_mfma_f32_16x16x32_bf16 v[104:107], v[172:175], a[156:159], v[104:107]
    ds_read_b64_tr_b16 a[206:207], v227 offset:12288
    v_mfma_f32_16x16x32_bf16 v[112:115], v[172:175], a[172:175], v[112:115]
    v_exp_f32 v71, v71
    ds_read_b64_tr_b16 a[208:209], v228 offset:8192
    v_mfma_f32_16x16x32_bf16 v[120:123], v[172:175], a[188:191], v[120:123]
    v_cvt_pk_bf16_f32 v131, v70, v71
    ds_read_b64_tr_b16 a[210:211], v228 offset:12288
    v_mfma_f32_16x16x32_bf16 v[100:103], v[176:179], a[128:131], 0
    v_exp_f32 v72, v72
    v_mfma_f32_16x16x32_bf16 v[108:111], v[176:179], a[144:147], 0
    ds_read_b64_tr_b16 a[212:213], v229 offset:8192
    v_mfma_f32_16x16x32_bf16 v[116:119], v[176:179], a[160:163], 0
    buffer_load_dwordx4 v233, s[8:11], s35 offen offset:1024 nt lds
    v_exp_f32 v73, v73
    v_mfma_f32_16x16x32_bf16 v[124:127], v[176:179], a[176:179], 0
    v_cvt_pk_bf16_f32 v132, v72, v73
    ds_read_b64_tr_b16 a[214:215], v229 offset:12288
    v_mfma_f32_16x16x32_bf16 v[100:103], v[180:183], a[132:135], v[100:103]
    v_exp_f32 v74, v74
    v_mfma_f32_16x16x32_bf16 v[108:111], v[180:183], a[148:151], v[108:111]
    ds_read_b64_tr_b16 a[216:217], v230 offset:8192
    v_mfma_f32_16x16x32_bf16 v[116:119], v[180:183], a[164:167], v[116:119]
    v_exp_f32 v75, v75
    ds_read_b64_tr_b16 a[218:219], v230 offset:12288
    v_mfma_f32_16x16x32_bf16 v[124:127], v[180:183], a[180:183], v[124:127]
    v_cvt_pk_bf16_f32 v133, v74, v75
    ds_read_b64_tr_b16 a[220:221], v231 offset:8192
    v_mfma_f32_16x16x32_bf16 v[100:103], v[184:187], a[136:139], v[100:103]
    v_exp_f32 v76, v76
    v_mfma_f32_16x16x32_bf16 v[108:111], v[184:187], a[152:155], v[108:111]
    ds_read_b64_tr_b16 a[222:223], v231 offset:12288
    v_mfma_f32_16x16x32_bf16 v[116:119], v[184:187], a[168:171], v[116:119]
    v_exp_f32 v77, v77
    v_mfma_f32_16x16x32_bf16 v[124:127], v[184:187], a[184:187], v[124:127]
    v_cvt_pk_bf16_f32 v134, v76, v77
    v_mfma_f32_16x16x32_bf16 v[100:103], v[188:191], a[140:143], v[100:103]
    v_mfma_f32_16x16x32_bf16 v[108:111], v[188:191], a[156:159], v[108:111]
    v_mfma_f32_16x16x32_bf16 v[116:119], v[188:191], a[172:175], v[116:119]
    v_exp_f32 v78, v78
    v_exp_f32 v79, v79
    v_mfma_f32_16x16x32_bf16 v[124:127], v[188:191], a[188:191], v[124:127]
    v_cvt_pk_bf16_f32 v135, v78, v79
    s_waitcnt vmcnt(6) lgkmcnt(0)
    s_barrier
    v_mfma_f32_16x16x32_bf16 a[224:227], a[240:243], v[144:147], a[224:227]
    v_exp_f32 v80, v80
    v_mfma_f32_16x16x32_bf16 a[228:231], a[240:243], v[148:151], a[228:231]
    s_add_u32 m0, s25, 32768
    ds_read_b128 v[160:163], v216 offset:0
    v_mfma_f32_16x16x32_bf16 a[232:235], a[240:243], v[152:155], a[232:235]
    s_add_u32 s35, s21, 32768
    v_exp_f32 v81, v81
    v_mfma_f32_16x16x32_bf16 a[236:239], a[240:243], v[156:159], a[236:239]
    buffer_load_dwordx4 v234, s[12:15], s35 offen nt lds
    v_cvt_pk_bf16_f32 v136, v80, v81
    v_mfma_f32_16x16x32_bf16 v[0:3], a[192:195], v[144:147], v[0:3]
    v_mfma_f32_16x16x32_bf16 v[4:7], a[192:195], v[148:151], v[4:7]
    v_exp_f32 v82, v82
    ds_read_b128 v[164:167], v217 offset:0
    v_mfma_f32_16x16x32_bf16 a[0:3], a[192:195], v[152:155], a[0:3]
    v_exp_f32 v83, v83
    v_mfma_f32_16x16x32_bf16 a[4:7], a[192:195], v[156:159], a[4:7]
    v_cvt_pk_bf16_f32 v137, v82, v83
    v_mfma_f32_16x16x32_bf16 v[8:11], a[196:199], v[144:147], v[8:11]
    v_exp_f32 v84, v84
    v_mfma_f32_16x16x32_bf16 v[12:15], a[196:199], v[148:151], v[12:15]
    ds_read_b128 v[168:171], v218 offset:0
    v_mfma_f32_16x16x32_bf16 a[8:11], a[196:199], v[152:155], a[8:11]
    v_exp_f32 v85, v85
    v_mfma_f32_16x16x32_bf16 a[12:15], a[196:199], v[156:159], a[12:15]
    v_cvt_pk_bf16_f32 v138, v84, v85
    v_mfma_f32_16x16x32_bf16 v[16:19], a[200:203], v[144:147], v[16:19]
    v_exp_f32 v86, v86
    v_mfma_f32_16x16x32_bf16 v[20:23], a[200:203], v[148:151], v[20:23]
    ds_read_b128 v[172:175], v219 offset:0
    v_mfma_f32_16x16x32_bf16 a[16:19], a[200:203], v[152:155], a[16:19]
    v_exp_f32 v87, v87
    v_mfma_f32_16x16x32_bf16 a[20:23], a[200:203], v[156:159], a[20:23]
    v_cvt_pk_bf16_f32 v139, v86, v87
    v_mfma_f32_16x16x32_bf16 v[24:27], a[204:207], v[144:147], v[24:27]
    v_exp_f32 v88, v88
    v_mfma_f32_16x16x32_bf16 v[28:31], a[204:207], v[148:151], v[28:31]
    ds_read_b128 v[176:179], v216 offset:4096
    v_mfma_f32_16x16x32_bf16 a[24:27], a[204:207], v[152:155], a[24:27]
    v_exp_f32 v89, v89
    v_mfma_f32_16x16x32_bf16 a[28:31], a[204:207], v[156:159], a[28:31]
    buffer_load_dwordx4 v235, s[12:15], s35 offen offset:1024 nt lds
    v_cvt_pk_bf16_f32 v140, v88, v89
    v_mfma_f32_16x16x32_bf16 v[32:35], a[208:211], v[144:147], v[32:35]
    v_exp_f32 v90, v90
    v_mfma_f32_16x16x32_bf16 v[36:39], a[208:211], v[148:151], v[36:39]
    ds_read_b128 v[180:183], v217 offset:4096
    v_mfma_f32_16x16x32_bf16 a[32:35], a[208:211], v[152:155], a[32:35]
    v_exp_f32 v91, v91
    v_mfma_f32_16x16x32_bf16 a[36:39], a[208:211], v[156:159], a[36:39]
    v_cvt_pk_bf16_f32 v141, v90, v91
    ds_read_b128 v[184:187], v218 offset:4096
    v_mfma_f32_16x16x32_bf16 v[40:43], a[212:215], v[144:147], v[40:43]
    v_mfma_f32_16x16x32_bf16 v[44:47], a[212:215], v[148:151], v[44:47]
    v_exp_f32 v92, v92
    ds_read_b128 v[188:191], v219 offset:4096
    v_mfma_f32_16x16x32_bf16 a[40:43], a[212:215], v[152:155], a[40:43]
    v_exp_f32 v93, v93
    v_mfma_f32_16x16x32_bf16 a[44:47], a[212:215], v[156:159], a[44:47]
    v_cvt_pk_bf16_f32 v142, v92, v93
    v_mfma_f32_16x16x32_bf16 v[48:51], a[216:219], v[144:147], v[48:51]
    v_exp_f32 v94, v94
    v_mfma_f32_16x16x32_bf16 v[52:55], a[216:219], v[148:151], v[52:55]
    v_mfma_f32_16x16x32_bf16 a[48:51], a[216:219], v[152:155], a[48:51]
    v_exp_f32 v95, v95
    v_mfma_f32_16x16x32_bf16 a[52:55], a[216:219], v[156:159], a[52:55]
    v_cvt_pk_bf16_f32 v143, v94, v95
    v_mfma_f32_16x16x32_bf16 v[56:59], a[220:223], v[144:147], v[56:59]
    v_mfma_f32_16x16x32_bf16 v[60:63], a[220:223], v[148:151], v[60:63]
    v_mfma_f32_16x16x32_bf16 a[56:59], a[220:223], v[152:155], a[56:59]
    v_mfma_f32_16x16x32_bf16 a[60:63], a[220:223], v[156:159], a[60:63]
    s_waitcnt lgkmcnt(0)
    v_pk_fma_f32 v[96:97], v[96:97], s[26:27], v[244:245] op_sel:[0,0,0] op_sel_hi:[1,0,0]
    v_pk_fma_f32 v[98:99], v[98:99], s[26:27], v[244:245] op_sel:[0,0,0] op_sel_hi:[1,0,0]
    v_pk_fma_f32 v[100:101], v[100:101], s[26:27], v[244:245] op_sel:[0,0,0] op_sel_hi:[1,0,0]
    v_pk_fma_f32 v[102:103], v[102:103], s[26:27], v[244:245] op_sel:[0,0,0] op_sel_hi:[1,0,0]
    v_pk_fma_f32 v[104:105], v[104:105], s[26:27], v[244:245] op_sel:[0,0,1] op_sel_hi:[1,0,1]
    v_pk_fma_f32 v[106:107], v[106:107], s[26:27], v[244:245] op_sel:[0,0,1] op_sel_hi:[1,0,1]
    v_pk_fma_f32 v[108:109], v[108:109], s[26:27], v[244:245] op_sel:[0,0,1] op_sel_hi:[1,0,1]
    v_pk_fma_f32 v[110:111], v[110:111], s[26:27], v[244:245] op_sel:[0,0,1] op_sel_hi:[1,0,1]
    v_pk_fma_f32 v[112:113], v[112:113], s[26:27], v[246:247] op_sel:[0,0,0] op_sel_hi:[1,0,0]
    v_pk_fma_f32 v[114:115], v[114:115], s[26:27], v[246:247] op_sel:[0,0,0] op_sel_hi:[1,0,0]
    v_pk_fma_f32 v[116:117], v[116:117], s[26:27], v[246:247] op_sel:[0,0,0] op_sel_hi:[1,0,0]
    v_pk_fma_f32 v[118:119], v[118:119], s[26:27], v[246:247] op_sel:[0,0,0] op_sel_hi:[1,0,0]
    v_pk_fma_f32 v[120:121], v[120:121], s[26:27], v[246:247] op_sel:[0,0,1] op_sel_hi:[1,0,1]
    v_pk_fma_f32 v[122:123], v[122:123], s[26:27], v[246:247] op_sel:[0,0,1] op_sel_hi:[1,0,1]
    v_pk_fma_f32 v[124:125], v[124:125], s[26:27], v[246:247] op_sel:[0,0,1] op_sel_hi:[1,0,1]
    v_pk_fma_f32 v[126:127], v[126:127], s[26:27], v[246:247] op_sel:[0,0,1] op_sel_hi:[1,0,1]
    s_nop 1
    v_mfma_f32_16x16x32_bf16 v[64:67], v[160:163], a[128:131], 0
    v_mfma_f32_16x16x32_bf16 v[72:75], v[160:163], a[144:147], 0
    v_exp_f32 v96, v96
    ds_read_b64_tr_b16 a[192:193], v224 offset:16384
    v_mfma_f32_16x16x32_bf16 v[80:83], v[160:163], a[160:163], 0
    v_exp_f32 v97, v97
    v_mfma_f32_16x16x32_bf16 v[88:91], v[160:163], a[176:179], 0
    s_add_u32 m0, s25, 16384
    v_cvt_pk_bf16_f32 v144, v96, v97
    ds_read_b64_tr_b16 a[194:195], v224 offset:20480
    v_mfma_f32_16x16x32_bf16 v[64:67], v[164:167], a[132:135], v[64:67]
    s_add_u32 s35, s21, 40960
    v_exp_f32 v98, v98
    ds_read_b64_tr_b16 a[196:197], v225 offset:16384
    v_mfma_f32_16x16x32_bf16 v[72:75], v[164:167], a[148:151], v[72:75]
    ds_read_b64_tr_b16 a[198:199], v225 offset:20480
    buffer_load_dwordx4 v232, s[8:11], s35 offen nt lds
    v_mfma_f32_16x16x32_bf16 v[80:83], v[164:167], a[164:167], v[80:83]
    v_exp_f32 v99, v99
    v_mfma_f32_16x16x32_bf16 v[88:91], v[164:167], a[180:183], v[88:91]
    v_cvt_pk_bf16_f32 v145, v98, v99
    ds_read_b64_tr_b16 a[200:201], v226 offset:16384
    v_mfma_f32_16x16x32_bf16 v[64:67], v[168:171], a[136:139], v[64:67]
    v_exp_f32 v100, v100
    v_mfma_f32_16x16x32_bf16 v[72:75], v[168:171], a[152:155], v[72:75]
    ds_read_b64_tr_b16 a[202:203], v226 offset:20480
    v_mfma_f32_16x16x32_bf16 v[80:83], v[168:171], a[168:171], v[80:83]
    v_exp_f32 v101, v101
    v_mfma_f32_16x16x32_bf16 v[88:91], v[168:171], a[184:187], v[88:91]
    v_cvt_pk_bf16_f32 v146, v100, v101
    ds_read_b64_tr_b16 a[204:205], v227 offset:16384
    v_mfma_f32_16x16x32_bf16 v[64:67], v[172:175], a[140:143], v[64:67]
    v_exp_f32 v102, v102
    v_mfma_f32_16x16x32_bf16 v[72:75], v[172:175], a[156:159], v[72:75]
    ds_read_b64_tr_b16 a[206:207], v227 offset:20480
    v_mfma_f32_16x16x32_bf16 v[80:83], v[172:175], a[172:175], v[80:83]
    v_exp_f32 v103, v103
    ds_read_b64_tr_b16 a[208:209], v228 offset:16384
    v_mfma_f32_16x16x32_bf16 v[88:91], v[172:175], a[188:191], v[88:91]
    v_cvt_pk_bf16_f32 v147, v102, v103
    ds_read_b64_tr_b16 a[210:211], v228 offset:20480
    v_mfma_f32_16x16x32_bf16 v[68:71], v[176:179], a[128:131], 0
    v_exp_f32 v104, v104
    v_mfma_f32_16x16x32_bf16 v[76:79], v[176:179], a[144:147], 0
    ds_read_b64_tr_b16 a[212:213], v229 offset:16384
    v_mfma_f32_16x16x32_bf16 v[84:87], v[176:179], a[160:163], 0
    buffer_load_dwordx4 v233, s[8:11], s35 offen offset:1024 nt lds
    v_exp_f32 v105, v105
    v_mfma_f32_16x16x32_bf16 v[92:95], v[176:179], a[176:179], 0
    v_cvt_pk_bf16_f32 v148, v104, v105
    ds_read_b64_tr_b16 a[214:215], v229 offset:20480
    v_mfma_f32_16x16x32_bf16 v[68:71], v[180:183], a[132:135], v[68:71]
    v_exp_f32 v106, v106
    v_mfma_f32_16x16x32_bf16 v[76:79], v[180:183], a[148:151], v[76:79]
    ds_read_b64_tr_b16 a[216:217], v230 offset:16384
    v_mfma_f32_16x16x32_bf16 v[84:87], v[180:183], a[164:167], v[84:87]
    v_exp_f32 v107, v107
    ds_read_b64_tr_b16 a[218:219], v230 offset:20480
    v_mfma_f32_16x16x32_bf16 v[92:95], v[180:183], a[180:183], v[92:95]
    v_cvt_pk_bf16_f32 v149, v106, v107
    ds_read_b64_tr_b16 a[220:221], v231 offset:16384
    v_mfma_f32_16x16x32_bf16 v[68:71], v[184:187], a[136:139], v[68:71]
    v_exp_f32 v108, v108
    v_mfma_f32_16x16x32_bf16 v[76:79], v[184:187], a[152:155], v[76:79]
    ds_read_b64_tr_b16 a[222:223], v231 offset:20480
    v_mfma_f32_16x16x32_bf16 v[84:87], v[184:187], a[168:171], v[84:87]
    v_exp_f32 v109, v109
    v_mfma_f32_16x16x32_bf16 v[92:95], v[184:187], a[184:187], v[92:95]
    v_cvt_pk_bf16_f32 v150, v108, v109
    v_mfma_f32_16x16x32_bf16 v[68:71], v[188:191], a[140:143], v[68:71]
    v_exp_f32 v110, v110
    v_mfma_f32_16x16x32_bf16 v[76:79], v[188:191], a[156:159], v[76:79]
    v_mfma_f32_16x16x32_bf16 v[84:87], v[188:191], a[172:175], v[84:87]
    v_exp_f32 v111, v111
    v_mfma_f32_16x16x32_bf16 v[92:95], v[188:191], a[188:191], v[92:95]
    v_cvt_pk_bf16_f32 v151, v110, v111
    s_waitcnt vmcnt(4) lgkmcnt(0)
    s_barrier
    v_mfma_f32_16x16x32_bf16 a[224:227], a[240:243], v[128:131], a[224:227]
    v_exp_f32 v112, v112
    v_mfma_f32_16x16x32_bf16 a[228:231], a[240:243], v[132:135], a[228:231]
    s_add_u32 m0, s29, 0
    ds_read_b128 v[160:163], v216 offset:8192
    v_mfma_f32_16x16x32_bf16 a[232:235], a[240:243], v[136:139], a[232:235]
    s_add_u32 s35, s23, 16384
    v_exp_f32 v113, v113
    v_mfma_f32_16x16x32_bf16 a[236:239], a[240:243], v[140:143], a[236:239]
    buffer_load_dwordx4 v236, s[4:7], s35 offen nt lds
    v_cvt_pk_bf16_f32 v152, v112, v113
    v_mfma_f32_16x16x32_bf16 v[0:3], a[192:195], v[128:131], v[0:3]
    v_exp_f32 v114, v114
    v_mfma_f32_16x16x32_bf16 v[4:7], a[192:195], v[132:135], v[4:7]
    ds_read_b128 v[164:167], v217 offset:8192
    v_mfma_f32_16x16x32_bf16 a[0:3], a[192:195], v[136:139], a[0:3]
    v_exp_f32 v115, v115
    v_mfma_f32_16x16x32_bf16 a[4:7], a[192:195], v[140:143], a[4:7]
    v_cvt_pk_bf16_f32 v153, v114, v115
    v_mfma_f32_16x16x32_bf16 v[8:11], a[196:199], v[128:131], v[8:11]
    v_exp_f32 v116, v116
    v_mfma_f32_16x16x32_bf16 v[12:15], a[196:199], v[132:135], v[12:15]
    ds_read_b128 v[168:171], v218 offset:8192
    v_mfma_f32_16x16x32_bf16 a[8:11], a[196:199], v[136:139], a[8:11]
    v_exp_f32 v117, v117
    v_mfma_f32_16x16x32_bf16 a[12:15], a[196:199], v[140:143], a[12:15]
    buffer_load_dwordx4 v237, s[4:7], s35 offen offset:1024 nt lds
    v_cvt_pk_bf16_f32 v154, v116, v117
    v_mfma_f32_16x16x32_bf16 v[16:19], a[200:203], v[128:131], v[16:19]
    v_exp_f32 v118, v118
    v_mfma_f32_16x16x32_bf16 v[20:23], a[200:203], v[132:135], v[20:23]
    ds_read_b128 v[172:175], v219 offset:8192
    v_mfma_f32_16x16x32_bf16 a[16:19], a[200:203], v[136:139], a[16:19]
    v_exp_f32 v119, v119
    v_mfma_f32_16x16x32_bf16 a[20:23], a[200:203], v[140:143], a[20:23]
    v_cvt_pk_bf16_f32 v155, v118, v119
    v_mfma_f32_16x16x32_bf16 v[24:27], a[204:207], v[128:131], v[24:27]
    v_exp_f32 v120, v120
    v_mfma_f32_16x16x32_bf16 v[28:31], a[204:207], v[132:135], v[28:31]
    s_add_u32 m0, s25, 40960
    ds_read_b128 v[176:179], v216 offset:12288
    v_mfma_f32_16x16x32_bf16 a[24:27], a[204:207], v[136:139], a[24:27]
    s_add_u32 s35, s21, 36864
    v_exp_f32 v121, v121
    v_mfma_f32_16x16x32_bf16 a[28:31], a[204:207], v[140:143], a[28:31]
    buffer_load_dwordx4 v234, s[12:15], s35 offen nt lds
    v_cvt_pk_bf16_f32 v156, v120, v121
    v_mfma_f32_16x16x32_bf16 v[32:35], a[208:211], v[128:131], v[32:35]
    v_exp_f32 v122, v122
    v_mfma_f32_16x16x32_bf16 v[36:39], a[208:211], v[132:135], v[36:39]
    ds_read_b128 v[180:183], v217 offset:12288
    v_mfma_f32_16x16x32_bf16 a[32:35], a[208:211], v[136:139], a[32:35]
    v_exp_f32 v123, v123
    v_mfma_f32_16x16x32_bf16 a[36:39], a[208:211], v[140:143], a[36:39]
    v_cvt_pk_bf16_f32 v157, v122, v123
    ds_read_b128 v[184:187], v218 offset:12288
    v_mfma_f32_16x16x32_bf16 v[40:43], a[212:215], v[128:131], v[40:43]
    v_exp_f32 v124, v124
    v_mfma_f32_16x16x32_bf16 v[44:47], a[212:215], v[132:135], v[44:47]
    ds_read_b128 v[188:191], v219 offset:12288
    v_mfma_f32_16x16x32_bf16 a[40:43], a[212:215], v[136:139], a[40:43]
    v_exp_f32 v125, v125
    v_mfma_f32_16x16x32_bf16 a[44:47], a[212:215], v[140:143], a[44:47]
    buffer_load_dwordx4 v235, s[12:15], s35 offen offset:1024 nt lds
    v_cvt_pk_bf16_f32 v158, v124, v125
    v_mfma_f32_16x16x32_bf16 v[48:51], a[216:219], v[128:131], v[48:51]
    v_exp_f32 v126, v126
    v_mfma_f32_16x16x32_bf16 v[52:55], a[216:219], v[132:135], v[52:55]
    v_mfma_f32_16x16x32_bf16 a[48:51], a[216:219], v[136:139], a[48:51]
    v_exp_f32 v127, v127
    v_mfma_f32_16x16x32_bf16 a[52:55], a[216:219], v[140:143], a[52:55]
    v_cvt_pk_bf16_f32 v159, v126, v127
    v_mfma_f32_16x16x32_bf16 v[56:59], a[220:223], v[128:131], v[56:59]
    v_mfma_f32_16x16x32_bf16 v[60:63], a[220:223], v[132:135], v[60:63]
    v_mfma_f32_16x16x32_bf16 a[56:59], a[220:223], v[136:139], a[56:59]
    v_mfma_f32_16x16x32_bf16 a[60:63], a[220:223], v[140:143], a[60:63]
    s_waitcnt lgkmcnt(0)
    v_pk_fma_f32 v[64:65], v[64:65], s[26:27], v[244:245] op_sel:[0,0,0] op_sel_hi:[1,0,0]
    v_pk_fma_f32 v[66:67], v[66:67], s[26:27], v[244:245] op_sel:[0,0,0] op_sel_hi:[1,0,0]
    v_pk_fma_f32 v[68:69], v[68:69], s[26:27], v[244:245] op_sel:[0,0,0] op_sel_hi:[1,0,0]
    v_pk_fma_f32 v[70:71], v[70:71], s[26:27], v[244:245] op_sel:[0,0,0] op_sel_hi:[1,0,0]
    v_pk_fma_f32 v[72:73], v[72:73], s[26:27], v[244:245] op_sel:[0,0,1] op_sel_hi:[1,0,1]
    v_pk_fma_f32 v[74:75], v[74:75], s[26:27], v[244:245] op_sel:[0,0,1] op_sel_hi:[1,0,1]
    v_pk_fma_f32 v[76:77], v[76:77], s[26:27], v[244:245] op_sel:[0,0,1] op_sel_hi:[1,0,1]
    v_pk_fma_f32 v[78:79], v[78:79], s[26:27], v[244:245] op_sel:[0,0,1] op_sel_hi:[1,0,1]
    v_pk_fma_f32 v[80:81], v[80:81], s[26:27], v[246:247] op_sel:[0,0,0] op_sel_hi:[1,0,0]
    v_pk_fma_f32 v[82:83], v[82:83], s[26:27], v[246:247] op_sel:[0,0,0] op_sel_hi:[1,0,0]
    v_pk_fma_f32 v[84:85], v[84:85], s[26:27], v[246:247] op_sel:[0,0,0] op_sel_hi:[1,0,0]
    v_pk_fma_f32 v[86:87], v[86:87], s[26:27], v[246:247] op_sel:[0,0,0] op_sel_hi:[1,0,0]
    v_pk_fma_f32 v[88:89], v[88:89], s[26:27], v[246:247] op_sel:[0,0,1] op_sel_hi:[1,0,1]
    v_pk_fma_f32 v[90:91], v[90:91], s[26:27], v[246:247] op_sel:[0,0,1] op_sel_hi:[1,0,1]
    v_pk_fma_f32 v[92:93], v[92:93], s[26:27], v[246:247] op_sel:[0,0,1] op_sel_hi:[1,0,1]
    v_pk_fma_f32 v[94:95], v[94:95], s[26:27], v[246:247] op_sel:[0,0,1] op_sel_hi:[1,0,1]
    s_nop 1
    v_mfma_f32_16x16x32_bf16 v[96:99], v[160:163], a[128:131], 0
    v_mfma_f32_16x16x32_bf16 v[104:107], v[160:163], a[144:147], 0
    v_exp_f32 v64, v64
    ds_read_b64_tr_b16 a[192:193], v224 offset:24576
    v_mfma_f32_16x16x32_bf16 v[112:115], v[160:163], a[160:163], 0
    v_exp_f32 v65, v65
    v_mfma_f32_16x16x32_bf16 v[120:123], v[160:163], a[176:179], 0
    s_add_u32 m0, s25, 24576
    v_cvt_pk_bf16_f32 v128, v64, v65
    ds_read_b64_tr_b16 a[194:195], v224 offset:28672
    v_mfma_f32_16x16x32_bf16 v[96:99], v[164:167], a[132:135], v[96:99]
    s_add_u32 s35, s21, 45056
    v_exp_f32 v66, v66
    ds_read_b64_tr_b16 a[196:197], v225 offset:24576
    v_mfma_f32_16x16x32_bf16 v[104:107], v[164:167], a[148:151], v[104:107]
    ds_read_b64_tr_b16 a[198:199], v225 offset:28672
    buffer_load_dwordx4 v232, s[8:11], s35 offen nt lds
    v_mfma_f32_16x16x32_bf16 v[112:115], v[164:167], a[164:167], v[112:115]
    v_exp_f32 v67, v67
    v_mfma_f32_16x16x32_bf16 v[120:123], v[164:167], a[180:183], v[120:123]
    v_cvt_pk_bf16_f32 v129, v66, v67
    ds_read_b64_tr_b16 a[200:201], v226 offset:24576
    v_mfma_f32_16x16x32_bf16 v[96:99], v[168:171], a[136:139], v[96:99]
    v_mfma_f32_16x16x32_bf16 v[104:107], v[168:171], a[152:155], v[104:107]
    v_exp_f32 v68, v68
    ds_read_b64_tr_b16 a[202:203], v226 offset:28672
    v_mfma_f32_16x16x32_bf16 v[112:115], v[168:171], a[168:171], v[112:115]
    v_exp_f32 v69, v69
    v_mfma_f32_16x16x32_bf16 v[120:123], v[168:171], a[184:187], v[120:123]
    v_cvt_pk_bf16_f32 v130, v68, v69
    ds_read_b64_tr_b16 a[204:205], v227 offset:24576
    v_mfma_f32_16x16x32_bf16 v[96:99], v[172:175], a[140:143], v[96:99]
    v_exp_f32 v70, v70
    v_mfma_f32_16x16x32_bf16 v[104:107], v[172:175], a[156:159], v[104:107]
    ds_read_b64_tr_b16 a[206:207], v227 offset:28672
    v_mfma_f32_16x16x32_bf16 v[112:115], v[172:175], a[172:175], v[112:115]
    v_exp_f32 v71, v71
    ds_read_b64_tr_b16 a[208:209], v228 offset:24576
    v_mfma_f32_16x16x32_bf16 v[120:123], v[172:175], a[188:191], v[120:123]
    v_cvt_pk_bf16_f32 v131, v70, v71
    ds_read_b64_tr_b16 a[210:211], v228 offset:28672
    v_mfma_f32_16x16x32_bf16 v[100:103], v[176:179], a[128:131], 0
    v_exp_f32 v72, v72
    v_mfma_f32_16x16x32_bf16 v[108:111], v[176:179], a[144:147], 0
    ds_read_b64_tr_b16 a[212:213], v229 offset:24576
    v_mfma_f32_16x16x32_bf16 v[116:119], v[176:179], a[160:163], 0
    buffer_load_dwordx4 v233, s[8:11], s35 offen offset:1024 nt lds
    v_exp_f32 v73, v73
    v_mfma_f32_16x16x32_bf16 v[124:127], v[176:179], a[176:179], 0
    v_cvt_pk_bf16_f32 v132, v72, v73
    ds_read_b64_tr_b16 a[214:215], v229 offset:28672
    v_mfma_f32_16x16x32_bf16 v[100:103], v[180:183], a[132:135], v[100:103]
    v_exp_f32 v74, v74
    v_mfma_f32_16x16x32_bf16 v[108:111], v[180:183], a[148:151], v[108:111]
    ds_read_b64_tr_b16 a[216:217], v230 offset:24576
    v_mfma_f32_16x16x32_bf16 v[116:119], v[180:183], a[164:167], v[116:119]
    v_exp_f32 v75, v75
    ds_read_b64_tr_b16 a[218:219], v230 offset:28672
    v_mfma_f32_16x16x32_bf16 v[124:127], v[180:183], a[180:183], v[124:127]
    v_cvt_pk_bf16_f32 v133, v74, v75
    ds_read_b64_tr_b16 a[220:221], v231 offset:24576
    v_mfma_f32_16x16x32_bf16 v[100:103], v[184:187], a[136:139], v[100:103]
    v_exp_f32 v76, v76
    v_mfma_f32_16x16x32_bf16 v[108:111], v[184:187], a[152:155], v[108:111]
    ds_read_b64_tr_b16 a[222:223], v231 offset:28672
    v_mfma_f32_16x16x32_bf16 v[116:119], v[184:187], a[168:171], v[116:119]
    v_exp_f32 v77, v77
    v_mfma_f32_16x16x32_bf16 v[124:127], v[184:187], a[184:187], v[124:127]
    v_cvt_pk_bf16_f32 v134, v76, v77
    v_mfma_f32_16x16x32_bf16 v[100:103], v[188:191], a[140:143], v[100:103]
    v_mfma_f32_16x16x32_bf16 v[108:111], v[188:191], a[156:159], v[108:111]
    v_exp_f32 v78, v78
    v_mfma_f32_16x16x32_bf16 v[116:119], v[188:191], a[172:175], v[116:119]
    v_exp_f32 v79, v79
    v_mfma_f32_16x16x32_bf16 v[124:127], v[188:191], a[188:191], v[124:127]
    v_cvt_pk_bf16_f32 v135, v78, v79
    s_waitcnt vmcnt(6) lgkmcnt(0)
    s_barrier
    v_mfma_f32_16x16x32_bf16 a[224:227], a[240:243], v[144:147], a[224:227]
    v_exp_f32 v80, v80
    v_mfma_f32_16x16x32_bf16 a[228:231], a[240:243], v[148:151], a[228:231]
    s_add_u32 m0, s25, 49152
    ds_read_b128 v[160:163], v216 offset:16384
    v_mfma_f32_16x16x32_bf16 a[232:235], a[240:243], v[152:155], a[232:235]
    s_add_u32 s35, s21, 40960
    v_exp_f32 v81, v81
    v_mfma_f32_16x16x32_bf16 a[236:239], a[240:243], v[156:159], a[236:239]
    buffer_load_dwordx4 v234, s[12:15], s35 offen nt lds
    v_cvt_pk_bf16_f32 v136, v80, v81
    v_mfma_f32_16x16x32_bf16 v[0:3], a[192:195], v[144:147], v[0:3]
    v_exp_f32 v82, v82
    v_mfma_f32_16x16x32_bf16 v[4:7], a[192:195], v[148:151], v[4:7]
    ds_read_b128 v[164:167], v217 offset:16384
    v_mfma_f32_16x16x32_bf16 a[0:3], a[192:195], v[152:155], a[0:3]
    v_exp_f32 v83, v83
    v_mfma_f32_16x16x32_bf16 a[4:7], a[192:195], v[156:159], a[4:7]
    v_cvt_pk_bf16_f32 v137, v82, v83
    v_mfma_f32_16x16x32_bf16 v[8:11], a[196:199], v[144:147], v[8:11]
    v_exp_f32 v84, v84
    v_mfma_f32_16x16x32_bf16 v[12:15], a[196:199], v[148:151], v[12:15]
    ds_read_b128 v[168:171], v218 offset:16384
    v_mfma_f32_16x16x32_bf16 a[8:11], a[196:199], v[152:155], a[8:11]
    v_exp_f32 v85, v85
    v_mfma_f32_16x16x32_bf16 a[12:15], a[196:199], v[156:159], a[12:15]
    v_cvt_pk_bf16_f32 v138, v84, v85
    v_mfma_f32_16x16x32_bf16 v[16:19], a[200:203], v[144:147], v[16:19]
    v_exp_f32 v86, v86
    v_mfma_f32_16x16x32_bf16 v[20:23], a[200:203], v[148:151], v[20:23]
    ds_read_b128 v[172:175], v219 offset:16384
    v_mfma_f32_16x16x32_bf16 a[16:19], a[200:203], v[152:155], a[16:19]
    v_exp_f32 v87, v87
    v_mfma_f32_16x16x32_bf16 a[20:23], a[200:203], v[156:159], a[20:23]
    v_cvt_pk_bf16_f32 v139, v86, v87
    v_mfma_f32_16x16x32_bf16 v[24:27], a[204:207], v[144:147], v[24:27]
    v_exp_f32 v88, v88
    v_mfma_f32_16x16x32_bf16 v[28:31], a[204:207], v[148:151], v[28:31]
    ds_read_b128 v[176:179], v216 offset:20480
    v_mfma_f32_16x16x32_bf16 a[24:27], a[204:207], v[152:155], a[24:27]
    v_exp_f32 v89, v89
    v_mfma_f32_16x16x32_bf16 a[28:31], a[204:207], v[156:159], a[28:31]
    buffer_load_dwordx4 v235, s[12:15], s35 offen offset:1024 nt lds
    v_cvt_pk_bf16_f32 v140, v88, v89
    v_mfma_f32_16x16x32_bf16 v[32:35], a[208:211], v[144:147], v[32:35]
    v_exp_f32 v90, v90
    v_mfma_f32_16x16x32_bf16 v[36:39], a[208:211], v[148:151], v[36:39]
    ds_read_b128 v[180:183], v217 offset:20480
    v_mfma_f32_16x16x32_bf16 a[32:35], a[208:211], v[152:155], a[32:35]
    v_exp_f32 v91, v91
    v_mfma_f32_16x16x32_bf16 a[36:39], a[208:211], v[156:159], a[36:39]
    v_cvt_pk_bf16_f32 v141, v90, v91
    ds_read_b128 v[184:187], v218 offset:20480
    v_mfma_f32_16x16x32_bf16 v[40:43], a[212:215], v[144:147], v[40:43]
    v_mfma_f32_16x16x32_bf16 v[44:47], a[212:215], v[148:151], v[44:47]
    v_exp_f32 v92, v92
    ds_read_b128 v[188:191], v219 offset:20480
    v_mfma_f32_16x16x32_bf16 a[40:43], a[212:215], v[152:155], a[40:43]
    v_exp_f32 v93, v93
    v_mfma_f32_16x16x32_bf16 a[44:47], a[212:215], v[156:159], a[44:47]
    v_cvt_pk_bf16_f32 v142, v92, v93
    v_mfma_f32_16x16x32_bf16 v[48:51], a[216:219], v[144:147], v[48:51]
    v_exp_f32 v94, v94
    v_mfma_f32_16x16x32_bf16 v[52:55], a[216:219], v[148:151], v[52:55]
    v_mfma_f32_16x16x32_bf16 a[48:51], a[216:219], v[152:155], a[48:51]
    v_exp_f32 v95, v95
    v_mfma_f32_16x16x32_bf16 a[52:55], a[216:219], v[156:159], a[52:55]
    v_cvt_pk_bf16_f32 v143, v94, v95
    v_mfma_f32_16x16x32_bf16 v[56:59], a[220:223], v[144:147], v[56:59]
    v_mfma_f32_16x16x32_bf16 v[60:63], a[220:223], v[148:151], v[60:63]
    v_mfma_f32_16x16x32_bf16 a[56:59], a[220:223], v[152:155], a[56:59]
    v_mfma_f32_16x16x32_bf16 a[60:63], a[220:223], v[156:159], a[60:63]
    s_waitcnt lgkmcnt(0)
    v_pk_fma_f32 v[96:97], v[96:97], s[26:27], v[244:245] op_sel:[0,0,0] op_sel_hi:[1,0,0]
    v_pk_fma_f32 v[98:99], v[98:99], s[26:27], v[244:245] op_sel:[0,0,0] op_sel_hi:[1,0,0]
    v_pk_fma_f32 v[100:101], v[100:101], s[26:27], v[244:245] op_sel:[0,0,0] op_sel_hi:[1,0,0]
    v_pk_fma_f32 v[102:103], v[102:103], s[26:27], v[244:245] op_sel:[0,0,0] op_sel_hi:[1,0,0]
    v_pk_fma_f32 v[104:105], v[104:105], s[26:27], v[244:245] op_sel:[0,0,1] op_sel_hi:[1,0,1]
    v_pk_fma_f32 v[106:107], v[106:107], s[26:27], v[244:245] op_sel:[0,0,1] op_sel_hi:[1,0,1]
    v_pk_fma_f32 v[108:109], v[108:109], s[26:27], v[244:245] op_sel:[0,0,1] op_sel_hi:[1,0,1]
    v_pk_fma_f32 v[110:111], v[110:111], s[26:27], v[244:245] op_sel:[0,0,1] op_sel_hi:[1,0,1]
    v_pk_fma_f32 v[112:113], v[112:113], s[26:27], v[246:247] op_sel:[0,0,0] op_sel_hi:[1,0,0]
    v_pk_fma_f32 v[114:115], v[114:115], s[26:27], v[246:247] op_sel:[0,0,0] op_sel_hi:[1,0,0]
    v_pk_fma_f32 v[116:117], v[116:117], s[26:27], v[246:247] op_sel:[0,0,0] op_sel_hi:[1,0,0]
    v_pk_fma_f32 v[118:119], v[118:119], s[26:27], v[246:247] op_sel:[0,0,0] op_sel_hi:[1,0,0]
    v_pk_fma_f32 v[120:121], v[120:121], s[26:27], v[246:247] op_sel:[0,0,1] op_sel_hi:[1,0,1]
    v_pk_fma_f32 v[122:123], v[122:123], s[26:27], v[246:247] op_sel:[0,0,1] op_sel_hi:[1,0,1]
    v_pk_fma_f32 v[124:125], v[124:125], s[26:27], v[246:247] op_sel:[0,0,1] op_sel_hi:[1,0,1]
    v_pk_fma_f32 v[126:127], v[126:127], s[26:27], v[246:247] op_sel:[0,0,1] op_sel_hi:[1,0,1]
    s_nop 1
    v_mfma_f32_16x16x32_bf16 v[64:67], v[160:163], a[128:131], 0
    v_mfma_f32_16x16x32_bf16 v[72:75], v[160:163], a[144:147], 0
    v_exp_f32 v96, v96
    ds_read_b64_tr_b16 a[192:193], v224 offset:0
    v_mfma_f32_16x16x32_bf16 v[80:83], v[160:163], a[160:163], 0
    v_exp_f32 v97, v97
    v_mfma_f32_16x16x32_bf16 v[88:91], v[160:163], a[176:179], 0
    s_add_u32 m0, s25, 0
    v_cvt_pk_bf16_f32 v144, v96, v97
    ds_read_b64_tr_b16 a[194:195], v224 offset:4096
    v_mfma_f32_16x16x32_bf16 v[64:67], v[164:167], a[132:135], v[64:67]
    s_add_u32 s35, s21, 49152
    v_exp_f32 v98, v98
    ds_read_b64_tr_b16 a[196:197], v225 offset:0
    v_mfma_f32_16x16x32_bf16 v[72:75], v[164:167], a[148:151], v[72:75]
    ds_read_b64_tr_b16 a[198:199], v225 offset:4096
    buffer_load_dwordx4 v232, s[8:11], s35 offen nt lds
    v_mfma_f32_16x16x32_bf16 v[80:83], v[164:167], a[164:167], v[80:83]
    v_exp_f32 v99, v99
    v_mfma_f32_16x16x32_bf16 v[88:91], v[164:167], a[180:183], v[88:91]
    v_cvt_pk_bf16_f32 v145, v98, v99
    ds_read_b64_tr_b16 a[200:201], v226 offset:0
    v_mfma_f32_16x16x32_bf16 v[64:67], v[168:171], a[136:139], v[64:67]
    v_exp_f32 v100, v100
    v_mfma_f32_16x16x32_bf16 v[72:75], v[168:171], a[152:155], v[72:75]
    ds_read_b64_tr_b16 a[202:203], v226 offset:4096
    v_mfma_f32_16x16x32_bf16 v[80:83], v[168:171], a[168:171], v[80:83]
    v_exp_f32 v101, v101
    v_mfma_f32_16x16x32_bf16 v[88:91], v[168:171], a[184:187], v[88:91]
    v_cvt_pk_bf16_f32 v146, v100, v101
    ds_read_b64_tr_b16 a[204:205], v227 offset:0
    v_mfma_f32_16x16x32_bf16 v[64:67], v[172:175], a[140:143], v[64:67]
    v_exp_f32 v102, v102
    v_mfma_f32_16x16x32_bf16 v[72:75], v[172:175], a[156:159], v[72:75]
    ds_read_b64_tr_b16 a[206:207], v227 offset:4096
    v_mfma_f32_16x16x32_bf16 v[80:83], v[172:175], a[172:175], v[80:83]
    v_exp_f32 v103, v103
    ds_read_b64_tr_b16 a[208:209], v228 offset:0
    v_mfma_f32_16x16x32_bf16 v[88:91], v[172:175], a[188:191], v[88:91]
    v_cvt_pk_bf16_f32 v147, v102, v103
    ds_read_b64_tr_b16 a[210:211], v228 offset:4096
    v_mfma_f32_16x16x32_bf16 v[68:71], v[176:179], a[128:131], 0
    v_exp_f32 v104, v104
    v_mfma_f32_16x16x32_bf16 v[76:79], v[176:179], a[144:147], 0
    ds_read_b64_tr_b16 a[212:213], v229 offset:0
    v_mfma_f32_16x16x32_bf16 v[84:87], v[176:179], a[160:163], 0
    buffer_load_dwordx4 v233, s[8:11], s35 offen offset:1024 nt lds
    v_exp_f32 v105, v105
    v_mfma_f32_16x16x32_bf16 v[92:95], v[176:179], a[176:179], 0
    v_cvt_pk_bf16_f32 v148, v104, v105
    ds_read_b64_tr_b16 a[214:215], v229 offset:4096
    v_mfma_f32_16x16x32_bf16 v[68:71], v[180:183], a[132:135], v[68:71]
    v_exp_f32 v106, v106
    v_mfma_f32_16x16x32_bf16 v[76:79], v[180:183], a[148:151], v[76:79]
    ds_read_b64_tr_b16 a[216:217], v230 offset:0
    v_mfma_f32_16x16x32_bf16 v[84:87], v[180:183], a[164:167], v[84:87]
    v_exp_f32 v107, v107
    ds_read_b64_tr_b16 a[218:219], v230 offset:4096
    v_mfma_f32_16x16x32_bf16 v[92:95], v[180:183], a[180:183], v[92:95]
    v_cvt_pk_bf16_f32 v149, v106, v107
    ds_read_b64_tr_b16 a[220:221], v231 offset:0
    v_mfma_f32_16x16x32_bf16 v[68:71], v[184:187], a[136:139], v[68:71]
    v_exp_f32 v108, v108
    v_mfma_f32_16x16x32_bf16 v[76:79], v[184:187], a[152:155], v[76:79]
    ds_read_b64_tr_b16 a[222:223], v231 offset:4096
    v_mfma_f32_16x16x32_bf16 v[84:87], v[184:187], a[168:171], v[84:87]
    v_exp_f32 v109, v109
    v_mfma_f32_16x16x32_bf16 v[92:95], v[184:187], a[184:187], v[92:95]
    v_cvt_pk_bf16_f32 v150, v108, v109
    v_mfma_f32_16x16x32_bf16 v[68:71], v[188:191], a[140:143], v[68:71]
    v_exp_f32 v110, v110
    v_mfma_f32_16x16x32_bf16 v[76:79], v[188:191], a[156:159], v[76:79]
    v_mfma_f32_16x16x32_bf16 v[84:87], v[188:191], a[172:175], v[84:87]
    v_exp_f32 v111, v111
    v_mfma_f32_16x16x32_bf16 v[92:95], v[188:191], a[188:191], v[92:95]
    v_cvt_pk_bf16_f32 v151, v110, v111
    s_waitcnt vmcnt(4) lgkmcnt(0)
    s_barrier
    v_mfma_f32_16x16x32_bf16 a[224:227], a[240:243], v[128:131], a[224:227]
    v_exp_f32 v112, v112
    v_mfma_f32_16x16x32_bf16 a[228:231], a[240:243], v[132:135], a[228:231]
    s_add_u32 m0, s29, 2048
    ds_read_b128 v[160:163], v216 offset:24576
    v_mfma_f32_16x16x32_bf16 a[232:235], a[240:243], v[136:139], a[232:235]
    s_add_u32 s35, s23, 18432
    v_exp_f32 v113, v113
    v_mfma_f32_16x16x32_bf16 a[236:239], a[240:243], v[140:143], a[236:239]
    buffer_load_dwordx4 v238, s[4:7], s35 offen nt lds
    v_cvt_pk_bf16_f32 v152, v112, v113
    v_mfma_f32_16x16x32_bf16 v[0:3], a[192:195], v[128:131], v[0:3]
    v_exp_f32 v114, v114
    v_mfma_f32_16x16x32_bf16 v[4:7], a[192:195], v[132:135], v[4:7]
    ds_read_b128 v[164:167], v217 offset:24576
    v_mfma_f32_16x16x32_bf16 a[0:3], a[192:195], v[136:139], a[0:3]
    v_exp_f32 v115, v115
    v_mfma_f32_16x16x32_bf16 a[4:7], a[192:195], v[140:143], a[4:7]
    v_cvt_pk_bf16_f32 v153, v114, v115
    v_mfma_f32_16x16x32_bf16 v[8:11], a[196:199], v[128:131], v[8:11]
    v_exp_f32 v116, v116
    v_mfma_f32_16x16x32_bf16 v[12:15], a[196:199], v[132:135], v[12:15]
    ds_read_b128 v[168:171], v218 offset:24576
    v_mfma_f32_16x16x32_bf16 a[8:11], a[196:199], v[136:139], a[8:11]
    v_exp_f32 v117, v117
    v_mfma_f32_16x16x32_bf16 a[12:15], a[196:199], v[140:143], a[12:15]
    buffer_load_dwordx4 v239, s[4:7], s35 offen offset:1024 nt lds
    v_cvt_pk_bf16_f32 v154, v116, v117
    v_mfma_f32_16x16x32_bf16 v[16:19], a[200:203], v[128:131], v[16:19]
    v_exp_f32 v118, v118
    v_mfma_f32_16x16x32_bf16 v[20:23], a[200:203], v[132:135], v[20:23]
    ds_read_b128 v[172:175], v219 offset:24576
    v_mfma_f32_16x16x32_bf16 a[16:19], a[200:203], v[136:139], a[16:19]
    v_exp_f32 v119, v119
    v_mfma_f32_16x16x32_bf16 a[20:23], a[200:203], v[140:143], a[20:23]
    v_cvt_pk_bf16_f32 v155, v118, v119
    v_mfma_f32_16x16x32_bf16 v[24:27], a[204:207], v[128:131], v[24:27]
    v_exp_f32 v120, v120
    v_mfma_f32_16x16x32_bf16 v[28:31], a[204:207], v[132:135], v[28:31]
    s_add_u32 m0, s25, 57344
    ds_read_b128 v[176:179], v216 offset:28672
    v_mfma_f32_16x16x32_bf16 a[24:27], a[204:207], v[136:139], a[24:27]
    s_add_u32 s35, s21, 45056
    v_exp_f32 v121, v121
    v_mfma_f32_16x16x32_bf16 a[28:31], a[204:207], v[140:143], a[28:31]
    buffer_load_dwordx4 v234, s[12:15], s35 offen nt lds
    v_cvt_pk_bf16_f32 v156, v120, v121
    v_mfma_f32_16x16x32_bf16 v[32:35], a[208:211], v[128:131], v[32:35]
    v_exp_f32 v122, v122
    v_mfma_f32_16x16x32_bf16 v[36:39], a[208:211], v[132:135], v[36:39]
    ds_read_b128 v[180:183], v217 offset:28672
    v_mfma_f32_16x16x32_bf16 a[32:35], a[208:211], v[136:139], a[32:35]
    v_exp_f32 v123, v123
    v_mfma_f32_16x16x32_bf16 a[36:39], a[208:211], v[140:143], a[36:39]
    v_cvt_pk_bf16_f32 v157, v122, v123
    ds_read_b128 v[184:187], v218 offset:28672
    v_mfma_f32_16x16x32_bf16 v[40:43], a[212:215], v[128:131], v[40:43]
    v_exp_f32 v124, v124
    v_mfma_f32_16x16x32_bf16 v[44:47], a[212:215], v[132:135], v[44:47]
    ds_read_b128 v[188:191], v219 offset:28672
    v_mfma_f32_16x16x32_bf16 a[40:43], a[212:215], v[136:139], a[40:43]
    v_exp_f32 v125, v125
    v_mfma_f32_16x16x32_bf16 a[44:47], a[212:215], v[140:143], a[44:47]
    buffer_load_dwordx4 v235, s[12:15], s35 offen offset:1024 nt lds
    v_cvt_pk_bf16_f32 v158, v124, v125
    v_mfma_f32_16x16x32_bf16 v[48:51], a[216:219], v[128:131], v[48:51]
    v_exp_f32 v126, v126
    v_mfma_f32_16x16x32_bf16 v[52:55], a[216:219], v[132:135], v[52:55]
    v_mfma_f32_16x16x32_bf16 a[48:51], a[216:219], v[136:139], a[48:51]
    v_exp_f32 v127, v127
    v_mfma_f32_16x16x32_bf16 a[52:55], a[216:219], v[140:143], a[52:55]
    v_cvt_pk_bf16_f32 v159, v126, v127
    v_mfma_f32_16x16x32_bf16 v[56:59], a[220:223], v[128:131], v[56:59]
    v_mfma_f32_16x16x32_bf16 v[60:63], a[220:223], v[132:135], v[60:63]
    v_mfma_f32_16x16x32_bf16 a[56:59], a[220:223], v[136:139], a[56:59]
    v_mfma_f32_16x16x32_bf16 a[60:63], a[220:223], v[140:143], a[60:63]
    s_waitcnt lgkmcnt(0)
    v_pk_fma_f32 v[64:65], v[64:65], s[26:27], v[244:245] op_sel:[0,0,0] op_sel_hi:[1,0,0]
    v_pk_fma_f32 v[66:67], v[66:67], s[26:27], v[244:245] op_sel:[0,0,0] op_sel_hi:[1,0,0]
    v_pk_fma_f32 v[68:69], v[68:69], s[26:27], v[244:245] op_sel:[0,0,0] op_sel_hi:[1,0,0]
    v_pk_fma_f32 v[70:71], v[70:71], s[26:27], v[244:245] op_sel:[0,0,0] op_sel_hi:[1,0,0]
    v_pk_fma_f32 v[72:73], v[72:73], s[26:27], v[244:245] op_sel:[0,0,1] op_sel_hi:[1,0,1]
    v_pk_fma_f32 v[74:75], v[74:75], s[26:27], v[244:245] op_sel:[0,0,1] op_sel_hi:[1,0,1]
    v_pk_fma_f32 v[76:77], v[76:77], s[26:27], v[244:245] op_sel:[0,0,1] op_sel_hi:[1,0,1]
    v_pk_fma_f32 v[78:79], v[78:79], s[26:27], v[244:245] op_sel:[0,0,1] op_sel_hi:[1,0,1]
    v_pk_fma_f32 v[80:81], v[80:81], s[26:27], v[246:247] op_sel:[0,0,0] op_sel_hi:[1,0,0]
    v_pk_fma_f32 v[82:83], v[82:83], s[26:27], v[246:247] op_sel:[0,0,0] op_sel_hi:[1,0,0]
    v_pk_fma_f32 v[84:85], v[84:85], s[26:27], v[246:247] op_sel:[0,0,0] op_sel_hi:[1,0,0]
    v_pk_fma_f32 v[86:87], v[86:87], s[26:27], v[246:247] op_sel:[0,0,0] op_sel_hi:[1,0,0]
    v_pk_fma_f32 v[88:89], v[88:89], s[26:27], v[246:247] op_sel:[0,0,1] op_sel_hi:[1,0,1]
    v_pk_fma_f32 v[90:91], v[90:91], s[26:27], v[246:247] op_sel:[0,0,1] op_sel_hi:[1,0,1]
    v_pk_fma_f32 v[92:93], v[92:93], s[26:27], v[246:247] op_sel:[0,0,1] op_sel_hi:[1,0,1]
    v_pk_fma_f32 v[94:95], v[94:95], s[26:27], v[246:247] op_sel:[0,0,1] op_sel_hi:[1,0,1]
    s_nop 1
    v_mfma_f32_16x16x32_bf16 v[96:99], v[160:163], a[128:131], 0
    v_mfma_f32_16x16x32_bf16 v[104:107], v[160:163], a[144:147], 0
    v_exp_f32 v64, v64
    ds_read_b64_tr_b16 a[192:193], v224 offset:8192
    v_mfma_f32_16x16x32_bf16 v[112:115], v[160:163], a[160:163], 0
    v_exp_f32 v65, v65
    v_mfma_f32_16x16x32_bf16 v[120:123], v[160:163], a[176:179], 0
    s_add_u32 m0, s25, 8192
    v_cvt_pk_bf16_f32 v128, v64, v65
    ds_read_b64_tr_b16 a[194:195], v224 offset:12288
    v_mfma_f32_16x16x32_bf16 v[96:99], v[164:167], a[132:135], v[96:99]
    s_add_u32 s35, s21, 53248
    v_exp_f32 v66, v66
    ds_read_b64_tr_b16 a[196:197], v225 offset:8192
    v_mfma_f32_16x16x32_bf16 v[104:107], v[164:167], a[148:151], v[104:107]
    ds_read_b64_tr_b16 a[198:199], v225 offset:12288
    buffer_load_dwordx4 v232, s[8:11], s35 offen nt lds
    v_mfma_f32_16x16x32_bf16 v[112:115], v[164:167], a[164:167], v[112:115]
    v_exp_f32 v67, v67
    v_mfma_f32_16x16x32_bf16 v[120:123], v[164:167], a[180:183], v[120:123]
    v_cvt_pk_bf16_f32 v129, v66, v67
    ds_read_b64_tr_b16 a[200:201], v226 offset:8192
    v_mfma_f32_16x16x32_bf16 v[96:99], v[168:171], a[136:139], v[96:99]
    v_mfma_f32_16x16x32_bf16 v[104:107], v[168:171], a[152:155], v[104:107]
    v_exp_f32 v68, v68
    ds_read_b64_tr_b16 a[202:203], v226 offset:12288
    v_mfma_f32_16x16x32_bf16 v[112:115], v[168:171], a[168:171], v[112:115]
    v_exp_f32 v69, v69
    v_mfma_f32_16x16x32_bf16 v[120:123], v[168:171], a[184:187], v[120:123]
    v_cvt_pk_bf16_f32 v130, v68, v69
    ds_read_b64_tr_b16 a[204:205], v227 offset:8192
    v_mfma_f32_16x16x32_bf16 v[96:99], v[172:175], a[140:143], v[96:99]
    v_exp_f32 v70, v70
    v_mfma_f32_16x16x32_bf16 v[104:107], v[172:175], a[156:159], v[104:107]
    ds_read_b64_tr_b16 a[206:207], v227 offset:12288
    v_mfma_f32_16x16x32_bf16 v[112:115], v[172:175], a[172:175], v[112:115]
    v_exp_f32 v71, v71
    ds_read_b64_tr_b16 a[208:209], v228 offset:8192
    v_mfma_f32_16x16x32_bf16 v[120:123], v[172:175], a[188:191], v[120:123]
    v_cvt_pk_bf16_f32 v131, v70, v71
    ds_read_b64_tr_b16 a[210:211], v228 offset:12288
    v_mfma_f32_16x16x32_bf16 v[100:103], v[176:179], a[128:131], 0
    v_exp_f32 v72, v72
    v_mfma_f32_16x16x32_bf16 v[108:111], v[176:179], a[144:147], 0
    ds_read_b64_tr_b16 a[212:213], v229 offset:8192
    v_mfma_f32_16x16x32_bf16 v[116:119], v[176:179], a[160:163], 0
    buffer_load_dwordx4 v233, s[8:11], s35 offen offset:1024 nt lds
    v_exp_f32 v73, v73
    v_mfma_f32_16x16x32_bf16 v[124:127], v[176:179], a[176:179], 0
    v_cvt_pk_bf16_f32 v132, v72, v73
    ds_read_b64_tr_b16 a[214:215], v229 offset:12288
    v_mfma_f32_16x16x32_bf16 v[100:103], v[180:183], a[132:135], v[100:103]
    v_exp_f32 v74, v74
    v_mfma_f32_16x16x32_bf16 v[108:111], v[180:183], a[148:151], v[108:111]
    ds_read_b64_tr_b16 a[216:217], v230 offset:8192
    v_mfma_f32_16x16x32_bf16 v[116:119], v[180:183], a[164:167], v[116:119]
    v_exp_f32 v75, v75
    ds_read_b64_tr_b16 a[218:219], v230 offset:12288
    v_mfma_f32_16x16x32_bf16 v[124:127], v[180:183], a[180:183], v[124:127]
    v_cvt_pk_bf16_f32 v133, v74, v75
    ds_read_b64_tr_b16 a[220:221], v231 offset:8192
    v_mfma_f32_16x16x32_bf16 v[100:103], v[184:187], a[136:139], v[100:103]
    v_exp_f32 v76, v76
    v_mfma_f32_16x16x32_bf16 v[108:111], v[184:187], a[152:155], v[108:111]
    ds_read_b64_tr_b16 a[222:223], v231 offset:12288
    v_mfma_f32_16x16x32_bf16 v[116:119], v[184:187], a[168:171], v[116:119]
    v_exp_f32 v77, v77
    v_mfma_f32_16x16x32_bf16 v[124:127], v[184:187], a[184:187], v[124:127]
    v_cvt_pk_bf16_f32 v134, v76, v77
    v_mfma_f32_16x16x32_bf16 v[100:103], v[188:191], a[140:143], v[100:103]
    v_mfma_f32_16x16x32_bf16 v[108:111], v[188:191], a[156:159], v[108:111]
    v_exp_f32 v78, v78
    v_mfma_f32_16x16x32_bf16 v[116:119], v[188:191], a[172:175], v[116:119]
    v_exp_f32 v79, v79
    v_mfma_f32_16x16x32_bf16 v[124:127], v[188:191], a[188:191], v[124:127]
    v_cvt_pk_bf16_f32 v135, v78, v79
    s_waitcnt vmcnt(6) lgkmcnt(0)
    s_barrier
    v_mfma_f32_16x16x32_bf16 a[224:227], a[240:243], v[144:147], a[224:227]
    v_exp_f32 v80, v80
    v_mfma_f32_16x16x32_bf16 a[228:231], a[240:243], v[148:151], a[228:231]
    s_add_u32 m0, s25, 32768
    ds_read_b128 v[160:163], v216 offset:0
    v_mfma_f32_16x16x32_bf16 a[232:235], a[240:243], v[152:155], a[232:235]
    s_add_u32 s35, s21, 49152
    v_exp_f32 v81, v81
    v_mfma_f32_16x16x32_bf16 a[236:239], a[240:243], v[156:159], a[236:239]
    buffer_load_dwordx4 v234, s[12:15], s35 offen nt lds
    v_cvt_pk_bf16_f32 v136, v80, v81
    v_mfma_f32_16x16x32_bf16 v[0:3], a[192:195], v[144:147], v[0:3]
    v_exp_f32 v82, v82
    v_mfma_f32_16x16x32_bf16 v[4:7], a[192:195], v[148:151], v[4:7]
    ds_read_b128 v[164:167], v217 offset:0
    v_mfma_f32_16x16x32_bf16 a[0:3], a[192:195], v[152:155], a[0:3]
    v_exp_f32 v83, v83
    v_mfma_f32_16x16x32_bf16 a[4:7], a[192:195], v[156:159], a[4:7]
    v_cvt_pk_bf16_f32 v137, v82, v83
    v_mfma_f32_16x16x32_bf16 v[8:11], a[196:199], v[144:147], v[8:11]
    v_exp_f32 v84, v84
    v_mfma_f32_16x16x32_bf16 v[12:15], a[196:199], v[148:151], v[12:15]
    ds_read_b128 v[168:171], v218 offset:0
    v_mfma_f32_16x16x32_bf16 a[8:11], a[196:199], v[152:155], a[8:11]
    v_exp_f32 v85, v85
    v_mfma_f32_16x16x32_bf16 a[12:15], a[196:199], v[156:159], a[12:15]
    v_cvt_pk_bf16_f32 v138, v84, v85
    v_mfma_f32_16x16x32_bf16 v[16:19], a[200:203], v[144:147], v[16:19]
    v_exp_f32 v86, v86
    v_mfma_f32_16x16x32_bf16 v[20:23], a[200:203], v[148:151], v[20:23]
    ds_read_b128 v[172:175], v219 offset:0
    v_mfma_f32_16x16x32_bf16 a[16:19], a[200:203], v[152:155], a[16:19]
    v_exp_f32 v87, v87
    v_mfma_f32_16x16x32_bf16 a[20:23], a[200:203], v[156:159], a[20:23]
    v_cvt_pk_bf16_f32 v139, v86, v87
    v_mfma_f32_16x16x32_bf16 v[24:27], a[204:207], v[144:147], v[24:27]
    v_exp_f32 v88, v88
    v_mfma_f32_16x16x32_bf16 v[28:31], a[204:207], v[148:151], v[28:31]
    ds_read_b128 v[176:179], v216 offset:4096
    v_mfma_f32_16x16x32_bf16 a[24:27], a[204:207], v[152:155], a[24:27]
    v_exp_f32 v89, v89
    v_mfma_f32_16x16x32_bf16 a[28:31], a[204:207], v[156:159], a[28:31]
    buffer_load_dwordx4 v235, s[12:15], s35 offen offset:1024 nt lds
    v_cvt_pk_bf16_f32 v140, v88, v89
    v_mfma_f32_16x16x32_bf16 v[32:35], a[208:211], v[144:147], v[32:35]
    v_exp_f32 v90, v90
    v_mfma_f32_16x16x32_bf16 v[36:39], a[208:211], v[148:151], v[36:39]
    ds_read_b128 v[180:183], v217 offset:4096
    v_mfma_f32_16x16x32_bf16 a[32:35], a[208:211], v[152:155], a[32:35]
    v_exp_f32 v91, v91
    v_mfma_f32_16x16x32_bf16 a[36:39], a[208:211], v[156:159], a[36:39]
    v_cvt_pk_bf16_f32 v141, v90, v91
    ds_read_b128 v[184:187], v218 offset:4096
    v_mfma_f32_16x16x32_bf16 v[40:43], a[212:215], v[144:147], v[40:43]
    v_mfma_f32_16x16x32_bf16 v[44:47], a[212:215], v[148:151], v[44:47]
    v_exp_f32 v92, v92
    ds_read_b128 v[188:191], v219 offset:4096
    v_mfma_f32_16x16x32_bf16 a[40:43], a[212:215], v[152:155], a[40:43]
    v_exp_f32 v93, v93
    v_mfma_f32_16x16x32_bf16 a[44:47], a[212:215], v[156:159], a[44:47]
    v_cvt_pk_bf16_f32 v142, v92, v93
    v_mfma_f32_16x16x32_bf16 v[48:51], a[216:219], v[144:147], v[48:51]
    v_exp_f32 v94, v94
    v_mfma_f32_16x16x32_bf16 v[52:55], a[216:219], v[148:151], v[52:55]
    v_mfma_f32_16x16x32_bf16 a[48:51], a[216:219], v[152:155], a[48:51]
    v_exp_f32 v95, v95
    v_mfma_f32_16x16x32_bf16 a[52:55], a[216:219], v[156:159], a[52:55]
    v_cvt_pk_bf16_f32 v143, v94, v95
    v_mfma_f32_16x16x32_bf16 v[56:59], a[220:223], v[144:147], v[56:59]
    v_mfma_f32_16x16x32_bf16 v[60:63], a[220:223], v[148:151], v[60:63]
    v_mfma_f32_16x16x32_bf16 a[56:59], a[220:223], v[152:155], a[56:59]
    v_mfma_f32_16x16x32_bf16 a[60:63], a[220:223], v[156:159], a[60:63]
    s_waitcnt lgkmcnt(0)
    v_pk_fma_f32 v[96:97], v[96:97], s[26:27], v[244:245] op_sel:[0,0,0] op_sel_hi:[1,0,0]
    v_pk_fma_f32 v[98:99], v[98:99], s[26:27], v[244:245] op_sel:[0,0,0] op_sel_hi:[1,0,0]
    v_pk_fma_f32 v[100:101], v[100:101], s[26:27], v[244:245] op_sel:[0,0,0] op_sel_hi:[1,0,0]
    v_pk_fma_f32 v[102:103], v[102:103], s[26:27], v[244:245] op_sel:[0,0,0] op_sel_hi:[1,0,0]
    v_pk_fma_f32 v[104:105], v[104:105], s[26:27], v[244:245] op_sel:[0,0,1] op_sel_hi:[1,0,1]
    v_pk_fma_f32 v[106:107], v[106:107], s[26:27], v[244:245] op_sel:[0,0,1] op_sel_hi:[1,0,1]
    v_pk_fma_f32 v[108:109], v[108:109], s[26:27], v[244:245] op_sel:[0,0,1] op_sel_hi:[1,0,1]
    v_pk_fma_f32 v[110:111], v[110:111], s[26:27], v[244:245] op_sel:[0,0,1] op_sel_hi:[1,0,1]
    v_pk_fma_f32 v[112:113], v[112:113], s[26:27], v[246:247] op_sel:[0,0,0] op_sel_hi:[1,0,0]
    v_pk_fma_f32 v[114:115], v[114:115], s[26:27], v[246:247] op_sel:[0,0,0] op_sel_hi:[1,0,0]
    v_pk_fma_f32 v[116:117], v[116:117], s[26:27], v[246:247] op_sel:[0,0,0] op_sel_hi:[1,0,0]
    v_pk_fma_f32 v[118:119], v[118:119], s[26:27], v[246:247] op_sel:[0,0,0] op_sel_hi:[1,0,0]
    v_pk_fma_f32 v[120:121], v[120:121], s[26:27], v[246:247] op_sel:[0,0,1] op_sel_hi:[1,0,1]
    v_pk_fma_f32 v[122:123], v[122:123], s[26:27], v[246:247] op_sel:[0,0,1] op_sel_hi:[1,0,1]
    v_pk_fma_f32 v[124:125], v[124:125], s[26:27], v[246:247] op_sel:[0,0,1] op_sel_hi:[1,0,1]
    v_pk_fma_f32 v[126:127], v[126:127], s[26:27], v[246:247] op_sel:[0,0,1] op_sel_hi:[1,0,1]
    s_nop 1
    v_mfma_f32_16x16x32_bf16 v[64:67], v[160:163], a[128:131], 0
    v_mfma_f32_16x16x32_bf16 v[72:75], v[160:163], a[144:147], 0
    v_exp_f32 v96, v96
    ds_read_b64_tr_b16 a[192:193], v224 offset:16384
    v_mfma_f32_16x16x32_bf16 v[80:83], v[160:163], a[160:163], 0
    v_exp_f32 v97, v97
    v_mfma_f32_16x16x32_bf16 v[88:91], v[160:163], a[176:179], 0
    s_add_u32 m0, s25, 16384
    v_cvt_pk_bf16_f32 v144, v96, v97
    ds_read_b64_tr_b16 a[194:195], v224 offset:20480
    v_mfma_f32_16x16x32_bf16 v[64:67], v[164:167], a[132:135], v[64:67]
    s_add_u32 s35, s21, 57344
    v_exp_f32 v98, v98
    ds_read_b64_tr_b16 a[196:197], v225 offset:16384
    v_mfma_f32_16x16x32_bf16 v[72:75], v[164:167], a[148:151], v[72:75]
    ds_read_b64_tr_b16 a[198:199], v225 offset:20480
    buffer_load_dwordx4 v232, s[8:11], s35 offen nt lds
    v_mfma_f32_16x16x32_bf16 v[80:83], v[164:167], a[164:167], v[80:83]
    v_exp_f32 v99, v99
    v_mfma_f32_16x16x32_bf16 v[88:91], v[164:167], a[180:183], v[88:91]
    v_cvt_pk_bf16_f32 v145, v98, v99
    ds_read_b64_tr_b16 a[200:201], v226 offset:16384
    v_mfma_f32_16x16x32_bf16 v[64:67], v[168:171], a[136:139], v[64:67]
    v_mfma_f32_16x16x32_bf16 v[72:75], v[168:171], a[152:155], v[72:75]
    v_exp_f32 v100, v100
    ds_read_b64_tr_b16 a[202:203], v226 offset:20480
    v_mfma_f32_16x16x32_bf16 v[80:83], v[168:171], a[168:171], v[80:83]
    v_exp_f32 v101, v101
    v_mfma_f32_16x16x32_bf16 v[88:91], v[168:171], a[184:187], v[88:91]
    v_cvt_pk_bf16_f32 v146, v100, v101
    ds_read_b64_tr_b16 a[204:205], v227 offset:16384
    v_mfma_f32_16x16x32_bf16 v[64:67], v[172:175], a[140:143], v[64:67]
    v_exp_f32 v102, v102
    v_mfma_f32_16x16x32_bf16 v[72:75], v[172:175], a[156:159], v[72:75]
    ds_read_b64_tr_b16 a[206:207], v227 offset:20480
    v_mfma_f32_16x16x32_bf16 v[80:83], v[172:175], a[172:175], v[80:83]
    v_exp_f32 v103, v103
    ds_read_b64_tr_b16 a[208:209], v228 offset:16384
    v_mfma_f32_16x16x32_bf16 v[88:91], v[172:175], a[188:191], v[88:91]
    v_cvt_pk_bf16_f32 v147, v102, v103
    ds_read_b64_tr_b16 a[210:211], v228 offset:20480
    v_mfma_f32_16x16x32_bf16 v[68:71], v[176:179], a[128:131], 0
    v_exp_f32 v104, v104
    v_mfma_f32_16x16x32_bf16 v[76:79], v[176:179], a[144:147], 0
    ds_read_b64_tr_b16 a[212:213], v229 offset:16384
    v_mfma_f32_16x16x32_bf16 v[84:87], v[176:179], a[160:163], 0
    buffer_load_dwordx4 v233, s[8:11], s35 offen offset:1024 nt lds
    v_exp_f32 v105, v105
    v_mfma_f32_16x16x32_bf16 v[92:95], v[176:179], a[176:179], 0
    v_cvt_pk_bf16_f32 v148, v104, v105
    ds_read_b64_tr_b16 a[214:215], v229 offset:20480
    v_mfma_f32_16x16x32_bf16 v[68:71], v[180:183], a[132:135], v[68:71]
    v_exp_f32 v106, v106
    v_mfma_f32_16x16x32_bf16 v[76:79], v[180:183], a[148:151], v[76:79]
    ds_read_b64_tr_b16 a[216:217], v230 offset:16384
    v_mfma_f32_16x16x32_bf16 v[84:87], v[180:183], a[164:167], v[84:87]
    v_exp_f32 v107, v107
    ds_read_b64_tr_b16 a[218:219], v230 offset:20480
    v_mfma_f32_16x16x32_bf16 v[92:95], v[180:183], a[180:183], v[92:95]
    v_cvt_pk_bf16_f32 v149, v106, v107
    ds_read_b64_tr_b16 a[220:221], v231 offset:16384
    v_mfma_f32_16x16x32_bf16 v[68:71], v[184:187], a[136:139], v[68:71]
    v_exp_f32 v108, v108
    v_mfma_f32_16x16x32_bf16 v[76:79], v[184:187], a[152:155], v[76:79]
    ds_read_b64_tr_b16 a[222:223], v231 offset:20480
    v_mfma_f32_16x16x32_bf16 v[84:87], v[184:187], a[168:171], v[84:87]
    v_exp_f32 v109, v109
    v_mfma_f32_16x16x32_bf16 v[92:95], v[184:187], a[184:187], v[92:95]
    v_cvt_pk_bf16_f32 v150, v108, v109
    v_mfma_f32_16x16x32_bf16 v[68:71], v[188:191], a[140:143], v[68:71]
    v_mfma_f32_16x16x32_bf16 v[76:79], v[188:191], a[156:159], v[76:79]
    v_mfma_f32_16x16x32_bf16 v[84:87], v[188:191], a[172:175], v[84:87]
    v_exp_f32 v110, v110
    v_exp_f32 v111, v111
    v_mfma_f32_16x16x32_bf16 v[92:95], v[188:191], a[188:191], v[92:95]
    v_cvt_pk_bf16_f32 v151, v110, v111
    s_waitcnt vmcnt(4) lgkmcnt(0)
    s_barrier
    v_mfma_f32_16x16x32_bf16 a[224:227], a[240:243], v[128:131], a[224:227]
    v_exp_f32 v112, v112
    v_mfma_f32_16x16x32_bf16 a[228:231], a[240:243], v[132:135], a[228:231]
    s_add_u32 m0, s29, 4096
    ds_read_b128 v[160:163], v216 offset:8192
    v_mfma_f32_16x16x32_bf16 a[232:235], a[240:243], v[136:139], a[232:235]
    s_add_u32 s35, s23, 20480
    v_exp_f32 v113, v113
    v_mfma_f32_16x16x32_bf16 a[236:239], a[240:243], v[140:143], a[236:239]
    buffer_load_dwordx4 v236, s[4:7], s35 offen nt lds
    v_cvt_pk_bf16_f32 v152, v112, v113
    v_mfma_f32_16x16x32_bf16 v[0:3], a[192:195], v[128:131], v[0:3]
    v_mfma_f32_16x16x32_bf16 v[4:7], a[192:195], v[132:135], v[4:7]
    v_exp_f32 v114, v114
    ds_read_b128 v[164:167], v217 offset:8192
    v_mfma_f32_16x16x32_bf16 a[0:3], a[192:195], v[136:139], a[0:3]
    v_exp_f32 v115, v115
    v_mfma_f32_16x16x32_bf16 a[4:7], a[192:195], v[140:143], a[4:7]
    v_cvt_pk_bf16_f32 v153, v114, v115
    v_mfma_f32_16x16x32_bf16 v[8:11], a[196:199], v[128:131], v[8:11]
    v_exp_f32 v116, v116
    v_mfma_f32_16x16x32_bf16 v[12:15], a[196:199], v[132:135], v[12:15]
    ds_read_b128 v[168:171], v218 offset:8192
    v_mfma_f32_16x16x32_bf16 a[8:11], a[196:199], v[136:139], a[8:11]
    v_exp_f32 v117, v117
    v_mfma_f32_16x16x32_bf16 a[12:15], a[196:199], v[140:143], a[12:15]
    buffer_load_dwordx4 v237, s[4:7], s35 offen offset:1024 nt lds
    v_cvt_pk_bf16_f32 v154, v116, v117
    v_mfma_f32_16x16x32_bf16 v[16:19], a[200:203], v[128:131], v[16:19]
    v_exp_f32 v118, v118
    v_mfma_f32_16x16x32_bf16 v[20:23], a[200:203], v[132:135], v[20:23]
    ds_read_b128 v[172:175], v219 offset:8192
    v_mfma_f32_16x16x32_bf16 a[16:19], a[200:203], v[136:139], a[16:19]
    v_exp_f32 v119, v119
    v_mfma_f32_16x16x32_bf16 a[20:23], a[200:203], v[140:143], a[20:23]
    v_cvt_pk_bf16_f32 v155, v118, v119
    v_mfma_f32_16x16x32_bf16 v[24:27], a[204:207], v[128:131], v[24:27]
    v_exp_f32 v120, v120
    v_mfma_f32_16x16x32_bf16 v[28:31], a[204:207], v[132:135], v[28:31]
    s_add_u32 m0, s25, 40960
    ds_read_b128 v[176:179], v216 offset:12288
    v_mfma_f32_16x16x32_bf16 a[24:27], a[204:207], v[136:139], a[24:27]
    s_add_u32 s35, s21, 53248
    v_exp_f32 v121, v121
    v_mfma_f32_16x16x32_bf16 a[28:31], a[204:207], v[140:143], a[28:31]
    buffer_load_dwordx4 v234, s[12:15], s35 offen nt lds
    v_cvt_pk_bf16_f32 v156, v120, v121
    v_mfma_f32_16x16x32_bf16 v[32:35], a[208:211], v[128:131], v[32:35]
    v_exp_f32 v122, v122
    v_mfma_f32_16x16x32_bf16 v[36:39], a[208:211], v[132:135], v[36:39]
    ds_read_b128 v[180:183], v217 offset:12288
    v_mfma_f32_16x16x32_bf16 a[32:35], a[208:211], v[136:139], a[32:35]
    v_exp_f32 v123, v123
    v_mfma_f32_16x16x32_bf16 a[36:39], a[208:211], v[140:143], a[36:39]
    v_cvt_pk_bf16_f32 v157, v122, v123
    ds_read_b128 v[184:187], v218 offset:12288
    v_mfma_f32_16x16x32_bf16 v[40:43], a[212:215], v[128:131], v[40:43]
    v_mfma_f32_16x16x32_bf16 v[44:47], a[212:215], v[132:135], v[44:47]
    v_exp_f32 v124, v124
    ds_read_b128 v[188:191], v219 offset:12288
    v_mfma_f32_16x16x32_bf16 a[40:43], a[212:215], v[136:139], a[40:43]
    v_exp_f32 v125, v125
    v_mfma_f32_16x16x32_bf16 a[44:47], a[212:215], v[140:143], a[44:47]
    buffer_load_dwordx4 v235, s[12:15], s35 offen offset:1024 nt lds
    v_cvt_pk_bf16_f32 v158, v124, v125
    v_mfma_f32_16x16x32_bf16 v[48:51], a[216:219], v[128:131], v[48:51]
    v_exp_f32 v126, v126
    v_mfma_f32_16x16x32_bf16 v[52:55], a[216:219], v[132:135], v[52:55]
    v_mfma_f32_16x16x32_bf16 a[48:51], a[216:219], v[136:139], a[48:51]
    v_exp_f32 v127, v127
    v_mfma_f32_16x16x32_bf16 a[52:55], a[216:219], v[140:143], a[52:55]
    v_cvt_pk_bf16_f32 v159, v126, v127
    v_mfma_f32_16x16x32_bf16 v[56:59], a[220:223], v[128:131], v[56:59]
    v_mfma_f32_16x16x32_bf16 v[60:63], a[220:223], v[132:135], v[60:63]
    v_mfma_f32_16x16x32_bf16 a[56:59], a[220:223], v[136:139], a[56:59]
    v_mfma_f32_16x16x32_bf16 a[60:63], a[220:223], v[140:143], a[60:63]
    s_waitcnt lgkmcnt(0)
    v_pk_fma_f32 v[64:65], v[64:65], s[26:27], v[244:245] op_sel:[0,0,0] op_sel_hi:[1,0,0]
    v_pk_fma_f32 v[66:67], v[66:67], s[26:27], v[244:245] op_sel:[0,0,0] op_sel_hi:[1,0,0]
    v_pk_fma_f32 v[68:69], v[68:69], s[26:27], v[244:245] op_sel:[0,0,0] op_sel_hi:[1,0,0]
    v_pk_fma_f32 v[70:71], v[70:71], s[26:27], v[244:245] op_sel:[0,0,0] op_sel_hi:[1,0,0]
    v_pk_fma_f32 v[72:73], v[72:73], s[26:27], v[244:245] op_sel:[0,0,1] op_sel_hi:[1,0,1]
    v_pk_fma_f32 v[74:75], v[74:75], s[26:27], v[244:245] op_sel:[0,0,1] op_sel_hi:[1,0,1]
    v_pk_fma_f32 v[76:77], v[76:77], s[26:27], v[244:245] op_sel:[0,0,1] op_sel_hi:[1,0,1]
    v_pk_fma_f32 v[78:79], v[78:79], s[26:27], v[244:245] op_sel:[0,0,1] op_sel_hi:[1,0,1]
    v_pk_fma_f32 v[80:81], v[80:81], s[26:27], v[246:247] op_sel:[0,0,0] op_sel_hi:[1,0,0]
    v_pk_fma_f32 v[82:83], v[82:83], s[26:27], v[246:247] op_sel:[0,0,0] op_sel_hi:[1,0,0]
    v_pk_fma_f32 v[84:85], v[84:85], s[26:27], v[246:247] op_sel:[0,0,0] op_sel_hi:[1,0,0]
    v_pk_fma_f32 v[86:87], v[86:87], s[26:27], v[246:247] op_sel:[0,0,0] op_sel_hi:[1,0,0]
    v_pk_fma_f32 v[88:89], v[88:89], s[26:27], v[246:247] op_sel:[0,0,1] op_sel_hi:[1,0,1]
    v_pk_fma_f32 v[90:91], v[90:91], s[26:27], v[246:247] op_sel:[0,0,1] op_sel_hi:[1,0,1]
    v_pk_fma_f32 v[92:93], v[92:93], s[26:27], v[246:247] op_sel:[0,0,1] op_sel_hi:[1,0,1]
    v_pk_fma_f32 v[94:95], v[94:95], s[26:27], v[246:247] op_sel:[0,0,1] op_sel_hi:[1,0,1]
    s_nop 1
    v_mfma_f32_16x16x32_bf16 v[96:99], v[160:163], a[128:131], 0
    v_mfma_f32_16x16x32_bf16 v[104:107], v[160:163], a[144:147], 0
    v_exp_f32 v64, v64
    ds_read_b64_tr_b16 a[192:193], v224 offset:24576
    v_mfma_f32_16x16x32_bf16 v[112:115], v[160:163], a[160:163], 0
    v_exp_f32 v65, v65
    v_mfma_f32_16x16x32_bf16 v[120:123], v[160:163], a[176:179], 0
    s_add_u32 m0, s25, 24576
    v_cvt_pk_bf16_f32 v128, v64, v65
    ds_read_b64_tr_b16 a[194:195], v224 offset:28672
    v_mfma_f32_16x16x32_bf16 v[96:99], v[164:167], a[132:135], v[96:99]
    s_add_u32 s35, s21, 61440
    v_exp_f32 v66, v66
    ds_read_b64_tr_b16 a[196:197], v225 offset:24576
    v_mfma_f32_16x16x32_bf16 v[104:107], v[164:167], a[148:151], v[104:107]
    ds_read_b64_tr_b16 a[198:199], v225 offset:28672
    buffer_load_dwordx4 v232, s[8:11], s35 offen nt lds
    v_mfma_f32_16x16x32_bf16 v[112:115], v[164:167], a[164:167], v[112:115]
    v_exp_f32 v67, v67
    v_mfma_f32_16x16x32_bf16 v[120:123], v[164:167], a[180:183], v[120:123]
    v_cvt_pk_bf16_f32 v129, v66, v67
    ds_read_b64_tr_b16 a[200:201], v226 offset:24576
    v_mfma_f32_16x16x32_bf16 v[96:99], v[168:171], a[136:139], v[96:99]
    v_mfma_f32_16x16x32_bf16 v[104:107], v[168:171], a[152:155], v[104:107]
    v_exp_f32 v68, v68
    ds_read_b64_tr_b16 a[202:203], v226 offset:28672
    v_mfma_f32_16x16x32_bf16 v[112:115], v[168:171], a[168:171], v[112:115]
    v_exp_f32 v69, v69
    v_mfma_f32_16x16x32_bf16 v[120:123], v[168:171], a[184:187], v[120:123]
    v_cvt_pk_bf16_f32 v130, v68, v69
    ds_read_b64_tr_b16 a[204:205], v227 offset:24576
    v_mfma_f32_16x16x32_bf16 v[96:99], v[172:175], a[140:143], v[96:99]
    v_exp_f32 v70, v70
    v_mfma_f32_16x16x32_bf16 v[104:107], v[172:175], a[156:159], v[104:107]
    ds_read_b64_tr_b16 a[206:207], v227 offset:28672
    v_mfma_f32_16x16x32_bf16 v[112:115], v[172:175], a[172:175], v[112:115]
    v_exp_f32 v71, v71
    ds_read_b64_tr_b16 a[208:209], v228 offset:24576
    v_mfma_f32_16x16x32_bf16 v[120:123], v[172:175], a[188:191], v[120:123]
    v_cvt_pk_bf16_f32 v131, v70, v71
    ds_read_b64_tr_b16 a[210:211], v228 offset:28672
    v_mfma_f32_16x16x32_bf16 v[100:103], v[176:179], a[128:131], 0
    v_exp_f32 v72, v72
    v_mfma_f32_16x16x32_bf16 v[108:111], v[176:179], a[144:147], 0
    ds_read_b64_tr_b16 a[212:213], v229 offset:24576
    v_mfma_f32_16x16x32_bf16 v[116:119], v[176:179], a[160:163], 0
    buffer_load_dwordx4 v233, s[8:11], s35 offen offset:1024 nt lds
    v_exp_f32 v73, v73
    v_mfma_f32_16x16x32_bf16 v[124:127], v[176:179], a[176:179], 0
    v_cvt_pk_bf16_f32 v132, v72, v73
    ds_read_b64_tr_b16 a[214:215], v229 offset:28672
    v_mfma_f32_16x16x32_bf16 v[100:103], v[180:183], a[132:135], v[100:103]
    v_exp_f32 v74, v74
    v_mfma_f32_16x16x32_bf16 v[108:111], v[180:183], a[148:151], v[108:111]
    ds_read_b64_tr_b16 a[216:217], v230 offset:24576
    v_mfma_f32_16x16x32_bf16 v[116:119], v[180:183], a[164:167], v[116:119]
    v_exp_f32 v75, v75
    ds_read_b64_tr_b16 a[218:219], v230 offset:28672
    v_mfma_f32_16x16x32_bf16 v[124:127], v[180:183], a[180:183], v[124:127]
    v_cvt_pk_bf16_f32 v133, v74, v75
    ds_read_b64_tr_b16 a[220:221], v231 offset:24576
    v_mfma_f32_16x16x32_bf16 v[100:103], v[184:187], a[136:139], v[100:103]
    v_exp_f32 v76, v76
    v_mfma_f32_16x16x32_bf16 v[108:111], v[184:187], a[152:155], v[108:111]
    ds_read_b64_tr_b16 a[222:223], v231 offset:28672
    v_mfma_f32_16x16x32_bf16 v[116:119], v[184:187], a[168:171], v[116:119]
    v_exp_f32 v77, v77
    v_mfma_f32_16x16x32_bf16 v[124:127], v[184:187], a[184:187], v[124:127]
    v_cvt_pk_bf16_f32 v134, v76, v77
    v_mfma_f32_16x16x32_bf16 v[100:103], v[188:191], a[140:143], v[100:103]
    v_mfma_f32_16x16x32_bf16 v[108:111], v[188:191], a[156:159], v[108:111]
    v_mfma_f32_16x16x32_bf16 v[116:119], v[188:191], a[172:175], v[116:119]
    v_exp_f32 v78, v78
    v_exp_f32 v79, v79
    v_mfma_f32_16x16x32_bf16 v[124:127], v[188:191], a[188:191], v[124:127]
    v_cvt_pk_bf16_f32 v135, v78, v79
    s_waitcnt vmcnt(6) lgkmcnt(0)
    s_barrier
    v_mfma_f32_16x16x32_bf16 a[224:227], a[240:243], v[144:147], a[224:227]
    v_exp_f32 v80, v80
    v_mfma_f32_16x16x32_bf16 a[228:231], a[240:243], v[148:151], a[228:231]
    s_add_u32 m0, s29, 6144
    ds_read_b128 v[160:163], v216 offset:16384
    v_mfma_f32_16x16x32_bf16 a[232:235], a[240:243], v[152:155], a[232:235]
    s_add_u32 s35, s23, 22528
    v_exp_f32 v81, v81
    v_mfma_f32_16x16x32_bf16 a[236:239], a[240:243], v[156:159], a[236:239]
    buffer_load_dwordx4 v238, s[4:7], s35 offen nt lds
    v_cvt_pk_bf16_f32 v136, v80, v81
    v_mfma_f32_16x16x32_bf16 v[0:3], a[192:195], v[144:147], v[0:3]
    v_mfma_f32_16x16x32_bf16 v[4:7], a[192:195], v[148:151], v[4:7]
    v_exp_f32 v82, v82
    ds_read_b128 v[164:167], v217 offset:16384
    v_mfma_f32_16x16x32_bf16 a[0:3], a[192:195], v[152:155], a[0:3]
    v_exp_f32 v83, v83
    v_mfma_f32_16x16x32_bf16 a[4:7], a[192:195], v[156:159], a[4:7]
    v_cvt_pk_bf16_f32 v137, v82, v83
    v_mfma_f32_16x16x32_bf16 v[8:11], a[196:199], v[144:147], v[8:11]
    v_exp_f32 v84, v84
    v_mfma_f32_16x16x32_bf16 v[12:15], a[196:199], v[148:151], v[12:15]
    ds_read_b128 v[168:171], v218 offset:16384
    v_mfma_f32_16x16x32_bf16 a[8:11], a[196:199], v[152:155], a[8:11]
    v_exp_f32 v85, v85
    v_mfma_f32_16x16x32_bf16 a[12:15], a[196:199], v[156:159], a[12:15]
    buffer_load_dwordx4 v239, s[4:7], s35 offen offset:1024 nt lds
    v_cvt_pk_bf16_f32 v138, v84, v85
    v_mfma_f32_16x16x32_bf16 v[16:19], a[200:203], v[144:147], v[16:19]
    v_exp_f32 v86, v86
    v_mfma_f32_16x16x32_bf16 v[20:23], a[200:203], v[148:151], v[20:23]
    ds_read_b128 v[172:175], v219 offset:16384
    v_mfma_f32_16x16x32_bf16 a[16:19], a[200:203], v[152:155], a[16:19]
    v_exp_f32 v87, v87
    v_mfma_f32_16x16x32_bf16 a[20:23], a[200:203], v[156:159], a[20:23]
    v_cvt_pk_bf16_f32 v139, v86, v87
    v_mfma_f32_16x16x32_bf16 v[24:27], a[204:207], v[144:147], v[24:27]
    v_exp_f32 v88, v88
    v_mfma_f32_16x16x32_bf16 v[28:31], a[204:207], v[148:151], v[28:31]
    s_add_u32 m0, s25, 49152
    ds_read_b128 v[176:179], v216 offset:20480
    v_mfma_f32_16x16x32_bf16 a[24:27], a[204:207], v[152:155], a[24:27]
    s_add_u32 s35, s21, 57344
    v_exp_f32 v89, v89
    v_mfma_f32_16x16x32_bf16 a[28:31], a[204:207], v[156:159], a[28:31]
    buffer_load_dwordx4 v234, s[12:15], s35 offen nt lds
    v_cvt_pk_bf16_f32 v140, v88, v89
    v_mfma_f32_16x16x32_bf16 v[32:35], a[208:211], v[144:147], v[32:35]
    v_exp_f32 v90, v90
    v_mfma_f32_16x16x32_bf16 v[36:39], a[208:211], v[148:151], v[36:39]
    ds_read_b128 v[180:183], v217 offset:20480
    v_mfma_f32_16x16x32_bf16 a[32:35], a[208:211], v[152:155], a[32:35]
    v_exp_f32 v91, v91
    v_mfma_f32_16x16x32_bf16 a[36:39], a[208:211], v[156:159], a[36:39]
    v_cvt_pk_bf16_f32 v141, v90, v91
    ds_read_b128 v[184:187], v218 offset:20480
    v_mfma_f32_16x16x32_bf16 v[40:43], a[212:215], v[144:147], v[40:43]
    v_mfma_f32_16x16x32_bf16 v[44:47], a[212:215], v[148:151], v[44:47]
    v_exp_f32 v92, v92
    ds_read_b128 v[188:191], v219 offset:20480
    v_mfma_f32_16x16x32_bf16 a[40:43], a[212:215], v[152:155], a[40:43]
    v_exp_f32 v93, v93
    v_mfma_f32_16x16x32_bf16 a[44:47], a[212:215], v[156:159], a[44:47]
    buffer_load_dwordx4 v235, s[12:15], s35 offen offset:1024 nt lds
    v_cvt_pk_bf16_f32 v142, v92, v93
    v_mfma_f32_16x16x32_bf16 v[48:51], a[216:219], v[144:147], v[48:51]
    v_exp_f32 v94, v94
    v_mfma_f32_16x16x32_bf16 v[52:55], a[216:219], v[148:151], v[52:55]
    v_mfma_f32_16x16x32_bf16 a[48:51], a[216:219], v[152:155], a[48:51]
    v_exp_f32 v95, v95
    v_mfma_f32_16x16x32_bf16 a[52:55], a[216:219], v[156:159], a[52:55]
    v_cvt_pk_bf16_f32 v143, v94, v95
    v_mfma_f32_16x16x32_bf16 v[56:59], a[220:223], v[144:147], v[56:59]
    v_mfma_f32_16x16x32_bf16 v[60:63], a[220:223], v[148:151], v[60:63]
    v_mfma_f32_16x16x32_bf16 a[56:59], a[220:223], v[152:155], a[56:59]
    v_mfma_f32_16x16x32_bf16 a[60:63], a[220:223], v[156:159], a[60:63]
    s_waitcnt lgkmcnt(0)
    v_pk_fma_f32 v[96:97], v[96:97], s[26:27], v[244:245] op_sel:[0,0,0] op_sel_hi:[1,0,0]
    v_pk_fma_f32 v[98:99], v[98:99], s[26:27], v[244:245] op_sel:[0,0,0] op_sel_hi:[1,0,0]
    v_pk_fma_f32 v[100:101], v[100:101], s[26:27], v[244:245] op_sel:[0,0,0] op_sel_hi:[1,0,0]
    v_pk_fma_f32 v[102:103], v[102:103], s[26:27], v[244:245] op_sel:[0,0,0] op_sel_hi:[1,0,0]
    v_pk_fma_f32 v[104:105], v[104:105], s[26:27], v[244:245] op_sel:[0,0,1] op_sel_hi:[1,0,1]
    v_pk_fma_f32 v[106:107], v[106:107], s[26:27], v[244:245] op_sel:[0,0,1] op_sel_hi:[1,0,1]
    v_pk_fma_f32 v[108:109], v[108:109], s[26:27], v[244:245] op_sel:[0,0,1] op_sel_hi:[1,0,1]
    v_pk_fma_f32 v[110:111], v[110:111], s[26:27], v[244:245] op_sel:[0,0,1] op_sel_hi:[1,0,1]
    v_pk_fma_f32 v[112:113], v[112:113], s[26:27], v[246:247] op_sel:[0,0,0] op_sel_hi:[1,0,0]
    v_pk_fma_f32 v[114:115], v[114:115], s[26:27], v[246:247] op_sel:[0,0,0] op_sel_hi:[1,0,0]
    v_pk_fma_f32 v[116:117], v[116:117], s[26:27], v[246:247] op_sel:[0,0,0] op_sel_hi:[1,0,0]
    v_pk_fma_f32 v[118:119], v[118:119], s[26:27], v[246:247] op_sel:[0,0,0] op_sel_hi:[1,0,0]
    v_pk_fma_f32 v[120:121], v[120:121], s[26:27], v[246:247] op_sel:[0,0,1] op_sel_hi:[1,0,1]
    v_pk_fma_f32 v[122:123], v[122:123], s[26:27], v[246:247] op_sel:[0,0,1] op_sel_hi:[1,0,1]
    v_pk_fma_f32 v[124:125], v[124:125], s[26:27], v[246:247] op_sel:[0,0,1] op_sel_hi:[1,0,1]
    v_pk_fma_f32 v[126:127], v[126:127], s[26:27], v[246:247] op_sel:[0,0,1] op_sel_hi:[1,0,1]
    s_nop 1
    v_mfma_f32_16x16x32_bf16 v[64:67], v[160:163], a[128:131], 0
    v_mfma_f32_16x16x32_bf16 v[72:75], v[160:163], a[144:147], 0
    v_exp_f32 v96, v96
    ds_read_b64_tr_b16 a[192:193], v224 offset:0
    v_mfma_f32_16x16x32_bf16 v[80:83], v[160:163], a[160:163], 0
    v_exp_f32 v97, v97
    v_mfma_f32_16x16x32_bf16 v[88:91], v[160:163], a[176:179], 0
    s_add_u32 m0, s25, 0
    v_cvt_pk_bf16_f32 v144, v96, v97
    ds_read_b64_tr_b16 a[194:195], v224 offset:4096
    v_mfma_f32_16x16x32_bf16 v[64:67], v[164:167], a[132:135], v[64:67]
    s_add_u32 s35, s22, 0
    v_exp_f32 v98, v98
    ds_read_b64_tr_b16 a[196:197], v225 offset:0
    v_mfma_f32_16x16x32_bf16 v[72:75], v[164:167], a[148:151], v[72:75]
    ds_read_b64_tr_b16 a[198:199], v225 offset:4096
    buffer_load_dwordx4 v232, s[8:11], s35 offen nt lds
    v_mfma_f32_16x16x32_bf16 v[80:83], v[164:167], a[164:167], v[80:83]
    v_exp_f32 v99, v99
    v_mfma_f32_16x16x32_bf16 v[88:91], v[164:167], a[180:183], v[88:91]
    v_cvt_pk_bf16_f32 v145, v98, v99
    ds_read_b64_tr_b16 a[200:201], v226 offset:0
    v_mfma_f32_16x16x32_bf16 v[64:67], v[168:171], a[136:139], v[64:67]
    v_mfma_f32_16x16x32_bf16 v[72:75], v[168:171], a[152:155], v[72:75]
    v_exp_f32 v100, v100
    ds_read_b64_tr_b16 a[202:203], v226 offset:4096
    v_mfma_f32_16x16x32_bf16 v[80:83], v[168:171], a[168:171], v[80:83]
    v_exp_f32 v101, v101
    v_mfma_f32_16x16x32_bf16 v[88:91], v[168:171], a[184:187], v[88:91]
    v_cvt_pk_bf16_f32 v146, v100, v101
    ds_read_b64_tr_b16 a[204:205], v227 offset:0
    v_mfma_f32_16x16x32_bf16 v[64:67], v[172:175], a[140:143], v[64:67]
    v_exp_f32 v102, v102
    v_mfma_f32_16x16x32_bf16 v[72:75], v[172:175], a[156:159], v[72:75]
    ds_read_b64_tr_b16 a[206:207], v227 offset:4096
    buffer_load_dwordx4 v233, s[8:11], s35 offen offset:1024 nt lds
    v_mfma_f32_16x16x32_bf16 v[80:83], v[172:175], a[172:175], v[80:83]
    v_exp_f32 v103, v103
    ds_read_b64_tr_b16 a[208:209], v228 offset:0
    v_mfma_f32_16x16x32_bf16 v[88:91], v[172:175], a[188:191], v[88:91]
    v_cvt_pk_bf16_f32 v147, v102, v103
    ds_read_b64_tr_b16 a[210:211], v228 offset:4096
    v_mfma_f32_16x16x32_bf16 v[68:71], v[176:179], a[128:131], 0
    s_add_u32 m0, s25, 8192
    v_mfma_f32_16x16x32_bf16 v[76:79], v[176:179], a[144:147], 0
    s_add_u32 s35, s22, 4096
    v_exp_f32 v104, v104
    ds_read_b64_tr_b16 a[212:213], v229 offset:0
    v_mfma_f32_16x16x32_bf16 v[84:87], v[176:179], a[160:163], 0
    buffer_load_dwordx4 v232, s[8:11], s35 offen nt lds
    v_exp_f32 v105, v105
    v_mfma_f32_16x16x32_bf16 v[92:95], v[176:179], a[176:179], 0
    v_cvt_pk_bf16_f32 v148, v104, v105
    ds_read_b64_tr_b16 a[214:215], v229 offset:4096
    v_mfma_f32_16x16x32_bf16 v[68:71], v[180:183], a[132:135], v[68:71]
    v_exp_f32 v106, v106
    v_mfma_f32_16x16x32_bf16 v[76:79], v[180:183], a[148:151], v[76:79]
    ds_read_b64_tr_b16 a[216:217], v230 offset:0
    v_mfma_f32_16x16x32_bf16 v[84:87], v[180:183], a[164:167], v[84:87]
    v_exp_f32 v107, v107
    ds_read_b64_tr_b16 a[218:219], v230 offset:4096
    v_mfma_f32_16x16x32_bf16 v[92:95], v[180:183], a[180:183], v[92:95]
    v_cvt_pk_bf16_f32 v149, v106, v107
    ds_read_b64_tr_b16 a[220:221], v231 offset:0
    v_mfma_f32_16x16x32_bf16 v[68:71], v[184:187], a[136:139], v[68:71]
    v_exp_f32 v108, v108
    v_mfma_f32_16x16x32_bf16 v[76:79], v[184:187], a[152:155], v[76:79]
    ds_read_b64_tr_b16 a[222:223], v231 offset:4096
    buffer_load_dwordx4 v233, s[8:11], s35 offen offset:1024 nt lds
    v_mfma_f32_16x16x32_bf16 v[84:87], v[184:187], a[168:171], v[84:87]
    v_exp_f32 v109, v109
    v_mfma_f32_16x16x32_bf16 v[92:95], v[184:187], a[184:187], v[92:95]
    v_cvt_pk_bf16_f32 v150, v108, v109
    v_mfma_f32_16x16x32_bf16 v[68:71], v[188:191], a[140:143], v[68:71]
    v_mfma_f32_16x16x32_bf16 v[76:79], v[188:191], a[156:159], v[76:79]
    v_mfma_f32_16x16x32_bf16 v[84:87], v[188:191], a[172:175], v[84:87]
    v_exp_f32 v110, v110
    v_exp_f32 v111, v111
    v_mfma_f32_16x16x32_bf16 v[92:95], v[188:191], a[188:191], v[92:95]
    v_cvt_pk_bf16_f32 v151, v110, v111
    s_waitcnt vmcnt(8) lgkmcnt(0)
    s_barrier
    v_mfma_f32_16x16x32_bf16 a[224:227], a[240:243], v[128:131], a[224:227]
    v_exp_f32 v112, v112
    v_mfma_f32_16x16x32_bf16 a[228:231], a[240:243], v[132:135], a[228:231]
    s_add_u32 m0, s25, 57344
    ds_read_b128 v[160:163], v216 offset:24576
    v_mfma_f32_16x16x32_bf16 a[232:235], a[240:243], v[136:139], a[232:235]
    s_add_u32 s35, s21, 61440
    v_exp_f32 v113, v113
    v_mfma_f32_16x16x32_bf16 a[236:239], a[240:243], v[140:143], a[236:239]
    buffer_load_dwordx4 v234, s[12:15], s35 offen nt lds
    v_cvt_pk_bf16_f32 v152, v112, v113
    v_mfma_f32_16x16x32_bf16 v[0:3], a[192:195], v[128:131], v[0:3]
    v_mfma_f32_16x16x32_bf16 v[4:7], a[192:195], v[132:135], v[4:7]
    v_exp_f32 v114, v114
    ds_read_b128 v[164:167], v217 offset:24576
    v_mfma_f32_16x16x32_bf16 a[0:3], a[192:195], v[136:139], a[0:3]
    v_exp_f32 v115, v115
    v_mfma_f32_16x16x32_bf16 a[4:7], a[192:195], v[140:143], a[4:7]
    v_cvt_pk_bf16_f32 v153, v114, v115
    v_mfma_f32_16x16x32_bf16 v[8:11], a[196:199], v[128:131], v[8:11]
    v_exp_f32 v116, v116
    v_mfma_f32_16x16x32_bf16 v[12:15], a[196:199], v[132:135], v[12:15]
    ds_read_b128 v[168:171], v218 offset:24576
    v_mfma_f32_16x16x32_bf16 a[8:11], a[196:199], v[136:139], a[8:11]
    v_exp_f32 v117, v117
    v_mfma_f32_16x16x32_bf16 a[12:15], a[196:199], v[140:143], a[12:15]
    v_mfma_f32_16x16x32_bf16 v[16:19], a[200:203], v[128:131], v[16:19]
    v_cvt_pk_bf16_f32 v154, v116, v117
    v_exp_f32 v118, v118
    v_mfma_f32_16x16x32_bf16 v[20:23], a[200:203], v[132:135], v[20:23]
    ds_read_b128 v[172:175], v219 offset:24576
    v_mfma_f32_16x16x32_bf16 a[16:19], a[200:203], v[136:139], a[16:19]
    v_exp_f32 v119, v119
    v_mfma_f32_16x16x32_bf16 a[20:23], a[200:203], v[140:143], a[20:23]
    v_cvt_pk_bf16_f32 v155, v118, v119
    v_mfma_f32_16x16x32_bf16 v[24:27], a[204:207], v[128:131], v[24:27]
    v_exp_f32 v120, v120
    v_mfma_f32_16x16x32_bf16 v[28:31], a[204:207], v[132:135], v[28:31]
    ds_read_b128 v[176:179], v216 offset:28672
    v_mfma_f32_16x16x32_bf16 a[24:27], a[204:207], v[136:139], a[24:27]
    v_exp_f32 v121, v121
    v_mfma_f32_16x16x32_bf16 a[28:31], a[204:207], v[140:143], a[28:31]
    buffer_load_dwordx4 v235, s[12:15], s35 offen offset:1024 nt lds
    v_cvt_pk_bf16_f32 v156, v120, v121
    v_mfma_f32_16x16x32_bf16 v[32:35], a[208:211], v[128:131], v[32:35]
    v_exp_f32 v122, v122
    v_mfma_f32_16x16x32_bf16 v[36:39], a[208:211], v[132:135], v[36:39]
    ds_read_b128 v[180:183], v217 offset:28672
    v_mfma_f32_16x16x32_bf16 a[32:35], a[208:211], v[136:139], a[32:35]
    v_exp_f32 v123, v123
    v_mfma_f32_16x16x32_bf16 a[36:39], a[208:211], v[140:143], a[36:39]
    v_cvt_pk_bf16_f32 v157, v122, v123
    ds_read_b128 v[184:187], v218 offset:28672
    v_mfma_f32_16x16x32_bf16 v[40:43], a[212:215], v[128:131], v[40:43]
    v_mfma_f32_16x16x32_bf16 v[44:47], a[212:215], v[132:135], v[44:47]
    v_exp_f32 v124, v124
    ds_read_b128 v[188:191], v219 offset:28672
    v_mfma_f32_16x16x32_bf16 a[40:43], a[212:215], v[136:139], a[40:43]
    v_exp_f32 v125, v125
    v_mfma_f32_16x16x32_bf16 a[44:47], a[212:215], v[140:143], a[44:47]
    v_cvt_pk_bf16_f32 v158, v124, v125
    v_mfma_f32_16x16x32_bf16 v[48:51], a[216:219], v[128:131], v[48:51]
    v_exp_f32 v126, v126
    v_mfma_f32_16x16x32_bf16 v[52:55], a[216:219], v[132:135], v[52:55]
    v_mfma_f32_16x16x32_bf16 a[48:51], a[216:219], v[136:139], a[48:51]
    v_exp_f32 v127, v127
    v_mfma_f32_16x16x32_bf16 a[52:55], a[216:219], v[140:143], a[52:55]
    v_cvt_pk_bf16_f32 v159, v126, v127
    v_mfma_f32_16x16x32_bf16 v[56:59], a[220:223], v[128:131], v[56:59]
    v_mfma_f32_16x16x32_bf16 v[60:63], a[220:223], v[132:135], v[60:63]
    v_mfma_f32_16x16x32_bf16 a[56:59], a[220:223], v[136:139], a[56:59]
    v_mfma_f32_16x16x32_bf16 a[60:63], a[220:223], v[140:143], a[60:63]
    s_waitcnt lgkmcnt(0)
    v_pk_fma_f32 v[64:65], v[64:65], s[26:27], v[244:245] op_sel:[0,0,0] op_sel_hi:[1,0,0]
    v_pk_fma_f32 v[66:67], v[66:67], s[26:27], v[244:245] op_sel:[0,0,0] op_sel_hi:[1,0,0]
    v_pk_fma_f32 v[68:69], v[68:69], s[26:27], v[244:245] op_sel:[0,0,0] op_sel_hi:[1,0,0]
    v_pk_fma_f32 v[70:71], v[70:71], s[26:27], v[244:245] op_sel:[0,0,0] op_sel_hi:[1,0,0]
    v_pk_fma_f32 v[72:73], v[72:73], s[26:27], v[244:245] op_sel:[0,0,1] op_sel_hi:[1,0,1]
    v_pk_fma_f32 v[74:75], v[74:75], s[26:27], v[244:245] op_sel:[0,0,1] op_sel_hi:[1,0,1]
    v_pk_fma_f32 v[76:77], v[76:77], s[26:27], v[244:245] op_sel:[0,0,1] op_sel_hi:[1,0,1]
    v_pk_fma_f32 v[78:79], v[78:79], s[26:27], v[244:245] op_sel:[0,0,1] op_sel_hi:[1,0,1]
    v_pk_fma_f32 v[80:81], v[80:81], s[26:27], v[246:247] op_sel:[0,0,0] op_sel_hi:[1,0,0]
    v_pk_fma_f32 v[82:83], v[82:83], s[26:27], v[246:247] op_sel:[0,0,0] op_sel_hi:[1,0,0]
    v_pk_fma_f32 v[84:85], v[84:85], s[26:27], v[246:247] op_sel:[0,0,0] op_sel_hi:[1,0,0]
    v_pk_fma_f32 v[86:87], v[86:87], s[26:27], v[246:247] op_sel:[0,0,0] op_sel_hi:[1,0,0]
    v_pk_fma_f32 v[88:89], v[88:89], s[26:27], v[246:247] op_sel:[0,0,1] op_sel_hi:[1,0,1]
    v_pk_fma_f32 v[90:91], v[90:91], s[26:27], v[246:247] op_sel:[0,0,1] op_sel_hi:[1,0,1]
    v_pk_fma_f32 v[92:93], v[92:93], s[26:27], v[246:247] op_sel:[0,0,1] op_sel_hi:[1,0,1]
    v_pk_fma_f32 v[94:95], v[94:95], s[26:27], v[246:247] op_sel:[0,0,1] op_sel_hi:[1,0,1]
    s_nop 1
    v_mfma_f32_16x16x32_bf16 v[96:99], v[160:163], a[128:131], 0
    v_mfma_f32_16x16x32_bf16 v[104:107], v[160:163], a[144:147], 0
    v_exp_f32 v64, v64
    ds_read_b64_tr_b16 a[192:193], v224 offset:8192
    v_mfma_f32_16x16x32_bf16 v[112:115], v[160:163], a[160:163], 0
    v_exp_f32 v65, v65
    v_mfma_f32_16x16x32_bf16 v[120:123], v[160:163], a[176:179], 0
    s_add_u32 m0, s25, 16384
    v_cvt_pk_bf16_f32 v128, v64, v65
    ds_read_b64_tr_b16 a[194:195], v224 offset:12288
    v_mfma_f32_16x16x32_bf16 v[96:99], v[164:167], a[132:135], v[96:99]
    s_add_u32 s35, s22, 8192
    ds_read_b64_tr_b16 a[196:197], v225 offset:8192
    v_exp_f32 v66, v66
    v_mfma_f32_16x16x32_bf16 v[104:107], v[164:167], a[148:151], v[104:107]
    ds_read_b64_tr_b16 a[198:199], v225 offset:12288
    buffer_load_dwordx4 v232, s[8:11], s35 offen nt lds
    v_mfma_f32_16x16x32_bf16 v[112:115], v[164:167], a[164:167], v[112:115]
    v_exp_f32 v67, v67
    v_mfma_f32_16x16x32_bf16 v[120:123], v[164:167], a[180:183], v[120:123]
    v_cvt_pk_bf16_f32 v129, v66, v67
    ds_read_b64_tr_b16 a[200:201], v226 offset:8192
    v_mfma_f32_16x16x32_bf16 v[96:99], v[168:171], a[136:139], v[96:99]
    v_exp_f32 v68, v68
    v_mfma_f32_16x16x32_bf16 v[104:107], v[168:171], a[152:155], v[104:107]
    ds_read_b64_tr_b16 a[202:203], v226 offset:12288
    v_mfma_f32_16x16x32_bf16 v[112:115], v[168:171], a[168:171], v[112:115]
    v_exp_f32 v69, v69
    v_mfma_f32_16x16x32_bf16 v[120:123], v[168:171], a[184:187], v[120:123]
    ds_read_b64_tr_b16 a[204:205], v227 offset:8192
    v_cvt_pk_bf16_f32 v130, v68, v69
    v_mfma_f32_16x16x32_bf16 v[96:99], v[172:175], a[140:143], v[96:99]
    v_exp_f32 v70, v70
    v_mfma_f32_16x16x32_bf16 v[104:107], v[172:175], a[156:159], v[104:107]
    ds_read_b64_tr_b16 a[206:207], v227 offset:12288
    v_mfma_f32_16x16x32_bf16 v[112:115], v[172:175], a[172:175], v[112:115]
    v_exp_f32 v71, v71
    ds_read_b64_tr_b16 a[208:209], v228 offset:8192
    v_mfma_f32_16x16x32_bf16 v[120:123], v[172:175], a[188:191], v[120:123]
    ds_read_b64_tr_b16 a[210:211], v228 offset:12288
    v_cvt_pk_bf16_f32 v131, v70, v71
    v_mfma_f32_16x16x32_bf16 v[100:103], v[176:179], a[128:131], 0
    v_exp_f32 v72, v72
    v_mfma_f32_16x16x32_bf16 v[108:111], v[176:179], a[144:147], 0
    ds_read_b64_tr_b16 a[212:213], v229 offset:8192
    v_mfma_f32_16x16x32_bf16 v[116:119], v[176:179], a[160:163], 0
    buffer_load_dwordx4 v233, s[8:11], s35 offen offset:1024 nt lds
    v_exp_f32 v73, v73
    v_mfma_f32_16x16x32_bf16 v[124:127], v[176:179], a[176:179], 0
    v_cvt_pk_bf16_f32 v132, v72, v73
    ds_read_b64_tr_b16 a[214:215], v229 offset:12288
    v_mfma_f32_16x16x32_bf16 v[100:103], v[180:183], a[132:135], v[100:103]
    v_exp_f32 v74, v74
    v_mfma_f32_16x16x32_bf16 v[108:111], v[180:183], a[148:151], v[108:111]
    ds_read_b64_tr_b16 a[216:217], v230 offset:8192
    v_mfma_f32_16x16x32_bf16 v[116:119], v[180:183], a[164:167], v[116:119]
    ds_read_b64_tr_b16 a[218:219], v230 offset:12288
    v_exp_f32 v75, v75
    v_mfma_f32_16x16x32_bf16 v[124:127], v[180:183], a[180:183], v[124:127]
    v_cvt_pk_bf16_f32 v133, v74, v75
    ds_read_b64_tr_b16 a[220:221], v231 offset:8192
    v_mfma_f32_16x16x32_bf16 v[100:103], v[184:187], a[136:139], v[100:103]
    s_add_u32 s23, s20, 262144
    v_exp_f32 v76, v76
    v_mfma_f32_16x16x32_bf16 v[108:111], v[184:187], a[152:155], v[108:111]
    s_xor_b32 s23, s23, s32
    ds_read_b64_tr_b16 a[222:223], v231 offset:12288
    v_add_u32 v200, s29, v216
    v_mfma_f32_16x16x32_bf16 v[116:119], v[184:187], a[168:171], v[116:119]
    s_lshr_b32 s23, s23, 1
    v_exp_f32 v77, v77
    v_mfma_f32_16x16x32_bf16 v[124:127], v[184:187], a[184:187], v[124:127]
    v_cvt_pk_bf16_f32 v134, v76, v77
    v_add_u32 v201, s29, v217
    v_mfma_f32_16x16x32_bf16 v[100:103], v[188:191], a[140:143], v[100:103]
    v_exp_f32 v78, v78
    v_mfma_f32_16x16x32_bf16 v[108:111], v[188:191], a[156:159], v[108:111]
    v_add_u32 v202, s29, v218
    v_add_u32 v203, s29, v219
    v_mfma_f32_16x16x32_bf16 v[116:119], v[188:191], a[172:175], v[116:119]
    v_exp_f32 v79, v79
    v_mfma_f32_16x16x32_bf16 v[124:127], v[188:191], a[188:191], v[124:127]
    v_cvt_pk_bf16_f32 v135, v78, v79
    s_waitcnt vmcnt(6) lgkmcnt(0)
    s_barrier
    v_mfma_f32_16x16x32_bf16 a[224:227], a[240:243], v[144:147], a[224:227]
    v_exp_f32 v80, v80
    v_mfma_f32_16x16x32_bf16 a[228:231], a[240:243], v[148:151], a[228:231]
    s_add_u32 m0, s25, 32768
    ds_read_b128 v[160:163], v216 offset:0
    v_mfma_f32_16x16x32_bf16 a[232:235], a[240:243], v[152:155], a[232:235]
    s_add_u32 s35, s22, 0
    v_exp_f32 v81, v81
    ds_read_b128 v[164:167], v217 offset:0
    v_mfma_f32_16x16x32_bf16 a[236:239], a[240:243], v[156:159], a[236:239]
    buffer_load_dwordx4 v234, s[12:15], s35 offen nt lds
    ds_read_b128 v[168:171], v218 offset:0
    v_cvt_pk_bf16_f32 v136, v80, v81
    v_mfma_f32_16x16x32_bf16 v[0:3], a[192:195], v[144:147], v[0:3]
    v_exp_f32 v82, v82
    v_mfma_f32_16x16x32_bf16 v[4:7], a[192:195], v[148:151], v[4:7]
    ds_read_b128 v[172:175], v219 offset:0
    v_mfma_f32_16x16x32_bf16 a[0:3], a[192:195], v[152:155], a[0:3]
    ds_read_b128 a[128:131], v200 offset:16384
    v_exp_f32 v83, v83
    v_mfma_f32_16x16x32_bf16 a[4:7], a[192:195], v[156:159], a[4:7]
    ds_read_b128 a[132:135], v201 offset:16384
    v_cvt_pk_bf16_f32 v137, v82, v83
    v_mfma_f32_16x16x32_bf16 v[8:11], a[196:199], v[144:147], v[8:11]
    v_exp_f32 v84, v84
    ds_read_b128 a[136:139], v202 offset:16384
    v_mfma_f32_16x16x32_bf16 v[12:15], a[196:199], v[148:151], v[12:15]
    ds_read_b128 a[140:143], v203 offset:16384
    v_mfma_f32_16x16x32_bf16 a[8:11], a[196:199], v[152:155], a[8:11]
    ds_read_b128 v[176:179], v216 offset:4096
    v_exp_f32 v85, v85
    v_mfma_f32_16x16x32_bf16 a[12:15], a[196:199], v[156:159], a[12:15]
    buffer_load_dwordx4 v235, s[12:15], s35 offen offset:1024 nt lds
    v_cvt_pk_bf16_f32 v138, v84, v85
    v_mfma_f32_16x16x32_bf16 v[16:19], a[200:203], v[144:147], v[16:19]
    v_exp_f32 v86, v86
    ds_read_b128 v[180:183], v217 offset:4096
    v_mfma_f32_16x16x32_bf16 v[20:23], a[200:203], v[148:151], v[20:23]
    ds_read_b128 v[184:187], v218 offset:4096
    v_mfma_f32_16x16x32_bf16 a[16:19], a[200:203], v[152:155], a[16:19]
    v_exp_f32 v87, v87
    v_mfma_f32_16x16x32_bf16 a[20:23], a[200:203], v[156:159], a[20:23]
    ds_read_b128 v[188:191], v219 offset:4096
    v_cvt_pk_bf16_f32 v139, v86, v87
    v_mfma_f32_16x16x32_bf16 v[24:27], a[204:207], v[144:147], v[24:27]
    v_exp_f32 v88, v88
    ds_read_b128 a[144:147], v200 offset:20480
    v_mfma_f32_16x16x32_bf16 v[28:31], a[204:207], v[148:151], v[28:31]
    s_add_u32 m0, s25, 40960
    ds_read_b128 a[148:151], v201 offset:20480
    v_mfma_f32_16x16x32_bf16 a[24:27], a[204:207], v[152:155], a[24:27]
    s_add_u32 s35, s22, 4096
    ds_read_b128 a[152:155], v202 offset:20480
    v_exp_f32 v89, v89
    v_mfma_f32_16x16x32_bf16 a[28:31], a[204:207], v[156:159], a[28:31]
    buffer_load_dwordx4 v234, s[12:15], s35 offen nt lds
    v_cvt_pk_bf16_f32 v140, v88, v89
    v_mfma_f32_16x16x32_bf16 v[32:35], a[208:211], v[144:147], v[32:35]
    v_exp_f32 v90, v90
    ds_read_b128 a[156:159], v203 offset:20480
    v_mfma_f32_16x16x32_bf16 v[36:39], a[208:211], v[148:151], v[36:39]
    ds_read_b128 a[160:163], v200 offset:0
    v_mfma_f32_16x16x32_bf16 a[32:35], a[208:211], v[152:155], a[32:35]
    ds_read_b128 a[164:167], v201 offset:0
    v_exp_f32 v91, v91
    v_mfma_f32_16x16x32_bf16 a[36:39], a[208:211], v[156:159], a[36:39]
    v_cvt_pk_bf16_f32 v141, v90, v91
    ds_read_b128 a[168:171], v202 offset:0
    v_mfma_f32_16x16x32_bf16 v[40:43], a[212:215], v[144:147], v[40:43]
    v_exp_f32 v92, v92
    v_mfma_f32_16x16x32_bf16 v[44:47], a[212:215], v[148:151], v[44:47]
    ds_read_b128 a[172:175], v203 offset:0
    v_mfma_f32_16x16x32_bf16 a[40:43], a[212:215], v[152:155], a[40:43]
    ds_read_b128 a[176:179], v200 offset:4096
    v_exp_f32 v93, v93
    v_mfma_f32_16x16x32_bf16 a[44:47], a[212:215], v[156:159], a[44:47]
    buffer_load_dwordx4 v235, s[12:15], s35 offen offset:1024 nt lds
    ds_read_b128 a[180:183], v201 offset:4096
    v_cvt_pk_bf16_f32 v142, v92, v93
    v_mfma_f32_16x16x32_bf16 v[48:51], a[216:219], v[144:147], v[48:51]
    ds_read_b128 a[184:187], v202 offset:4096
    v_exp_f32 v94, v94
    v_mfma_f32_16x16x32_bf16 v[52:55], a[216:219], v[148:151], v[52:55]
    ds_read_b128 a[188:191], v203 offset:4096
    v_mfma_f32_16x16x32_bf16 a[48:51], a[216:219], v[152:155], a[48:51]
    v_exp_f32 v95, v95
    v_mfma_f32_16x16x32_bf16 a[52:55], a[216:219], v[156:159], a[52:55]
    v_cvt_pk_bf16_f32 v143, v94, v95
    v_mfma_f32_16x16x32_bf16 v[56:59], a[220:223], v[144:147], v[56:59]
    v_mfma_f32_16x16x32_bf16 v[60:63], a[220:223], v[148:151], v[60:63]
    v_mfma_f32_16x16x32_bf16 a[56:59], a[220:223], v[152:155], a[56:59]
    v_mfma_f32_16x16x32_bf16 a[60:63], a[220:223], v[156:159], a[60:63]
    s_waitcnt lgkmcnt(0)
    v_pk_fma_f32 v[96:97], v[96:97], s[26:27], v[244:245] op_sel:[0,0,0] op_sel_hi:[1,0,0]
    v_pk_fma_f32 v[98:99], v[98:99], s[26:27], v[244:245] op_sel:[0,0,0] op_sel_hi:[1,0,0]
    v_pk_fma_f32 v[100:101], v[100:101], s[26:27], v[244:245] op_sel:[0,0,0] op_sel_hi:[1,0,0]
    v_pk_fma_f32 v[102:103], v[102:103], s[26:27], v[244:245] op_sel:[0,0,0] op_sel_hi:[1,0,0]
    v_pk_fma_f32 v[104:105], v[104:105], s[26:27], v[244:245] op_sel:[0,0,1] op_sel_hi:[1,0,1]
    v_pk_fma_f32 v[106:107], v[106:107], s[26:27], v[244:245] op_sel:[0,0,1] op_sel_hi:[1,0,1]
    v_pk_fma_f32 v[108:109], v[108:109], s[26:27], v[244:245] op_sel:[0,0,1] op_sel_hi:[1,0,1]
    v_pk_fma_f32 v[110:111], v[110:111], s[26:27], v[244:245] op_sel:[0,0,1] op_sel_hi:[1,0,1]
    v_pk_fma_f32 v[112:113], v[112:113], s[26:27], v[246:247] op_sel:[0,0,0] op_sel_hi:[1,0,0]
    v_pk_fma_f32 v[114:115], v[114:115], s[26:27], v[246:247] op_sel:[0,0,0] op_sel_hi:[1,0,0]
    v_pk_fma_f32 v[116:117], v[116:117], s[26:27], v[246:247] op_sel:[0,0,0] op_sel_hi:[1,0,0]
    v_pk_fma_f32 v[118:119], v[118:119], s[26:27], v[246:247] op_sel:[0,0,0] op_sel_hi:[1,0,0]
    v_pk_fma_f32 v[120:121], v[120:121], s[26:27], v[246:247] op_sel:[0,0,1] op_sel_hi:[1,0,1]
    v_pk_fma_f32 v[122:123], v[122:123], s[26:27], v[246:247] op_sel:[0,0,1] op_sel_hi:[1,0,1]
    v_pk_fma_f32 v[124:125], v[124:125], s[26:27], v[246:247] op_sel:[0,0,1] op_sel_hi:[1,0,1]
    v_pk_fma_f32 v[126:127], v[126:127], s[26:27], v[246:247] op_sel:[0,0,1] op_sel_hi:[1,0,1]
    s_nop 1
    v_mfma_f32_16x16x32_bf16 v[64:67], v[160:163], a[128:131], 0
    v_mfma_f32_16x16x32_bf16 v[72:75], v[160:163], a[144:147], 0
    v_exp_f32 v96, v96
    ds_read_b64_tr_b16 a[192:193], v224 offset:16384
    v_mfma_f32_16x16x32_bf16 v[80:83], v[160:163], a[160:163], 0
    v_exp_f32 v97, v97
    v_mfma_f32_16x16x32_bf16 v[88:91], v[160:163], a[176:179], 0
    s_add_u32 m0, s25, 24576
    v_cvt_pk_bf16_f32 v144, v96, v97
    ds_read_b64_tr_b16 a[194:195], v224 offset:20480
    v_mfma_f32_16x16x32_bf16 v[64:67], v[164:167], a[132:135], v[64:67]
    s_add_u32 s35, s22, 12288
    v_exp_f32 v98, v98
    ds_read_b64_tr_b16 a[196:197], v225 offset:16384
    v_mfma_f32_16x16x32_bf16 v[72:75], v[164:167], a[148:151], v[72:75]
    ds_read_b64_tr_b16 a[198:199], v225 offset:20480
    buffer_load_dwordx4 v232, s[8:11], s35 offen nt lds
    v_mfma_f32_16x16x32_bf16 v[80:83], v[164:167], a[164:167], v[80:83]
    v_exp_f32 v99, v99
    v_mfma_f32_16x16x32_bf16 v[88:91], v[164:167], a[180:183], v[88:91]
    ds_read_b64_tr_b16 a[200:201], v226 offset:16384
    v_cvt_pk_bf16_f32 v145, v98, v99
    v_mfma_f32_16x16x32_bf16 v[64:67], v[168:171], a[136:139], v[64:67]
    v_exp_f32 v100, v100
    v_mfma_f32_16x16x32_bf16 v[72:75], v[168:171], a[152:155], v[72:75]
    ds_read_b64_tr_b16 a[202:203], v226 offset:20480
    v_mfma_f32_16x16x32_bf16 v[80:83], v[168:171], a[168:171], v[80:83]
    v_exp_f32 v101, v101
    v_mfma_f32_16x16x32_bf16 v[88:91], v[168:171], a[184:187], v[88:91]
    v_cvt_pk_bf16_f32 v146, v100, v101
    ds_read_b64_tr_b16 a[204:205], v227 offset:16384
    v_mfma_f32_16x16x32_bf16 v[64:67], v[172:175], a[140:143], v[64:67]
    v_exp_f32 v102, v102
    v_mfma_f32_16x16x32_bf16 v[72:75], v[172:175], a[156:159], v[72:75]
    ds_read_b64_tr_b16 a[206:207], v227 offset:20480
    v_mfma_f32_16x16x32_bf16 v[80:83], v[172:175], a[172:175], v[80:83]
    ds_read_b64_tr_b16 a[208:209], v228 offset:16384
    v_exp_f32 v103, v103
    v_mfma_f32_16x16x32_bf16 v[88:91], v[172:175], a[188:191], v[88:91]
    v_cvt_pk_bf16_f32 v147, v102, v103
    ds_read_b64_tr_b16 a[210:211], v228 offset:20480
    v_mfma_f32_16x16x32_bf16 v[68:71], v[176:179], a[128:131], 0
    v_exp_f32 v104, v104
    v_mfma_f32_16x16x32_bf16 v[76:79], v[176:179], a[144:147], 0
    ds_read_b64_tr_b16 a[212:213], v229 offset:16384
    v_mfma_f32_16x16x32_bf16 v[84:87], v[176:179], a[160:163], 0
    buffer_load_dwordx4 v233, s[8:11], s35 offen offset:1024 nt lds
    v_exp_f32 v105, v105
    v_mfma_f32_16x16x32_bf16 v[92:95], v[176:179], a[176:179], 0
    ds_read_b64_tr_b16 a[214:215], v229 offset:20480
    v_cvt_pk_bf16_f32 v148, v104, v105
    v_mfma_f32_16x16x32_bf16 v[68:71], v[180:183], a[132:135], v[68:71]
    v_exp_f32 v106, v106
    v_mfma_f32_16x16x32_bf16 v[76:79], v[180:183], a[148:151], v[76:79]
    ds_read_b64_tr_b16 a[216:217], v230 offset:16384
    v_mfma_f32_16x16x32_bf16 v[84:87], v[180:183], a[164:167], v[84:87]
    v_exp_f32 v107, v107
    ds_read_b64_tr_b16 a[218:219], v230 offset:20480
    v_mfma_f32_16x16x32_bf16 v[92:95], v[180:183], a[180:183], v[92:95]
    v_cvt_pk_bf16_f32 v149, v106, v107
    ds_read_b64_tr_b16 a[220:221], v231 offset:16384
    v_mfma_f32_16x16x32_bf16 v[68:71], v[184:187], a[136:139], v[68:71]
    v_exp_f32 v108, v108
    v_mfma_f32_16x16x32_bf16 v[76:79], v[184:187], a[152:155], v[76:79]
    ds_read_b64_tr_b16 a[222:223], v231 offset:20480
    v_mfma_f32_16x16x32_bf16 v[84:87], v[184:187], a[168:171], v[84:87]
    v_exp_f32 v109, v109
    v_mfma_f32_16x16x32_bf16 v[92:95], v[184:187], a[184:187], v[92:95]
    v_cvt_pk_bf16_f32 v150, v108, v109
    v_mfma_f32_16x16x32_bf16 v[68:71], v[188:191], a[140:143], v[68:71]
    v_exp_f32 v110, v110
    v_mfma_f32_16x16x32_bf16 v[76:79], v[188:191], a[156:159], v[76:79]
    v_mfma_f32_16x16x32_bf16 v[84:87], v[188:191], a[172:175], v[84:87]
    v_exp_f32 v111, v111
    v_mfma_f32_16x16x32_bf16 v[92:95], v[188:191], a[188:191], v[92:95]
    v_cvt_pk_bf16_f32 v151, v110, v111
    s_waitcnt vmcnt(8) lgkmcnt(0)
    s_barrier
    v_mfma_f32_16x16x32_bf16 a[224:227], a[240:243], v[128:131], a[224:227]
    v_exp_f32 v112, v112
    v_mfma_f32_16x16x32_bf16 a[228:231], a[240:243], v[132:135], a[228:231]
    s_add_u32 m0, s29, 16384
    ds_read_b128 v[160:163], v216 offset:8192
    v_mfma_f32_16x16x32_bf16 a[232:235], a[240:243], v[136:139], a[232:235]
    s_add_u32 s35, s23, 0
    v_exp_f32 v113, v113
    v_max3_f32 v220, v64, v65, v66
    v_mfma_f32_16x16x32_bf16 a[236:239], a[240:243], v[140:143], a[236:239]
    buffer_load_dwordx4 v236, s[4:7], s35 offen nt lds
    v_cvt_pk_bf16_f32 v152, v112, v113
    v_mfma_f32_16x16x32_bf16 v[0:3], a[192:195], v[128:131], v[0:3]
    v_exp_f32 v114, v114
    v_max3_f32 v221, v72, v73, v74
    v_mfma_f32_16x16x32_bf16 v[4:7], a[192:195], v[132:135], v[4:7]
    ds_read_b128 v[164:167], v217 offset:8192
    v_max3_f32 v222, v80, v81, v82
    v_max3_f32 v223, v88, v89, v90
    v_mfma_f32_16x16x32_bf16 a[0:3], a[192:195], v[136:139], a[0:3]
    v_exp_f32 v115, v115
    v_mfma_f32_16x16x32_bf16 a[4:7], a[192:195], v[140:143], a[4:7]
    v_cvt_pk_bf16_f32 v153, v114, v115
    v_max3_f32 v220, v220, v67, v68
    v_mfma_f32_16x16x32_bf16 v[8:11], a[196:199], v[128:131], v[8:11]
    v_exp_f32 v116, v116
    v_mfma_f32_16x16x32_bf16 v[12:15], a[196:199], v[132:135], v[12:15]
    v_max3_f32 v221, v221, v75, v76
    v_max3_f32 v222, v222, v83, v84
    ds_read_b128 v[168:171], v218 offset:8192
    v_mfma_f32_16x16x32_bf16 a[8:11], a[196:199], v[136:139], a[8:11]
    v_exp_f32 v117, v117
    v_max3_f32 v223, v223, v91, v92
    v_mfma_f32_16x16x32_bf16 a[12:15], a[196:199], v[140:143], a[12:15]
    buffer_load_dwordx4 v237, s[4:7], s35 offen offset:1024 nt lds
    v_cvt_pk_bf16_f32 v154, v116, v117
    v_mfma_f32_16x16x32_bf16 v[16:19], a[200:203], v[128:131], v[16:19]
    v_exp_f32 v118, v118
    v_max3_f32 v220, v220, v69, v70
    v_mfma_f32_16x16x32_bf16 v[20:23], a[200:203], v[132:135], v[20:23]
    ds_read_b128 v[172:175], v219 offset:8192
    v_max3_f32 v221, v221, v77, v78
    v_max3_f32 v222, v222, v85, v86
    v_mfma_f32_16x16x32_bf16 a[16:19], a[200:203], v[136:139], a[16:19]
    v_exp_f32 v119, v119
    v_mfma_f32_16x16x32_bf16 a[20:23], a[200:203], v[140:143], a[20:23]
    v_cvt_pk_bf16_f32 v155, v118, v119
    v_max3_f32 v223, v223, v93, v94
    v_mfma_f32_16x16x32_bf16 v[24:27], a[204:207], v[128:131], v[24:27]
    v_exp_f32 v120, v120
    v_mfma_f32_16x16x32_bf16 v[28:31], a[204:207], v[132:135], v[28:31]
    s_add_u32 m0, s25, 49152
    v_max3_f32 v220, v220, v71, v71
    v_max3_f32 v221, v221, v79, v79
    ds_read_b128 v[176:179], v216 offset:12288
    v_mfma_f32_16x16x32_bf16 a[24:27], a[204:207], v[136:139], a[24:27]
    s_add_u32 s35, s22, 8192
    v_exp_f32 v121, v121
    v_max3_f32 v222, v222, v87, v87
    v_mfma_f32_16x16x32_bf16 a[28:31], a[204:207], v[140:143], a[28:31]
    buffer_load_dwordx4 v234, s[12:15], s35 offen nt lds
    v_cvt_pk_bf16_f32 v156, v120, v121
    v_mfma_f32_16x16x32_bf16 v[32:35], a[208:211], v[128:131], v[32:35]
    v_exp_f32 v122, v122
    v_max3_f32 v223, v223, v95, v95
    v_mfma_f32_16x16x32_bf16 v[36:39], a[208:211], v[132:135], v[36:39]
    ds_read_b128 v[180:183], v217 offset:12288
    s_nop 0
    v_permlane32_swap_b32 v220, v221
    v_permlane32_swap_b32 v222, v223
    v_mfma_f32_16x16x32_bf16 a[32:35], a[208:211], v[136:139], a[32:35]
    v_exp_f32 v123, v123
    v_max_f32 v220, v220, v221
    v_mfma_f32_16x16x32_bf16 a[36:39], a[208:211], v[140:143], a[36:39]
    v_cvt_pk_bf16_f32 v157, v122, v123
    v_max_f32 v222, v222, v223
    ds_read_b128 v[184:187], v218 offset:12288
    v_mfma_f32_16x16x32_bf16 v[40:43], a[212:215], v[128:131], v[40:43]
    v_exp_f32 v124, v124
    v_mfma_f32_16x16x32_bf16 v[44:47], a[212:215], v[132:135], v[44:47]
    ds_read_b128 v[188:191], v219 offset:12288
    s_nop 1
    v_permlane16_swap_b32 v220, v222
    v_mfma_f32_16x16x32_bf16 a[40:43], a[212:215], v[136:139], a[40:43]
    v_exp_f32 v125, v125
    v_max_f32 v220, v220, v222
    v_mul_f32 v220, s26, v220
    v_mfma_f32_16x16x32_bf16 a[44:47], a[212:215], v[140:143], a[44:47]
    buffer_load_dwordx4 v235, s[12:15], s35 offen offset:1024 nt lds
    v_cvt_pk_bf16_f32 v158, v124, v125
    v_mfma_f32_16x16x32_bf16 v[48:51], a[216:219], v[128:131], v[48:51]
    s_lshr_b32 s24, s21, 1
    v_exp_f32 v126, v126
    v_mfma_f32_16x16x32_bf16 v[52:55], a[216:219], v[132:135], v[52:55]
    s_mov_b32 s21, s22
    v_sub_f32 v244, s27, v220
    v_sub_f32 v246, s27, v220
    v_mfma_f32_16x16x32_bf16 a[48:51], a[216:219], v[136:139], a[48:51]
    s_add_u32 s20, s20, 131072
    v_exp_f32 v127, v127
    v_mfma_f32_16x16x32_bf16 a[52:55], a[216:219], v[140:143], a[52:55]
    s_add_u32 s22, s20, 131072
    v_cvt_pk_bf16_f32 v159, v126, v127
    s_nop 1
    v_permlane16_swap_b32 v244, v246
    v_mfma_f32_16x16x32_bf16 v[56:59], a[220:223], v[128:131], v[56:59]
    s_xor_b32 s22, s22, s32
    v_mov_b32 v245, v244
    v_mfma_f32_16x16x32_bf16 v[60:63], a[220:223], v[132:135], v[60:63]
    v_mov_b32 v247, v246
    v_mfma_f32_16x16x32_bf16 a[56:59], a[220:223], v[136:139], a[56:59]
    s_nop 0
    v_permlane32_swap_b32 v244, v245
    v_permlane32_swap_b32 v246, v247
    v_mfma_f32_16x16x32_bf16 a[60:63], a[220:223], v[140:143], a[60:63]
L_head:
    s_waitcnt lgkmcnt(0)
    v_pk_fma_f32 v[64:65], v[64:65], s[26:27], v[244:245] op_sel:[0,0,0] op_sel_hi:[1,0,0]
    v_pk_fma_f32 v[66:67], v[66:67], s[26:27], v[244:245] op_sel:[0,0,0] op_sel_hi:[1,0,0]
    v_pk_fma_f32 v[68:69], v[68:69], s[26:27], v[244:245] op_sel:[0,0,0] op_sel_hi:[1,0,0]
    v_pk_fma_f32 v[70:71], v[70:71], s[26:27], v[244:245] op_sel:[0,0,0] op_sel_hi:[1,0,0]
    v_pk_fma_f32 v[72:73], v[72:73], s[26:27], v[244:245] op_sel:[0,0,1] op_sel_hi:[1,0,1]
    v_pk_fma_f32 v[74:75], v[74:75], s[26:27], v[244:245] op_sel:[0,0,1] op_sel_hi:[1,0,1]
    v_pk_fma_f32 v[76:77], v[76:77], s[26:27], v[244:245] op_sel:[0,0,1] op_sel_hi:[1,0,1]
    v_pk_fma_f32 v[78:79], v[78:79], s[26:27], v[244:245] op_sel:[0,0,1] op_sel_hi:[1,0,1]
    v_pk_fma_f32 v[80:81], v[80:81], s[26:27], v[246:247] op_sel:[0,0,0] op_sel_hi:[1,0,0]
    v_pk_fma_f32 v[82:83], v[82:83], s[26:27], v[246:247] op_sel:[0,0,0] op_sel_hi:[1,0,0]
    v_pk_fma_f32 v[84:85], v[84:85], s[26:27], v[246:247] op_sel:[0,0,0] op_sel_hi:[1,0,0]
    v_pk_fma_f32 v[86:87], v[86:87], s[26:27], v[246:247] op_sel:[0,0,0] op_sel_hi:[1,0,0]
    v_pk_fma_f32 v[88:89], v[88:89], s[26:27], v[246:247] op_sel:[0,0,1] op_sel_hi:[1,0,1]
    v_pk_fma_f32 v[90:91], v[90:91], s[26:27], v[246:247] op_sel:[0,0,1] op_sel_hi:[1,0,1]
    v_pk_fma_f32 v[92:93], v[92:93], s[26:27], v[246:247] op_sel:[0,0,1] op_sel_hi:[1,0,1]
    v_pk_fma_f32 v[94:95], v[94:95], s[26:27], v[246:247] op_sel:[0,0,1] op_sel_hi:[1,0,1]
    s_nop 1
    v_mfma_f32_16x16x32_bf16 v[96:99], v[160:163], a[128:131], 0
    v_exp_f32 v64, v64
    v_mfma_f32_16x16x32_bf16 v[104:107], v[160:163], a[144:147], 0
    ds_read_b64_tr_b16 a[192:193], v224 offset:24576
    v_mfma_f32_16x16x32_bf16 v[112:115], v[160:163], a[160:163], 0
    v_exp_f32 v65, v65
    v_mfma_f32_16x16x32_bf16 v[120:123], v[160:163], a[176:179], 0
    s_add_u32 m0, s25, 0
    v_cvt_pk_bf16_f32 v128, v64, v65
    ds_read_b64_tr_b16 a[194:195], v224 offset:28672
    v_mfma_f32_16x16x32_bf16 v[96:99], v[164:167], a[132:135], v[96:99]
    s_add_u32 s35, s21, 16384
    v_exp_f32 v66, v66
    ds_read_b64_tr_b16 a[196:197], v225 offset:24576
    v_mfma_f32_16x16x32_bf16 v[104:107], v[164:167], a[148:151], v[104:107]
    ds_read_b64_tr_b16 a[198:199], v225 offset:28672
    buffer_load_dwordx4 v232, s[8:11], s35 offen nt lds
    v_mfma_f32_16x16x32_bf16 v[112:115], v[164:167], a[164:167], v[112:115]
    v_exp_f32 v67, v67
    v_mfma_f32_16x16x32_bf16 v[120:123], v[164:167], a[180:183], v[120:123]
    v_cvt_pk_bf16_f32 v129, v66, v67
    ds_read_b64_tr_b16 a[200:201], v226 offset:24576
    v_mfma_f32_16x16x32_bf16 v[96:99], v[168:171], a[136:139], v[96:99]
    v_exp_f32 v68, v68
    v_mfma_f32_16x16x32_bf16 v[104:107], v[168:171], a[152:155], v[104:107]
    ds_read_b64_tr_b16 a[202:203], v226 offset:28672
    v_mfma_f32_16x16x32_bf16 v[112:115], v[168:171], a[168:171], v[112:115]
    v_exp_f32 v69, v69
    v_mfma_f32_16x16x32_bf16 v[120:123], v[168:171], a[184:187], v[120:123]
    v_cvt_pk_bf16_f32 v130, v68, v69
    ds_read_b64_tr_b16 a[204:205], v227 offset:24576
    v_mfma_f32_16x16x32_bf16 v[96:99], v[172:175], a[140:143], v[96:99]
    v_exp_f32 v70, v70
    v_mfma_f32_16x16x32_bf16 v[104:107], v[172:175], a[156:159], v[104:107]
    ds_read_b64_tr_b16 a[206:207], v227 offset:28672
    v_mfma_f32_16x16x32_bf16 v[112:115], v[172:175], a[172:175], v[112:115]
    v_exp_f32 v71, v71
    ds_read_b64_tr_b16 a[208:209], v228 offset:24576
    v_mfma_f32_16x16x32_bf16 v[120:123], v[172:175], a[188:191], v[120:123]
    v_cvt_pk_bf16_f32 v131, v70, v71
    ds_read_b64_tr_b16 a[210:211], v228 offset:28672
    v_mfma_f32_16x16x32_bf16 v[100:103], v[176:179], a[128:131], 0
    v_exp_f32 v72, v72
    v_mfma_f32_16x16x32_bf16 v[108:111], v[176:179], a[144:147], 0
    ds_read_b64_tr_b16 a[212:213], v229 offset:24576
    v_mfma_f32_16x16x32_bf16 v[116:119], v[176:179], a[160:163], 0
    buffer_load_dwordx4 v233, s[8:11], s35 offen offset:1024 nt lds
    v_exp_f32 v73, v73
    v_mfma_f32_16x16x32_bf16 v[124:127], v[176:179], a[176:179], 0
    v_cvt_pk_bf16_f32 v132, v72, v73
    ds_read_b64_tr_b16 a[214:215], v229 offset:28672
    v_mfma_f32_16x16x32_bf16 v[100:103], v[180:183], a[132:135], v[100:103]
    v_exp_f32 v74, v74
    v_mfma_f32_16x16x32_bf16 v[108:111], v[180:183], a[148:151], v[108:111]
    ds_read_b64_tr_b16 a[216:217], v230 offset:24576
    v_mfma_f32_16x16x32_bf16 v[116:119], v[180:183], a[164:167], v[116:119]
    v_exp_f32 v75, v75
    ds_read_b64_tr_b16 a[218:219], v230 offset:28672
    v_mfma_f32_16x16x32_bf16 v[124:127], v[180:183], a[180:183], v[124:127]
    v_cvt_pk_bf16_f32 v133, v74, v75
    ds_read_b64_tr_b16 a[220:221], v231 offset:24576
    v_mfma_f32_16x16x32_bf16 v[100:103], v[184:187], a[136:139], v[100:103]
    v_exp_f32 v76, v76
    v_mfma_f32_16x16x32_bf16 v[108:111], v[184:187], a[152:155], v[108:111]
    ds_read_b64_tr_b16 a[222:223], v231 offset:28672
    v_mfma_f32_16x16x32_bf16 v[116:119], v[184:187], a[168:171], v[116:119]
    v_exp_f32 v77, v77
    v_mfma_f32_16x16x32_bf16 v[124:127], v[184:187], a[184:187], v[124:127]
    v_cvt_pk_bf16_f32 v134, v76, v77
    v_mfma_f32_16x16x32_bf16 v[100:103], v[188:191], a[140:143], v[100:103]
    v_exp_f32 v78, v78
    v_mfma_f32_16x16x32_bf16 v[108:111], v[188:191], a[156:159], v[108:111]
    v_mfma_f32_16x16x32_bf16 v[116:119], v[188:191], a[172:175], v[116:119]
    v_exp_f32 v79, v79
    v_mfma_f32_16x16x32_bf16 v[124:127], v[188:191], a[188:191], v[124:127]
    v_cvt_pk_bf16_f32 v135, v78, v79
    s_waitcnt vmcnt(10) lgkmcnt(0)
    s_barrier
    v_mfma_f32_16x16x32_bf16 a[224:227], a[240:243], v[144:147], a[224:227]
    v_exp_f32 v80, v80
    v_mfma_f32_16x16x32_bf16 a[228:231], a[240:243], v[148:151], a[228:231]
    s_add_u32 m0, s25, 57344
    ds_read_b128 v[160:163], v216 offset:16384
    v_mfma_f32_16x16x32_bf16 a[232:235], a[240:243], v[152:155], a[232:235]
    s_add_u32 s35, s21, 12288
    v_exp_f32 v81, v81
    v_mfma_f32_16x16x32_bf16 a[236:239], a[240:243], v[156:159], a[236:239]
    buffer_load_dwordx4 v234, s[12:15], s35 offen nt lds
    v_cvt_pk_bf16_f32 v136, v80, v81
    v_mfma_f32_16x16x32_bf16 v[0:3], a[192:195], v[144:147], v[0:3]
    v_exp_f32 v82, v82
    v_mfma_f32_16x16x32_bf16 v[4:7], a[192:195], v[148:151], v[4:7]
    ds_read_b128 v[164:167], v217 offset:16384
    v_mfma_f32_16x16x32_bf16 a[64:67], a[192:195], v[152:155], a[0:3]
    v_exp_f32 v83, v83
    v_mfma_f32_16x16x32_bf16 a[68:71], a[192:195], v[156:159], a[4:7]
    v_cvt_pk_bf16_f32 v137, v82, v83
    v_accvgpr_read_b32 v248, a224
    v_accvgpr_read_b32 v249, a228
    v_mfma_f32_16x16x32_bf16 v[8:11], a[196:199], v[144:147], v[8:11]
    v_exp_f32 v84, v84
    v_accvgpr_read_b32 v250, a232
    v_accvgpr_read_b32 v251, a236
    v_add_f32 v214, v248, v249
    v_mfma_f32_16x16x32_bf16 v[12:15], a[196:199], v[148:151], v[12:15]
    v_add_f32 v214, v214, v250
    v_add_f32 v214, v214, v251
    ds_read_b128 v[168:171], v218 offset:16384
    v_mfma_f32_16x16x32_bf16 a[72:75], a[196:199], v[152:155], a[8:11]
    v_exp_f32 v85, v85
    v_cmp_nge_f32 vcc, s39, v214
    v_rcp_f32 v248, v248
    v_rcp_f32 v249, v249
    v_mfma_f32_16x16x32_bf16 a[76:79], a[196:199], v[156:159], a[12:15]
    v_cvt_pk_bf16_f32 v138, v84, v85
    v_rcp_f32 v250, v250
    v_rcp_f32 v251, v251
    s_nop 0
    v_mfma_f32_16x16x32_bf16 v[16:19], a[200:203], v[144:147], v[16:19]
    v_exp_f32 v86, v86
    v_mfma_f32_16x16x32_bf16 v[20:23], a[200:203], v[148:151], v[20:23]
    v_mul_f32 v0, v0, v248
    v_mul_f32 v1, v1, v248
    ds_read_b128 v[172:175], v219 offset:16384
    v_mfma_f32_16x16x32_bf16 a[80:83], a[200:203], v[152:155], a[16:19]
    v_exp_f32 v87, v87
    v_mul_f32 v2, v2, v248
    v_mfma_f32_16x16x32_bf16 a[84:87], a[200:203], v[156:159], a[20:23]
    s_cmp_lg_u64 vcc, 0
    s_addc_u32 s38, s38, s38
    v_cvt_pk_bf16_f32 v139, v86, v87
    v_mul_f32 v3, v3, v248
    v_mfma_f32_16x16x32_bf16 v[24:27], a[204:207], v[144:147], v[24:27]
    v_exp_f32 v88, v88
    v_cvt_pk_bf16_f32 v0, v0, v1
    v_mfma_f32_16x16x32_bf16 v[28:31], a[204:207], v[148:151], v[28:31]
    v_cvt_pk_bf16_f32 v1, v2, v3
    ds_read_b128 v[176:179], v216 offset:20480
    v_mfma_f32_16x16x32_bf16 a[88:91], a[204:207], v[152:155], a[24:27]
    ds_write_b64 v240, v[0:1] offset:0
    v_exp_f32 v89, v89
    v_mul_f32 v4, v4, v249
    v_mfma_f32_16x16x32_bf16 a[92:95], a[204:207], v[156:159], a[28:31]
    buffer_load_dwordx4 v235, s[12:15], s35 offen offset:1024 nt lds
    v_cvt_pk_bf16_f32 v140, v88, v89
    v_mul_f32 v5, v5, v249
    v_mfma_f32_16x16x32_bf16 v[32:35], a[208:211], v[144:147], v[32:35]
    v_exp_f32 v90, v90
    v_mul_f32 v6, v6, v249
    v_mfma_f32_16x16x32_bf16 v[36:39], a[208:211], v[148:151], v[36:39]
    v_mul_f32 v7, v7, v249
    v_cvt_pk_bf16_f32 v4, v4, v5
    ds_read_b128 v[180:183], v217 offset:20480
    v_mfma_f32_16x16x32_bf16 a[96:99], a[208:211], v[152:155], a[32:35]
    v_exp_f32 v91, v91
    v_cvt_pk_bf16_f32 v5, v6, v7
    v_mfma_f32_16x16x32_bf16 a[100:103], a[208:211], v[156:159], a[36:39]
    ds_read_b128 v[184:187], v218 offset:20480
    ds_write_b64 v240, v[4:5] offset:4096
    v_cvt_pk_bf16_f32 v141, v90, v91
    v_mfma_f32_16x16x32_bf16 v[40:43], a[212:215], v[144:147], v[40:43]
    v_exp_f32 v92, v92
    v_mul_f32 v8, v8, v248
    v_mfma_f32_16x16x32_bf16 v[44:47], a[212:215], v[148:151], v[44:47]
    v_mul_f32 v9, v9, v248
    v_mul_f32 v10, v10, v248
    ds_read_b128 v[188:191], v219 offset:20480
    v_mfma_f32_16x16x32_bf16 a[104:107], a[212:215], v[152:155], a[40:43]
    v_exp_f32 v93, v93
    v_mul_f32 v11, v11, v248
    v_mfma_f32_16x16x32_bf16 a[108:111], a[212:215], v[156:159], a[44:47]
    v_cvt_pk_bf16_f32 v142, v92, v93
    v_cvt_pk_bf16_f32 v8, v8, v9
    v_cvt_pk_bf16_f32 v9, v10, v11
    v_mfma_f32_16x16x32_bf16 v[48:51], a[216:219], v[144:147], v[48:51]
    ds_write_b64 v241, v[8:9] offset:0
    v_exp_f32 v94, v94
    v_mfma_f32_16x16x32_bf16 v[52:55], a[216:219], v[148:151], v[52:55]
    v_mul_f32 v12, v12, v249
    v_mul_f32 v13, v13, v249
    v_mfma_f32_16x16x32_bf16 a[112:115], a[216:219], v[152:155], a[48:51]
    v_exp_f32 v95, v95
    v_mfma_f32_16x16x32_bf16 a[116:119], a[216:219], v[156:159], a[52:55]
    v_cvt_pk_bf16_f32 v143, v94, v95
    v_mul_f32 v14, v14, v249
    v_mul_f32 v15, v15, v249
    v_mfma_f32_16x16x32_bf16 v[56:59], a[220:223], v[144:147], v[56:59]
    v_cvt_pk_bf16_f32 v12, v12, v13
    v_mfma_f32_16x16x32_bf16 v[60:63], a[220:223], v[148:151], v[60:63]
    v_cvt_pk_bf16_f32 v13, v14, v15
    v_mfma_f32_16x16x32_bf16 a[120:123], a[220:223], v[152:155], a[56:59]
    v_mfma_f32_16x16x32_bf16 a[124:127], a[220:223], v[156:159], a[60:63]
    s_waitcnt lgkmcnt(0)
    v_pk_fma_f32 v[96:97], v[96:97], s[26:27], v[244:245] op_sel:[0,0,0] op_sel_hi:[1,0,0]
    v_pk_fma_f32 v[98:99], v[98:99], s[26:27], v[244:245] op_sel:[0,0,0] op_sel_hi:[1,0,0]
    v_pk_fma_f32 v[100:101], v[100:101], s[26:27], v[244:245] op_sel:[0,0,0] op_sel_hi:[1,0,0]
    v_pk_fma_f32 v[102:103], v[102:103], s[26:27], v[244:245] op_sel:[0,0,0] op_sel_hi:[1,0,0]
    v_pk_fma_f32 v[104:105], v[104:105], s[26:27], v[244:245] op_sel:[0,0,1] op_sel_hi:[1,0,1]
    v_pk_fma_f32 v[106:107], v[106:107], s[26:27], v[244:245] op_sel:[0,0,1] op_sel_hi:[1,0,1]
    v_pk_fma_f32 v[108:109], v[108:109], s[26:27], v[244:245] op_sel:[0,0,1] op_sel_hi:[1,0,1]
    v_pk_fma_f32 v[110:111], v[110:111], s[26:27], v[244:245] op_sel:[0,0,1] op_sel_hi:[1,0,1]
    v_pk_fma_f32 v[112:113], v[112:113], s[26:27], v[246:247] op_sel:[0,0,0] op_sel_hi:[1,0,0]
    v_pk_fma_f32 v[114:115], v[114:115], s[26:27], v[246:247] op_sel:[0,0,0] op_sel_hi:[1,0,0]
    v_pk_fma_f32 v[116:117], v[116:117], s[26:27], v[246:247] op_sel:[0,0,0] op_sel_hi:[1,0,0]
    v_pk_fma_f32 v[118:119], v[118:119], s[26:27], v[246:247] op_sel:[0,0,0] op_sel_hi:[1,0,0]
    v_pk_fma_f32 v[120:121], v[120:121], s[26:27], v[246:247] op_sel:[0,0,1] op_sel_hi:[1,0,1]
    v_pk_fma_f32 v[122:123], v[122:123], s[26:27], v[246:247] op_sel:[0,0,1] op_sel_hi:[1,0,1]
    v_pk_fma_f32 v[124:125], v[124:125], s[26:27], v[246:247] op_sel:[0,0,1] op_sel_hi:[1,0,1]
    v_pk_fma_f32 v[126:127], v[126:127], s[26:27], v[246:247] op_sel:[0,0,1] op_sel_hi:[1,0,1]
    s_nop 1
    v_mfma_f32_16x16x32_bf16 v[64:67], v[160:163], a[128:131], 0
    ds_write_b64 v241, v[12:13] offset:4096
    v_exp_f32 v96, v96
    v_mul_f32 v16, v16, v248
    v_mul_f32 v17, v17, v248
    v_mul_f32 v18, v18, v248
    v_mfma_f32_16x16x32_bf16 v[72:75], v[160:163], a[144:147], 0
    ds_read_b64_tr_b16 a[192:193], v224 offset:0
    v_mul_f32 v19, v19, v248
    v_cvt_pk_bf16_f32 v16, v16, v17
    v_mfma_f32_16x16x32_bf16 v[80:83], v[160:163], a[160:163], 0
    v_exp_f32 v97, v97
    v_cvt_pk_bf16_f32 v17, v18, v19
    v_mfma_f32_16x16x32_bf16 v[88:91], v[160:163], a[176:179], 0
    s_add_u32 m0, s25, 8192
    ds_read_b64_tr_b16 a[194:195], v224 offset:4096
    ds_write_b64 v242, v[16:17] offset:0
    v_cvt_pk_bf16_f32 v144, v96, v97
    v_mfma_f32_16x16x32_bf16 v[64:67], v[164:167], a[132:135], v[64:67]
    s_add_u32 s35, s21, 20480
    ds_read_b64_tr_b16 a[196:197], v225 offset:0
    v_exp_f32 v98, v98
    v_mul_f32 v20, v20, v249
    v_mul_f32 v21, v21, v249
    v_mul_f32 v22, v22, v249
    v_mfma_f32_16x16x32_bf16 v[72:75], v[164:167], a[148:151], v[72:75]
    ds_read_b64_tr_b16 a[198:199], v225 offset:4096
    buffer_load_dwordx4 v232, s[8:11], s35 offen nt lds
    v_mfma_f32_16x16x32_bf16 v[80:83], v[164:167], a[164:167], v[80:83]
    v_exp_f32 v99, v99
    v_mul_f32 v23, v23, v249
    v_mfma_f32_16x16x32_bf16 v[88:91], v[164:167], a[180:183], v[88:91]
    ds_read_b64_tr_b16 a[200:201], v226 offset:0
    v_cvt_pk_bf16_f32 v145, v98, v99
    v_cvt_pk_bf16_f32 v20, v20, v21
    v_mfma_f32_16x16x32_bf16 v[64:67], v[168:171], a[136:139], v[64:67]
    v_exp_f32 v100, v100
    v_cvt_pk_bf16_f32 v21, v22, v23
    v_mfma_f32_16x16x32_bf16 v[72:75], v[168:171], a[152:155], v[72:75]
    ds_read_b64_tr_b16 a[202:203], v226 offset:4096
    ds_write_b64 v242, v[20:21] offset:4096
    v_mul_f32 v24, v24, v248
    v_mfma_f32_16x16x32_bf16 v[80:83], v[168:171], a[168:171], v[80:83]
    v_exp_f32 v101, v101
    v_mul_f32 v25, v25, v248
    v_mfma_f32_16x16x32_bf16 v[88:91], v[168:171], a[184:187], v[88:91]
    ds_read_b64_tr_b16 a[204:205], v227 offset:0
    v_cvt_pk_bf16_f32 v146, v100, v101
    v_mul_f32 v26, v26, v248
    v_mul_f32 v27, v27, v248
    v_mfma_f32_16x16x32_bf16 v[64:67], v[172:175], a[140:143], v[64:67]
    v_exp_f32 v102, v102
    v_cvt_pk_bf16_f32 v24, v24, v25
    v_mfma_f32_16x16x32_bf16 v[72:75], v[172:175], a[156:159], v[72:75]
    ds_read_b64_tr_b16 a[206:207], v227 offset:4096
    v_cvt_pk_bf16_f32 v25, v26, v27
    v_mfma_f32_16x16x32_bf16 v[80:83], v[172:175], a[172:175], v[80:83]
    ds_read_b64_tr_b16 a[208:209], v228 offset:0
    ds_write_b64 v243, v[24:25] offset:0
    v_exp_f32 v103, v103
    v_mul_f32 v28, v28, v249
    v_mfma_f32_16x16x32_bf16 v[88:91], v[172:175], a[188:191], v[88:91]
    ds_read_b64_tr_b16 a[210:211], v228 offset:4096
    v_cvt_pk_bf16_f32 v147, v102, v103
    v_mul_f32 v29, v29, v249
    v_mfma_f32_16x16x32_bf16 v[68:71], v[176:179], a[128:131], 0
    v_exp_f32 v104, v104
    v_mul_f32 v30, v30, v249
    v_mfma_f32_16x16x32_bf16 v[76:79], v[176:179], a[144:147], 0
    ds_read_b64_tr_b16 a[212:213], v229 offset:0
    v_mul_f32 v31, v31, v249
    v_cvt_pk_bf16_f32 v28, v28, v29
    v_cvt_pk_bf16_f32 v29, v30, v31
    v_mfma_f32_16x16x32_bf16 v[84:87], v[176:179], a[160:163], 0
    buffer_load_dwordx4 v233, s[8:11], s35 offen offset:1024 nt lds
    v_exp_f32 v105, v105
    v_mfma_f32_16x16x32_bf16 v[92:95], v[176:179], a[176:179], 0
    ds_read_b64_tr_b16 a[214:215], v229 offset:4096
    ds_write_b64 v243, v[28:29] offset:4096
    v_cvt_pk_bf16_f32 v148, v104, v105
    v_mfma_f32_16x16x32_bf16 v[68:71], v[180:183], a[132:135], v[68:71]
    v_exp_f32 v106, v106
    v_mul_f32 v32, v32, v248
    v_mfma_f32_16x16x32_bf16 v[76:79], v[180:183], a[148:151], v[76:79]
    ds_read_b64_tr_b16 a[216:217], v230 offset:0
    v_mul_f32 v33, v33, v248
    v_mul_f32 v34, v34, v248
    v_mul_f32 v35, v35, v248
    v_mfma_f32_16x16x32_bf16 v[84:87], v[180:183], a[164:167], v[84:87]
    ds_read_b64_tr_b16 a[218:219], v230 offset:4096
    v_exp_f32 v107, v107
    v_mfma_f32_16x16x32_bf16 v[92:95], v[180:183], a[180:183], v[92:95]
    ds_read_b64_tr_b16 a[220:221], v231 offset:0
    v_cvt_pk_bf16_f32 v149, v106, v107
    v_cvt_pk_bf16_f32 v32, v32, v33
    v_mfma_f32_16x16x32_bf16 v[68:71], v[184:187], a[136:139], v[68:71]
    v_exp_f32 v108, v108
    v_cvt_pk_bf16_f32 v33, v34, v35
    v_mfma_f32_16x16x32_bf16 v[76:79], v[184:187], a[152:155], v[76:79]
    ds_read_b64_tr_b16 a[222:223], v231 offset:4096
    ds_write_b64 v240, v[32:33] offset:128
    v_mul_f32 v36, v36, v249
    v_mfma_f32_16x16x32_bf16 v[84:87], v[184:187], a[168:171], v[84:87]
    v_exp_f32 v109, v109
    v_mul_f32 v37, v37, v249
    v_mfma_f32_16x16x32_bf16 v[92:95], v[184:187], a[184:187], v[92:95]
    v_cvt_pk_bf16_f32 v150, v108, v109
    v_mul_f32 v38, v38, v249
    v_mul_f32 v39, v39, v249
    v_mfma_f32_16x16x32_bf16 v[68:71], v[188:191], a[140:143], v[68:71]
    v_exp_f32 v110, v110
    v_cvt_pk_bf16_f32 v36, v36, v37
    v_mfma_f32_16x16x32_bf16 v[76:79], v[188:191], a[156:159], v[76:79]
    v_cvt_pk_bf16_f32 v37, v38, v39
    v_mfma_f32_16x16x32_bf16 v[84:87], v[188:191], a[172:175], v[84:87]
    v_exp_f32 v111, v111
    v_mfma_f32_16x16x32_bf16 v[92:95], v[188:191], a[188:191], v[92:95]
    v_cvt_pk_bf16_f32 v151, v110, v111
    s_waitcnt vmcnt(10) lgkmcnt(0)
    s_barrier
    v_mfma_f32_16x16x32_bf16 a[224:227], a[240:243], v[128:131], 0
    ds_write_b64 v240, v[36:37] offset:4224
    v_exp_f32 v112, v112
    v_mul_f32 v40, v40, v248
    v_mul_f32 v41, v41, v248
    v_mul_f32 v42, v42, v248
    v_mfma_f32_16x16x32_bf16 a[228:231], a[240:243], v[132:135], 0
    s_add_u32 m0, s29, 18432
    ds_read_b128 v[160:163], v216 offset:24576
    v_mul_f32 v43, v43, v248
    v_cvt_pk_bf16_f32 v40, v40, v41
    v_mfma_f32_16x16x32_bf16 a[232:235], a[240:243], v[136:139], 0
    s_add_u32 s35, s23, 2048
    v_exp_f32 v113, v113
    v_cvt_pk_bf16_f32 v41, v42, v43
    v_mfma_f32_16x16x32_bf16 a[236:239], a[240:243], v[140:143], 0
    buffer_load_dwordx4 v238, s[4:7], s35 offen nt lds
    ds_write_b64 v241, v[40:41] offset:128
    v_cvt_pk_bf16_f32 v152, v112, v113
    v_mfma_f32_16x16x32_bf16 v[0:3], a[192:195], v[128:131], 0
    v_exp_f32 v114, v114
    v_mul_f32 v44, v44, v249
    v_mul_f32 v45, v45, v249
    v_mfma_f32_16x16x32_bf16 v[4:7], a[192:195], v[132:135], 0
    ds_read_b128 v[164:167], v217 offset:24576
    v_mul_f32 v46, v46, v249
    v_mul_f32 v47, v47, v249
    v_mfma_f32_16x16x32_bf16 a[0:3], a[192:195], v[136:139], 0
    v_exp_f32 v115, v115
    v_mfma_f32_16x16x32_bf16 a[4:7], a[192:195], v[140:143], 0
    v_cvt_pk_bf16_f32 v153, v114, v115
    v_cvt_pk_bf16_f32 v44, v44, v45
    v_cvt_pk_bf16_f32 v45, v46, v47
    v_mfma_f32_16x16x32_bf16 v[8:11], a[196:199], v[128:131], 0
    ds_write_b64 v241, v[44:45] offset:4224
    v_exp_f32 v116, v116
    v_mfma_f32_16x16x32_bf16 v[12:15], a[196:199], v[132:135], 0
    ds_read_b128 v[168:171], v218 offset:24576
    v_mul_f32 v48, v48, v248
    v_mul_f32 v49, v49, v248
    v_mfma_f32_16x16x32_bf16 a[8:11], a[196:199], v[136:139], 0
    v_exp_f32 v117, v117
    v_mul_f32 v50, v50, v248
    v_mul_f32 v51, v51, v248
    v_mfma_f32_16x16x32_bf16 a[12:15], a[196:199], v[140:143], 0
    buffer_load_dwordx4 v239, s[4:7], s35 offen offset:1024 nt lds
    v_cvt_pk_bf16_f32 v154, v116, v117
    v_mfma_f32_16x16x32_bf16 v[16:19], a[200:203], v[128:131], 0
    v_exp_f32 v118, v118
    v_cvt_pk_bf16_f32 v48, v48, v49
    v_mfma_f32_16x16x32_bf16 v[20:23], a[200:203], v[132:135], 0
    ds_read_b128 v[172:175], v219 offset:24576
    v_cvt_pk_bf16_f32 v49, v50, v51
    v_mfma_f32_16x16x32_bf16 a[16:19], a[200:203], v[136:139], 0
    ds_write_b64 v242, v[48:49] offset:128
    v_exp_f32 v119, v119
    v_mul_f32 v52, v52, v249
    v_mfma_f32_16x16x32_bf16 a[20:23], a[200:203], v[140:143], 0
    v_cvt_pk_bf16_f32 v155, v118, v119
    v_mul_f32 v53, v53, v249
    v_mul_f32 v54, v54, v249
    v_mfma_f32_16x16x32_bf16 v[24:27], a[204:207], v[128:131], 0
    v_exp_f32 v120, v120
    v_mfma_f32_16x16x32_bf16 v[28:31], a[204:207], v[132:135], 0
    s_add_u32 m0, s25, 32768
    ds_read_b128 v[176:179], v216 offset:28672
    v_mul_f32 v55, v55, v249
    v_cvt_pk_bf16_f32 v52, v52, v53
    v_mfma_f32_16x16x32_bf16 a[24:27], a[204:207], v[136:139], 0
    s_add_u32 s35, s21, 16384
    v_exp_f32 v121, v121
    v_cvt_pk_bf16_f32 v53, v54, v55
    v_mfma_f32_16x16x32_bf16 a[28:31], a[204:207], v[140:143], 0
    buffer_load_dwordx4 v234, s[12:15], s35 offen nt lds
    ds_write_b64 v242, v[52:53] offset:4224
    v_cvt_pk_bf16_f32 v156, v120, v121
    v_mfma_f32_16x16x32_bf16 v[32:35], a[208:211], v[128:131], 0
    v_exp_f32 v122, v122
    v_mul_f32 v56, v56, v248
    v_mul_f32 v57, v57, v248
    v_mfma_f32_16x16x32_bf16 v[36:39], a[208:211], v[132:135], 0
    ds_read_b128 v[180:183], v217 offset:28672
    v_mul_f32 v58, v58, v248
    v_mul_f32 v59, v59, v248
    v_mfma_f32_16x16x32_bf16 a[32:35], a[208:211], v[136:139], 0
    v_exp_f32 v123, v123
    v_cvt_pk_bf16_f32 v56, v56, v57
    v_mfma_f32_16x16x32_bf16 a[36:39], a[208:211], v[140:143], 0
    ds_read_b128 v[184:187], v218 offset:28672
    v_cvt_pk_bf16_f32 v157, v122, v123
    v_cvt_pk_bf16_f32 v57, v58, v59
    v_mfma_f32_16x16x32_bf16 v[40:43], a[212:215], v[128:131], 0
    ds_write_b64 v243, v[56:57] offset:128
    v_exp_f32 v124, v124
    v_mfma_f32_16x16x32_bf16 v[44:47], a[212:215], v[132:135], 0
    ds_read_b128 v[188:191], v219 offset:28672
    v_mul_f32 v60, v60, v249
    v_mul_f32 v61, v61, v249
    v_mfma_f32_16x16x32_bf16 a[40:43], a[212:215], v[136:139], 0
    v_exp_f32 v125, v125
    v_mul_f32 v62, v62, v249
    v_mul_f32 v63, v63, v249
    v_mfma_f32_16x16x32_bf16 a[44:47], a[212:215], v[140:143], 0
    buffer_load_dwordx4 v235, s[12:15], s35 offen offset:1024 nt lds
    v_cvt_pk_bf16_f32 v158, v124, v125
    v_mfma_f32_16x16x32_bf16 v[48:51], a[216:219], v[128:131], 0
    v_exp_f32 v126, v126
    v_cvt_pk_bf16_f32 v60, v60, v61
    v_mfma_f32_16x16x32_bf16 v[52:55], a[216:219], v[132:135], 0
    v_cvt_pk_bf16_f32 v61, v62, v63
    v_mfma_f32_16x16x32_bf16 a[48:51], a[216:219], v[136:139], 0
    ds_write_b64 v243, v[60:61] offset:4224
    v_exp_f32 v127, v127
    v_mfma_f32_16x16x32_bf16 a[52:55], a[216:219], v[140:143], 0
    v_cvt_pk_bf16_f32 v159, v126, v127
    v_mfma_f32_16x16x32_bf16 v[56:59], a[220:223], v[128:131], 0
    v_mfma_f32_16x16x32_bf16 v[60:63], a[220:223], v[132:135], 0
    v_mfma_f32_16x16x32_bf16 a[56:59], a[220:223], v[136:139], 0
    v_mfma_f32_16x16x32_bf16 a[60:63], a[220:223], v[140:143], 0
    s_waitcnt lgkmcnt(0)
    v_pk_fma_f32 v[64:65], v[64:65], s[26:27], v[244:245] op_sel:[0,0,0] op_sel_hi:[1,0,0]
    v_pk_fma_f32 v[66:67], v[66:67], s[26:27], v[244:245] op_sel:[0,0,0] op_sel_hi:[1,0,0]
    v_pk_fma_f32 v[68:69], v[68:69], s[26:27], v[244:245] op_sel:[0,0,0] op_sel_hi:[1,0,0]
    v_pk_fma_f32 v[70:71], v[70:71], s[26:27], v[244:245] op_sel:[0,0,0] op_sel_hi:[1,0,0]
    v_pk_fma_f32 v[72:73], v[72:73], s[26:27], v[244:245] op_sel:[0,0,1] op_sel_hi:[1,0,1]
    v_pk_fma_f32 v[74:75], v[74:75], s[26:27], v[244:245] op_sel:[0,0,1] op_sel_hi:[1,0,1]
    v_pk_fma_f32 v[76:77], v[76:77], s[26:27], v[244:245] op_sel:[0,0,1] op_sel_hi:[1,0,1]
    v_pk_fma_f32 v[78:79], v[78:79], s[26:27], v[244:245] op_sel:[0,0,1] op_sel_hi:[1,0,1]
    v_pk_fma_f32 v[80:81], v[80:81], s[26:27], v[246:247] op_sel:[0,0,0] op_sel_hi:[1,0,0]
    v_pk_fma_f32 v[82:83], v[82:83], s[26:27], v[246:247] op_sel:[0,0,0] op_sel_hi:[1,0,0]
    v_pk_fma_f32 v[84:85], v[84:85], s[26:27], v[246:247] op_sel:[0,0,0] op_sel_hi:[1,0,0]
    v_pk_fma_f32 v[86:87], v[86:87], s[26:27], v[246:247] op_sel:[0,0,0] op_sel_hi:[1,0,0]
    v_pk_fma_f32 v[88:89], v[88:89], s[26:27], v[246:247] op_sel:[0,0,1] op_sel_hi:[1,0,1]
    v_pk_fma_f32 v[90:91], v[90:91], s[26:27], v[246:247] op_sel:[0,0,1] op_sel_hi:[1,0,1]
    v_pk_fma_f32 v[92:93], v[92:93], s[26:27], v[246:247] op_sel:[0,0,1] op_sel_hi:[1,0,1]
    v_pk_fma_f32 v[94:95], v[94:95], s[26:27], v[246:247] op_sel:[0,0,1] op_sel_hi:[1,0,1]
    s_nop 1
    v_mfma_f32_16x16x32_bf16 v[96:99], v[160:163], a[128:131], 0
    v_exp_f32 v64, v64
    v_mfma_f32_16x16x32_bf16 v[104:107], v[160:163], a[144:147], 0
    v_accvgpr_read_b32 v200, a64
    v_accvgpr_read_b32 v201, a65
    ds_read_b64_tr_b16 a[192:193], v224 offset:8192
    v_mfma_f32_16x16x32_bf16 v[112:115], v[160:163], a[160:163], 0
    v_exp_f32 v65, v65
    ds_read_b64_tr_b16 a[194:195], v224 offset:12288
    v_mfma_f32_16x16x32_bf16 v[120:123], v[160:163], a[176:179], 0
    s_add_u32 m0, s25, 16384
    v_cvt_pk_bf16_f32 v128, v64, v65
    ds_read_b64_tr_b16 a[196:197], v225 offset:8192
    v_mfma_f32_16x16x32_bf16 v[96:99], v[164:167], a[132:135], v[96:99]
    s_add_u32 s35, s21, 24576
    v_exp_f32 v66, v66
    v_accvgpr_read_b32 v202, a66
    v_mfma_f32_16x16x32_bf16 v[104:107], v[164:167], a[148:151], v[104:107]
    ds_read_b64_tr_b16 a[198:199], v225 offset:12288
    buffer_load_dwordx4 v232, s[8:11], s35 offen nt lds
    v_mfma_f32_16x16x32_bf16 v[112:115], v[164:167], a[164:167], v[112:115]
    v_exp_f32 v67, v67
    v_mfma_f32_16x16x32_bf16 v[120:123], v[164:167], a[180:183], v[120:123]
    v_cvt_pk_bf16_f32 v129, v66, v67
    ds_read_b64_tr_b16 a[200:201], v226 offset:8192
    v_mfma_f32_16x16x32_bf16 v[96:99], v[168:171], a[136:139], v[96:99]
    v_exp_f32 v68, v68
    ds_read_b64_tr_b16 a[202:203], v226 offset:12288
    v_mfma_f32_16x16x32_bf16 v[104:107], v[168:171], a[152:155], v[104:107]
    v_accvgpr_read_b32 v203, a67
    ds_read_b64_tr_b16 a[204:205], v227 offset:8192
    v_mfma_f32_16x16x32_bf16 v[112:115], v[168:171], a[168:171], v[112:115]
    v_exp_f32 v69, v69
    v_mfma_f32_16x16x32_bf16 v[120:123], v[168:171], a[184:187], v[120:123]
    v_cvt_pk_bf16_f32 v130, v68, v69
    ds_read_b64_tr_b16 a[206:207], v227 offset:12288
    v_mfma_f32_16x16x32_bf16 v[96:99], v[172:175], a[140:143], v[96:99]
    v_exp_f32 v70, v70
    v_mfma_f32_16x16x32_bf16 v[104:107], v[172:175], a[156:159], v[104:107]
    v_mul_f32 v200, v200, v250
    v_mul_f32 v201, v201, v250
    ds_read_b64_tr_b16 a[208:209], v228 offset:8192
    v_mfma_f32_16x16x32_bf16 v[112:115], v[172:175], a[172:175], v[112:115]
    v_exp_f32 v71, v71
    ds_read_b64_tr_b16 a[210:211], v228 offset:12288
    v_mfma_f32_16x16x32_bf16 v[120:123], v[172:175], a[188:191], v[120:123]
    v_cvt_pk_bf16_f32 v131, v70, v71
    ds_read_b64_tr_b16 a[212:213], v229 offset:8192
    v_mfma_f32_16x16x32_bf16 v[100:103], v[176:179], a[128:131], 0
    v_exp_f32 v72, v72
    v_mfma_f32_16x16x32_bf16 v[108:111], v[176:179], a[144:147], 0
    v_mul_f32 v202, v202, v250
    ds_read_b64_tr_b16 a[214:215], v229 offset:12288
    v_mfma_f32_16x16x32_bf16 v[116:119], v[176:179], a[160:163], 0
    v_exp_f32 v73, v73
    ds_read_b64_tr_b16 a[216:217], v230 offset:8192
    v_mfma_f32_16x16x32_bf16 v[124:127], v[176:179], a[176:179], 0
    ds_read_b64_tr_b16 a[218:219], v230 offset:12288
    buffer_load_dwordx4 v233, s[8:11], s35 offen offset:1024 nt lds
    v_cvt_pk_bf16_f32 v132, v72, v73
    v_mfma_f32_16x16x32_bf16 v[100:103], v[180:183], a[132:135], v[100:103]
    v_exp_f32 v74, v74
    v_mfma_f32_16x16x32_bf16 v[108:111], v[180:183], a[148:151], v[108:111]
    v_mul_f32 v203, v203, v250
    v_cvt_pk_bf16_f32 v200, v200, v201
    ds_read_b64_tr_b16 a[220:221], v231 offset:8192
    v_mfma_f32_16x16x32_bf16 v[116:119], v[180:183], a[164:167], v[116:119]
    v_exp_f32 v75, v75
    v_mfma_f32_16x16x32_bf16 v[124:127], v[180:183], a[180:183], v[124:127]
    v_cvt_pk_bf16_f32 v133, v74, v75
    ds_read_b64_tr_b16 a[222:223], v231 offset:12288
    v_mfma_f32_16x16x32_bf16 v[100:103], v[184:187], a[136:139], v[100:103]
    v_exp_f32 v76, v76
    ds_read_b128 v[192:195], v215 offset:0
    v_mfma_f32_16x16x32_bf16 v[108:111], v[184:187], a[152:155], v[108:111]
    v_cvt_pk_bf16_f32 v201, v202, v203
    ds_read_b128 v[196:199], v215 offset:1024
    v_mfma_f32_16x16x32_bf16 v[116:119], v[184:187], a[168:171], v[116:119]
    v_exp_f32 v77, v77
    v_mfma_f32_16x16x32_bf16 v[124:127], v[184:187], a[184:187], v[124:127]
    ds_write_b64 v240, v[200:201] offset:8192
    v_cvt_pk_bf16_f32 v134, v76, v77
    v_mfma_f32_16x16x32_bf16 v[100:103], v[188:191], a[140:143], v[100:103]
    v_mfma_f32_16x16x32_bf16 v[108:111], v[188:191], a[156:159], v[108:111]
    v_mfma_f32_16x16x32_bf16 v[116:119], v[188:191], a[172:175], v[116:119]
    v_exp_f32 v78, v78
    v_accvgpr_read_b32 v204, a72
    v_exp_f32 v79, v79
    v_mfma_f32_16x16x32_bf16 v[124:127], v[188:191], a[188:191], v[124:127]
    v_cvt_pk_bf16_f32 v135, v78, v79
    v_accvgpr_read_b32 v205, a73
    s_waitcnt vmcnt(10) lgkmcnt(0)
    s_barrier
    v_mfma_f32_16x16x32_bf16 a[224:227], a[240:243], v[144:147], a[224:227]
    v_mfma_f32_16x16x32_bf16 a[228:231], a[240:243], v[148:151], a[228:231]
    v_exp_f32 v80, v80
    ds_read_b128 v[160:163], v216 offset:0
    v_mfma_f32_16x16x32_bf16 a[232:235], a[240:243], v[152:155], a[232:235]
    s_add_u32 s35, s24, 0
    v_exp_f32 v81, v81
    v_mfma_f32_16x16x32_bf16 a[236:239], a[240:243], v[156:159], a[236:239]
    buffer_store_dwordx4 v[192:195], v236, s[16:19], s35 offen sc1
    v_cvt_pk_bf16_f32 v136, v80, v81
    v_mfma_f32_16x16x32_bf16 v[0:3], a[192:195], v[144:147], v[0:3]
    v_exp_f32 v82, v82
    v_mfma_f32_16x16x32_bf16 v[4:7], a[192:195], v[148:151], v[4:7]
    v_accvgpr_read_b32 v206, a74
    ds_read_b128 v[164:167], v217 offset:0
    v_mfma_f32_16x16x32_bf16 a[0:3], a[192:195], v[152:155], a[0:3]
    v_exp_f32 v83, v83
    v_mfma_f32_16x16x32_bf16 a[4:7], a[192:195], v[156:159], a[4:7]
    v_mfma_f32_16x16x32_bf16 v[8:11], a[196:199], v[144:147], v[8:11]
    v_cvt_pk_bf16_f32 v137, v82, v83
    v_accvgpr_read_b32 v207, a75
    v_exp_f32 v84, v84
    v_mfma_f32_16x16x32_bf16 v[12:15], a[196:199], v[148:151], v[12:15]
    v_mul_f32 v204, v204, v250
    ds_read_b128 v[168:171], v218 offset:0
    v_mfma_f32_16x16x32_bf16 a[8:11], a[196:199], v[152:155], a[8:11]
    v_exp_f32 v85, v85
    v_mfma_f32_16x16x32_bf16 a[12:15], a[196:199], v[156:159], a[12:15]
    buffer_store_dwordx4 v[196:199], v237, s[16:19], s35 offen offset:1024 sc1
    v_cvt_pk_bf16_f32 v138, v84, v85
    v_mfma_f32_16x16x32_bf16 v[16:19], a[200:203], v[144:147], v[16:19]
    v_exp_f32 v86, v86
    v_mfma_f32_16x16x32_bf16 v[20:23], a[200:203], v[148:151], v[20:23]
    v_mul_f32 v205, v205, v250
    ds_read_b128 v[172:175], v219 offset:0
    v_mfma_f32_16x16x32_bf16 a[16:19], a[200:203], v[152:155], a[16:19]
    v_exp_f32 v87, v87
    v_mfma_f32_16x16x32_bf16 a[20:23], a[200:203], v[156:159], a[20:23]
    v_mfma_f32_16x16x32_bf16 v[24:27], a[204:207], v[144:147], v[24:27]
    v_cvt_pk_bf16_f32 v139, v86, v87
    v_mul_f32 v206, v206, v250
    v_exp_f32 v88, v88
    v_mfma_f32_16x16x32_bf16 v[28:31], a[204:207], v[148:151], v[28:31]
    s_add_u32 m0, s25, 40960
    v_mul_f32 v207, v207, v250
    ds_read_b128 v[176:179], v216 offset:4096
    v_mfma_f32_16x16x32_bf16 a[24:27], a[204:207], v[152:155], a[24:27]
    s_add_u32 s35, s21, 20480
    v_exp_f32 v89, v89
    v_mfma_f32_16x16x32_bf16 a[28:31], a[204:207], v[156:159], a[28:31]
    buffer_load_dwordx4 v234, s[12:15], s35 offen nt lds
    v_cvt_pk_bf16_f32 v140, v88, v89
    v_mfma_f32_16x16x32_bf16 v[32:35], a[208:211], v[144:147], v[32:35]
    v_exp_f32 v90, v90
    v_mfma_f32_16x16x32_bf16 v[36:39], a[208:211], v[148:151], v[36:39]
    v_cvt_pk_bf16_f32 v204, v204, v205
    ds_read_b128 v[180:183], v217 offset:4096
    v_mfma_f32_16x16x32_bf16 a[32:35], a[208:211], v[152:155], a[32:35]
    v_exp_f32 v91, v91
    v_mfma_f32_16x16x32_bf16 a[36:39], a[208:211], v[156:159], a[36:39]
    v_cvt_pk_bf16_f32 v141, v90, v91
    ds_read_b128 v[184:187], v218 offset:4096
    v_mfma_f32_16x16x32_bf16 v[40:43], a[212:215], v[144:147], v[40:43]
    v_exp_f32 v92, v92
    v_mfma_f32_16x16x32_bf16 v[44:47], a[212:215], v[148:151], v[44:47]
    v_cvt_pk_bf16_f32 v205, v206, v207
    ds_read_b128 v[188:191], v219 offset:4096
    v_mfma_f32_16x16x32_bf16 a[40:43], a[212:215], v[152:155], a[40:43]
    ds_write_b64 v241, v[204:205] offset:8192
    v_exp_f32 v93, v93
    v_mfma_f32_16x16x32_bf16 a[44:47], a[212:215], v[156:159], a[44:47]
    buffer_load_dwordx4 v235, s[12:15], s35 offen offset:1024 nt lds
    v_cvt_pk_bf16_f32 v142, v92, v93
    v_mfma_f32_16x16x32_bf16 v[48:51], a[216:219], v[144:147], v[48:51]
    v_mfma_f32_16x16x32_bf16 v[52:55], a[216:219], v[148:151], v[52:55]
    v_exp_f32 v94, v94
    v_mfma_f32_16x16x32_bf16 a[48:51], a[216:219], v[152:155], a[48:51]
    v_exp_f32 v95, v95
    v_mfma_f32_16x16x32_bf16 a[52:55], a[216:219], v[156:159], a[52:55]
    v_cvt_pk_bf16_f32 v143, v94, v95
    v_mfma_f32_16x16x32_bf16 v[56:59], a[220:223], v[144:147], v[56:59]
    v_mfma_f32_16x16x32_bf16 v[60:63], a[220:223], v[148:151], v[60:63]
    v_mfma_f32_16x16x32_bf16 a[56:59], a[220:223], v[152:155], a[56:59]
    v_mfma_f32_16x16x32_bf16 a[60:63], a[220:223], v[156:159], a[60:63]
    s_waitcnt lgkmcnt(0)
    v_pk_fma_f32 v[96:97], v[96:97], s[26:27], v[244:245] op_sel:[0,0,0] op_sel_hi:[1,0,0]
    v_pk_fma_f32 v[98:99], v[98:99], s[26:27], v[244:245] op_sel:[0,0,0] op_sel_hi:[1,0,0]
    v_pk_fma_f32 v[100:101], v[100:101], s[26:27], v[244:245] op_sel:[0,0,0] op_sel_hi:[1,0,0]
    v_pk_fma_f32 v[102:103], v[102:103], s[26:27], v[244:245] op_sel:[0,0,0] op_sel_hi:[1,0,0]
    v_pk_fma_f32 v[104:105], v[104:105], s[26:27], v[244:245] op_sel:[0,0,1] op_sel_hi:[1,0,1]
    v_pk_fma_f32 v[106:107], v[106:107], s[26:27], v[244:245] op_sel:[0,0,1] op_sel_hi:[1,0,1]
    v_pk_fma_f32 v[108:109], v[108:109], s[26:27], v[244:245] op_sel:[0,0,1] op_sel_hi:[1,0,1]
    v_pk_fma_f32 v[110:111], v[110:111], s[26:27], v[244:245] op_sel:[0,0,1] op_sel_hi:[1,0,1]
    v_pk_fma_f32 v[112:113], v[112:113], s[26:27], v[246:247] op_sel:[0,0,0] op_sel_hi:[1,0,0]
    v_pk_fma_f32 v[114:115], v[114:115], s[26:27], v[246:247] op_sel:[0,0,0] op_sel_hi:[1,0,0]
    v_pk_fma_f32 v[116:117], v[116:117], s[26:27], v[246:247] op_sel:[0,0,0] op_sel_hi:[1,0,0]
    v_pk_fma_f32 v[118:119], v[118:119], s[26:27], v[246:247] op_sel:[0,0,0] op_sel_hi:[1,0,0]
    v_pk_fma_f32 v[120:121], v[120:121], s[26:27], v[246:247] op_sel:[0,0,1] op_sel_hi:[1,0,1]
    v_pk_fma_f32 v[122:123], v[122:123], s[26:27], v[246:247] op_sel:[0,0,1] op_sel_hi:[1,0,1]
    v_pk_fma_f32 v[124:125], v[124:125], s[26:27], v[246:247] op_sel:[0,0,1] op_sel_hi:[1,0,1]
    v_pk_fma_f32 v[126:127], v[126:127], s[26:27], v[246:247] op_sel:[0,0,1] op_sel_hi:[1,0,1]
    s_nop 1
    v_mfma_f32_16x16x32_bf16 v[64:67], v[160:163], a[128:131], 0
    v_mfma_f32_16x16x32_bf16 v[72:75], v[160:163], a[144:147], 0
    v_exp_f32 v96, v96
    v_accvgpr_read_b32 v200, a80
    ds_read_b64_tr_b16 a[192:193], v224 offset:16384
    v_mfma_f32_16x16x32_bf16 v[80:83], v[160:163], a[160:163], 0
    v_exp_f32 v97, v97
    v_mfma_f32_16x16x32_bf16 v[88:91], v[160:163], a[176:179], 0
    s_add_u32 m0, s25, 24576
    v_cvt_pk_bf16_f32 v144, v96, v97
    ds_read_b64_tr_b16 a[194:195], v224 offset:20480
    v_mfma_f32_16x16x32_bf16 v[64:67], v[164:167], a[132:135], v[64:67]
    s_add_u32 s35, s21, 28672
    v_exp_f32 v98, v98
    ds_read_b64_tr_b16 a[196:197], v225 offset:16384
    v_mfma_f32_16x16x32_bf16 v[72:75], v[164:167], a[148:151], v[72:75]
    ds_read_b64_tr_b16 a[198:199], v225 offset:20480
    buffer_load_dwordx4 v232, s[8:11], s35 offen nt lds
    v_mfma_f32_16x16x32_bf16 v[80:83], v[164:167], a[164:167], v[80:83]
    v_exp_f32 v99, v99
    v_mfma_f32_16x16x32_bf16 v[88:91], v[164:167], a[180:183], v[88:91]
    v_cvt_pk_bf16_f32 v145, v98, v99
    ds_read_b64_tr_b16 a[200:201], v226 offset:16384
    v_mfma_f32_16x16x32_bf16 v[64:67], v[168:171], a[136:139], v[64:67]
    v_mfma_f32_16x16x32_bf16 v[72:75], v[168:171], a[152:155], v[72:75]
    v_exp_f32 v100, v100
    v_accvgpr_read_b32 v201, a81
    ds_read_b64_tr_b16 a[202:203], v226 offset:20480
    v_mfma_f32_16x16x32_bf16 v[80:83], v[168:171], a[168:171], v[80:83]
    v_exp_f32 v101, v101
    v_mfma_f32_16x16x32_bf16 v[88:91], v[168:171], a[184:187], v[88:91]
    v_cvt_pk_bf16_f32 v146, v100, v101
    ds_read_b64_tr_b16 a[204:205], v227 offset:16384
    v_mfma_f32_16x16x32_bf16 v[64:67], v[172:175], a[140:143], v[64:67]
    v_mfma_f32_16x16x32_bf16 v[72:75], v[172:175], a[156:159], v[72:75]
    v_exp_f32 v102, v102
    v_accvgpr_read_b32 v202, a82
    ds_read_b64_tr_b16 a[206:207], v227 offset:20480
    v_mfma_f32_16x16x32_bf16 v[80:83], v[172:175], a[172:175], v[80:83]
    v_exp_f32 v103, v103
    ds_read_b64_tr_b16 a[208:209], v228 offset:16384
    v_mfma_f32_16x16x32_bf16 v[88:91], v[172:175], a[188:191], v[88:91]
    v_cvt_pk_bf16_f32 v147, v102, v103
    ds_read_b64_tr_b16 a[210:211], v228 offset:20480
    v_mfma_f32_16x16x32_bf16 v[68:71], v[176:179], a[128:131], 0
    v_mfma_f32_16x16x32_bf16 v[76:79], v[176:179], a[144:147], 0
    v_exp_f32 v104, v104
    v_accvgpr_read_b32 v203, a83
    ds_read_b64_tr_b16 a[212:213], v229 offset:16384
    v_mfma_f32_16x16x32_bf16 v[84:87], v[176:179], a[160:163], 0
    buffer_load_dwordx4 v233, s[8:11], s35 offen offset:1024 nt lds
    v_exp_f32 v105, v105
    v_mfma_f32_16x16x32_bf16 v[92:95], v[176:179], a[176:179], 0
    v_cvt_pk_bf16_f32 v148, v104, v105
    ds_read_b64_tr_b16 a[214:215], v229 offset:20480
    v_mfma_f32_16x16x32_bf16 v[68:71], v[180:183], a[132:135], v[68:71]
    v_exp_f32 v106, v106
    v_mfma_f32_16x16x32_bf16 v[76:79], v[180:183], a[148:151], v[76:79]
    v_mul_f32 v200, v200, v250
    ds_read_b64_tr_b16 a[216:217], v230 offset:16384
    v_mfma_f32_16x16x32_bf16 v[84:87], v[180:183], a[164:167], v[84:87]
    v_exp_f32 v107, v107
    ds_read_b64_tr_b16 a[218:219], v230 offset:20480
    v_mfma_f32_16x16x32_bf16 v[92:95], v[180:183], a[180:183], v[92:95]
    v_cvt_pk_bf16_f32 v149, v106, v107
    ds_read_b64_tr_b16 a[220:221], v231 offset:16384
    v_mfma_f32_16x16x32_bf16 v[68:71], v[184:187], a[136:139], v[68:71]
    v_mfma_f32_16x16x32_bf16 v[76:79], v[184:187], a[152:155], v[76:79]
    v_exp_f32 v108, v108
    ds_read_b64_tr_b16 a[222:223], v231 offset:20480
    v_mfma_f32_16x16x32_bf16 v[84:87], v[184:187], a[168:171], v[84:87]
    v_mfma_f32_16x16x32_bf16 v[92:95], v[184:187], a[184:187], v[92:95]
    v_mfma_f32_16x16x32_bf16 v[68:71], v[188:191], a[140:143], v[68:71]
    v_exp_f32 v109, v109
    v_mfma_f32_16x16x32_bf16 v[76:79], v[188:191], a[156:159], v[76:79]
    v_mfma_f32_16x16x32_bf16 v[84:87], v[188:191], a[172:175], v[84:87]
    v_cvt_pk_bf16_f32 v150, v108, v109
    v_exp_f32 v110, v110
    v_mul_f32 v201, v201, v250
    v_exp_f32 v111, v111
    v_mfma_f32_16x16x32_bf16 v[92:95], v[188:191], a[188:191], v[92:95]
    v_cvt_pk_bf16_f32 v151, v110, v111
    v_mul_f32 v202, v202, v250
    s_waitcnt vmcnt(12) lgkmcnt(0)
    s_barrier
    v_mfma_f32_16x16x32_bf16 a[224:227], a[240:243], v[128:131], a[224:227]
    v_mfma_f32_16x16x32_bf16 a[228:231], a[240:243], v[132:135], a[228:231]
    s_add_u32 m0, s29, 20480
    v_exp_f32 v112, v112
    ds_read_b128 v[160:163], v216 offset:8192
    v_mfma_f32_16x16x32_bf16 a[232:235], a[240:243], v[136:139], a[232:235]
    s_add_u32 s35, s23, 4096
    v_exp_f32 v113, v113
    v_mfma_f32_16x16x32_bf16 a[236:239], a[240:243], v[140:143], a[236:239]
    buffer_load_dwordx4 v236, s[4:7], s35 offen nt lds
    v_cvt_pk_bf16_f32 v152, v112, v113
    v_mfma_f32_16x16x32_bf16 v[0:3], a[192:195], v[128:131], v[0:3]
    v_mfma_f32_16x16x32_bf16 v[4:7], a[192:195], v[132:135], v[4:7]
    v_exp_f32 v114, v114
    v_mul_f32 v203, v203, v250
    ds_read_b128 v[164:167], v217 offset:8192
    v_mfma_f32_16x16x32_bf16 a[0:3], a[192:195], v[136:139], a[0:3]
    v_mfma_f32_16x16x32_bf16 a[4:7], a[192:195], v[140:143], a[4:7]
    v_mfma_f32_16x16x32_bf16 v[8:11], a[196:199], v[128:131], v[8:11]
    v_exp_f32 v115, v115
    v_mfma_f32_16x16x32_bf16 v[12:15], a[196:199], v[132:135], v[12:15]
    v_cvt_pk_bf16_f32 v153, v114, v115
    v_exp_f32 v116, v116
    ds_read_b128 v[168:171], v218 offset:8192
    v_mfma_f32_16x16x32_bf16 a[8:11], a[196:199], v[136:139], a[8:11]
    v_exp_f32 v117, v117
    v_mfma_f32_16x16x32_bf16 a[12:15], a[196:199], v[140:143], a[12:15]
    buffer_load_dwordx4 v237, s[4:7], s35 offen offset:1024 nt lds
    v_cvt_pk_bf16_f32 v154, v116, v117
    v_mfma_f32_16x16x32_bf16 v[16:19], a[200:203], v[128:131], v[16:19]
    v_mfma_f32_16x16x32_bf16 v[20:23], a[200:203], v[132:135], v[20:23]
    v_exp_f32 v118, v118
    v_cvt_pk_bf16_f32 v200, v200, v201
    ds_read_b128 v[172:175], v219 offset:8192
    v_mfma_f32_16x16x32_bf16 a[16:19], a[200:203], v[136:139], a[16:19]
    v_mfma_f32_16x16x32_bf16 a[20:23], a[200:203], v[140:143], a[20:23]
    v_exp_f32 v119, v119
    v_mfma_f32_16x16x32_bf16 v[24:27], a[204:207], v[128:131], v[24:27]
    v_cvt_pk_bf16_f32 v155, v118, v119
    v_exp_f32 v120, v120
    v_mfma_f32_16x16x32_bf16 v[28:31], a[204:207], v[132:135], v[28:31]
    s_add_u32 m0, s25, 49152
    v_cvt_pk_bf16_f32 v201, v202, v203
    ds_read_b128 v[176:179], v216 offset:12288
    v_mfma_f32_16x16x32_bf16 a[24:27], a[204:207], v[136:139], a[24:27]
    s_add_u32 s35, s21, 24576
    v_exp_f32 v121, v121
    v_mfma_f32_16x16x32_bf16 a[28:31], a[204:207], v[140:143], a[28:31]
    buffer_load_dwordx4 v234, s[12:15], s35 offen nt lds
    v_cvt_pk_bf16_f32 v156, v120, v121
    v_mfma_f32_16x16x32_bf16 v[32:35], a[208:211], v[128:131], v[32:35]
    v_exp_f32 v122, v122
    v_mfma_f32_16x16x32_bf16 v[36:39], a[208:211], v[132:135], v[36:39]
    ds_read_b128 v[180:183], v217 offset:12288
    ds_write_b64 v242, v[200:201] offset:8192
    v_mfma_f32_16x16x32_bf16 a[32:35], a[208:211], v[136:139], a[32:35]
    v_exp_f32 v123, v123
    v_mfma_f32_16x16x32_bf16 a[36:39], a[208:211], v[140:143], a[36:39]
    v_cvt_pk_bf16_f32 v157, v122, v123
    ds_read_b128 v[184:187], v218 offset:12288
    v_mfma_f32_16x16x32_bf16 v[40:43], a[212:215], v[128:131], v[40:43]
    v_mfma_f32_16x16x32_bf16 v[44:47], a[212:215], v[132:135], v[44:47]
    v_exp_f32 v124, v124
    ds_read_b128 v[188:191], v219 offset:12288
    v_mfma_f32_16x16x32_bf16 a[40:43], a[212:215], v[136:139], a[40:43]
    v_exp_f32 v125, v125
    v_mfma_f32_16x16x32_bf16 a[44:47], a[212:215], v[140:143], a[44:47]
    buffer_load_dwordx4 v235, s[12:15], s35 offen offset:1024 nt lds
    v_cvt_pk_bf16_f32 v158, v124, v125
    v_mfma_f32_16x16x32_bf16 v[48:51], a[216:219], v[128:131], v[48:51]
    v_mfma_f32_16x16x32_bf16 v[52:55], a[216:219], v[132:135], v[52:55]
    v_exp_f32 v126, v126
    v_mfma_f32_16x16x32_bf16 a[48:51], a[216:219], v[136:139], a[48:51]
    v_exp_f32 v127, v127
    v_mfma_f32_16x16x32_bf16 a[52:55], a[216:219], v[140:143], a[52:55]
    v_cvt_pk_bf16_f32 v159, v126, v127
    v_mfma_f32_16x16x32_bf16 v[56:59], a[220:223], v[128:131], v[56:59]
    v_mfma_f32_16x16x32_bf16 v[60:63], a[220:223], v[132:135], v[60:63]
    v_mfma_f32_16x16x32_bf16 a[56:59], a[220:223], v[136:139], a[56:59]
    v_mfma_f32_16x16x32_bf16 a[60:63], a[220:223], v[140:143], a[60:63]
    s_waitcnt lgkmcnt(0)
    v_pk_fma_f32 v[64:65], v[64:65], s[26:27], v[244:245] op_sel:[0,0,0] op_sel_hi:[1,0,0]
    v_pk_fma_f32 v[66:67], v[66:67], s[26:27], v[244:245] op_sel:[0,0,0] op_sel_hi:[1,0,0]
    v_pk_fma_f32 v[68:69], v[68:69], s[26:27], v[244:245] op_sel:[0,0,0] op_sel_hi:[1,0,0]
    v_pk_fma_f32 v[70:71], v[70:71], s[26:27], v[244:245] op_sel:[0,0,0] op_sel_hi:[1,0,0]
    v_pk_fma_f32 v[72:73], v[72:73], s[26:27], v[244:245] op_sel:[0,0,1] op_sel_hi:[1,0,1]
    v_pk_fma_f32 v[74:75], v[74:75], s[26:27], v[244:245] op_sel:[0,0,1] op_sel_hi:[1,0,1]
    v_pk_fma_f32 v[76:77], v[76:77], s[26:27], v[244:245] op_sel:[0,0,1] op_sel_hi:[1,0,1]
    v_pk_fma_f32 v[78:79], v[78:79], s[26:27], v[244:245] op_sel:[0,0,1] op_sel_hi:[1,0,1]
    v_pk_fma_f32 v[80:81], v[80:81], s[26:27], v[246:247] op_sel:[0,0,0] op_sel_hi:[1,0,0]
    v_pk_fma_f32 v[82:83], v[82:83], s[26:27], v[246:247] op_sel:[0,0,0] op_sel_hi:[1,0,0]
    v_pk_fma_f32 v[84:85], v[84:85], s[26:27], v[246:247] op_sel:[0,0,0] op_sel_hi:[1,0,0]
    v_pk_fma_f32 v[86:87], v[86:87], s[26:27], v[246:247] op_sel:[0,0,0] op_sel_hi:[1,0,0]
    v_pk_fma_f32 v[88:89], v[88:89], s[26:27], v[246:247] op_sel:[0,0,1] op_sel_hi:[1,0,1]
    v_pk_fma_f32 v[90:91], v[90:91], s[26:27], v[246:247] op_sel:[0,0,1] op_sel_hi:[1,0,1]
    v_pk_fma_f32 v[92:93], v[92:93], s[26:27], v[246:247] op_sel:[0,0,1] op_sel_hi:[1,0,1]
    v_pk_fma_f32 v[94:95], v[94:95], s[26:27], v[246:247] op_sel:[0,0,1] op_sel_hi:[1,0,1]
    s_nop 1
    v_mfma_f32_16x16x32_bf16 v[96:99], v[160:163], a[128:131], 0
    v_exp_f32 v64, v64
    v_mfma_f32_16x16x32_bf16 v[104:107], v[160:163], a[144:147], 0
    v_accvgpr_read_b32 v204, a88
    v_accvgpr_read_b32 v205, a89
    ds_read_b64_tr_b16 a[192:193], v224 offset:24576
    v_mfma_f32_16x16x32_bf16 v[112:115], v[160:163], a[160:163], 0
    v_exp_f32 v65, v65
    ds_read_b64_tr_b16 a[194:195], v224 offset:28672
    v_mfma_f32_16x16x32_bf16 v[120:123], v[160:163], a[176:179], 0
    s_add_u32 m0, s25, 0
    v_cvt_pk_bf16_f32 v128, v64, v65
    ds_read_b64_tr_b16 a[196:197], v225 offset:24576
    v_mfma_f32_16x16x32_bf16 v[96:99], v[164:167], a[132:135], v[96:99]
    s_add_u32 s35, s21, 32768
    v_exp_f32 v66, v66
    v_accvgpr_read_b32 v206, a90
    v_mfma_f32_16x16x32_bf16 v[104:107], v[164:167], a[148:151], v[104:107]
    ds_read_b64_tr_b16 a[198:199], v225 offset:28672
    buffer_load_dwordx4 v232, s[8:11], s35 offen nt lds
    v_mfma_f32_16x16x32_bf16 v[112:115], v[164:167], a[164:167], v[112:115]
    v_exp_f32 v67, v67
    v_mfma_f32_16x16x32_bf16 v[120:123], v[164:167], a[180:183], v[120:123]
    v_cvt_pk_bf16_f32 v129, v66, v67
    ds_read_b64_tr_b16 a[200:201], v226 offset:24576
    v_mfma_f32_16x16x32_bf16 v[96:99], v[168:171], a[136:139], v[96:99]
    v_exp_f32 v68, v68
    ds_read_b64_tr_b16 a[202:203], v226 offset:28672
    v_mfma_f32_16x16x32_bf16 v[104:107], v[168:171], a[152:155], v[104:107]
    v_accvgpr_read_b32 v207, a91
    ds_read_b64_tr_b16 a[204:205], v227 offset:24576
    v_mfma_f32_16x16x32_bf16 v[112:115], v[168:171], a[168:171], v[112:115]
    v_exp_f32 v69, v69
    v_mfma_f32_16x16x32_bf16 v[120:123], v[168:171], a[184:187], v[120:123]
    v_cvt_pk_bf16_f32 v130, v68, v69
    ds_read_b64_tr_b16 a[206:207], v227 offset:28672
    v_mfma_f32_16x16x32_bf16 v[96:99], v[172:175], a[140:143], v[96:99]
    v_exp_f32 v70, v70
    v_mfma_f32_16x16x32_bf16 v[104:107], v[172:175], a[156:159], v[104:107]
    v_mul_f32 v204, v204, v250
    v_mul_f32 v205, v205, v250
    ds_read_b64_tr_b16 a[208:209], v228 offset:24576
    v_mfma_f32_16x16x32_bf16 v[112:115], v[172:175], a[172:175], v[112:115]
    v_exp_f32 v71, v71
    ds_read_b64_tr_b16 a[210:211], v228 offset:28672
    v_mfma_f32_16x16x32_bf16 v[120:123], v[172:175], a[188:191], v[120:123]
    v_cvt_pk_bf16_f32 v131, v70, v71
    ds_read_b64_tr_b16 a[212:213], v229 offset:24576
    v_mfma_f32_16x16x32_bf16 v[100:103], v[176:179], a[128:131], 0
    v_exp_f32 v72, v72
    v_mfma_f32_16x16x32_bf16 v[108:111], v[176:179], a[144:147], 0
    v_mul_f32 v206, v206, v250
    ds_read_b64_tr_b16 a[214:215], v229 offset:28672
    v_mfma_f32_16x16x32_bf16 v[116:119], v[176:179], a[160:163], 0
    v_exp_f32 v73, v73
    ds_read_b64_tr_b16 a[216:217], v230 offset:24576
    v_mfma_f32_16x16x32_bf16 v[124:127], v[176:179], a[176:179], 0
    ds_read_b64_tr_b16 a[218:219], v230 offset:28672
    buffer_load_dwordx4 v233, s[8:11], s35 offen offset:1024 nt lds
    v_cvt_pk_bf16_f32 v132, v72, v73
    v_mfma_f32_16x16x32_bf16 v[100:103], v[180:183], a[132:135], v[100:103]
    v_exp_f32 v74, v74
    v_mfma_f32_16x16x32_bf16 v[108:111], v[180:183], a[148:151], v[108:111]
    v_mul_f32 v207, v207, v250
    v_cvt_pk_bf16_f32 v204, v204, v205
    ds_read_b64_tr_b16 a[220:221], v231 offset:24576
    v_mfma_f32_16x16x32_bf16 v[116:119], v[180:183], a[164:167], v[116:119]
    v_exp_f32 v75, v75
    v_mfma_f32_16x16x32_bf16 v[124:127], v[180:183], a[180:183], v[124:127]
    v_cvt_pk_bf16_f32 v133, v74, v75
    ds_read_b64_tr_b16 a[222:223], v231 offset:28672
    v_mfma_f32_16x16x32_bf16 v[100:103], v[184:187], a[136:139], v[100:103]
    v_exp_f32 v76, v76
    ds_read_b128 v[192:195], v215 offset:2048
    v_mfma_f32_16x16x32_bf16 v[108:111], v[184:187], a[152:155], v[108:111]
    v_cvt_pk_bf16_f32 v205, v206, v207
    ds_read_b128 v[196:199], v215 offset:3072
    v_mfma_f32_16x16x32_bf16 v[116:119], v[184:187], a[168:171], v[116:119]
    v_exp_f32 v77, v77
    v_mfma_f32_16x16x32_bf16 v[124:127], v[184:187], a[184:187], v[124:127]
    ds_write_b64 v243, v[204:205] offset:8192
    v_cvt_pk_bf16_f32 v134, v76, v77
    v_mfma_f32_16x16x32_bf16 v[100:103], v[188:191], a[140:143], v[100:103]
    v_mfma_f32_16x16x32_bf16 v[108:111], v[188:191], a[156:159], v[108:111]
    v_mfma_f32_16x16x32_bf16 v[116:119], v[188:191], a[172:175], v[116:119]
    v_exp_f32 v78, v78
    v_accvgpr_read_b32 v200, a96
    v_exp_f32 v79, v79
    v_mfma_f32_16x16x32_bf16 v[124:127], v[188:191], a[188:191], v[124:127]
    v_cvt_pk_bf16_f32 v135, v78, v79
    v_accvgpr_read_b32 v201, a97
    s_waitcnt vmcnt(12) lgkmcnt(0)
    s_barrier
    v_mfma_f32_16x16x32_bf16 a[224:227], a[240:243], v[144:147], a[224:227]
    v_mfma_f32_16x16x32_bf16 a[228:231], a[240:243], v[148:151], a[228:231]
    v_exp_f32 v80, v80
    ds_read_b128 v[160:163], v216 offset:16384
    v_mfma_f32_16x16x32_bf16 a[232:235], a[240:243], v[152:155], a[232:235]
    v_exp_f32 v81, v81
    v_mfma_f32_16x16x32_bf16 a[236:239], a[240:243], v[156:159], a[236:239]
    global_load_dwordx4 a[248:251], v[254:255], off
    v_cvt_pk_bf16_f32 v136, v80, v81
    v_mfma_f32_16x16x32_bf16 v[0:3], a[192:195], v[144:147], v[0:3]
    v_exp_f32 v82, v82
    v_mfma_f32_16x16x32_bf16 v[4:7], a[192:195], v[148:151], v[4:7]
    v_accvgpr_read_b32 v202, a98
    v_accvgpr_read_b32 v203, a99
    ds_read_b128 v[164:167], v217 offset:16384
    v_mfma_f32_16x16x32_bf16 a[0:3], a[192:195], v[152:155], a[0:3]
    v_exp_f32 v83, v83
    v_mfma_f32_16x16x32_bf16 a[4:7], a[192:195], v[156:159], a[4:7]
    v_cvt_pk_bf16_f32 v137, v82, v83
    ds_read_b128 v[168:171], v218 offset:16384
    v_mfma_f32_16x16x32_bf16 v[8:11], a[196:199], v[144:147], v[8:11]
    s_add_u32 s35, s24, 2048
    v_exp_f32 v84, v84
    v_mfma_f32_16x16x32_bf16 v[12:15], a[196:199], v[148:151], v[12:15]
    buffer_store_dwordx4 v[192:195], v236, s[16:19], s35 offen sc1
    v_mfma_f32_16x16x32_bf16 a[8:11], a[196:199], v[152:155], a[8:11]
    v_exp_f32 v85, v85
    v_mfma_f32_16x16x32_bf16 a[12:15], a[196:199], v[156:159], a[12:15]
    v_mfma_f32_16x16x32_bf16 v[16:19], a[200:203], v[144:147], v[16:19]
    v_cvt_pk_bf16_f32 v138, v84, v85
    v_mul_f32 v200, v200, v250
    v_exp_f32 v86, v86
    v_mfma_f32_16x16x32_bf16 v[20:23], a[200:203], v[148:151], v[20:23]
    v_mul_f32 v201, v201, v250
    v_mul_f32 v202, v202, v250
    ds_read_b128 v[172:175], v219 offset:16384
    v_mfma_f32_16x16x32_bf16 a[16:19], a[200:203], v[152:155], a[16:19]
    v_exp_f32 v87, v87
    v_mfma_f32_16x16x32_bf16 a[20:23], a[200:203], v[156:159], a[20:23]
    v_cvt_pk_bf16_f32 v139, v86, v87
    ds_read_b128 v[176:179], v216 offset:20480
    v_mfma_f32_16x16x32_bf16 v[24:27], a[204:207], v[144:147], v[24:27]
    v_exp_f32 v88, v88
    v_mul_f32 v203, v203, v250
    v_mfma_f32_16x16x32_bf16 v[28:31], a[204:207], v[148:151], v[28:31]
    buffer_store_dwordx4 v[196:199], v237, s[16:19], s35 offen offset:1024 sc1
    v_mfma_f32_16x16x32_bf16 a[24:27], a[204:207], v[152:155], a[24:27]
    v_exp_f32 v89, v89
    v_cvt_pk_bf16_f32 v200, v200, v201
    v_mfma_f32_16x16x32_bf16 a[28:31], a[204:207], v[156:159], a[28:31]
    s_add_u32 m0, s25, 57344
    v_cvt_pk_bf16_f32 v140, v88, v89
    ds_read_b128 v[180:183], v217 offset:20480
    v_mfma_f32_16x16x32_bf16 v[32:35], a[208:211], v[144:147], v[32:35]
    s_add_u32 s35, s21, 28672
    v_exp_f32 v90, v90
    v_mfma_f32_16x16x32_bf16 v[36:39], a[208:211], v[148:151], v[36:39]
    buffer_load_dwordx4 v234, s[12:15], s35 offen nt lds
    v_mfma_f32_16x16x32_bf16 a[32:35], a[208:211], v[152:155], a[32:35]
    v_exp_f32 v91, v91
    v_mfma_f32_16x16x32_bf16 a[36:39], a[208:211], v[156:159], a[36:39]
    v_cvt_pk_bf16_f32 v141, v90, v91
    ds_read_b128 v[184:187], v218 offset:20480
    v_mfma_f32_16x16x32_bf16 v[40:43], a[212:215], v[144:147], v[40:43]
    v_exp_f32 v92, v92
    v_mfma_f32_16x16x32_bf16 v[44:47], a[212:215], v[148:151], v[44:47]
    v_cvt_pk_bf16_f32 v201, v202, v203
    ds_read_b128 v[188:191], v219 offset:20480
    v_mfma_f32_16x16x32_bf16 a[40:43], a[212:215], v[152:155], a[40:43]
    v_exp_f32 v93, v93
    v_mfma_f32_16x16x32_bf16 a[44:47], a[212:215], v[156:159], a[44:47]
    ds_write_b64 v240, v[200:201] offset:8320
    v_cvt_pk_bf16_f32 v142, v92, v93
    v_mfma_f32_16x16x32_bf16 v[48:51], a[216:219], v[144:147], v[48:51]
    v_exp_f32 v94, v94
    v_mfma_f32_16x16x32_bf16 v[52:55], a[216:219], v[148:151], v[52:55]
    buffer_load_dwordx4 v235, s[12:15], s35 offen offset:1024 nt lds
    v_mfma_f32_16x16x32_bf16 a[48:51], a[216:219], v[152:155], a[48:51]
    v_exp_f32 v95, v95
    v_mfma_f32_16x16x32_bf16 a[52:55], a[216:219], v[156:159], a[52:55]
    v_cvt_pk_bf16_f32 v143, v94, v95
    v_mfma_f32_16x16x32_bf16 v[56:59], a[220:223], v[144:147], v[56:59]
    v_mfma_f32_16x16x32_bf16 v[60:63], a[220:223], v[148:151], v[60:63]
    v_mfma_f32_16x16x32_bf16 a[56:59], a[220:223], v[152:155], a[56:59]
    v_mfma_f32_16x16x32_bf16 a[60:63], a[220:223], v[156:159], a[60:63]
    s_waitcnt lgkmcnt(0)
    v_pk_fma_f32 v[96:97], v[96:97], s[26:27], v[244:245] op_sel:[0,0,0] op_sel_hi:[1,0,0]
    v_pk_fma_f32 v[98:99], v[98:99], s[26:27], v[244:245] op_sel:[0,0,0] op_sel_hi:[1,0,0]
    v_pk_fma_f32 v[100:101], v[100:101], s[26:27], v[244:245] op_sel:[0,0,0] op_sel_hi:[1,0,0]
    v_pk_fma_f32 v[102:103], v[102:103], s[26:27], v[244:245] op_sel:[0,0,0] op_sel_hi:[1,0,0]
    v_pk_fma_f32 v[104:105], v[104:105], s[26:27], v[244:245] op_sel:[0,0,1] op_sel_hi:[1,0,1]
    v_pk_fma_f32 v[106:107], v[106:107], s[26:27], v[244:245] op_sel:[0,0,1] op_sel_hi:[1,0,1]
    v_pk_fma_f32 v[108:109], v[108:109], s[26:27], v[244:245] op_sel:[0,0,1] op_sel_hi:[1,0,1]
    v_pk_fma_f32 v[110:111], v[110:111], s[26:27], v[244:245] op_sel:[0,0,1] op_sel_hi:[1,0,1]
    v_pk_fma_f32 v[112:113], v[112:113], s[26:27], v[246:247] op_sel:[0,0,0] op_sel_hi:[1,0,0]
    v_pk_fma_f32 v[114:115], v[114:115], s[26:27], v[246:247] op_sel:[0,0,0] op_sel_hi:[1,0,0]
    v_pk_fma_f32 v[116:117], v[116:117], s[26:27], v[246:247] op_sel:[0,0,0] op_sel_hi:[1,0,0]
    v_pk_fma_f32 v[118:119], v[118:119], s[26:27], v[246:247] op_sel:[0,0,0] op_sel_hi:[1,0,0]
    v_pk_fma_f32 v[120:121], v[120:121], s[26:27], v[246:247] op_sel:[0,0,1] op_sel_hi:[1,0,1]
    v_pk_fma_f32 v[122:123], v[122:123], s[26:27], v[246:247] op_sel:[0,0,1] op_sel_hi:[1,0,1]
    v_pk_fma_f32 v[124:125], v[124:125], s[26:27], v[246:247] op_sel:[0,0,1] op_sel_hi:[1,0,1]
    v_pk_fma_f32 v[126:127], v[126:127], s[26:27], v[246:247] op_sel:[0,0,1] op_sel_hi:[1,0,1]
    s_nop 1
    v_mfma_f32_16x16x32_bf16 v[64:67], v[160:163], a[128:131], 0
    v_mfma_f32_16x16x32_bf16 v[72:75], v[160:163], a[144:147], 0
    v_exp_f32 v96, v96
    v_accvgpr_read_b32 v204, a104
    ds_read_b64_tr_b16 a[192:193], v224 offset:0
    v_mfma_f32_16x16x32_bf16 v[80:83], v[160:163], a[160:163], 0
    v_exp_f32 v97, v97
    v_mfma_f32_16x16x32_bf16 v[88:91], v[160:163], a[176:179], 0
    s_add_u32 m0, s25, 8192
    v_cvt_pk_bf16_f32 v144, v96, v97
    ds_read_b64_tr_b16 a[194:195], v224 offset:4096
    v_mfma_f32_16x16x32_bf16 v[64:67], v[164:167], a[132:135], v[64:67]
    s_add_u32 s35, s21, 36864
    v_exp_f32 v98, v98
    ds_read_b64_tr_b16 a[196:197], v225 offset:0
    v_mfma_f32_16x16x32_bf16 v[72:75], v[164:167], a[148:151], v[72:75]
    ds_read_b64_tr_b16 a[198:199], v225 offset:4096
    buffer_load_dwordx4 v232, s[8:11], s35 offen nt lds
    v_mfma_f32_16x16x32_bf16 v[80:83], v[164:167], a[164:167], v[80:83]
    v_exp_f32 v99, v99
    v_mfma_f32_16x16x32_bf16 v[88:91], v[164:167], a[180:183], v[88:91]
    v_cvt_pk_bf16_f32 v145, v98, v99
    ds_read_b64_tr_b16 a[200:201], v226 offset:0
    v_mfma_f32_16x16x32_bf16 v[64:67], v[168:171], a[136:139], v[64:67]
    v_mfma_f32_16x16x32_bf16 v[72:75], v[168:171], a[152:155], v[72:75]
    v_exp_f32 v100, v100
    v_accvgpr_read_b32 v205, a105
    ds_read_b64_tr_b16 a[202:203], v226 offset:4096
    v_mfma_f32_16x16x32_bf16 v[80:83], v[168:171], a[168:171], v[80:83]
    v_exp_f32 v101, v101
    v_mfma_f32_16x16x32_bf16 v[88:91], v[168:171], a[184:187], v[88:91]
    v_cvt_pk_bf16_f32 v146, v100, v101
    ds_read_b64_tr_b16 a[204:205], v227 offset:0
    v_mfma_f32_16x16x32_bf16 v[64:67], v[172:175], a[140:143], v[64:67]
    v_mfma_f32_16x16x32_bf16 v[72:75], v[172:175], a[156:159], v[72:75]
    v_exp_f32 v102, v102
    v_accvgpr_read_b32 v206, a106
    ds_read_b64_tr_b16 a[206:207], v227 offset:4096
    v_mfma_f32_16x16x32_bf16 v[80:83], v[172:175], a[172:175], v[80:83]
    v_exp_f32 v103, v103
    ds_read_b64_tr_b16 a[208:209], v228 offset:0
    v_mfma_f32_16x16x32_bf16 v[88:91], v[172:175], a[188:191], v[88:91]
    v_cvt_pk_bf16_f32 v147, v102, v103
    ds_read_b64_tr_b16 a[210:211], v228 offset:4096
    v_mfma_f32_16x16x32_bf16 v[68:71], v[176:179], a[128:131], 0
    v_mfma_f32_16x16x32_bf16 v[76:79], v[176:179], a[144:147], 0
    v_exp_f32 v104, v104
    v_accvgpr_read_b32 v207, a107
    ds_read_b64_tr_b16 a[212:213], v229 offset:0
    v_mfma_f32_16x16x32_bf16 v[84:87], v[176:179], a[160:163], 0
    buffer_load_dwordx4 v233, s[8:11], s35 offen offset:1024 nt lds
    v_exp_f32 v105, v105
    v_mfma_f32_16x16x32_bf16 v[92:95], v[176:179], a[176:179], 0
    v_cvt_pk_bf16_f32 v148, v104, v105
    ds_read_b64_tr_b16 a[214:215], v229 offset:4096
    v_mfma_f32_16x16x32_bf16 v[68:71], v[180:183], a[132:135], v[68:71]
    v_exp_f32 v106, v106
    v_mfma_f32_16x16x32_bf16 v[76:79], v[180:183], a[148:151], v[76:79]
    v_mul_f32 v204, v204, v250
    ds_read_b64_tr_b16 a[216:217], v230 offset:0
    v_mfma_f32_16x16x32_bf16 v[84:87], v[180:183], a[164:167], v[84:87]
    v_exp_f32 v107, v107
    ds_read_b64_tr_b16 a[218:219], v230 offset:4096
    v_mfma_f32_16x16x32_bf16 v[92:95], v[180:183], a[180:183], v[92:95]
    v_cvt_pk_bf16_f32 v149, v106, v107
    ds_read_b64_tr_b16 a[220:221], v231 offset:0
    v_mfma_f32_16x16x32_bf16 v[68:71], v[184:187], a[136:139], v[68:71]
    v_mfma_f32_16x16x32_bf16 v[76:79], v[184:187], a[152:155], v[76:79]
    v_exp_f32 v108, v108
    ds_read_b64_tr_b16 a[222:223], v231 offset:4096
    v_mfma_f32_16x16x32_bf16 v[84:87], v[184:187], a[168:171], v[84:87]
    v_mfma_f32_16x16x32_bf16 v[92:95], v[184:187], a[184:187], v[92:95]
    v_mfma_f32_16x16x32_bf16 v[68:71], v[188:191], a[140:143], v[68:71]
    v_exp_f32 v109, v109
    v_mfma_f32_16x16x32_bf16 v[76:79], v[188:191], a[156:159], v[76:79]
    v_mfma_f32_16x16x32_bf16 v[84:87], v[188:191], a[172:175], v[84:87]
    v_cvt_pk_bf16_f32 v150, v108, v109
    v_exp_f32 v110, v110
    v_mul_f32 v205, v205, v250
    v_exp_f32 v111, v111
    v_mfma_f32_16x16x32_bf16 v[92:95], v[188:191], a[188:191], v[92:95]
    v_cvt_pk_bf16_f32 v151, v110, v111
    v_mul_f32 v206, v206, v250
    s_waitcnt vmcnt(13) lgkmcnt(0)
    s_barrier
    v_mfma_f32_16x16x32_bf16 a[224:227], a[240:243], v[128:131], a[224:227]
    v_mfma_f32_16x16x32_bf16 a[228:231], a[240:243], v[132:135], a[228:231]
    s_add_u32 m0, s29, 22528
    v_exp_f32 v112, v112
    ds_read_b128 v[160:163], v216 offset:24576
    v_mfma_f32_16x16x32_bf16 a[232:235], a[240:243], v[136:139], a[232:235]
    s_add_u32 s35, s23, 6144
    v_exp_f32 v113, v113
    v_mfma_f32_16x16x32_bf16 a[236:239], a[240:243], v[140:143], a[236:239]
    buffer_load_dwordx4 v238, s[4:7], s35 offen nt lds
    v_cvt_pk_bf16_f32 v152, v112, v113
    v_mfma_f32_16x16x32_bf16 v[0:3], a[192:195], v[128:131], v[0:3]
    v_mfma_f32_16x16x32_bf16 v[4:7], a[192:195], v[132:135], v[4:7]
    v_exp_f32 v114, v114
    v_mul_f32 v207, v207, v250
    ds_read_b128 v[164:167], v217 offset:24576
    v_mfma_f32_16x16x32_bf16 a[0:3], a[192:195], v[136:139], a[0:3]
    v_mfma_f32_16x16x32_bf16 a[4:7], a[192:195], v[140:143], a[4:7]
    v_mfma_f32_16x16x32_bf16 v[8:11], a[196:199], v[128:131], v[8:11]
    v_exp_f32 v115, v115
    v_mfma_f32_16x16x32_bf16 v[12:15], a[196:199], v[132:135], v[12:15]
    v_cvt_pk_bf16_f32 v153, v114, v115
    v_exp_f32 v116, v116
    ds_read_b128 v[168:171], v218 offset:24576
    v_mfma_f32_16x16x32_bf16 a[8:11], a[196:199], v[136:139], a[8:11]
    v_exp_f32 v117, v117
    v_mfma_f32_16x16x32_bf16 a[12:15], a[196:199], v[140:143], a[12:15]
    buffer_load_dwordx4 v239, s[4:7], s35 offen offset:1024 nt lds
    v_cvt_pk_bf16_f32 v154, v116, v117
    v_mfma_f32_16x16x32_bf16 v[16:19], a[200:203], v[128:131], v[16:19]
    v_mfma_f32_16x16x32_bf16 v[20:23], a[200:203], v[132:135], v[20:23]
    v_exp_f32 v118, v118
    v_cvt_pk_bf16_f32 v204, v204, v205
    ds_read_b128 v[172:175], v219 offset:24576
    v_mfma_f32_16x16x32_bf16 a[16:19], a[200:203], v[136:139], a[16:19]
    v_mfma_f32_16x16x32_bf16 a[20:23], a[200:203], v[140:143], a[20:23]
    v_exp_f32 v119, v119
    v_mfma_f32_16x16x32_bf16 v[24:27], a[204:207], v[128:131], v[24:27]
    v_cvt_pk_bf16_f32 v155, v118, v119
    v_exp_f32 v120, v120
    v_mfma_f32_16x16x32_bf16 v[28:31], a[204:207], v[132:135], v[28:31]
    s_add_u32 m0, s25, 32768
    v_cvt_pk_bf16_f32 v205, v206, v207
    ds_read_b128 v[176:179], v216 offset:28672
    v_mfma_f32_16x16x32_bf16 a[24:27], a[204:207], v[136:139], a[24:27]
    s_add_u32 s35, s21, 32768
    v_exp_f32 v121, v121
    v_mfma_f32_16x16x32_bf16 a[28:31], a[204:207], v[140:143], a[28:31]
    buffer_load_dwordx4 v234, s[12:15], s35 offen nt lds
    v_cvt_pk_bf16_f32 v156, v120, v121
    v_mfma_f32_16x16x32_bf16 v[32:35], a[208:211], v[128:131], v[32:35]
    v_exp_f32 v122, v122
    v_mfma_f32_16x16x32_bf16 v[36:39], a[208:211], v[132:135], v[36:39]
    ds_read_b128 v[180:183], v217 offset:28672
    ds_write_b64 v241, v[204:205] offset:8320
    v_mfma_f32_16x16x32_bf16 a[32:35], a[208:211], v[136:139], a[32:35]
    v_exp_f32 v123, v123
    v_mfma_f32_16x16x32_bf16 a[36:39], a[208:211], v[140:143], a[36:39]
    v_cvt_pk_bf16_f32 v157, v122, v123
    ds_read_b128 v[184:187], v218 offset:28672
    v_mfma_f32_16x16x32_bf16 v[40:43], a[212:215], v[128:131], v[40:43]
    v_mfma_f32_16x16x32_bf16 v[44:47], a[212:215], v[132:135], v[44:47]
    v_exp_f32 v124, v124
    ds_read_b128 v[188:191], v219 offset:28672
    v_mfma_f32_16x16x32_bf16 a[40:43], a[212:215], v[136:139], a[40:43]
    v_exp_f32 v125, v125
    v_mfma_f32_16x16x32_bf16 a[44:47], a[212:215], v[140:143], a[44:47]
    buffer_load_dwordx4 v235, s[12:15], s35 offen offset:1024 nt lds
    v_cvt_pk_bf16_f32 v158, v124, v125
    v_mfma_f32_16x16x32_bf16 v[48:51], a[216:219], v[128:131], v[48:51]
    v_mfma_f32_16x16x32_bf16 v[52:55], a[216:219], v[132:135], v[52:55]
    v_exp_f32 v126, v126
    v_mfma_f32_16x16x32_bf16 a[48:51], a[216:219], v[136:139], a[48:51]
    v_exp_f32 v127, v127
    v_mfma_f32_16x16x32_bf16 a[52:55], a[216:219], v[140:143], a[52:55]
    v_cvt_pk_bf16_f32 v159, v126, v127
    v_mfma_f32_16x16x32_bf16 v[56:59], a[220:223], v[128:131], v[56:59]
    v_mfma_f32_16x16x32_bf16 v[60:63], a[220:223], v[132:135], v[60:63]
    v_mfma_f32_16x16x32_bf16 a[56:59], a[220:223], v[136:139], a[56:59]
    v_mfma_f32_16x16x32_bf16 a[60:63], a[220:223], v[140:143], a[60:63]
    s_waitcnt lgkmcnt(0)
    v_pk_fma_f32 v[64:65], v[64:65], s[26:27], v[244:245] op_sel:[0,0,0] op_sel_hi:[1,0,0]
    v_pk_fma_f32 v[66:67], v[66:67], s[26:27], v[244:245] op_sel:[0,0,0] op_sel_hi:[1,0,0]
    v_pk_fma_f32 v[68:69], v[68:69], s[26:27], v[244:245] op_sel:[0,0,0] op_sel_hi:[1,0,0]
    v_pk_fma_f32 v[70:71], v[70:71], s[26:27], v[244:245] op_sel:[0,0,0] op_sel_hi:[1,0,0]
    v_pk_fma_f32 v[72:73], v[72:73], s[26:27], v[244:245] op_sel:[0,0,1] op_sel_hi:[1,0,1]
    v_pk_fma_f32 v[74:75], v[74:75], s[26:27], v[244:245] op_sel:[0,0,1] op_sel_hi:[1,0,1]
    v_pk_fma_f32 v[76:77], v[76:77], s[26:27], v[244:245] op_sel:[0,0,1] op_sel_hi:[1,0,1]
    v_pk_fma_f32 v[78:79], v[78:79], s[26:27], v[244:245] op_sel:[0,0,1] op_sel_hi:[1,0,1]
    v_pk_fma_f32 v[80:81], v[80:81], s[26:27], v[246:247] op_sel:[0,0,0] op_sel_hi:[1,0,0]
    v_pk_fma_f32 v[82:83], v[82:83], s[26:27], v[246:247] op_sel:[0,0,0] op_sel_hi:[1,0,0]
    v_pk_fma_f32 v[84:85], v[84:85], s[26:27], v[246:247] op_sel:[0,0,0] op_sel_hi:[1,0,0]
    v_pk_fma_f32 v[86:87], v[86:87], s[26:27], v[246:247] op_sel:[0,0,0] op_sel_hi:[1,0,0]
    v_pk_fma_f32 v[88:89], v[88:89], s[26:27], v[246:247] op_sel:[0,0,1] op_sel_hi:[1,0,1]
    v_pk_fma_f32 v[90:91], v[90:91], s[26:27], v[246:247] op_sel:[0,0,1] op_sel_hi:[1,0,1]
    v_pk_fma_f32 v[92:93], v[92:93], s[26:27], v[246:247] op_sel:[0,0,1] op_sel_hi:[1,0,1]
    v_pk_fma_f32 v[94:95], v[94:95], s[26:27], v[246:247] op_sel:[0,0,1] op_sel_hi:[1,0,1]
    s_nop 1
    v_mfma_f32_16x16x32_bf16 v[96:99], v[160:163], a[128:131], 0
    v_exp_f32 v64, v64
    v_mfma_f32_16x16x32_bf16 v[104:107], v[160:163], a[144:147], 0
    v_accvgpr_read_b32 v200, a112
    v_accvgpr_read_b32 v201, a113
    ds_read_b64_tr_b16 a[192:193], v224 offset:8192
    v_mfma_f32_16x16x32_bf16 v[112:115], v[160:163], a[160:163], 0
    v_exp_f32 v65, v65
    ds_read_b64_tr_b16 a[194:195], v224 offset:12288
    v_mfma_f32_16x16x32_bf16 v[120:123], v[160:163], a[176:179], 0
    s_add_u32 m0, s25, 16384
    v_cvt_pk_bf16_f32 v128, v64, v65
    ds_read_b64_tr_b16 a[196:197], v225 offset:8192
    v_mfma_f32_16x16x32_bf16 v[96:99], v[164:167], a[132:135], v[96:99]
    s_add_u32 s35, s21, 40960
    v_exp_f32 v66, v66
    v_accvgpr_read_b32 v202, a114
    v_mfma_f32_16x16x32_bf16 v[104:107], v[164:167], a[148:151], v[104:107]
    ds_read_b64_tr_b16 a[198:199], v225 offset:12288
    buffer_load_dwordx4 v232, s[8:11], s35 offen nt lds
    v_mfma_f32_16x16x32_bf16 v[112:115], v[164:167], a[164:167], v[112:115]
    v_exp_f32 v67, v67
    v_mfma_f32_16x16x32_bf16 v[120:123], v[164:167], a[180:183], v[120:123]
    v_cvt_pk_bf16_f32 v129, v66, v67
    ds_read_b64_tr_b16 a[200:201], v226 offset:8192
    v_mfma_f32_16x16x32_bf16 v[96:99], v[168:171], a[136:139], v[96:99]
    v_exp_f32 v68, v68
    ds_read_b64_tr_b16 a[202:203], v226 offset:12288
    v_mfma_f32_16x16x32_bf16 v[104:107], v[168:171], a[152:155], v[104:107]
    v_accvgpr_read_b32 v203, a115
    ds_read_b64_tr_b16 a[204:205], v227 offset:8192
    v_mfma_f32_16x16x32_bf16 v[112:115], v[168:171], a[168:171], v[112:115]
    v_exp_f32 v69, v69
    v_mfma_f32_16x16x32_bf16 v[120:123], v[168:171], a[184:187], v[120:123]
    v_cvt_pk_bf16_f32 v130, v68, v69
    ds_read_b64_tr_b16 a[206:207], v227 offset:12288
    v_mfma_f32_16x16x32_bf16 v[96:99], v[172:175], a[140:143], v[96:99]
    v_exp_f32 v70, v70
    v_mfma_f32_16x16x32_bf16 v[104:107], v[172:175], a[156:159], v[104:107]
    v_mul_f32 v200, v200, v250
    v_mul_f32 v201, v201, v250
    ds_read_b64_tr_b16 a[208:209], v228 offset:8192
    v_mfma_f32_16x16x32_bf16 v[112:115], v[172:175], a[172:175], v[112:115]
    v_exp_f32 v71, v71
    ds_read_b64_tr_b16 a[210:211], v228 offset:12288
    v_mfma_f32_16x16x32_bf16 v[120:123], v[172:175], a[188:191], v[120:123]
    v_cvt_pk_bf16_f32 v131, v70, v71
    ds_read_b64_tr_b16 a[212:213], v229 offset:8192
    v_mfma_f32_16x16x32_bf16 v[100:103], v[176:179], a[128:131], 0
    v_exp_f32 v72, v72
    v_mfma_f32_16x16x32_bf16 v[108:111], v[176:179], a[144:147], 0
    v_mul_f32 v202, v202, v250
    ds_read_b64_tr_b16 a[214:215], v229 offset:12288
    v_mfma_f32_16x16x32_bf16 v[116:119], v[176:179], a[160:163], 0
    v_exp_f32 v73, v73
    ds_read_b64_tr_b16 a[216:217], v230 offset:8192
    v_mfma_f32_16x16x32_bf16 v[124:127], v[176:179], a[176:179], 0
    ds_read_b64_tr_b16 a[218:219], v230 offset:12288
    buffer_load_dwordx4 v233, s[8:11], s35 offen offset:1024 nt lds
    v_cvt_pk_bf16_f32 v132, v72, v73
    v_mfma_f32_16x16x32_bf16 v[100:103], v[180:183], a[132:135], v[100:103]
    v_exp_f32 v74, v74
    v_mfma_f32_16x16x32_bf16 v[108:111], v[180:183], a[148:151], v[108:111]
    v_mul_f32 v203, v203, v250
    v_cvt_pk_bf16_f32 v200, v200, v201
    ds_read_b64_tr_b16 a[220:221], v231 offset:8192
    v_mfma_f32_16x16x32_bf16 v[116:119], v[180:183], a[164:167], v[116:119]
    v_exp_f32 v75, v75
    v_mfma_f32_16x16x32_bf16 v[124:127], v[180:183], a[180:183], v[124:127]
    v_cvt_pk_bf16_f32 v133, v74, v75
    ds_read_b64_tr_b16 a[222:223], v231 offset:12288
    v_mfma_f32_16x16x32_bf16 v[100:103], v[184:187], a[136:139], v[100:103]
    v_exp_f32 v76, v76
    ds_read_b128 v[192:195], v215 offset:4096
    v_mfma_f32_16x16x32_bf16 v[108:111], v[184:187], a[152:155], v[108:111]
    v_cvt_pk_bf16_f32 v201, v202, v203
    ds_read_b128 v[196:199], v215 offset:5120
    v_mfma_f32_16x16x32_bf16 v[116:119], v[184:187], a[168:171], v[116:119]
    v_exp_f32 v77, v77
    v_mfma_f32_16x16x32_bf16 v[124:127], v[184:187], a[184:187], v[124:127]
    ds_write_b64 v242, v[200:201] offset:8320
    v_cvt_pk_bf16_f32 v134, v76, v77
    v_mfma_f32_16x16x32_bf16 v[100:103], v[188:191], a[140:143], v[100:103]
    v_mfma_f32_16x16x32_bf16 v[108:111], v[188:191], a[156:159], v[108:111]
    v_mfma_f32_16x16x32_bf16 v[116:119], v[188:191], a[172:175], v[116:119]
    v_exp_f32 v78, v78
    v_accvgpr_read_b32 v204, a120
    v_exp_f32 v79, v79
    v_mfma_f32_16x16x32_bf16 v[124:127], v[188:191], a[188:191], v[124:127]
    v_cvt_pk_bf16_f32 v135, v78, v79
    v_accvgpr_read_b32 v205, a121
    s_waitcnt vmcnt(13) lgkmcnt(0)
    s_barrier
    v_mfma_f32_16x16x32_bf16 a[224:227], a[240:243], v[144:147], a[224:227]
    v_mfma_f32_16x16x32_bf16 a[228:231], a[240:243], v[148:151], a[228:231]
    v_exp_f32 v80, v80
    ds_read_b128 v[160:163], v216 offset:0
    v_mfma_f32_16x16x32_bf16 a[232:235], a[240:243], v[152:155], a[232:235]
    s_add_u32 s35, s24, 4096
    v_exp_f32 v81, v81
    v_mfma_f32_16x16x32_bf16 a[236:239], a[240:243], v[156:159], a[236:239]
    buffer_store_dwordx4 v[192:195], v236, s[16:19], s35 offen sc1
    v_cvt_pk_bf16_f32 v136, v80, v81
    v_mfma_f32_16x16x32_bf16 v[0:3], a[192:195], v[144:147], v[0:3]
    v_exp_f32 v82, v82
    v_mfma_f32_16x16x32_bf16 v[4:7], a[192:195], v[148:151], v[4:7]
    v_accvgpr_read_b32 v206, a122
    ds_read_b128 v[164:167], v217 offset:0
    v_mfma_f32_16x16x32_bf16 a[0:3], a[192:195], v[152:155], a[0:3]
    v_exp_f32 v83, v83
    v_mfma_f32_16x16x32_bf16 a[4:7], a[192:195], v[156:159], a[4:7]
    v_mfma_f32_16x16x32_bf16 v[8:11], a[196:199], v[144:147], v[8:11]
    v_cvt_pk_bf16_f32 v137, v82, v83
    v_accvgpr_read_b32 v207, a123
    v_exp_f32 v84, v84
    v_mfma_f32_16x16x32_bf16 v[12:15], a[196:199], v[148:151], v[12:15]
    v_mul_f32 v204, v204, v250
    ds_read_b128 v[168:171], v218 offset:0
    v_mfma_f32_16x16x32_bf16 a[8:11], a[196:199], v[152:155], a[8:11]
    v_exp_f32 v85, v85
    v_mfma_f32_16x16x32_bf16 a[12:15], a[196:199], v[156:159], a[12:15]
    buffer_store_dwordx4 v[196:199], v237, s[16:19], s35 offen offset:1024 sc1
    v_cvt_pk_bf16_f32 v138, v84, v85
    v_mfma_f32_16x16x32_bf16 v[16:19], a[200:203], v[144:147], v[16:19]
    v_exp_f32 v86, v86
    v_mfma_f32_16x16x32_bf16 v[20:23], a[200:203], v[148:151], v[20:23]
    v_mul_f32 v205, v205, v250
    ds_read_b128 v[172:175], v219 offset:0
    v_mfma_f32_16x16x32_bf16 a[16:19], a[200:203], v[152:155], a[16:19]
    v_exp_f32 v87, v87
    v_mfma_f32_16x16x32_bf16 a[20:23], a[200:203], v[156:159], a[20:23]
    v_mfma_f32_16x16x32_bf16 v[24:27], a[204:207], v[144:147], v[24:27]
    v_cvt_pk_bf16_f32 v139, v86, v87
    v_mul_f32 v206, v206, v250
    v_exp_f32 v88, v88
    v_mfma_f32_16x16x32_bf16 v[28:31], a[204:207], v[148:151], v[28:31]
    s_add_u32 m0, s25, 40960
    v_mul_f32 v207, v207, v250
    ds_read_b128 v[176:179], v216 offset:4096
    v_mfma_f32_16x16x32_bf16 a[24:27], a[204:207], v[152:155], a[24:27]
    s_add_u32 s35, s21, 36864
    v_exp_f32 v89, v89
    v_mfma_f32_16x16x32_bf16 a[28:31], a[204:207], v[156:159], a[28:31]
    buffer_load_dwordx4 v234, s[12:15], s35 offen nt lds
    v_cvt_pk_bf16_f32 v140, v88, v89
    v_mfma_f32_16x16x32_bf16 v[32:35], a[208:211], v[144:147], v[32:35]
    v_exp_f32 v90, v90
    v_mfma_f32_16x16x32_bf16 v[36:39], a[208:211], v[148:151], v[36:39]
    v_cvt_pk_bf16_f32 v204, v204, v205
    ds_read_b128 v[180:183], v217 offset:4096
    v_mfma_f32_16x16x32_bf16 a[32:35], a[208:211], v[152:155], a[32:35]
    v_exp_f32 v91, v91
    v_mfma_f32_16x16x32_bf16 a[36:39], a[208:211], v[156:159], a[36:39]
    v_cvt_pk_bf16_f32 v141, v90, v91
    ds_read_b128 v[184:187], v218 offset:4096
    v_mfma_f32_16x16x32_bf16 v[40:43], a[212:215], v[144:147], v[40:43]
    v_exp_f32 v92, v92
    v_mfma_f32_16x16x32_bf16 v[44:47], a[212:215], v[148:151], v[44:47]
    v_cvt_pk_bf16_f32 v205, v206, v207
    ds_read_b128 v[188:191], v219 offset:4096
    v_mfma_f32_16x16x32_bf16 a[40:43], a[212:215], v[152:155], a[40:43]
    ds_write_b64 v243, v[204:205] offset:8320
    v_exp_f32 v93, v93
    v_mfma_f32_16x16x32_bf16 a[44:47], a[212:215], v[156:159], a[44:47]
    buffer_load_dwordx4 v235, s[12:15], s35 offen offset:1024 nt lds
    v_cvt_pk_bf16_f32 v142, v92, v93
    v_mfma_f32_16x16x32_bf16 v[48:51], a[216:219], v[144:147], v[48:51]
    v_mfma_f32_16x16x32_bf16 v[52:55], a[216:219], v[148:151], v[52:55]
    v_exp_f32 v94, v94
    v_mfma_f32_16x16x32_bf16 a[48:51], a[216:219], v[152:155], a[48:51]
    v_exp_f32 v95, v95
    v_mfma_f32_16x16x32_bf16 a[52:55], a[216:219], v[156:159], a[52:55]
    v_cvt_pk_bf16_f32 v143, v94, v95
    v_mfma_f32_16x16x32_bf16 v[56:59], a[220:223], v[144:147], v[56:59]
    v_mfma_f32_16x16x32_bf16 v[60:63], a[220:223], v[148:151], v[60:63]
    v_mfma_f32_16x16x32_bf16 a[56:59], a[220:223], v[152:155], a[56:59]
    v_mfma_f32_16x16x32_bf16 a[60:63], a[220:223], v[156:159], a[60:63]
    s_waitcnt lgkmcnt(0)
    v_pk_fma_f32 v[96:97], v[96:97], s[26:27], v[244:245] op_sel:[0,0,0] op_sel_hi:[1,0,0]
    v_pk_fma_f32 v[98:99], v[98:99], s[26:27], v[244:245] op_sel:[0,0,0] op_sel_hi:[1,0,0]
    v_pk_fma_f32 v[100:101], v[100:101], s[26:27], v[244:245] op_sel:[0,0,0] op_sel_hi:[1,0,0]
    v_pk_fma_f32 v[102:103], v[102:103], s[26:27], v[244:245] op_sel:[0,0,0] op_sel_hi:[1,0,0]
    v_pk_fma_f32 v[104:105], v[104:105], s[26:27], v[244:245] op_sel:[0,0,1] op_sel_hi:[1,0,1]
    v_pk_fma_f32 v[106:107], v[106:107], s[26:27], v[244:245] op_sel:[0,0,1] op_sel_hi:[1,0,1]
    v_pk_fma_f32 v[108:109], v[108:109], s[26:27], v[244:245] op_sel:[0,0,1] op_sel_hi:[1,0,1]
    v_pk_fma_f32 v[110:111], v[110:111], s[26:27], v[244:245] op_sel:[0,0,1] op_sel_hi:[1,0,1]
    v_pk_fma_f32 v[112:113], v[112:113], s[26:27], v[246:247] op_sel:[0,0,0] op_sel_hi:[1,0,0]
    v_pk_fma_f32 v[114:115], v[114:115], s[26:27], v[246:247] op_sel:[0,0,0] op_sel_hi:[1,0,0]
    v_pk_fma_f32 v[116:117], v[116:117], s[26:27], v[246:247] op_sel:[0,0,0] op_sel_hi:[1,0,0]
    v_pk_fma_f32 v[118:119], v[118:119], s[26:27], v[246:247] op_sel:[0,0,0] op_sel_hi:[1,0,0]
    v_pk_fma_f32 v[120:121], v[120:121], s[26:27], v[246:247] op_sel:[0,0,1] op_sel_hi:[1,0,1]
    v_pk_fma_f32 v[122:123], v[122:123], s[26:27], v[246:247] op_sel:[0,0,1] op_sel_hi:[1,0,1]
    v_pk_fma_f32 v[124:125], v[124:125], s[26:27], v[246:247] op_sel:[0,0,1] op_sel_hi:[1,0,1]
    v_pk_fma_f32 v[126:127], v[126:127], s[26:27], v[246:247] op_sel:[0,0,1] op_sel_hi:[1,0,1]
    s_nop 1
    v_mfma_f32_16x16x32_bf16 v[64:67], v[160:163], a[128:131], 0
    v_mfma_f32_16x16x32_bf16 v[72:75], v[160:163], a[144:147], 0
    v_exp_f32 v96, v96
    v_accvgpr_read_b32 v200, a68
    ds_read_b64_tr_b16 a[192:193], v224 offset:16384
    v_mfma_f32_16x16x32_bf16 v[80:83], v[160:163], a[160:163], 0
    v_exp_f32 v97, v97
    v_mfma_f32_16x16x32_bf16 v[88:91], v[160:163], a[176:179], 0
    s_add_u32 m0, s25, 24576
    v_cvt_pk_bf16_f32 v144, v96, v97
    ds_read_b64_tr_b16 a[194:195], v224 offset:20480
    v_mfma_f32_16x16x32_bf16 v[64:67], v[164:167], a[132:135], v[64:67]
    s_add_u32 s35, s21, 45056
    v_exp_f32 v98, v98
    ds_read_b64_tr_b16 a[196:197], v225 offset:16384
    v_mfma_f32_16x16x32_bf16 v[72:75], v[164:167], a[148:151], v[72:75]
    ds_read_b64_tr_b16 a[198:199], v225 offset:20480
    buffer_load_dwordx4 v232, s[8:11], s35 offen nt lds
    v_mfma_f32_16x16x32_bf16 v[80:83], v[164:167], a[164:167], v[80:83]
    v_exp_f32 v99, v99
    v_mfma_f32_16x16x32_bf16 v[88:91], v[164:167], a[180:183], v[88:91]
    v_cvt_pk_bf16_f32 v145, v98, v99
    ds_read_b64_tr_b16 a[200:201], v226 offset:16384
    v_mfma_f32_16x16x32_bf16 v[64:67], v[168:171], a[136:139], v[64:67]
    v_mfma_f32_16x16x32_bf16 v[72:75], v[168:171], a[152:155], v[72:75]
    v_exp_f32 v100, v100
    v_accvgpr_read_b32 v201, a69
    ds_read_b64_tr_b16 a[202:203], v226 offset:20480
    v_mfma_f32_16x16x32_bf16 v[80:83], v[168:171], a[168:171], v[80:83]
    v_exp_f32 v101, v101
    v_mfma_f32_16x16x32_bf16 v[88:91], v[168:171], a[184:187], v[88:91]
    v_cvt_pk_bf16_f32 v146, v100, v101
    ds_read_b64_tr_b16 a[204:205], v227 offset:16384
    v_mfma_f32_16x16x32_bf16 v[64:67], v[172:175], a[140:143], v[64:67]
    v_mfma_f32_16x16x32_bf16 v[72:75], v[172:175], a[156:159], v[72:75]
    v_exp_f32 v102, v102
    v_accvgpr_read_b32 v202, a70
    ds_read_b64_tr_b16 a[206:207], v227 offset:20480
    v_mfma_f32_16x16x32_bf16 v[80:83], v[172:175], a[172:175], v[80:83]
    v_exp_f32 v103, v103
    ds_read_b64_tr_b16 a[208:209], v228 offset:16384
    v_mfma_f32_16x16x32_bf16 v[88:91], v[172:175], a[188:191], v[88:91]
    v_cvt_pk_bf16_f32 v147, v102, v103
    ds_read_b64_tr_b16 a[210:211], v228 offset:20480
    v_mfma_f32_16x16x32_bf16 v[68:71], v[176:179], a[128:131], 0
    v_mfma_f32_16x16x32_bf16 v[76:79], v[176:179], a[144:147], 0
    v_exp_f32 v104, v104
    v_accvgpr_read_b32 v203, a71
    ds_read_b64_tr_b16 a[212:213], v229 offset:16384
    v_mfma_f32_16x16x32_bf16 v[84:87], v[176:179], a[160:163], 0
    buffer_load_dwordx4 v233, s[8:11], s35 offen offset:1024 nt lds
    v_exp_f32 v105, v105
    v_mfma_f32_16x16x32_bf16 v[92:95], v[176:179], a[176:179], 0
    v_cvt_pk_bf16_f32 v148, v104, v105
    ds_read_b64_tr_b16 a[214:215], v229 offset:20480
    v_mfma_f32_16x16x32_bf16 v[68:71], v[180:183], a[132:135], v[68:71]
    v_exp_f32 v106, v106
    v_mfma_f32_16x16x32_bf16 v[76:79], v[180:183], a[148:151], v[76:79]
    v_mul_f32 v200, v200, v251
    ds_read_b64_tr_b16 a[216:217], v230 offset:16384
    v_mfma_f32_16x16x32_bf16 v[84:87], v[180:183], a[164:167], v[84:87]
    v_exp_f32 v107, v107
    ds_read_b64_tr_b16 a[218:219], v230 offset:20480
    v_mfma_f32_16x16x32_bf16 v[92:95], v[180:183], a[180:183], v[92:95]
    v_cvt_pk_bf16_f32 v149, v106, v107
    ds_read_b64_tr_b16 a[220:221], v231 offset:16384
    v_mfma_f32_16x16x32_bf16 v[68:71], v[184:187], a[136:139], v[68:71]
    v_mfma_f32_16x16x32_bf16 v[76:79], v[184:187], a[152:155], v[76:79]
    v_exp_f32 v108, v108
    ds_read_b64_tr_b16 a[222:223], v231 offset:20480
    v_mfma_f32_16x16x32_bf16 v[84:87], v[184:187], a[168:171], v[84:87]
    v_mfma_f32_16x16x32_bf16 v[92:95], v[184:187], a[184:187], v[92:95]
    v_mfma_f32_16x16x32_bf16 v[68:71], v[188:191], a[140:143], v[68:71]
    v_exp_f32 v109, v109
    v_mfma_f32_16x16x32_bf16 v[76:79], v[188:191], a[156:159], v[76:79]
    v_mfma_f32_16x16x32_bf16 v[84:87], v[188:191], a[172:175], v[84:87]
    v_cvt_pk_bf16_f32 v150, v108, v109
    v_exp_f32 v110, v110
    v_mul_f32 v201, v201, v251
    v_exp_f32 v111, v111
    v_mfma_f32_16x16x32_bf16 v[92:95], v[188:191], a[188:191], v[92:95]
    v_cvt_pk_bf16_f32 v151, v110, v111
    v_mul_f32 v202, v202, v251
    s_waitcnt vmcnt(12) lgkmcnt(0)
    s_barrier
    v_mfma_f32_16x16x32_bf16 a[224:227], a[240:243], v[128:131], a[224:227]
    v_mfma_f32_16x16x32_bf16 a[228:231], a[240:243], v[132:135], a[228:231]
    s_add_u32 m0, s29, 0
    v_exp_f32 v112, v112
    ds_read_b128 v[160:163], v216 offset:8192
    v_mfma_f32_16x16x32_bf16 a[232:235], a[240:243], v[136:139], a[232:235]
    s_add_u32 s35, s23, 16384
    v_exp_f32 v113, v113
    v_mfma_f32_16x16x32_bf16 a[236:239], a[240:243], v[140:143], a[236:239]
    buffer_load_dwordx4 v236, s[4:7], s35 offen nt lds
    v_cvt_pk_bf16_f32 v152, v112, v113
    v_mfma_f32_16x16x32_bf16 v[0:3], a[192:195], v[128:131], v[0:3]
    v_mfma_f32_16x16x32_bf16 v[4:7], a[192:195], v[132:135], v[4:7]
    v_exp_f32 v114, v114
    v_mul_f32 v203, v203, v251
    ds_read_b128 v[164:167], v217 offset:8192
    v_mfma_f32_16x16x32_bf16 a[0:3], a[192:195], v[136:139], a[0:3]
    v_mfma_f32_16x16x32_bf16 a[4:7], a[192:195], v[140:143], a[4:7]
    v_mfma_f32_16x16x32_bf16 v[8:11], a[196:199], v[128:131], v[8:11]
    v_exp_f32 v115, v115
    v_mfma_f32_16x16x32_bf16 v[12:15], a[196:199], v[132:135], v[12:15]
    v_cvt_pk_bf16_f32 v153, v114, v115
    v_exp_f32 v116, v116
    ds_read_b128 v[168:171], v218 offset:8192
    v_mfma_f32_16x16x32_bf16 a[8:11], a[196:199], v[136:139], a[8:11]
    v_exp_f32 v117, v117
    v_mfma_f32_16x16x32_bf16 a[12:15], a[196:199], v[140:143], a[12:15]
    buffer_load_dwordx4 v237, s[4:7], s35 offen offset:1024 nt lds
    v_cvt_pk_bf16_f32 v154, v116, v117
    v_mfma_f32_16x16x32_bf16 v[16:19], a[200:203], v[128:131], v[16:19]
    v_mfma_f32_16x16x32_bf16 v[20:23], a[200:203], v[132:135], v[20:23]
    v_exp_f32 v118, v118
    v_cvt_pk_bf16_f32 v200, v200, v201
    ds_read_b128 v[172:175], v219 offset:8192
    v_mfma_f32_16x16x32_bf16 a[16:19], a[200:203], v[136:139], a[16:19]
    v_mfma_f32_16x16x32_bf16 a[20:23], a[200:203], v[140:143], a[20:23]
    v_exp_f32 v119, v119
    v_mfma_f32_16x16x32_bf16 v[24:27], a[204:207], v[128:131], v[24:27]
    v_cvt_pk_bf16_f32 v155, v118, v119
    v_exp_f32 v120, v120
    v_mfma_f32_16x16x32_bf16 v[28:31], a[204:207], v[132:135], v[28:31]
    s_add_u32 m0, s25, 49152
    v_cvt_pk_bf16_f32 v201, v202, v203
    ds_read_b128 v[176:179], v216 offset:12288
    v_mfma_f32_16x16x32_bf16 a[24:27], a[204:207], v[136:139], a[24:27]
    s_add_u32 s35, s21, 40960
    v_exp_f32 v121, v121
    v_mfma_f32_16x16x32_bf16 a[28:31], a[204:207], v[140:143], a[28:31]
    buffer_load_dwordx4 v234, s[12:15], s35 offen nt lds
    v_cvt_pk_bf16_f32 v156, v120, v121
    v_mfma_f32_16x16x32_bf16 v[32:35], a[208:211], v[128:131], v[32:35]
    v_exp_f32 v122, v122
    v_mfma_f32_16x16x32_bf16 v[36:39], a[208:211], v[132:135], v[36:39]
    ds_read_b128 v[180:183], v217 offset:12288
    ds_write_b64 v240, v[200:201] offset:12288
    v_mfma_f32_16x16x32_bf16 a[32:35], a[208:211], v[136:139], a[32:35]
    v_exp_f32 v123, v123
    v_mfma_f32_16x16x32_bf16 a[36:39], a[208:211], v[140:143], a[36:39]
    v_cvt_pk_bf16_f32 v157, v122, v123
    ds_read_b128 v[184:187], v218 offset:12288
    v_mfma_f32_16x16x32_bf16 v[40:43], a[212:215], v[128:131], v[40:43]
    v_mfma_f32_16x16x32_bf16 v[44:47], a[212:215], v[132:135], v[44:47]
    v_exp_f32 v124, v124
    ds_read_b128 v[188:191], v219 offset:12288
    v_mfma_f32_16x16x32_bf16 a[40:43], a[212:215], v[136:139], a[40:43]
    v_exp_f32 v125, v125
    v_mfma_f32_16x16x32_bf16 a[44:47], a[212:215], v[140:143], a[44:47]
    buffer_load_dwordx4 v235, s[12:15], s35 offen offset:1024 nt lds
    v_cvt_pk_bf16_f32 v158, v124, v125
    v_mfma_f32_16x16x32_bf16 v[48:51], a[216:219], v[128:131], v[48:51]
    v_mfma_f32_16x16x32_bf16 v[52:55], a[216:219], v[132:135], v[52:55]
    v_exp_f32 v126, v126
    v_mfma_f32_16x16x32_bf16 a[48:51], a[216:219], v[136:139], a[48:51]
    v_exp_f32 v127, v127
    v_mfma_f32_16x16x32_bf16 a[52:55], a[216:219], v[140:143], a[52:55]
    v_cvt_pk_bf16_f32 v159, v126, v127
    v_mfma_f32_16x16x32_bf16 v[56:59], a[220:223], v[128:131], v[56:59]
    v_mfma_f32_16x16x32_bf16 v[60:63], a[220:223], v[132:135], v[60:63]
    v_mfma_f32_16x16x32_bf16 a[56:59], a[220:223], v[136:139], a[56:59]
    v_mfma_f32_16x16x32_bf16 a[60:63], a[220:223], v[140:143], a[60:63]
    s_waitcnt lgkmcnt(0)
    v_pk_fma_f32 v[64:65], v[64:65], s[26:27], v[244:245] op_sel:[0,0,0] op_sel_hi:[1,0,0]
    v_pk_fma_f32 v[66:67], v[66:67], s[26:27], v[244:245] op_sel:[0,0,0] op_sel_hi:[1,0,0]
    v_pk_fma_f32 v[68:69], v[68:69], s[26:27], v[244:245] op_sel:[0,0,0] op_sel_hi:[1,0,0]
    v_pk_fma_f32 v[70:71], v[70:71], s[26:27], v[244:245] op_sel:[0,0,0] op_sel_hi:[1,0,0]
    v_pk_fma_f32 v[72:73], v[72:73], s[26:27], v[244:245] op_sel:[0,0,1] op_sel_hi:[1,0,1]
    v_pk_fma_f32 v[74:75], v[74:75], s[26:27], v[244:245] op_sel:[0,0,1] op_sel_hi:[1,0,1]
    v_pk_fma_f32 v[76:77], v[76:77], s[26:27], v[244:245] op_sel:[0,0,1] op_sel_hi:[1,0,1]
    v_pk_fma_f32 v[78:79], v[78:79], s[26:27], v[244:245] op_sel:[0,0,1] op_sel_hi:[1,0,1]
    v_pk_fma_f32 v[80:81], v[80:81], s[26:27], v[246:247] op_sel:[0,0,0] op_sel_hi:[1,0,0]
    v_pk_fma_f32 v[82:83], v[82:83], s[26:27], v[246:247] op_sel:[0,0,0] op_sel_hi:[1,0,0]
    v_pk_fma_f32 v[84:85], v[84:85], s[26:27], v[246:247] op_sel:[0,0,0] op_sel_hi:[1,0,0]
    v_pk_fma_f32 v[86:87], v[86:87], s[26:27], v[246:247] op_sel:[0,0,0] op_sel_hi:[1,0,0]
    v_pk_fma_f32 v[88:89], v[88:89], s[26:27], v[246:247] op_sel:[0,0,1] op_sel_hi:[1,0,1]
    v_pk_fma_f32 v[90:91], v[90:91], s[26:27], v[246:247] op_sel:[0,0,1] op_sel_hi:[1,0,1]
    v_pk_fma_f32 v[92:93], v[92:93], s[26:27], v[246:247] op_sel:[0,0,1] op_sel_hi:[1,0,1]
    v_pk_fma_f32 v[94:95], v[94:95], s[26:27], v[246:247] op_sel:[0,0,1] op_sel_hi:[1,0,1]
    s_nop 1
    v_mfma_f32_16x16x32_bf16 v[96:99], v[160:163], a[128:131], 0
    v_exp_f32 v64, v64
    v_mfma_f32_16x16x32_bf16 v[104:107], v[160:163], a[144:147], 0
    v_accvgpr_read_b32 v204, a76
    v_accvgpr_read_b32 v205, a77
    ds_read_b64_tr_b16 a[192:193], v224 offset:24576
    v_mfma_f32_16x16x32_bf16 v[112:115], v[160:163], a[160:163], 0
    v_exp_f32 v65, v65
    ds_read_b64_tr_b16 a[194:195], v224 offset:28672
    v_mfma_f32_16x16x32_bf16 v[120:123], v[160:163], a[176:179], 0
    s_add_u32 m0, s25, 0
    v_cvt_pk_bf16_f32 v128, v64, v65
    ds_read_b64_tr_b16 a[196:197], v225 offset:24576
    v_mfma_f32_16x16x32_bf16 v[96:99], v[164:167], a[132:135], v[96:99]
    s_add_u32 s35, s21, 49152
    v_exp_f32 v66, v66
    v_accvgpr_read_b32 v206, a78
    v_mfma_f32_16x16x32_bf16 v[104:107], v[164:167], a[148:151], v[104:107]
    ds_read_b64_tr_b16 a[198:199], v225 offset:28672
    buffer_load_dwordx4 v232, s[8:11], s35 offen nt lds
    v_mfma_f32_16x16x32_bf16 v[112:115], v[164:167], a[164:167], v[112:115]
    v_exp_f32 v67, v67
    v_mfma_f32_16x16x32_bf16 v[120:123], v[164:167], a[180:183], v[120:123]
    v_cvt_pk_bf16_f32 v129, v66, v67
    ds_read_b64_tr_b16 a[200:201], v226 offset:24576
    v_mfma_f32_16x16x32_bf16 v[96:99], v[168:171], a[136:139], v[96:99]
    v_exp_f32 v68, v68
    ds_read_b64_tr_b16 a[202:203], v226 offset:28672
    v_mfma_f32_16x16x32_bf16 v[104:107], v[168:171], a[152:155], v[104:107]
    v_accvgpr_read_b32 v207, a79
    ds_read_b64_tr_b16 a[204:205], v227 offset:24576
    v_mfma_f32_16x16x32_bf16 v[112:115], v[168:171], a[168:171], v[112:115]
    v_exp_f32 v69, v69
    v_mfma_f32_16x16x32_bf16 v[120:123], v[168:171], a[184:187], v[120:123]
    v_cvt_pk_bf16_f32 v130, v68, v69
    ds_read_b64_tr_b16 a[206:207], v227 offset:28672
    v_mfma_f32_16x16x32_bf16 v[96:99], v[172:175], a[140:143], v[96:99]
    v_exp_f32 v70, v70
    v_mfma_f32_16x16x32_bf16 v[104:107], v[172:175], a[156:159], v[104:107]
    v_mul_f32 v204, v204, v251
    v_mul_f32 v205, v205, v251
    ds_read_b64_tr_b16 a[208:209], v228 offset:24576
    v_mfma_f32_16x16x32_bf16 v[112:115], v[172:175], a[172:175], v[112:115]
    v_exp_f32 v71, v71
    ds_read_b64_tr_b16 a[210:211], v228 offset:28672
    v_mfma_f32_16x16x32_bf16 v[120:123], v[172:175], a[188:191], v[120:123]
    v_cvt_pk_bf16_f32 v131, v70, v71
    ds_read_b64_tr_b16 a[212:213], v229 offset:24576
    v_mfma_f32_16x16x32_bf16 v[100:103], v[176:179], a[128:131], 0
    v_exp_f32 v72, v72
    v_mfma_f32_16x16x32_bf16 v[108:111], v[176:179], a[144:147], 0
    v_mul_f32 v206, v206, v251
    ds_read_b64_tr_b16 a[214:215], v229 offset:28672
    v_mfma_f32_16x16x32_bf16 v[116:119], v[176:179], a[160:163], 0
    v_exp_f32 v73, v73
    ds_read_b64_tr_b16 a[216:217], v230 offset:24576
    v_mfma_f32_16x16x32_bf16 v[124:127], v[176:179], a[176:179], 0
    ds_read_b64_tr_b16 a[218:219], v230 offset:28672
    buffer_load_dwordx4 v233, s[8:11], s35 offen offset:1024 nt lds
    v_cvt_pk_bf16_f32 v132, v72, v73
    v_mfma_f32_16x16x32_bf16 v[100:103], v[180:183], a[132:135], v[100:103]
    v_exp_f32 v74, v74
    v_mfma_f32_16x16x32_bf16 v[108:111], v[180:183], a[148:151], v[108:111]
    v_mul_f32 v207, v207, v251
    v_cvt_pk_bf16_f32 v204, v204, v205
    ds_read_b64_tr_b16 a[220:221], v231 offset:24576
    v_mfma_f32_16x16x32_bf16 v[116:119], v[180:183], a[164:167], v[116:119]
    v_exp_f32 v75, v75
    v_mfma_f32_16x16x32_bf16 v[124:127], v[180:183], a[180:183], v[124:127]
    v_cvt_pk_bf16_f32 v133, v74, v75
    ds_read_b64_tr_b16 a[222:223], v231 offset:28672
    v_mfma_f32_16x16x32_bf16 v[100:103], v[184:187], a[136:139], v[100:103]
    v_exp_f32 v76, v76
    ds_read_b128 v[192:195], v215 offset:6144
    v_mfma_f32_16x16x32_bf16 v[108:111], v[184:187], a[152:155], v[108:111]
    v_cvt_pk_bf16_f32 v205, v206, v207
    ds_read_b128 v[196:199], v215 offset:7168
    v_mfma_f32_16x16x32_bf16 v[116:119], v[184:187], a[168:171], v[116:119]
    v_exp_f32 v77, v77
    v_mfma_f32_16x16x32_bf16 v[124:127], v[184:187], a[184:187], v[124:127]
    ds_write_b64 v241, v[204:205] offset:12288
    v_cvt_pk_bf16_f32 v134, v76, v77
    v_mfma_f32_16x16x32_bf16 v[100:103], v[188:191], a[140:143], v[100:103]
    v_mfma_f32_16x16x32_bf16 v[108:111], v[188:191], a[156:159], v[108:111]
    v_mfma_f32_16x16x32_bf16 v[116:119], v[188:191], a[172:175], v[116:119]
    v_exp_f32 v78, v78
    v_accvgpr_read_b32 v200, a84
    v_exp_f32 v79, v79
    v_mfma_f32_16x16x32_bf16 v[124:127], v[188:191], a[188:191], v[124:127]
    v_cvt_pk_bf16_f32 v135, v78, v79
    v_accvgpr_read_b32 v201, a85
    s_waitcnt vmcnt(12) lgkmcnt(0)
    s_barrier
    v_mfma_f32_16x16x32_bf16 a[224:227], a[240:243], v[144:147], a[224:227]
    v_mfma_f32_16x16x32_bf16 a[228:231], a[240:243], v[148:151], a[228:231]
    v_exp_f32 v80, v80
    ds_read_b128 v[160:163], v216 offset:16384
    v_mfma_f32_16x16x32_bf16 a[232:235], a[240:243], v[152:155], a[232:235]
    s_add_u32 s35, s24, 6144
    v_exp_f32 v81, v81
    v_mfma_f32_16x16x32_bf16 a[236:239], a[240:243], v[156:159], a[236:239]
    buffer_store_dwordx4 v[192:195], v236, s[16:19], s35 offen sc1
    v_cvt_pk_bf16_f32 v136, v80, v81
    v_mfma_f32_16x16x32_bf16 v[0:3], a[192:195], v[144:147], v[0:3]
    v_exp_f32 v82, v82
    v_mfma_f32_16x16x32_bf16 v[4:7], a[192:195], v[148:151], v[4:7]
    v_accvgpr_read_b32 v202, a86
    ds_read_b128 v[164:167], v217 offset:16384
    v_mfma_f32_16x16x32_bf16 a[0:3], a[192:195], v[152:155], a[0:3]
    v_exp_f32 v83, v83
    v_mfma_f32_16x16x32_bf16 a[4:7], a[192:195], v[156:159], a[4:7]
    v_mfma_f32_16x16x32_bf16 v[8:11], a[196:199], v[144:147], v[8:11]
    v_cvt_pk_bf16_f32 v137, v82, v83
    v_accvgpr_read_b32 v203, a87
    v_exp_f32 v84, v84
    v_mfma_f32_16x16x32_bf16 v[12:15], a[196:199], v[148:151], v[12:15]
    v_mul_f32 v200, v200, v251
    ds_read_b128 v[168:171], v218 offset:16384
    v_mfma_f32_16x16x32_bf16 a[8:11], a[196:199], v[152:155], a[8:11]
    v_exp_f32 v85, v85
    v_mfma_f32_16x16x32_bf16 a[12:15], a[196:199], v[156:159], a[12:15]
    buffer_store_dwordx4 v[196:199], v237, s[16:19], s35 offen offset:1024 sc1
    v_cvt_pk_bf16_f32 v138, v84, v85
    v_mfma_f32_16x16x32_bf16 v[16:19], a[200:203], v[144:147], v[16:19]
    v_exp_f32 v86, v86
    v_mfma_f32_16x16x32_bf16 v[20:23], a[200:203], v[148:151], v[20:23]
    v_mul_f32 v201, v201, v251
    ds_read_b128 v[172:175], v219 offset:16384
    v_mfma_f32_16x16x32_bf16 a[16:19], a[200:203], v[152:155], a[16:19]
    v_exp_f32 v87, v87
    v_mfma_f32_16x16x32_bf16 a[20:23], a[200:203], v[156:159], a[20:23]
    v_mfma_f32_16x16x32_bf16 v[24:27], a[204:207], v[144:147], v[24:27]
    v_cvt_pk_bf16_f32 v139, v86, v87
    v_mul_f32 v202, v202, v251
    v_exp_f32 v88, v88
    v_mfma_f32_16x16x32_bf16 v[28:31], a[204:207], v[148:151], v[28:31]
    s_add_u32 m0, s25, 57344
    v_mul_f32 v203, v203, v251
    ds_read_b128 v[176:179], v216 offset:20480
    v_mfma_f32_16x16x32_bf16 a[24:27], a[204:207], v[152:155], a[24:27]
    s_add_u32 s35, s21, 45056
    v_exp_f32 v89, v89
    v_mfma_f32_16x16x32_bf16 a[28:31], a[204:207], v[156:159], a[28:31]
    buffer_load_dwordx4 v234, s[12:15], s35 offen nt lds
    v_cvt_pk_bf16_f32 v140, v88, v89
    v_mfma_f32_16x16x32_bf16 v[32:35], a[208:211], v[144:147], v[32:35]
    v_exp_f32 v90, v90
    v_mfma_f32_16x16x32_bf16 v[36:39], a[208:211], v[148:151], v[36:39]
    v_cvt_pk_bf16_f32 v200, v200, v201
    ds_read_b128 v[180:183], v217 offset:20480
    v_mfma_f32_16x16x32_bf16 a[32:35], a[208:211], v[152:155], a[32:35]
    v_exp_f32 v91, v91
    v_mfma_f32_16x16x32_bf16 a[36:39], a[208:211], v[156:159], a[36:39]
    v_cvt_pk_bf16_f32 v141, v90, v91
    ds_read_b128 v[184:187], v218 offset:20480
    v_mfma_f32_16x16x32_bf16 v[40:43], a[212:215], v[144:147], v[40:43]
    v_exp_f32 v92, v92
    v_mfma_f32_16x16x32_bf16 v[44:47], a[212:215], v[148:151], v[44:47]
    v_cvt_pk_bf16_f32 v201, v202, v203
    ds_read_b128 v[188:191], v219 offset:20480
    v_mfma_f32_16x16x32_bf16 a[40:43], a[212:215], v[152:155], a[40:43]
    ds_write_b64 v242, v[200:201] offset:12288
    v_exp_f32 v93, v93
    v_mfma_f32_16x16x32_bf16 a[44:47], a[212:215], v[156:159], a[44:47]
    buffer_load_dwordx4 v235, s[12:15], s35 offen offset:1024 nt lds
    v_cvt_pk_bf16_f32 v142, v92, v93
    v_mfma_f32_16x16x32_bf16 v[48:51], a[216:219], v[144:147], v[48:51]
    v_mfma_f32_16x16x32_bf16 v[52:55], a[216:219], v[148:151], v[52:55]
    v_exp_f32 v94, v94
    v_mfma_f32_16x16x32_bf16 a[48:51], a[216:219], v[152:155], a[48:51]
    v_exp_f32 v95, v95
    v_mfma_f32_16x16x32_bf16 a[52:55], a[216:219], v[156:159], a[52:55]
    v_cvt_pk_bf16_f32 v143, v94, v95
    v_mfma_f32_16x16x32_bf16 v[56:59], a[220:223], v[144:147], v[56:59]
    v_mfma_f32_16x16x32_bf16 v[60:63], a[220:223], v[148:151], v[60:63]
    v_mfma_f32_16x16x32_bf16 a[56:59], a[220:223], v[152:155], a[56:59]
    v_mfma_f32_16x16x32_bf16 a[60:63], a[220:223], v[156:159], a[60:63]
    s_waitcnt lgkmcnt(0)
    v_pk_fma_f32 v[96:97], v[96:97], s[26:27], v[244:245] op_sel:[0,0,0] op_sel_hi:[1,0,0]
    v_pk_fma_f32 v[98:99], v[98:99], s[26:27], v[244:245] op_sel:[0,0,0] op_sel_hi:[1,0,0]
    v_pk_fma_f32 v[100:101], v[100:101], s[26:27], v[244:245] op_sel:[0,0,0] op_sel_hi:[1,0,0]
    v_pk_fma_f32 v[102:103], v[102:103], s[26:27], v[244:245] op_sel:[0,0,0] op_sel_hi:[1,0,0]
    v_pk_fma_f32 v[104:105], v[104:105], s[26:27], v[244:245] op_sel:[0,0,1] op_sel_hi:[1,0,1]
    v_pk_fma_f32 v[106:107], v[106:107], s[26:27], v[244:245] op_sel:[0,0,1] op_sel_hi:[1,0,1]
    v_pk_fma_f32 v[108:109], v[108:109], s[26:27], v[244:245] op_sel:[0,0,1] op_sel_hi:[1,0,1]
    v_pk_fma_f32 v[110:111], v[110:111], s[26:27], v[244:245] op_sel:[0,0,1] op_sel_hi:[1,0,1]
    v_pk_fma_f32 v[112:113], v[112:113], s[26:27], v[246:247] op_sel:[0,0,0] op_sel_hi:[1,0,0]
    v_pk_fma_f32 v[114:115], v[114:115], s[26:27], v[246:247] op_sel:[0,0,0] op_sel_hi:[1,0,0]
    v_pk_fma_f32 v[116:117], v[116:117], s[26:27], v[246:247] op_sel:[0,0,0] op_sel_hi:[1,0,0]
    v_pk_fma_f32 v[118:119], v[118:119], s[26:27], v[246:247] op_sel:[0,0,0] op_sel_hi:[1,0,0]
    v_pk_fma_f32 v[120:121], v[120:121], s[26:27], v[246:247] op_sel:[0,0,1] op_sel_hi:[1,0,1]
    v_pk_fma_f32 v[122:123], v[122:123], s[26:27], v[246:247] op_sel:[0,0,1] op_sel_hi:[1,0,1]
    v_pk_fma_f32 v[124:125], v[124:125], s[26:27], v[246:247] op_sel:[0,0,1] op_sel_hi:[1,0,1]
    v_pk_fma_f32 v[126:127], v[126:127], s[26:27], v[246:247] op_sel:[0,0,1] op_sel_hi:[1,0,1]
    s_nop 1
    v_mfma_f32_16x16x32_bf16 v[64:67], v[160:163], a[128:131], 0
    v_mfma_f32_16x16x32_bf16 v[72:75], v[160:163], a[144:147], 0
    v_exp_f32 v96, v96
    v_accvgpr_read_b32 v204, a92
    ds_read_b64_tr_b16 a[192:193], v224 offset:0
    v_mfma_f32_16x16x32_bf16 v[80:83], v[160:163], a[160:163], 0
    v_exp_f32 v97, v97
    v_mfma_f32_16x16x32_bf16 v[88:91], v[160:163], a[176:179], 0
    s_add_u32 m0, s25, 8192
    v_cvt_pk_bf16_f32 v144, v96, v97
    ds_read_b64_tr_b16 a[194:195], v224 offset:4096
    v_mfma_f32_16x16x32_bf16 v[64:67], v[164:167], a[132:135], v[64:67]
    s_add_u32 s35, s21, 53248
    v_exp_f32 v98, v98
    ds_read_b64_tr_b16 a[196:197], v225 offset:0
    v_mfma_f32_16x16x32_bf16 v[72:75], v[164:167], a[148:151], v[72:75]
    ds_read_b64_tr_b16 a[198:199], v225 offset:4096
    buffer_load_dwordx4 v232, s[8:11], s35 offen nt lds
    v_mfma_f32_16x16x32_bf16 v[80:83], v[164:167], a[164:167], v[80:83]
    v_exp_f32 v99, v99
    v_mfma_f32_16x16x32_bf16 v[88:91], v[164:167], a[180:183], v[88:91]
    v_cvt_pk_bf16_f32 v145, v98, v99
    ds_read_b64_tr_b16 a[200:201], v226 offset:0
    v_mfma_f32_16x16x32_bf16 v[64:67], v[168:171], a[136:139], v[64:67]
    v_mfma_f32_16x16x32_bf16 v[72:75], v[168:171], a[152:155], v[72:75]
    v_exp_f32 v100, v100
    v_accvgpr_read_b32 v205, a93
    ds_read_b64_tr_b16 a[202:203], v226 offset:4096
    v_mfma_f32_16x16x32_bf16 v[80:83], v[168:171], a[168:171], v[80:83]
    v_exp_f32 v101, v101
    v_mfma_f32_16x16x32_bf16 v[88:91], v[168:171], a[184:187], v[88:91]
    v_cvt_pk_bf16_f32 v146, v100, v101
    ds_read_b64_tr_b16 a[204:205], v227 offset:0
    v_mfma_f32_16x16x32_bf16 v[64:67], v[172:175], a[140:143], v[64:67]
    v_mfma_f32_16x16x32_bf16 v[72:75], v[172:175], a[156:159], v[72:75]
    v_exp_f32 v102, v102
    v_accvgpr_read_b32 v206, a94
    ds_read_b64_tr_b16 a[206:207], v227 offset:4096
    v_mfma_f32_16x16x32_bf16 v[80:83], v[172:175], a[172:175], v[80:83]
    v_exp_f32 v103, v103
    ds_read_b64_tr_b16 a[208:209], v228 offset:0
    v_mfma_f32_16x16x32_bf16 v[88:91], v[172:175], a[188:191], v[88:91]
    v_cvt_pk_bf16_f32 v147, v102, v103
    ds_read_b64_tr_b16 a[210:211], v228 offset:4096
    v_mfma_f32_16x16x32_bf16 v[68:71], v[176:179], a[128:131], 0
    v_mfma_f32_16x16x32_bf16 v[76:79], v[176:179], a[144:147], 0
    v_exp_f32 v104, v104
    v_accvgpr_read_b32 v207, a95
    ds_read_b64_tr_b16 a[212:213], v229 offset:0
    v_mfma_f32_16x16x32_bf16 v[84:87], v[176:179], a[160:163], 0
    buffer_load_dwordx4 v233, s[8:11], s35 offen offset:1024 nt lds
    v_exp_f32 v105, v105
    v_mfma_f32_16x16x32_bf16 v[92:95], v[176:179], a[176:179], 0
    v_cvt_pk_bf16_f32 v148, v104, v105
    ds_read_b64_tr_b16 a[214:215], v229 offset:4096
    v_mfma_f32_16x16x32_bf16 v[68:71], v[180:183], a[132:135], v[68:71]
    v_exp_f32 v106, v106
    v_mfma_f32_16x16x32_bf16 v[76:79], v[180:183], a[148:151], v[76:79]
    v_mul_f32 v204, v204, v251
    ds_read_b64_tr_b16 a[216:217], v230 offset:0
    v_mfma_f32_16x16x32_bf16 v[84:87], v[180:183], a[164:167], v[84:87]
    v_exp_f32 v107, v107
    ds_read_b64_tr_b16 a[218:219], v230 offset:4096
    v_mfma_f32_16x16x32_bf16 v[92:95], v[180:183], a[180:183], v[92:95]
    v_cvt_pk_bf16_f32 v149, v106, v107
    ds_read_b64_tr_b16 a[220:221], v231 offset:0
    v_mfma_f32_16x16x32_bf16 v[68:71], v[184:187], a[136:139], v[68:71]
    v_mfma_f32_16x16x32_bf16 v[76:79], v[184:187], a[152:155], v[76:79]
    v_exp_f32 v108, v108
    ds_read_b64_tr_b16 a[222:223], v231 offset:4096
    v_mfma_f32_16x16x32_bf16 v[84:87], v[184:187], a[168:171], v[84:87]
    v_mfma_f32_16x16x32_bf16 v[92:95], v[184:187], a[184:187], v[92:95]
    v_mfma_f32_16x16x32_bf16 v[68:71], v[188:191], a[140:143], v[68:71]
    v_exp_f32 v109, v109
    v_mfma_f32_16x16x32_bf16 v[76:79], v[188:191], a[156:159], v[76:79]
    v_mfma_f32_16x16x32_bf16 v[84:87], v[188:191], a[172:175], v[84:87]
    v_cvt_pk_bf16_f32 v150, v108, v109
    v_exp_f32 v110, v110
    v_mul_f32 v205, v205, v251
    v_exp_f32 v111, v111
    v_mfma_f32_16x16x32_bf16 v[92:95], v[188:191], a[188:191], v[92:95]
    v_cvt_pk_bf16_f32 v151, v110, v111
    v_mul_f32 v206, v206, v251
    s_waitcnt vmcnt(12) lgkmcnt(0)
    s_barrier
    v_mfma_f32_16x16x32_bf16 a[224:227], a[240:243], v[128:131], a[224:227]
    v_mfma_f32_16x16x32_bf16 a[228:231], a[240:243], v[132:135], a[228:231]
    s_add_u32 m0, s29, 2048
    v_exp_f32 v112, v112
    ds_read_b128 v[160:163], v216 offset:24576
    v_mfma_f32_16x16x32_bf16 a[232:235], a[240:243], v[136:139], a[232:235]
    s_add_u32 s35, s23, 18432
    v_exp_f32 v113, v113
    v_mfma_f32_16x16x32_bf16 a[236:239], a[240:243], v[140:143], a[236:239]
    buffer_load_dwordx4 v238, s[4:7], s35 offen nt lds
    v_cvt_pk_bf16_f32 v152, v112, v113
    v_mfma_f32_16x16x32_bf16 v[0:3], a[192:195], v[128:131], v[0:3]
    v_mfma_f32_16x16x32_bf16 v[4:7], a[192:195], v[132:135], v[4:7]
    v_exp_f32 v114, v114
    v_mul_f32 v207, v207, v251
    ds_read_b128 v[164:167], v217 offset:24576
    v_mfma_f32_16x16x32_bf16 a[0:3], a[192:195], v[136:139], a[0:3]
    v_mfma_f32_16x16x32_bf16 a[4:7], a[192:195], v[140:143], a[4:7]
    v_mfma_f32_16x16x32_bf16 v[8:11], a[196:199], v[128:131], v[8:11]
    v_exp_f32 v115, v115
    v_mfma_f32_16x16x32_bf16 v[12:15], a[196:199], v[132:135], v[12:15]
    v_cvt_pk_bf16_f32 v153, v114, v115
    v_exp_f32 v116, v116
    ds_read_b128 v[168:171], v218 offset:24576
    v_mfma_f32_16x16x32_bf16 a[8:11], a[196:199], v[136:139], a[8:11]
    v_exp_f32 v117, v117
    v_mfma_f32_16x16x32_bf16 a[12:15], a[196:199], v[140:143], a[12:15]
    buffer_load_dwordx4 v239, s[4:7], s35 offen offset:1024 nt lds
    v_cvt_pk_bf16_f32 v154, v116, v117
    v_mfma_f32_16x16x32_bf16 v[16:19], a[200:203], v[128:131], v[16:19]
    v_mfma_f32_16x16x32_bf16 v[20:23], a[200:203], v[132:135], v[20:23]
    v_exp_f32 v118, v118
    v_cvt_pk_bf16_f32 v204, v204, v205
    ds_read_b128 v[172:175], v219 offset:24576
    v_mfma_f32_16x16x32_bf16 a[16:19], a[200:203], v[136:139], a[16:19]
    v_mfma_f32_16x16x32_bf16 a[20:23], a[200:203], v[140:143], a[20:23]
    v_exp_f32 v119, v119
    v_mfma_f32_16x16x32_bf16 v[24:27], a[204:207], v[128:131], v[24:27]
    v_cvt_pk_bf16_f32 v155, v118, v119
    v_exp_f32 v120, v120
    v_mfma_f32_16x16x32_bf16 v[28:31], a[204:207], v[132:135], v[28:31]
    s_add_u32 m0, s25, 32768
    v_cvt_pk_bf16_f32 v205, v206, v207
    ds_read_b128 v[176:179], v216 offset:28672
    v_mfma_f32_16x16x32_bf16 a[24:27], a[204:207], v[136:139], a[24:27]
    s_add_u32 s35, s21, 49152
    v_exp_f32 v121, v121
    v_mfma_f32_16x16x32_bf16 a[28:31], a[204:207], v[140:143], a[28:31]
    buffer_load_dwordx4 v234, s[12:15], s35 offen nt lds
    v_cvt_pk_bf16_f32 v156, v120, v121
    v_mfma_f32_16x16x32_bf16 v[32:35], a[208:211], v[128:131], v[32:35]
    v_exp_f32 v122, v122
    v_mfma_f32_16x16x32_bf16 v[36:39], a[208:211], v[132:135], v[36:39]
    ds_read_b128 v[180:183], v217 offset:28672
    ds_write_b64 v243, v[204:205] offset:12288
    v_mfma_f32_16x16x32_bf16 a[32:35], a[208:211], v[136:139], a[32:35]
    v_exp_f32 v123, v123
    v_mfma_f32_16x16x32_bf16 a[36:39], a[208:211], v[140:143], a[36:39]
    v_cvt_pk_bf16_f32 v157, v122, v123
    ds_read_b128 v[184:187], v218 offset:28672
    v_mfma_f32_16x16x32_bf16 v[40:43], a[212:215], v[128:131], v[40:43]
    v_mfma_f32_16x16x32_bf16 v[44:47], a[212:215], v[132:135], v[44:47]
    v_exp_f32 v124, v124
    ds_read_b128 v[188:191], v219 offset:28672
    v_mfma_f32_16x16x32_bf16 a[40:43], a[212:215], v[136:139], a[40:43]
    v_exp_f32 v125, v125
    v_mfma_f32_16x16x32_bf16 a[44:47], a[212:215], v[140:143], a[44:47]
    buffer_load_dwordx4 v235, s[12:15], s35 offen offset:1024 nt lds
    v_cvt_pk_bf16_f32 v158, v124, v125
    v_mfma_f32_16x16x32_bf16 v[48:51], a[216:219], v[128:131], v[48:51]
    v_mfma_f32_16x16x32_bf16 v[52:55], a[216:219], v[132:135], v[52:55]
    v_exp_f32 v126, v126
    v_mfma_f32_16x16x32_bf16 a[48:51], a[216:219], v[136:139], a[48:51]
    v_exp_f32 v127, v127
    v_mfma_f32_16x16x32_bf16 a[52:55], a[216:219], v[140:143], a[52:55]
    v_cvt_pk_bf16_f32 v159, v126, v127
    v_mfma_f32_16x16x32_bf16 v[56:59], a[220:223], v[128:131], v[56:59]
    v_mfma_f32_16x16x32_bf16 v[60:63], a[220:223], v[132:135], v[60:63]
    v_mfma_f32_16x16x32_bf16 a[56:59], a[220:223], v[136:139], a[56:59]
    v_mfma_f32_16x16x32_bf16 a[60:63], a[220:223], v[140:143], a[60:63]
    s_waitcnt lgkmcnt(0)
    v_pk_fma_f32 v[64:65], v[64:65], s[26:27], v[244:245] op_sel:[0,0,0] op_sel_hi:[1,0,0]
    v_pk_fma_f32 v[66:67], v[66:67], s[26:27], v[244:245] op_sel:[0,0,0] op_sel_hi:[1,0,0]
    v_pk_fma_f32 v[68:69], v[68:69], s[26:27], v[244:245] op_sel:[0,0,0] op_sel_hi:[1,0,0]
    v_pk_fma_f32 v[70:71], v[70:71], s[26:27], v[244:245] op_sel:[0,0,0] op_sel_hi:[1,0,0]
    v_pk_fma_f32 v[72:73], v[72:73], s[26:27], v[244:245] op_sel:[0,0,1] op_sel_hi:[1,0,1]
    v_pk_fma_f32 v[74:75], v[74:75], s[26:27], v[244:245] op_sel:[0,0,1] op_sel_hi:[1,0,1]
    v_pk_fma_f32 v[76:77], v[76:77], s[26:27], v[244:245] op_sel:[0,0,1] op_sel_hi:[1,0,1]
    v_pk_fma_f32 v[78:79], v[78:79], s[26:27], v[244:245] op_sel:[0,0,1] op_sel_hi:[1,0,1]
    v_pk_fma_f32 v[80:81], v[80:81], s[26:27], v[246:247] op_sel:[0,0,0] op_sel_hi:[1,0,0]
    v_pk_fma_f32 v[82:83], v[82:83], s[26:27], v[246:247] op_sel:[0,0,0] op_sel_hi:[1,0,0]
    v_pk_fma_f32 v[84:85], v[84:85], s[26:27], v[246:247] op_sel:[0,0,0] op_sel_hi:[1,0,0]
    v_pk_fma_f32 v[86:87], v[86:87], s[26:27], v[246:247] op_sel:[0,0,0] op_sel_hi:[1,0,0]
    v_pk_fma_f32 v[88:89], v[88:89], s[26:27], v[246:247] op_sel:[0,0,1] op_sel_hi:[1,0,1]
    v_pk_fma_f32 v[90:91], v[90:91], s[26:27], v[246:247] op_sel:[0,0,1] op_sel_hi:[1,0,1]
    v_pk_fma_f32 v[92:93], v[92:93], s[26:27], v[246:247] op_sel:[0,0,1] op_sel_hi:[1,0,1]
    v_pk_fma_f32 v[94:95], v[94:95], s[26:27], v[246:247] op_sel:[0,0,1] op_sel_hi:[1,0,1]
    s_nop 1
    v_mfma_f32_16x16x32_bf16 v[96:99], v[160:163], a[128:131], 0
    v_exp_f32 v64, v64
    v_mfma_f32_16x16x32_bf16 v[104:107], v[160:163], a[144:147], 0
    v_accvgpr_read_b32 v200, a100
    v_accvgpr_read_b32 v201, a101
    ds_read_b64_tr_b16 a[192:193], v224 offset:8192
    v_mfma_f32_16x16x32_bf16 v[112:115], v[160:163], a[160:163], 0
    v_exp_f32 v65, v65
    ds_read_b64_tr_b16 a[194:195], v224 offset:12288
    v_mfma_f32_16x16x32_bf16 v[120:123], v[160:163], a[176:179], 0
    s_add_u32 m0, s25, 16384
    v_cvt_pk_bf16_f32 v128, v64, v65
    ds_read_b64_tr_b16 a[196:197], v225 offset:8192
    v_mfma_f32_16x16x32_bf16 v[96:99], v[164:167], a[132:135], v[96:99]
    s_add_u32 s35, s21, 57344
    v_exp_f32 v66, v66
    v_accvgpr_read_b32 v202, a102
    v_mfma_f32_16x16x32_bf16 v[104:107], v[164:167], a[148:151], v[104:107]
    ds_read_b64_tr_b16 a[198:199], v225 offset:12288
    buffer_load_dwordx4 v232, s[8:11], s35 offen nt lds
    v_mfma_f32_16x16x32_bf16 v[112:115], v[164:167], a[164:167], v[112:115]
    v_exp_f32 v67, v67
    v_mfma_f32_16x16x32_bf16 v[120:123], v[164:167], a[180:183], v[120:123]
    v_cvt_pk_bf16_f32 v129, v66, v67
    ds_read_b64_tr_b16 a[200:201], v226 offset:8192
    v_mfma_f32_16x16x32_bf16 v[96:99], v[168:171], a[136:139], v[96:99]
    v_exp_f32 v68, v68
    ds_read_b64_tr_b16 a[202:203], v226 offset:12288
    v_mfma_f32_16x16x32_bf16 v[104:107], v[168:171], a[152:155], v[104:107]
    v_accvgpr_read_b32 v203, a103
    ds_read_b64_tr_b16 a[204:205], v227 offset:8192
    v_mfma_f32_16x16x32_bf16 v[112:115], v[168:171], a[168:171], v[112:115]
    v_exp_f32 v69, v69
    v_mfma_f32_16x16x32_bf16 v[120:123], v[168:171], a[184:187], v[120:123]
    v_cvt_pk_bf16_f32 v130, v68, v69
    ds_read_b64_tr_b16 a[206:207], v227 offset:12288
    v_mfma_f32_16x16x32_bf16 v[96:99], v[172:175], a[140:143], v[96:99]
    v_exp_f32 v70, v70
    v_mfma_f32_16x16x32_bf16 v[104:107], v[172:175], a[156:159], v[104:107]
    v_mul_f32 v200, v200, v251
    v_mul_f32 v201, v201, v251
    ds_read_b64_tr_b16 a[208:209], v228 offset:8192
    v_mfma_f32_16x16x32_bf16 v[112:115], v[172:175], a[172:175], v[112:115]
    v_exp_f32 v71, v71
    ds_read_b64_tr_b16 a[210:211], v228 offset:12288
    v_mfma_f32_16x16x32_bf16 v[120:123], v[172:175], a[188:191], v[120:123]
    v_cvt_pk_bf16_f32 v131, v70, v71
    ds_read_b64_tr_b16 a[212:213], v229 offset:8192
    v_mfma_f32_16x16x32_bf16 v[100:103], v[176:179], a[128:131], 0
    v_exp_f32 v72, v72
    v_mfma_f32_16x16x32_bf16 v[108:111], v[176:179], a[144:147], 0
    v_mul_f32 v202, v202, v251
    ds_read_b64_tr_b16 a[214:215], v229 offset:12288
    v_mfma_f32_16x16x32_bf16 v[116:119], v[176:179], a[160:163], 0
    v_exp_f32 v73, v73
    ds_read_b64_tr_b16 a[216:217], v230 offset:8192
    v_mfma_f32_16x16x32_bf16 v[124:127], v[176:179], a[176:179], 0
    ds_read_b64_tr_b16 a[218:219], v230 offset:12288
    buffer_load_dwordx4 v233, s[8:11], s35 offen offset:1024 nt lds
    v_cvt_pk_bf16_f32 v132, v72, v73
    v_mfma_f32_16x16x32_bf16 v[100:103], v[180:183], a[132:135], v[100:103]
    v_exp_f32 v74, v74
    v_mfma_f32_16x16x32_bf16 v[108:111], v[180:183], a[148:151], v[108:111]
    v_mul_f32 v203, v203, v251
    v_cvt_pk_bf16_f32 v200, v200, v201
    ds_read_b64_tr_b16 a[220:221], v231 offset:8192
    v_mfma_f32_16x16x32_bf16 v[116:119], v[180:183], a[164:167], v[116:119]
    v_exp_f32 v75, v75
    v_mfma_f32_16x16x32_bf16 v[124:127], v[180:183], a[180:183], v[124:127]
    v_cvt_pk_bf16_f32 v133, v74, v75
    ds_read_b64_tr_b16 a[222:223], v231 offset:12288
    v_mfma_f32_16x16x32_bf16 v[100:103], v[184:187], a[136:139], v[100:103]
    v_exp_f32 v76, v76
    ds_read_b128 v[192:195], v215 offset:8192
    v_mfma_f32_16x16x32_bf16 v[108:111], v[184:187], a[152:155], v[108:111]
    v_cvt_pk_bf16_f32 v201, v202, v203
    ds_read_b128 v[196:199], v215 offset:9216
    v_mfma_f32_16x16x32_bf16 v[116:119], v[184:187], a[168:171], v[116:119]
    v_exp_f32 v77, v77
    v_mfma_f32_16x16x32_bf16 v[124:127], v[184:187], a[184:187], v[124:127]
    ds_write_b64 v240, v[200:201] offset:12416
    v_cvt_pk_bf16_f32 v134, v76, v77
    v_mfma_f32_16x16x32_bf16 v[100:103], v[188:191], a[140:143], v[100:103]
    v_mfma_f32_16x16x32_bf16 v[108:111], v[188:191], a[156:159], v[108:111]
    v_mfma_f32_16x16x32_bf16 v[116:119], v[188:191], a[172:175], v[116:119]
    v_exp_f32 v78, v78
    v_accvgpr_read_b32 v204, a108
    v_exp_f32 v79, v79
    v_mfma_f32_16x16x32_bf16 v[124:127], v[188:191], a[188:191], v[124:127]
    v_cvt_pk_bf16_f32 v135, v78, v79
    v_accvgpr_read_b32 v205, a109
    s_waitcnt vmcnt(12) lgkmcnt(0)
    s_barrier
    v_mfma_f32_16x16x32_bf16 a[224:227], a[240:243], v[144:147], a[224:227]
    v_mfma_f32_16x16x32_bf16 a[228:231], a[240:243], v[148:151], a[228:231]
    v_exp_f32 v80, v80
    ds_read_b128 v[160:163], v216 offset:0
    v_mfma_f32_16x16x32_bf16 a[232:235], a[240:243], v[152:155], a[232:235]
    s_add_u32 s35, s24, 16384
    v_exp_f32 v81, v81
    v_mfma_f32_16x16x32_bf16 a[236:239], a[240:243], v[156:159], a[236:239]
    buffer_store_dwordx4 v[192:195], v236, s[16:19], s35 offen sc1
    v_cvt_pk_bf16_f32 v136, v80, v81
    v_mfma_f32_16x16x32_bf16 v[0:3], a[192:195], v[144:147], v[0:3]
    v_exp_f32 v82, v82
    v_mfma_f32_16x16x32_bf16 v[4:7], a[192:195], v[148:151], v[4:7]
    v_accvgpr_read_b32 v206, a110
    ds_read_b128 v[164:167], v217 offset:0
    v_mfma_f32_16x16x32_bf16 a[0:3], a[192:195], v[152:155], a[0:3]
    v_exp_f32 v83, v83
    v_mfma_f32_16x16x32_bf16 a[4:7], a[192:195], v[156:159], a[4:7]
    v_mfma_f32_16x16x32_bf16 v[8:11], a[196:199], v[144:147], v[8:11]
    v_cvt_pk_bf16_f32 v137, v82, v83
    v_accvgpr_read_b32 v207, a111
    v_exp_f32 v84, v84
    v_mfma_f32_16x16x32_bf16 v[12:15], a[196:199], v[148:151], v[12:15]
    v_mul_f32 v204, v204, v251
    ds_read_b128 v[168:171], v218 offset:0
    v_mfma_f32_16x16x32_bf16 a[8:11], a[196:199], v[152:155], a[8:11]
    v_exp_f32 v85, v85
    v_mfma_f32_16x16x32_bf16 a[12:15], a[196:199], v[156:159], a[12:15]
    buffer_store_dwordx4 v[196:199], v237, s[16:19], s35 offen offset:1024 sc1
    v_cvt_pk_bf16_f32 v138, v84, v85
    v_mfma_f32_16x16x32_bf16 v[16:19], a[200:203], v[144:147], v[16:19]
    v_exp_f32 v86, v86
    v_mfma_f32_16x16x32_bf16 v[20:23], a[200:203], v[148:151], v[20:23]
    v_mul_f32 v205, v205, v251
    ds_read_b128 v[172:175], v219 offset:0
    v_mfma_f32_16x16x32_bf16 a[16:19], a[200:203], v[152:155], a[16:19]
    v_exp_f32 v87, v87
    v_mfma_f32_16x16x32_bf16 a[20:23], a[200:203], v[156:159], a[20:23]
    v_mfma_f32_16x16x32_bf16 v[24:27], a[204:207], v[144:147], v[24:27]
    v_cvt_pk_bf16_f32 v139, v86, v87
    v_mul_f32 v206, v206, v251
    v_exp_f32 v88, v88
    v_mfma_f32_16x16x32_bf16 v[28:31], a[204:207], v[148:151], v[28:31]
    s_add_u32 m0, s25, 40960
    v_mul_f32 v207, v207, v251
    ds_read_b128 v[176:179], v216 offset:4096
    v_mfma_f32_16x16x32_bf16 a[24:27], a[204:207], v[152:155], a[24:27]
    s_add_u32 s35, s21, 53248
    v_exp_f32 v89, v89
    v_mfma_f32_16x16x32_bf16 a[28:31], a[204:207], v[156:159], a[28:31]
    buffer_load_dwordx4 v234, s[12:15], s35 offen nt lds
    v_cvt_pk_bf16_f32 v140, v88, v89
    v_mfma_f32_16x16x32_bf16 v[32:35], a[208:211], v[144:147], v[32:35]
    v_exp_f32 v90, v90
    v_mfma_f32_16x16x32_bf16 v[36:39], a[208:211], v[148:151], v[36:39]
    v_cvt_pk_bf16_f32 v204, v204, v205
    ds_read_b128 v[180:183], v217 offset:4096
    v_mfma_f32_16x16x32_bf16 a[32:35], a[208:211], v[152:155], a[32:35]
    v_exp_f32 v91, v91
    v_mfma_f32_16x16x32_bf16 a[36:39], a[208:211], v[156:159], a[36:39]
    v_cvt_pk_bf16_f32 v141, v90, v91
    ds_read_b128 v[184:187], v218 offset:4096
    v_mfma_f32_16x16x32_bf16 v[40:43], a[212:215], v[144:147], v[40:43]
    v_exp_f32 v92, v92
    v_mfma_f32_16x16x32_bf16 v[44:47], a[212:215], v[148:151], v[44:47]
    v_cvt_pk_bf16_f32 v205, v206, v207
    ds_read_b128 v[188:191], v219 offset:4096
    v_mfma_f32_16x16x32_bf16 a[40:43], a[212:215], v[152:155], a[40:43]
    ds_write_b64 v241, v[204:205] offset:12416
    v_exp_f32 v93, v93
    v_mfma_f32_16x16x32_bf16 a[44:47], a[212:215], v[156:159], a[44:47]
    buffer_load_dwordx4 v235, s[12:15], s35 offen offset:1024 nt lds
    v_cvt_pk_bf16_f32 v142, v92, v93
    v_mfma_f32_16x16x32_bf16 v[48:51], a[216:219], v[144:147], v[48:51]
    v_mfma_f32_16x16x32_bf16 v[52:55], a[216:219], v[148:151], v[52:55]
    v_exp_f32 v94, v94
    v_mfma_f32_16x16x32_bf16 a[48:51], a[216:219], v[152:155], a[48:51]
    v_exp_f32 v95, v95
    v_mfma_f32_16x16x32_bf16 a[52:55], a[216:219], v[156:159], a[52:55]
    v_cvt_pk_bf16_f32 v143, v94, v95
    v_mfma_f32_16x16x32_bf16 v[56:59], a[220:223], v[144:147], v[56:59]
    v_mfma_f32_16x16x32_bf16 v[60:63], a[220:223], v[148:151], v[60:63]
    v_mfma_f32_16x16x32_bf16 a[56:59], a[220:223], v[152:155], a[56:59]
    v_mfma_f32_16x16x32_bf16 a[60:63], a[220:223], v[156:159], a[60:63]
    s_waitcnt lgkmcnt(0)
    v_pk_fma_f32 v[96:97], v[96:97], s[26:27], v[244:245] op_sel:[0,0,0] op_sel_hi:[1,0,0]
    v_pk_fma_f32 v[98:99], v[98:99], s[26:27], v[244:245] op_sel:[0,0,0] op_sel_hi:[1,0,0]
    v_pk_fma_f32 v[100:101], v[100:101], s[26:27], v[244:245] op_sel:[0,0,0] op_sel_hi:[1,0,0]
    v_pk_fma_f32 v[102:103], v[102:103], s[26:27], v[244:245] op_sel:[0,0,0] op_sel_hi:[1,0,0]
    v_pk_fma_f32 v[104:105], v[104:105], s[26:27], v[244:245] op_sel:[0,0,1] op_sel_hi:[1,0,1]
    v_pk_fma_f32 v[106:107], v[106:107], s[26:27], v[244:245] op_sel:[0,0,1] op_sel_hi:[1,0,1]
    v_pk_fma_f32 v[108:109], v[108:109], s[26:27], v[244:245] op_sel:[0,0,1] op_sel_hi:[1,0,1]
    v_pk_fma_f32 v[110:111], v[110:111], s[26:27], v[244:245] op_sel:[0,0,1] op_sel_hi:[1,0,1]
    v_pk_fma_f32 v[112:113], v[112:113], s[26:27], v[246:247] op_sel:[0,0,0] op_sel_hi:[1,0,0]
    v_pk_fma_f32 v[114:115], v[114:115], s[26:27], v[246:247] op_sel:[0,0,0] op_sel_hi:[1,0,0]
    v_pk_fma_f32 v[116:117], v[116:117], s[26:27], v[246:247] op_sel:[0,0,0] op_sel_hi:[1,0,0]
    v_pk_fma_f32 v[118:119], v[118:119], s[26:27], v[246:247] op_sel:[0,0,0] op_sel_hi:[1,0,0]
    v_pk_fma_f32 v[120:121], v[120:121], s[26:27], v[246:247] op_sel:[0,0,1] op_sel_hi:[1,0,1]
    v_pk_fma_f32 v[122:123], v[122:123], s[26:27], v[246:247] op_sel:[0,0,1] op_sel_hi:[1,0,1]
    v_pk_fma_f32 v[124:125], v[124:125], s[26:27], v[246:247] op_sel:[0,0,1] op_sel_hi:[1,0,1]
    v_pk_fma_f32 v[126:127], v[126:127], s[26:27], v[246:247] op_sel:[0,0,1] op_sel_hi:[1,0,1]
    s_nop 1
    v_mfma_f32_16x16x32_bf16 v[64:67], v[160:163], a[128:131], 0
    v_mfma_f32_16x16x32_bf16 v[72:75], v[160:163], a[144:147], 0
    v_exp_f32 v96, v96
    v_accvgpr_read_b32 v200, a116
    ds_read_b64_tr_b16 a[192:193], v224 offset:16384
    v_mfma_f32_16x16x32_bf16 v[80:83], v[160:163], a[160:163], 0
    v_exp_f32 v97, v97
    v_mfma_f32_16x16x32_bf16 v[88:91], v[160:163], a[176:179], 0
    s_add_u32 m0, s25, 24576
    v_cvt_pk_bf16_f32 v144, v96, v97
    ds_read_b64_tr_b16 a[194:195], v224 offset:20480
    v_mfma_f32_16x16x32_bf16 v[64:67], v[164:167], a[132:135], v[64:67]
    s_add_u32 s35, s21, 61440
    v_exp_f32 v98, v98
    ds_read_b64_tr_b16 a[196:197], v225 offset:16384
    v_mfma_f32_16x16x32_bf16 v[72:75], v[164:167], a[148:151], v[72:75]
    ds_read_b64_tr_b16 a[198:199], v225 offset:20480
    buffer_load_dwordx4 v232, s[8:11], s35 offen nt lds
    v_mfma_f32_16x16x32_bf16 v[80:83], v[164:167], a[164:167], v[80:83]
    v_exp_f32 v99, v99
    v_mfma_f32_16x16x32_bf16 v[88:91], v[164:167], a[180:183], v[88:91]
    v_cvt_pk_bf16_f32 v145, v98, v99
    ds_read_b64_tr_b16 a[200:201], v226 offset:16384
    v_mfma_f32_16x16x32_bf16 v[64:67], v[168:171], a[136:139], v[64:67]
    v_mfma_f32_16x16x32_bf16 v[72:75], v[168:171], a[152:155], v[72:75]
    v_exp_f32 v100, v100
    v_accvgpr_read_b32 v201, a117
    ds_read_b64_tr_b16 a[202:203], v226 offset:20480
    v_mfma_f32_16x16x32_bf16 v[80:83], v[168:171], a[168:171], v[80:83]
    v_exp_f32 v101, v101
    v_mfma_f32_16x16x32_bf16 v[88:91], v[168:171], a[184:187], v[88:91]
    v_cvt_pk_bf16_f32 v146, v100, v101
    ds_read_b64_tr_b16 a[204:205], v227 offset:16384
    v_mfma_f32_16x16x32_bf16 v[64:67], v[172:175], a[140:143], v[64:67]
    v_mfma_f32_16x16x32_bf16 v[72:75], v[172:175], a[156:159], v[72:75]
    v_exp_f32 v102, v102
    v_accvgpr_read_b32 v202, a118
    ds_read_b64_tr_b16 a[206:207], v227 offset:20480
    v_mfma_f32_16x16x32_bf16 v[80:83], v[172:175], a[172:175], v[80:83]
    v_exp_f32 v103, v103
    ds_read_b64_tr_b16 a[208:209], v228 offset:16384
    v_mfma_f32_16x16x32_bf16 v[88:91], v[172:175], a[188:191], v[88:91]
    v_cvt_pk_bf16_f32 v147, v102, v103
    ds_read_b64_tr_b16 a[210:211], v228 offset:20480
    v_mfma_f32_16x16x32_bf16 v[68:71], v[176:179], a[128:131], 0
    v_mfma_f32_16x16x32_bf16 v[76:79], v[176:179], a[144:147], 0
    v_exp_f32 v104, v104
    v_accvgpr_read_b32 v203, a119
    ds_read_b64_tr_b16 a[212:213], v229 offset:16384
    v_mfma_f32_16x16x32_bf16 v[84:87], v[176:179], a[160:163], 0
    buffer_load_dwordx4 v233, s[8:11], s35 offen offset:1024 nt lds
    v_exp_f32 v105, v105
    v_mfma_f32_16x16x32_bf16 v[92:95], v[176:179], a[176:179], 0
    v_cvt_pk_bf16_f32 v148, v104, v105
    ds_read_b64_tr_b16 a[214:215], v229 offset:20480
    v_mfma_f32_16x16x32_bf16 v[68:71], v[180:183], a[132:135], v[68:71]
    v_exp_f32 v106, v106
    v_mfma_f32_16x16x32_bf16 v[76:79], v[180:183], a[148:151], v[76:79]
    v_mul_f32 v200, v200, v251
    ds_read_b64_tr_b16 a[216:217], v230 offset:16384
    v_mfma_f32_16x16x32_bf16 v[84:87], v[180:183], a[164:167], v[84:87]
    v_exp_f32 v107, v107
    ds_read_b64_tr_b16 a[218:219], v230 offset:20480
    v_mfma_f32_16x16x32_bf16 v[92:95], v[180:183], a[180:183], v[92:95]
    v_cvt_pk_bf16_f32 v149, v106, v107
    ds_read_b64_tr_b16 a[220:221], v231 offset:16384
    v_mfma_f32_16x16x32_bf16 v[68:71], v[184:187], a[136:139], v[68:71]
    v_mfma_f32_16x16x32_bf16 v[76:79], v[184:187], a[152:155], v[76:79]
    v_exp_f32 v108, v108
    ds_read_b64_tr_b16 a[222:223], v231 offset:20480
    v_mfma_f32_16x16x32_bf16 v[84:87], v[184:187], a[168:171], v[84:87]
    v_mfma_f32_16x16x32_bf16 v[92:95], v[184:187], a[184:187], v[92:95]
    v_mfma_f32_16x16x32_bf16 v[68:71], v[188:191], a[140:143], v[68:71]
    v_exp_f32 v109, v109
    v_mfma_f32_16x16x32_bf16 v[76:79], v[188:191], a[156:159], v[76:79]
    v_mfma_f32_16x16x32_bf16 v[84:87], v[188:191], a[172:175], v[84:87]
    v_cvt_pk_bf16_f32 v150, v108, v109
    v_exp_f32 v110, v110
    v_mul_f32 v201, v201, v251
    v_exp_f32 v111, v111
    v_mfma_f32_16x16x32_bf16 v[92:95], v[188:191], a[188:191], v[92:95]
    v_cvt_pk_bf16_f32 v151, v110, v111
    v_mul_f32 v202, v202, v251
    s_waitcnt vmcnt(12) lgkmcnt(0)
    s_barrier
    v_mfma_f32_16x16x32_bf16 a[224:227], a[240:243], v[128:131], a[224:227]
    v_mfma_f32_16x16x32_bf16 a[228:231], a[240:243], v[132:135], a[228:231]
    s_add_u32 m0, s29, 4096
    v_exp_f32 v112, v112
    ds_read_b128 v[160:163], v216 offset:8192
    v_mfma_f32_16x16x32_bf16 a[232:235], a[240:243], v[136:139], a[232:235]
    s_add_u32 s35, s23, 20480
    v_exp_f32 v113, v113
    v_mfma_f32_16x16x32_bf16 a[236:239], a[240:243], v[140:143], a[236:239]
    buffer_load_dwordx4 v236, s[4:7], s35 offen nt lds
    v_cvt_pk_bf16_f32 v152, v112, v113
    v_mfma_f32_16x16x32_bf16 v[0:3], a[192:195], v[128:131], v[0:3]
    v_mfma_f32_16x16x32_bf16 v[4:7], a[192:195], v[132:135], v[4:7]
    v_exp_f32 v114, v114
    v_mul_f32 v203, v203, v251
    ds_read_b128 v[164:167], v217 offset:8192
    v_mfma_f32_16x16x32_bf16 a[0:3], a[192:195], v[136:139], a[0:3]
    v_mfma_f32_16x16x32_bf16 a[4:7], a[192:195], v[140:143], a[4:7]
    v_mfma_f32_16x16x32_bf16 v[8:11], a[196:199], v[128:131], v[8:11]
    v_exp_f32 v115, v115
    v_mfma_f32_16x16x32_bf16 v[12:15], a[196:199], v[132:135], v[12:15]
    v_cvt_pk_bf16_f32 v153, v114, v115
    v_exp_f32 v116, v116
    ds_read_b128 v[168:171], v218 offset:8192
    v_mfma_f32_16x16x32_bf16 a[8:11], a[196:199], v[136:139], a[8:11]
    v_exp_f32 v117, v117
    v_mfma_f32_16x16x32_bf16 a[12:15], a[196:199], v[140:143], a[12:15]
    buffer_load_dwordx4 v237, s[4:7], s35 offen offset:1024 nt lds
    v_cvt_pk_bf16_f32 v154, v116, v117
    v_mfma_f32_16x16x32_bf16 v[16:19], a[200:203], v[128:131], v[16:19]
    v_mfma_f32_16x16x32_bf16 v[20:23], a[200:203], v[132:135], v[20:23]
    v_exp_f32 v118, v118
    v_cvt_pk_bf16_f32 v200, v200, v201
    ds_read_b128 v[172:175], v219 offset:8192
    v_mfma_f32_16x16x32_bf16 a[16:19], a[200:203], v[136:139], a[16:19]
    v_mfma_f32_16x16x32_bf16 a[20:23], a[200:203], v[140:143], a[20:23]
    v_exp_f32 v119, v119
    v_mfma_f32_16x16x32_bf16 v[24:27], a[204:207], v[128:131], v[24:27]
    v_cvt_pk_bf16_f32 v155, v118, v119
    v_exp_f32 v120, v120
    v_mfma_f32_16x16x32_bf16 v[28:31], a[204:207], v[132:135], v[28:31]
    s_add_u32 m0, s25, 49152
    v_cvt_pk_bf16_f32 v201, v202, v203
    ds_read_b128 v[176:179], v216 offset:12288
    v_mfma_f32_16x16x32_bf16 a[24:27], a[204:207], v[136:139], a[24:27]
    s_add_u32 s35, s21, 57344
    v_exp_f32 v121, v121
    v_mfma_f32_16x16x32_bf16 a[28:31], a[204:207], v[140:143], a[28:31]
    buffer_load_dwordx4 v234, s[12:15], s35 offen nt lds
    v_cvt_pk_bf16_f32 v156, v120, v121
    v_mfma_f32_16x16x32_bf16 v[32:35], a[208:211], v[128:131], v[32:35]
    v_exp_f32 v122, v122
    v_mfma_f32_16x16x32_bf16 v[36:39], a[208:211], v[132:135], v[36:39]
    ds_read_b128 v[180:183], v217 offset:12288
    ds_write_b64 v242, v[200:201] offset:12416
    v_mfma_f32_16x16x32_bf16 a[32:35], a[208:211], v[136:139], a[32:35]
    v_exp_f32 v123, v123
    v_mfma_f32_16x16x32_bf16 a[36:39], a[208:211], v[140:143], a[36:39]
    v_cvt_pk_bf16_f32 v157, v122, v123
    ds_read_b128 v[184:187], v218 offset:12288
    v_mfma_f32_16x16x32_bf16 v[40:43], a[212:215], v[128:131], v[40:43]
    v_mfma_f32_16x16x32_bf16 v[44:47], a[212:215], v[132:135], v[44:47]
    v_exp_f32 v124, v124
    ds_read_b128 v[188:191], v219 offset:12288
    v_mfma_f32_16x16x32_bf16 a[40:43], a[212:215], v[136:139], a[40:43]
    v_exp_f32 v125, v125
    v_mfma_f32_16x16x32_bf16 a[44:47], a[212:215], v[140:143], a[44:47]
    buffer_load_dwordx4 v235, s[12:15], s35 offen offset:1024 nt lds
    v_cvt_pk_bf16_f32 v158, v124, v125
    v_mfma_f32_16x16x32_bf16 v[48:51], a[216:219], v[128:131], v[48:51]
    v_mfma_f32_16x16x32_bf16 v[52:55], a[216:219], v[132:135], v[52:55]
    v_exp_f32 v126, v126
    v_mfma_f32_16x16x32_bf16 a[48:51], a[216:219], v[136:139], a[48:51]
    v_exp_f32 v127, v127
    v_mfma_f32_16x16x32_bf16 a[52:55], a[216:219], v[140:143], a[52:55]
    v_cvt_pk_bf16_f32 v159, v126, v127
    v_mfma_f32_16x16x32_bf16 v[56:59], a[220:223], v[128:131], v[56:59]
    v_mfma_f32_16x16x32_bf16 v[60:63], a[220:223], v[132:135], v[60:63]
    v_mfma_f32_16x16x32_bf16 a[56:59], a[220:223], v[136:139], a[56:59]
    v_mfma_f32_16x16x32_bf16 a[60:63], a[220:223], v[140:143], a[60:63]
    s_waitcnt lgkmcnt(0)
    v_pk_fma_f32 v[64:65], v[64:65], s[26:27], v[244:245] op_sel:[0,0,0] op_sel_hi:[1,0,0]
    v_pk_fma_f32 v[66:67], v[66:67], s[26:27], v[244:245] op_sel:[0,0,0] op_sel_hi:[1,0,0]
    v_pk_fma_f32 v[68:69], v[68:69], s[26:27], v[244:245] op_sel:[0,0,0] op_sel_hi:[1,0,0]
    v_pk_fma_f32 v[70:71], v[70:71], s[26:27], v[244:245] op_sel:[0,0,0] op_sel_hi:[1,0,0]
    v_pk_fma_f32 v[72:73], v[72:73], s[26:27], v[244:245] op_sel:[0,0,1] op_sel_hi:[1,0,1]
    v_pk_fma_f32 v[74:75], v[74:75], s[26:27], v[244:245] op_sel:[0,0,1] op_sel_hi:[1,0,1]
    v_pk_fma_f32 v[76:77], v[76:77], s[26:27], v[244:245] op_sel:[0,0,1] op_sel_hi:[1,0,1]
    v_pk_fma_f32 v[78:79], v[78:79], s[26:27], v[244:245] op_sel:[0,0,1] op_sel_hi:[1,0,1]
    v_pk_fma_f32 v[80:81], v[80:81], s[26:27], v[246:247] op_sel:[0,0,0] op_sel_hi:[1,0,0]
    v_pk_fma_f32 v[82:83], v[82:83], s[26:27], v[246:247] op_sel:[0,0,0] op_sel_hi:[1,0,0]
    v_pk_fma_f32 v[84:85], v[84:85], s[26:27], v[246:247] op_sel:[0,0,0] op_sel_hi:[1,0,0]
    v_pk_fma_f32 v[86:87], v[86:87], s[26:27], v[246:247] op_sel:[0,0,0] op_sel_hi:[1,0,0]
    v_pk_fma_f32 v[88:89], v[88:89], s[26:27], v[246:247] op_sel:[0,0,1] op_sel_hi:[1,0,1]
    v_pk_fma_f32 v[90:91], v[90:91], s[26:27], v[246:247] op_sel:[0,0,1] op_sel_hi:[1,0,1]
    v_pk_fma_f32 v[92:93], v[92:93], s[26:27], v[246:247] op_sel:[0,0,1] op_sel_hi:[1,0,1]
    v_pk_fma_f32 v[94:95], v[94:95], s[26:27], v[246:247] op_sel:[0,0,1] op_sel_hi:[1,0,1]
    s_nop 1
    v_mfma_f32_16x16x32_bf16 v[96:99], v[160:163], a[128:131], 0
    v_mfma_f32_16x16x32_bf16 v[104:107], v[160:163], a[144:147], 0
    v_exp_f32 v64, v64
    v_accvgpr_read_b32 v204, a124
    ds_read_b64_tr_b16 a[192:193], v224 offset:24576
    v_mfma_f32_16x16x32_bf16 v[112:115], v[160:163], a[160:163], 0
    v_exp_f32 v65, v65
    v_mfma_f32_16x16x32_bf16 v[120:123], v[160:163], a[176:179], 0
    s_add_u32 m0, s25, 0
    v_cvt_pk_bf16_f32 v128, v64, v65
    ds_read_b64_tr_b16 a[194:195], v224 offset:28672
    v_mfma_f32_16x16x32_bf16 v[96:99], v[164:167], a[132:135], v[96:99]
    s_add_u32 s35, s22, 0
    v_exp_f32 v66, v66
    ds_read_b64_tr_b16 a[196:197], v225 offset:24576
    v_mfma_f32_16x16x32_bf16 v[104:107], v[164:167], a[148:151], v[104:107]
    ds_read_b64_tr_b16 a[198:199], v225 offset:28672
    buffer_load_dwordx4 v232, s[8:11], s35 offen nt lds
    v_mfma_f32_16x16x32_bf16 v[112:115], v[164:167], a[164:167], v[112:115]
    v_exp_f32 v67, v67
    v_mfma_f32_16x16x32_bf16 v[120:123], v[164:167], a[180:183], v[120:123]
    v_cvt_pk_bf16_f32 v129, v66, v67
    ds_read_b64_tr_b16 a[200:201], v226 offset:24576
    v_mfma_f32_16x16x32_bf16 v[96:99], v[168:171], a[136:139], v[96:99]
    v_mfma_f32_16x16x32_bf16 v[104:107], v[168:171], a[152:155], v[104:107]
    v_exp_f32 v68, v68
    v_accvgpr_read_b32 v205, a125
    ds_read_b64_tr_b16 a[202:203], v226 offset:28672
    v_mfma_f32_16x16x32_bf16 v[112:115], v[168:171], a[168:171], v[112:115]
    v_exp_f32 v69, v69
    v_mfma_f32_16x16x32_bf16 v[120:123], v[168:171], a[184:187], v[120:123]
    v_cvt_pk_bf16_f32 v130, v68, v69
    ds_read_b64_tr_b16 a[204:205], v227 offset:24576
    v_mfma_f32_16x16x32_bf16 v[96:99], v[172:175], a[140:143], v[96:99]
    v_mfma_f32_16x16x32_bf16 v[104:107], v[172:175], a[156:159], v[104:107]
    v_exp_f32 v70, v70
    v_accvgpr_read_b32 v206, a126
    ds_read_b64_tr_b16 a[206:207], v227 offset:28672
    v_mfma_f32_16x16x32_bf16 v[112:115], v[172:175], a[172:175], v[112:115]
    v_exp_f32 v71, v71
    ds_read_b64_tr_b16 a[208:209], v228 offset:24576
    v_mfma_f32_16x16x32_bf16 v[120:123], v[172:175], a[188:191], v[120:123]
    v_cvt_pk_bf16_f32 v131, v70, v71
    ds_read_b64_tr_b16 a[210:211], v228 offset:28672
    v_mfma_f32_16x16x32_bf16 v[100:103], v[176:179], a[128:131], 0
    v_mfma_f32_16x16x32_bf16 v[108:111], v[176:179], a[144:147], 0
    v_exp_f32 v72, v72
    v_accvgpr_read_b32 v207, a127
    ds_read_b64_tr_b16 a[212:213], v229 offset:24576
    v_mfma_f32_16x16x32_bf16 v[116:119], v[176:179], a[160:163], 0
    buffer_load_dwordx4 v233, s[8:11], s35 offen offset:1024 nt lds
    v_exp_f32 v73, v73
    v_mfma_f32_16x16x32_bf16 v[124:127], v[176:179], a[176:179], 0
    v_cvt_pk_bf16_f32 v132, v72, v73
    ds_read_b64_tr_b16 a[214:215], v229 offset:28672
    v_mfma_f32_16x16x32_bf16 v[100:103], v[180:183], a[132:135], v[100:103]
    v_exp_f32 v74, v74
    v_mfma_f32_16x16x32_bf16 v[108:111], v[180:183], a[148:151], v[108:111]
    v_mul_f32 v204, v204, v251
    ds_read_b64_tr_b16 a[216:217], v230 offset:24576
    v_mfma_f32_16x16x32_bf16 v[116:119], v[180:183], a[164:167], v[116:119]
    v_exp_f32 v75, v75
    ds_read_b64_tr_b16 a[218:219], v230 offset:28672
    v_mfma_f32_16x16x32_bf16 v[124:127], v[180:183], a[180:183], v[124:127]
    v_cvt_pk_bf16_f32 v133, v74, v75
    ds_read_b64_tr_b16 a[220:221], v231 offset:24576
    v_mfma_f32_16x16x32_bf16 v[100:103], v[184:187], a[136:139], v[100:103]
    v_mfma_f32_16x16x32_bf16 v[108:111], v[184:187], a[152:155], v[108:111]
    v_exp_f32 v76, v76
    ds_read_b64_tr_b16 a[222:223], v231 offset:28672
    v_mfma_f32_16x16x32_bf16 v[116:119], v[184:187], a[168:171], v[116:119]
    v_mfma_f32_16x16x32_bf16 v[124:127], v[184:187], a[184:187], v[124:127]
    v_mfma_f32_16x16x32_bf16 v[100:103], v[188:191], a[140:143], v[100:103]
    v_exp_f32 v77, v77
    v_mfma_f32_16x16x32_bf16 v[108:111], v[188:191], a[156:159], v[108:111]
    v_mfma_f32_16x16x32_bf16 v[116:119], v[188:191], a[172:175], v[116:119]
    v_cvt_pk_bf16_f32 v134, v76, v77
    v_exp_f32 v78, v78
    v_mul_f32 v205, v205, v251
    v_exp_f32 v79, v79
    v_mfma_f32_16x16x32_bf16 v[124:127], v[188:191], a[188:191], v[124:127]
    v_cvt_pk_bf16_f32 v135, v78, v79
    v_mul_f32 v206, v206, v251
    s_waitcnt vmcnt(12) lgkmcnt(0)
    s_barrier
    v_mfma_f32_16x16x32_bf16 a[224:227], a[240:243], v[144:147], a[224:227]
    v_mfma_f32_16x16x32_bf16 a[228:231], a[240:243], v[148:151], a[228:231]
    s_add_u32 m0, s29, 6144
    v_exp_f32 v80, v80
    ds_read_b128 v[160:163], v216 offset:16384
    v_mfma_f32_16x16x32_bf16 a[232:235], a[240:243], v[152:155], a[232:235]
    s_add_u32 s35, s23, 22528
    v_exp_f32 v81, v81
    v_mfma_f32_16x16x32_bf16 a[236:239], a[240:243], v[156:159], a[236:239]
    buffer_load_dwordx4 v238, s[4:7], s35 offen nt lds
    v_cvt_pk_bf16_f32 v136, v80, v81
    v_mfma_f32_16x16x32_bf16 v[0:3], a[192:195], v[144:147], v[0:3]
    v_mfma_f32_16x16x32_bf16 v[4:7], a[192:195], v[148:151], v[4:7]
    v_exp_f32 v82, v82
    v_mul_f32 v207, v207, v251
    ds_read_b128 v[164:167], v217 offset:16384
    v_mfma_f32_16x16x32_bf16 a[0:3], a[192:195], v[152:155], a[0:3]
    v_mfma_f32_16x16x32_bf16 a[4:7], a[192:195], v[156:159], a[4:7]
    v_mfma_f32_16x16x32_bf16 v[8:11], a[196:199], v[144:147], v[8:11]
    v_exp_f32 v83, v83
    v_mfma_f32_16x16x32_bf16 v[12:15], a[196:199], v[148:151], v[12:15]
    v_cvt_pk_bf16_f32 v137, v82, v83
    v_exp_f32 v84, v84
    ds_read_b128 v[168:171], v218 offset:16384
    v_mfma_f32_16x16x32_bf16 a[8:11], a[196:199], v[152:155], a[8:11]
    v_exp_f32 v85, v85
    v_mfma_f32_16x16x32_bf16 a[12:15], a[196:199], v[156:159], a[12:15]
    buffer_load_dwordx4 v239, s[4:7], s35 offen offset:1024 nt lds
    v_cvt_pk_bf16_f32 v138, v84, v85
    v_mfma_f32_16x16x32_bf16 v[16:19], a[200:203], v[144:147], v[16:19]
    v_mfma_f32_16x16x32_bf16 v[20:23], a[200:203], v[148:151], v[20:23]
    v_exp_f32 v86, v86
    v_cvt_pk_bf16_f32 v204, v204, v205
    ds_read_b128 v[172:175], v219 offset:16384
    v_mfma_f32_16x16x32_bf16 a[16:19], a[200:203], v[152:155], a[16:19]
    v_mfma_f32_16x16x32_bf16 a[20:23], a[200:203], v[156:159], a[20:23]
    v_exp_f32 v87, v87
    v_mfma_f32_16x16x32_bf16 v[24:27], a[204:207], v[144:147], v[24:27]
    v_cvt_pk_bf16_f32 v139, v86, v87
    v_exp_f32 v88, v88
    v_mfma_f32_16x16x32_bf16 v[28:31], a[204:207], v[148:151], v[28:31]
    s_add_u32 m0, s25, 57344
    v_cvt_pk_bf16_f32 v205, v206, v207
    ds_read_b128 v[176:179], v216 offset:20480
    v_mfma_f32_16x16x32_bf16 a[24:27], a[204:207], v[152:155], a[24:27]
    s_add_u32 s35, s21, 61440
    v_exp_f32 v89, v89
    v_mfma_f32_16x16x32_bf16 a[28:31], a[204:207], v[156:159], a[28:31]
    buffer_load_dwordx4 v234, s[12:15], s35 offen nt lds
    v_cvt_pk_bf16_f32 v140, v88, v89
    v_mfma_f32_16x16x32_bf16 v[32:35], a[208:211], v[144:147], v[32:35]
    v_exp_f32 v90, v90
    v_mfma_f32_16x16x32_bf16 v[36:39], a[208:211], v[148:151], v[36:39]
    ds_read_b128 v[180:183], v217 offset:20480
    ds_write_b64 v243, v[204:205] offset:12416
    v_mfma_f32_16x16x32_bf16 a[32:35], a[208:211], v[152:155], a[32:35]
    v_exp_f32 v91, v91
    v_mfma_f32_16x16x32_bf16 a[36:39], a[208:211], v[156:159], a[36:39]
    v_cvt_pk_bf16_f32 v141, v90, v91
    ds_read_b128 v[184:187], v218 offset:20480
    v_mfma_f32_16x16x32_bf16 v[40:43], a[212:215], v[144:147], v[40:43]
    v_mfma_f32_16x16x32_bf16 v[44:47], a[212:215], v[148:151], v[44:47]
    v_exp_f32 v92, v92
    ds_read_b128 v[188:191], v219 offset:20480
    v_mfma_f32_16x16x32_bf16 a[40:43], a[212:215], v[152:155], a[40:43]
    v_exp_f32 v93, v93
    v_mfma_f32_16x16x32_bf16 a[44:47], a[212:215], v[156:159], a[44:47]
    buffer_load_dwordx4 v235, s[12:15], s35 offen offset:1024 nt lds
    v_cvt_pk_bf16_f32 v142, v92, v93
    v_mfma_f32_16x16x32_bf16 v[48:51], a[216:219], v[144:147], v[48:51]
    v_mfma_f32_16x16x32_bf16 v[52:55], a[216:219], v[148:151], v[52:55]
    v_exp_f32 v94, v94
    v_mfma_f32_16x16x32_bf16 a[48:51], a[216:219], v[152:155], a[48:51]
    v_exp_f32 v95, v95
    v_mfma_f32_16x16x32_bf16 a[52:55], a[216:219], v[156:159], a[52:55]
    v_cvt_pk_bf16_f32 v143, v94, v95
    v_mfma_f32_16x16x32_bf16 v[56:59], a[220:223], v[144:147], v[56:59]
    v_mfma_f32_16x16x32_bf16 v[60:63], a[220:223], v[148:151], v[60:63]
    v_mfma_f32_16x16x32_bf16 a[56:59], a[220:223], v[152:155], a[56:59]
    v_mfma_f32_16x16x32_bf16 a[60:63], a[220:223], v[156:159], a[60:63]
    s_waitcnt lgkmcnt(0)
    v_pk_fma_f32 v[96:97], v[96:97], s[26:27], v[244:245] op_sel:[0,0,0] op_sel_hi:[1,0,0]
    v_pk_fma_f32 v[98:99], v[98:99], s[26:27], v[244:245] op_sel:[0,0,0] op_sel_hi:[1,0,0]
    v_pk_fma_f32 v[100:101], v[100:101], s[26:27], v[244:245] op_sel:[0,0,0] op_sel_hi:[1,0,0]
    v_pk_fma_f32 v[102:103], v[102:103], s[26:27], v[244:245] op_sel:[0,0,0] op_sel_hi:[1,0,0]
    v_pk_fma_f32 v[104:105], v[104:105], s[26:27], v[244:245] op_sel:[0,0,1] op_sel_hi:[1,0,1]
    v_pk_fma_f32 v[106:107], v[106:107], s[26:27], v[244:245] op_sel:[0,0,1] op_sel_hi:[1,0,1]
    v_pk_fma_f32 v[108:109], v[108:109], s[26:27], v[244:245] op_sel:[0,0,1] op_sel_hi:[1,0,1]
    v_pk_fma_f32 v[110:111], v[110:111], s[26:27], v[244:245] op_sel:[0,0,1] op_sel_hi:[1,0,1]
    v_pk_fma_f32 v[112:113], v[112:113], s[26:27], v[246:247] op_sel:[0,0,0] op_sel_hi:[1,0,0]
    v_pk_fma_f32 v[114:115], v[114:115], s[26:27], v[246:247] op_sel:[0,0,0] op_sel_hi:[1,0,0]
    v_pk_fma_f32 v[116:117], v[116:117], s[26:27], v[246:247] op_sel:[0,0,0] op_sel_hi:[1,0,0]
    v_pk_fma_f32 v[118:119], v[118:119], s[26:27], v[246:247] op_sel:[0,0,0] op_sel_hi:[1,0,0]
    v_pk_fma_f32 v[120:121], v[120:121], s[26:27], v[246:247] op_sel:[0,0,1] op_sel_hi:[1,0,1]
    v_pk_fma_f32 v[122:123], v[122:123], s[26:27], v[246:247] op_sel:[0,0,1] op_sel_hi:[1,0,1]
    v_pk_fma_f32 v[124:125], v[124:125], s[26:27], v[246:247] op_sel:[0,0,1] op_sel_hi:[1,0,1]
    v_pk_fma_f32 v[126:127], v[126:127], s[26:27], v[246:247] op_sel:[0,0,1] op_sel_hi:[1,0,1]
    s_nop 1
    v_mfma_f32_16x16x32_bf16 v[64:67], v[160:163], a[128:131], 0
    v_mfma_f32_16x16x32_bf16 v[72:75], v[160:163], a[144:147], 0
    v_exp_f32 v96, v96
    ds_read_b64_tr_b16 a[192:193], v224 offset:0
    v_mfma_f32_16x16x32_bf16 v[80:83], v[160:163], a[160:163], 0
    v_exp_f32 v97, v97
    ds_read_b64_tr_b16 a[194:195], v224 offset:4096
    v_mfma_f32_16x16x32_bf16 v[88:91], v[160:163], a[176:179], 0
    s_add_u32 m0, s25, 8192
    v_cvt_pk_bf16_f32 v144, v96, v97
    ds_read_b64_tr_b16 a[196:197], v225 offset:0
    v_mfma_f32_16x16x32_bf16 v[64:67], v[164:167], a[132:135], v[64:67]
    s_add_u32 s35, s22, 4096
    v_mfma_f32_16x16x32_bf16 v[72:75], v[164:167], a[148:151], v[72:75]
    ds_read_b64_tr_b16 a[198:199], v225 offset:4096
    buffer_load_dwordx4 v232, s[8:11], s35 offen nt lds
    v_exp_f32 v98, v98
    v_mfma_f32_16x16x32_bf16 v[80:83], v[164:167], a[164:167], v[80:83]
    v_exp_f32 v99, v99
    v_mfma_f32_16x16x32_bf16 v[88:91], v[164:167], a[180:183], v[88:91]
    v_cvt_pk_bf16_f32 v145, v98, v99
    ds_read_b64_tr_b16 a[200:201], v226 offset:0
    v_mfma_f32_16x16x32_bf16 v[64:67], v[168:171], a[136:139], v[64:67]
    v_exp_f32 v100, v100
    ds_read_b64_tr_b16 a[202:203], v226 offset:4096
    v_mfma_f32_16x16x32_bf16 v[72:75], v[168:171], a[152:155], v[72:75]
    ds_read_b64_tr_b16 a[204:205], v227 offset:0
    v_mfma_f32_16x16x32_bf16 v[80:83], v[168:171], a[168:171], v[80:83]
    v_exp_f32 v101, v101
    v_mfma_f32_16x16x32_bf16 v[88:91], v[168:171], a[184:187], v[88:91]
    v_cvt_pk_bf16_f32 v146, v100, v101
    ds_read_b64_tr_b16 a[206:207], v227 offset:4096
    v_mfma_f32_16x16x32_bf16 v[64:67], v[172:175], a[140:143], v[64:67]
    v_mfma_f32_16x16x32_bf16 v[72:75], v[172:175], a[156:159], v[72:75]
    v_exp_f32 v102, v102
    ds_read_b64_tr_b16 a[208:209], v228 offset:0
    v_mfma_f32_16x16x32_bf16 v[80:83], v[172:175], a[172:175], v[80:83]
    v_exp_f32 v103, v103
    ds_read_b64_tr_b16 a[210:211], v228 offset:4096
    v_mfma_f32_16x16x32_bf16 v[88:91], v[172:175], a[188:191], v[88:91]
    v_cvt_pk_bf16_f32 v147, v102, v103
    ds_read_b64_tr_b16 a[212:213], v229 offset:0
    v_mfma_f32_16x16x32_bf16 v[68:71], v[176:179], a[128:131], 0
    v_mfma_f32_16x16x32_bf16 v[76:79], v[176:179], a[144:147], 0
    v_exp_f32 v104, v104
    ds_read_b64_tr_b16 a[214:215], v229 offset:4096
    v_mfma_f32_16x16x32_bf16 v[84:87], v[176:179], a[160:163], 0
    v_exp_f32 v105, v105
    ds_read_b64_tr_b16 a[216:217], v230 offset:0
    v_mfma_f32_16x16x32_bf16 v[92:95], v[176:179], a[176:179], 0
    ds_read_b64_tr_b16 a[218:219], v230 offset:4096
    buffer_load_dwordx4 v233, s[8:11], s35 offen offset:1024 nt lds
    v_cvt_pk_bf16_f32 v148, v104, v105
    v_mfma_f32_16x16x32_bf16 v[68:71], v[180:183], a[132:135], v[68:71]
    v_mfma_f32_16x16x32_bf16 v[76:79], v[180:183], a[148:151], v[76:79]
    v_exp_f32 v106, v106
    ds_read_b64_tr_b16 a[220:221], v231 offset:0
    v_mfma_f32_16x16x32_bf16 v[84:87], v[180:183], a[164:167], v[84:87]
    v_exp_f32 v107, v107
    v_mfma_f32_16x16x32_bf16 v[92:95], v[180:183], a[180:183], v[92:95]
    v_cvt_pk_bf16_f32 v149, v106, v107
    ds_read_b64_tr_b16 a[222:223], v231 offset:4096
    v_mfma_f32_16x16x32_bf16 v[68:71], v[184:187], a[136:139], v[68:71]
    v_exp_f32 v108, v108
    ds_read_b128 v[192:195], v215 offset:10240
    v_mfma_f32_16x16x32_bf16 v[76:79], v[184:187], a[152:155], v[76:79]
    ds_read_b128 v[196:199], v215 offset:11264
    v_mfma_f32_16x16x32_bf16 v[84:87], v[184:187], a[168:171], v[84:87]
    v_mfma_f32_16x16x32_bf16 v[92:95], v[184:187], a[184:187], v[92:95]
    v_mfma_f32_16x16x32_bf16 v[68:71], v[188:191], a[140:143], v[68:71]
    v_mfma_f32_16x16x32_bf16 v[76:79], v[188:191], a[156:159], v[76:79]
    v_exp_f32 v109, v109
    v_mfma_f32_16x16x32_bf16 v[84:87], v[188:191], a[172:175], v[84:87]
    v_cvt_pk_bf16_f32 v150, v108, v109
    v_exp_f32 v110, v110
    v_exp_f32 v111, v111
    v_mfma_f32_16x16x32_bf16 v[92:95], v[188:191], a[188:191], v[92:95]
    v_cvt_pk_bf16_f32 v151, v110, v111
    s_waitcnt vmcnt(12) lgkmcnt(0)
    s_barrier
    v_mfma_f32_16x16x32_bf16 a[224:227], a[240:243], v[128:131], a[224:227]
    v_mfma_f32_16x16x32_bf16 a[228:231], a[240:243], v[132:135], a[228:231]
    v_exp_f32 v112, v112
    ds_read_b128 v[160:163], v216 offset:24576
    v_mfma_f32_16x16x32_bf16 a[232:235], a[240:243], v[136:139], a[232:235]
    s_add_u32 s35, s24, 18432
    v_exp_f32 v113, v113
    v_mfma_f32_16x16x32_bf16 a[236:239], a[240:243], v[140:143], a[236:239]
    buffer_store_dwordx4 v[192:195], v236, s[16:19], s35 offen sc1
    v_cvt_pk_bf16_f32 v152, v112, v113
    v_mfma_f32_16x16x32_bf16 v[0:3], a[192:195], v[128:131], v[0:3]
    v_mfma_f32_16x16x32_bf16 v[4:7], a[192:195], v[132:135], v[4:7]
    v_exp_f32 v114, v114
    ds_read_b128 v[164:167], v217 offset:24576
    v_mfma_f32_16x16x32_bf16 a[0:3], a[192:195], v[136:139], a[0:3]
    v_mfma_f32_16x16x32_bf16 a[4:7], a[192:195], v[140:143], a[4:7]
    v_mfma_f32_16x16x32_bf16 v[8:11], a[196:199], v[128:131], v[8:11]
    v_exp_f32 v115, v115
    v_mfma_f32_16x16x32_bf16 v[12:15], a[196:199], v[132:135], v[12:15]
    v_cvt_pk_bf16_f32 v153, v114, v115
    v_exp_f32 v116, v116
    ds_read_b128 v[168:171], v218 offset:24576
    v_mfma_f32_16x16x32_bf16 a[8:11], a[196:199], v[136:139], a[8:11]
    v_exp_f32 v117, v117
    v_mfma_f32_16x16x32_bf16 a[12:15], a[196:199], v[140:143], a[12:15]
    buffer_store_dwordx4 v[196:199], v237, s[16:19], s35 offen offset:1024 sc1
    v_cvt_pk_bf16_f32 v154, v116, v117
    v_mfma_f32_16x16x32_bf16 v[16:19], a[200:203], v[128:131], v[16:19]
    v_mfma_f32_16x16x32_bf16 v[20:23], a[200:203], v[132:135], v[20:23]
    v_exp_f32 v118, v118
    ds_read_b128 v[172:175], v219 offset:24576
    v_mfma_f32_16x16x32_bf16 a[16:19], a[200:203], v[136:139], a[16:19]
    v_mfma_f32_16x16x32_bf16 a[20:23], a[200:203], v[140:143], a[20:23]
    v_mfma_f32_16x16x32_bf16 v[24:27], a[204:207], v[128:131], v[24:27]
    v_exp_f32 v119, v119
    v_mfma_f32_16x16x32_bf16 v[28:31], a[204:207], v[132:135], v[28:31]
    s_add_u32 m0, s25, 32768
    v_cvt_pk_bf16_f32 v155, v118, v119
    v_exp_f32 v120, v120
    ds_read_b128 v[176:179], v216 offset:28672
    v_mfma_f32_16x16x32_bf16 a[24:27], a[204:207], v[136:139], a[24:27]
    s_add_u32 s35, s22, 0
    v_exp_f32 v121, v121
    v_mfma_f32_16x16x32_bf16 a[28:31], a[204:207], v[140:143], a[28:31]
    buffer_load_dwordx4 v234, s[12:15], s35 offen nt lds
    v_cvt_pk_bf16_f32 v156, v120, v121
    v_mfma_f32_16x16x32_bf16 v[32:35], a[208:211], v[128:131], v[32:35]
    v_mfma_f32_16x16x32_bf16 v[36:39], a[208:211], v[132:135], v[36:39]
    v_exp_f32 v122, v122
    ds_read_b128 v[180:183], v217 offset:28672
    v_mfma_f32_16x16x32_bf16 a[32:35], a[208:211], v[136:139], a[32:35]
    v_exp_f32 v123, v123
    v_mfma_f32_16x16x32_bf16 a[36:39], a[208:211], v[140:143], a[36:39]
    v_cvt_pk_bf16_f32 v157, v122, v123
    ds_read_b128 v[184:187], v218 offset:28672
    v_mfma_f32_16x16x32_bf16 v[40:43], a[212:215], v[128:131], v[40:43]
    v_mfma_f32_16x16x32_bf16 v[44:47], a[212:215], v[132:135], v[44:47]
    v_exp_f32 v124, v124
    ds_read_b128 v[188:191], v219 offset:28672
    v_mfma_f32_16x16x32_bf16 a[40:43], a[212:215], v[136:139], a[40:43]
    v_exp_f32 v125, v125
    v_mfma_f32_16x16x32_bf16 a[44:47], a[212:215], v[140:143], a[44:47]
    buffer_load_dwordx4 v235, s[12:15], s35 offen offset:1024 nt lds
    v_cvt_pk_bf16_f32 v158, v124, v125
    v_mfma_f32_16x16x32_bf16 v[48:51], a[216:219], v[128:131], v[48:51]
    v_mfma_f32_16x16x32_bf16 v[52:55], a[216:219], v[132:135], v[52:55]
    v_exp_f32 v126, v126
    v_mfma_f32_16x16x32_bf16 a[48:51], a[216:219], v[136:139], a[48:51]
    v_exp_f32 v127, v127
    v_mfma_f32_16x16x32_bf16 a[52:55], a[216:219], v[140:143], a[52:55]
    v_cvt_pk_bf16_f32 v159, v126, v127
    v_mfma_f32_16x16x32_bf16 v[56:59], a[220:223], v[128:131], v[56:59]
    v_mfma_f32_16x16x32_bf16 v[60:63], a[220:223], v[132:135], v[60:63]
    v_mfma_f32_16x16x32_bf16 a[56:59], a[220:223], v[136:139], a[56:59]
    v_mfma_f32_16x16x32_bf16 a[60:63], a[220:223], v[140:143], a[60:63]
    s_waitcnt lgkmcnt(0)
    v_pk_fma_f32 v[64:65], v[64:65], s[26:27], v[244:245] op_sel:[0,0,0] op_sel_hi:[1,0,0]
    v_pk_fma_f32 v[66:67], v[66:67], s[26:27], v[244:245] op_sel:[0,0,0] op_sel_hi:[1,0,0]
    v_pk_fma_f32 v[68:69], v[68:69], s[26:27], v[244:245] op_sel:[0,0,0] op_sel_hi:[1,0,0]
    v_pk_fma_f32 v[70:71], v[70:71], s[26:27], v[244:245] op_sel:[0,0,0] op_sel_hi:[1,0,0]
    v_pk_fma_f32 v[72:73], v[72:73], s[26:27], v[244:245] op_sel:[0,0,1] op_sel_hi:[1,0,1]
    v_pk_fma_f32 v[74:75], v[74:75], s[26:27], v[244:245] op_sel:[0,0,1] op_sel_hi:[1,0,1]
    v_pk_fma_f32 v[76:77], v[76:77], s[26:27], v[244:245] op_sel:[0,0,1] op_sel_hi:[1,0,1]
    v_pk_fma_f32 v[78:79], v[78:79], s[26:27], v[244:245] op_sel:[0,0,1] op_sel_hi:[1,0,1]
    v_pk_fma_f32 v[80:81], v[80:81], s[26:27], v[246:247] op_sel:[0,0,0] op_sel_hi:[1,0,0]
    v_pk_fma_f32 v[82:83], v[82:83], s[26:27], v[246:247] op_sel:[0,0,0] op_sel_hi:[1,0,0]
    v_pk_fma_f32 v[84:85], v[84:85], s[26:27], v[246:247] op_sel:[0,0,0] op_sel_hi:[1,0,0]
    v_pk_fma_f32 v[86:87], v[86:87], s[26:27], v[246:247] op_sel:[0,0,0] op_sel_hi:[1,0,0]
    v_pk_fma_f32 v[88:89], v[88:89], s[26:27], v[246:247] op_sel:[0,0,1] op_sel_hi:[1,0,1]
    v_pk_fma_f32 v[90:91], v[90:91], s[26:27], v[246:247] op_sel:[0,0,1] op_sel_hi:[1,0,1]
    v_pk_fma_f32 v[92:93], v[92:93], s[26:27], v[246:247] op_sel:[0,0,1] op_sel_hi:[1,0,1]
    v_pk_fma_f32 v[94:95], v[94:95], s[26:27], v[246:247] op_sel:[0,0,1] op_sel_hi:[1,0,1]
    s_nop 1
    v_mfma_f32_16x16x32_bf16 v[96:99], v[160:163], a[128:131], 0
    v_exp_f32 v64, v64
    v_mfma_f32_16x16x32_bf16 v[104:107], v[160:163], a[144:147], 0
    ds_read_b64_tr_b16 a[192:193], v224 offset:8192
    v_mfma_f32_16x16x32_bf16 v[112:115], v[160:163], a[160:163], 0
    v_exp_f32 v65, v65
    ds_read_b64_tr_b16 a[194:195], v224 offset:12288
    v_mfma_f32_16x16x32_bf16 v[120:123], v[160:163], a[176:179], 0
    s_add_u32 m0, s25, 16384
    v_cvt_pk_bf16_f32 v128, v64, v65
    ds_read_b64_tr_b16 a[196:197], v225 offset:8192
    v_mfma_f32_16x16x32_bf16 v[96:99], v[164:167], a[132:135], v[96:99]
    s_add_u32 s35, s22, 8192
    v_exp_f32 v66, v66
    v_mfma_f32_16x16x32_bf16 v[104:107], v[164:167], a[148:151], v[104:107]
    ds_read_b64_tr_b16 a[198:199], v225 offset:12288
    buffer_load_dwordx4 v232, s[8:11], s35 offen nt lds
    v_mfma_f32_16x16x32_bf16 v[112:115], v[164:167], a[164:167], v[112:115]
    v_exp_f32 v67, v67
    v_mfma_f32_16x16x32_bf16 v[120:123], v[164:167], a[180:183], v[120:123]
    v_cvt_pk_bf16_f32 v129, v66, v67
    ds_read_b64_tr_b16 a[200:201], v226 offset:8192
    v_mfma_f32_16x16x32_bf16 v[96:99], v[168:171], a[136:139], v[96:99]
    v_exp_f32 v68, v68
    ds_read_b64_tr_b16 a[202:203], v226 offset:12288
    v_mfma_f32_16x16x32_bf16 v[104:107], v[168:171], a[152:155], v[104:107]
    ds_read_b64_tr_b16 a[204:205], v227 offset:8192
    v_mfma_f32_16x16x32_bf16 v[112:115], v[168:171], a[168:171], v[112:115]
    v_exp_f32 v69, v69
    v_mfma_f32_16x16x32_bf16 v[120:123], v[168:171], a[184:187], v[120:123]
    v_cvt_pk_bf16_f32 v130, v68, v69
    ds_read_b64_tr_b16 a[206:207], v227 offset:12288
    v_mfma_f32_16x16x32_bf16 v[96:99], v[172:175], a[140:143], v[96:99]
    v_exp_f32 v70, v70
    v_mfma_f32_16x16x32_bf16 v[104:107], v[172:175], a[156:159], v[104:107]
    ds_read_b64_tr_b16 a[208:209], v228 offset:8192
    v_mfma_f32_16x16x32_bf16 v[112:115], v[172:175], a[172:175], v[112:115]
    v_exp_f32 v71, v71
    ds_read_b64_tr_b16 a[210:211], v228 offset:12288
    v_mfma_f32_16x16x32_bf16 v[120:123], v[172:175], a[188:191], v[120:123]
    v_cvt_pk_bf16_f32 v131, v70, v71
    ds_read_b64_tr_b16 a[212:213], v229 offset:8192
    v_mfma_f32_16x16x32_bf16 v[100:103], v[176:179], a[128:131], 0
    v_exp_f32 v72, v72
    v_mfma_f32_16x16x32_bf16 v[108:111], v[176:179], a[144:147], 0
    ds_read_b64_tr_b16 a[214:215], v229 offset:12288
    v_mfma_f32_16x16x32_bf16 v[116:119], v[176:179], a[160:163], 0
    v_exp_f32 v73, v73
    ds_read_b64_tr_b16 a[216:217], v230 offset:8192
    v_mfma_f32_16x16x32_bf16 v[124:127], v[176:179], a[176:179], 0
    ds_read_b64_tr_b16 a[218:219], v230 offset:12288
    buffer_load_dwordx4 v233, s[8:11], s35 offen offset:1024 nt lds
    v_cvt_pk_bf16_f32 v132, v72, v73
    v_mfma_f32_16x16x32_bf16 v[100:103], v[180:183], a[132:135], v[100:103]
    v_exp_f32 v74, v74
    v_mfma_f32_16x16x32_bf16 v[108:111], v[180:183], a[148:151], v[108:111]
    ds_read_b64_tr_b16 a[220:221], v231 offset:8192
    v_mfma_f32_16x16x32_bf16 v[116:119], v[180:183], a[164:167], v[116:119]
    v_exp_f32 v75, v75
    v_mfma_f32_16x16x32_bf16 v[124:127], v[180:183], a[180:183], v[124:127]
    v_cvt_pk_bf16_f32 v133, v74, v75
    ds_read_b64_tr_b16 a[222:223], v231 offset:12288
    v_mfma_f32_16x16x32_bf16 v[100:103], v[184:187], a[136:139], v[100:103]
    s_add_u32 s23, s20, 262144
    v_exp_f32 v76, v76
    ds_read_b128 v[192:195], v215 offset:12288
    v_mfma_f32_16x16x32_bf16 v[108:111], v[184:187], a[152:155], v[108:111]
    s_xor_b32 s23, s23, s32
    v_add_u32 v200, s29, v216
    ds_read_b128 v[196:199], v215 offset:13312
    v_mfma_f32_16x16x32_bf16 v[116:119], v[184:187], a[168:171], v[116:119]
    s_lshr_b32 s23, s23, 1
    v_exp_f32 v77, v77
    v_mfma_f32_16x16x32_bf16 v[124:127], v[184:187], a[184:187], v[124:127]
    v_cvt_pk_bf16_f32 v134, v76, v77
    v_add_u32 v201, s29, v217
    v_mfma_f32_16x16x32_bf16 v[100:103], v[188:191], a[140:143], v[100:103]
    v_exp_f32 v78, v78
    v_mfma_f32_16x16x32_bf16 v[108:111], v[188:191], a[156:159], v[108:111]
    v_add_u32 v202, s29, v218
    v_add_u32 v203, s29, v219
    v_mfma_f32_16x16x32_bf16 v[116:119], v[188:191], a[172:175], v[116:119]
    v_exp_f32 v79, v79
    v_mfma_f32_16x16x32_bf16 v[124:127], v[188:191], a[188:191], v[124:127]
    v_cvt_pk_bf16_f32 v135, v78, v79
    s_waitcnt vmcnt(10) lgkmcnt(0)
    s_barrier
    v_mfma_f32_16x16x32_bf16 a[224:227], a[240:243], v[144:147], a[224:227]
    v_exp_f32 v80, v80
    v_mfma_f32_16x16x32_bf16 a[228:231], a[240:243], v[148:151], a[228:231]
    ds_read_b128 v[160:163], v216 offset:0
    v_mfma_f32_16x16x32_bf16 a[232:235], a[240:243], v[152:155], a[232:235]
    s_add_u32 s35, s24, 20480
    v_exp_f32 v81, v81
    ds_read_b128 v[164:167], v217 offset:0
    v_mfma_f32_16x16x32_bf16 a[236:239], a[240:243], v[156:159], a[236:239]
    buffer_store_dwordx4 v[192:195], v236, s[16:19], s35 offen sc1
    ds_read_b128 v[168:171], v218 offset:0
    v_cvt_pk_bf16_f32 v136, v80, v81
    v_mfma_f32_16x16x32_bf16 v[0:3], a[192:195], v[144:147], v[0:3]
    v_exp_f32 v82, v82
    v_mfma_f32_16x16x32_bf16 v[4:7], a[192:195], v[148:151], v[4:7]
    ds_read_b128 v[172:175], v219 offset:0
    v_mfma_f32_16x16x32_bf16 a[0:3], a[192:195], v[152:155], a[0:3]
    v_exp_f32 v83, v83
    ds_read_b128 a[128:131], v200 offset:16384
    v_mfma_f32_16x16x32_bf16 a[4:7], a[192:195], v[156:159], a[4:7]
    v_cvt_pk_bf16_f32 v137, v82, v83
    ds_read_b128 a[132:135], v201 offset:16384
    v_mfma_f32_16x16x32_bf16 v[8:11], a[196:199], v[144:147], v[8:11]
    v_exp_f32 v84, v84
    ds_read_b128 a[136:139], v202 offset:16384
    v_mfma_f32_16x16x32_bf16 v[12:15], a[196:199], v[148:151], v[12:15]
    ds_read_b128 a[140:143], v203 offset:16384
    v_mfma_f32_16x16x32_bf16 a[8:11], a[196:199], v[152:155], a[8:11]
    v_exp_f32 v85, v85
    ds_read_b128 v[176:179], v216 offset:4096
    v_mfma_f32_16x16x32_bf16 a[12:15], a[196:199], v[156:159], a[12:15]
    buffer_store_dwordx4 v[196:199], v237, s[16:19], s35 offen offset:1024 sc1
    v_cvt_pk_bf16_f32 v138, v84, v85
    v_mfma_f32_16x16x32_bf16 v[16:19], a[200:203], v[144:147], v[16:19]
    v_exp_f32 v86, v86
    ds_read_b128 v[180:183], v217 offset:4096
    v_mfma_f32_16x16x32_bf16 v[20:23], a[200:203], v[148:151], v[20:23]
    ds_read_b128 v[184:187], v218 offset:4096
    v_mfma_f32_16x16x32_bf16 a[16:19], a[200:203], v[152:155], a[16:19]
    v_exp_f32 v87, v87
    v_mfma_f32_16x16x32_bf16 a[20:23], a[200:203], v[156:159], a[20:23]
    v_cvt_pk_bf16_f32 v139, v86, v87
    ds_read_b128 v[188:191], v219 offset:4096
    v_mfma_f32_16x16x32_bf16 v[24:27], a[204:207], v[144:147], v[24:27]
    v_exp_f32 v88, v88
    ds_read_b128 a[144:147], v200 offset:20480
    v_mfma_f32_16x16x32_bf16 v[28:31], a[204:207], v[148:151], v[28:31]
    s_add_u32 m0, s25, 40960
    ds_read_b128 a[148:151], v201 offset:20480
    v_mfma_f32_16x16x32_bf16 a[24:27], a[204:207], v[152:155], a[24:27]
    s_add_u32 s35, s22, 4096
    v_exp_f32 v89, v89
    ds_read_b128 a[152:155], v202 offset:20480
    v_mfma_f32_16x16x32_bf16 a[28:31], a[204:207], v[156:159], a[28:31]
    buffer_load_dwordx4 v234, s[12:15], s35 offen nt lds
    v_cvt_pk_bf16_f32 v140, v88, v89
    v_mfma_f32_16x16x32_bf16 v[32:35], a[208:211], v[144:147], v[32:35]
    v_exp_f32 v90, v90
    ds_read_b128 a[156:159], v203 offset:20480
    v_mfma_f32_16x16x32_bf16 v[36:39], a[208:211], v[148:151], v[36:39]
    ds_read_b128 a[160:163], v200 offset:0
    v_mfma_f32_16x16x32_bf16 a[32:35], a[208:211], v[152:155], a[32:35]
    v_exp_f32 v91, v91
    ds_read_b128 a[164:167], v201 offset:0
    v_mfma_f32_16x16x32_bf16 a[36:39], a[208:211], v[156:159], a[36:39]
    v_cvt_pk_bf16_f32 v141, v90, v91
    ds_read_b128 a[168:171], v202 offset:0
    v_mfma_f32_16x16x32_bf16 v[40:43], a[212:215], v[144:147], v[40:43]
    v_exp_f32 v92, v92
    v_mfma_f32_16x16x32_bf16 v[44:47], a[212:215], v[148:151], v[44:47]
    ds_read_b128 a[172:175], v203 offset:0
    v_mfma_f32_16x16x32_bf16 a[40:43], a[212:215], v[152:155], a[40:43]
    v_exp_f32 v93, v93
    ds_read_b128 a[176:179], v200 offset:4096
    v_mfma_f32_16x16x32_bf16 a[44:47], a[212:215], v[156:159], a[44:47]
    buffer_load_dwordx4 v235, s[12:15], s35 offen offset:1024 nt lds
    ds_read_b128 a[180:183], v201 offset:4096
    v_cvt_pk_bf16_f32 v142, v92, v93
    v_mfma_f32_16x16x32_bf16 v[48:51], a[216:219], v[144:147], v[48:51]
    v_exp_f32 v94, v94
    ds_read_b128 a[184:187], v202 offset:4096
    v_mfma_f32_16x16x32_bf16 v[52:55], a[216:219], v[148:151], v[52:55]
    ds_read_b128 a[188:191], v203 offset:4096
    v_mfma_f32_16x16x32_bf16 a[48:51], a[216:219], v[152:155], a[48:51]
    v_exp_f32 v95, v95
    v_mfma_f32_16x16x32_bf16 a[52:55], a[216:219], v[156:159], a[52:55]
    v_cvt_pk_bf16_f32 v143, v94, v95
    v_mfma_f32_16x16x32_bf16 v[56:59], a[220:223], v[144:147], v[56:59]
    v_mfma_f32_16x16x32_bf16 v[60:63], a[220:223], v[148:151], v[60:63]
    v_mfma_f32_16x16x32_bf16 a[56:59], a[220:223], v[152:155], a[56:59]
    v_mfma_f32_16x16x32_bf16 a[60:63], a[220:223], v[156:159], a[60:63]
    s_waitcnt lgkmcnt(0)
    v_pk_fma_f32 v[96:97], v[96:97], s[26:27], v[244:245] op_sel:[0,0,0] op_sel_hi:[1,0,0]
    v_pk_fma_f32 v[98:99], v[98:99], s[26:27], v[244:245] op_sel:[0,0,0] op_sel_hi:[1,0,0]
    v_pk_fma_f32 v[100:101], v[100:101], s[26:27], v[244:245] op_sel:[0,0,0] op_sel_hi:[1,0,0]
    v_pk_fma_f32 v[102:103], v[102:103], s[26:27], v[244:245] op_sel:[0,0,0] op_sel_hi:[1,0,0]
    v_pk_fma_f32 v[104:105], v[104:105], s[26:27], v[244:245] op_sel:[0,0,1] op_sel_hi:[1,0,1]
    v_pk_fma_f32 v[106:107], v[106:107], s[26:27], v[244:245] op_sel:[0,0,1] op_sel_hi:[1,0,1]
    v_pk_fma_f32 v[108:109], v[108:109], s[26:27], v[244:245] op_sel:[0,0,1] op_sel_hi:[1,0,1]
    v_pk_fma_f32 v[110:111], v[110:111], s[26:27], v[244:245] op_sel:[0,0,1] op_sel_hi:[1,0,1]
    v_pk_fma_f32 v[112:113], v[112:113], s[26:27], v[246:247] op_sel:[0,0,0] op_sel_hi:[1,0,0]
    v_pk_fma_f32 v[114:115], v[114:115], s[26:27], v[246:247] op_sel:[0,0,0] op_sel_hi:[1,0,0]
    v_pk_fma_f32 v[116:117], v[116:117], s[26:27], v[246:247] op_sel:[0,0,0] op_sel_hi:[1,0,0]
    v_pk_fma_f32 v[118:119], v[118:119], s[26:27], v[246:247] op_sel:[0,0,0] op_sel_hi:[1,0,0]
    v_pk_fma_f32 v[120:121], v[120:121], s[26:27], v[246:247] op_sel:[0,0,1] op_sel_hi:[1,0,1]
    v_pk_fma_f32 v[122:123], v[122:123], s[26:27], v[246:247] op_sel:[0,0,1] op_sel_hi:[1,0,1]
    v_pk_fma_f32 v[124:125], v[124:125], s[26:27], v[246:247] op_sel:[0,0,1] op_sel_hi:[1,0,1]
    v_pk_fma_f32 v[126:127], v[126:127], s[26:27], v[246:247] op_sel:[0,0,1] op_sel_hi:[1,0,1]
    s_nop 1
    v_mfma_f32_16x16x32_bf16 v[64:67], v[160:163], a[128:131], 0
    v_mfma_f32_16x16x32_bf16 v[72:75], v[160:163], a[144:147], 0
    v_exp_f32 v96, v96
    ds_read_b64_tr_b16 a[192:193], v224 offset:16384
    v_mfma_f32_16x16x32_bf16 v[80:83], v[160:163], a[160:163], 0
    v_exp_f32 v97, v97
    ds_read_b64_tr_b16 a[194:195], v224 offset:20480
    v_mfma_f32_16x16x32_bf16 v[88:91], v[160:163], a[176:179], 0
    s_add_u32 m0, s25, 24576
    v_cvt_pk_bf16_f32 v144, v96, v97
    ds_read_b64_tr_b16 a[196:197], v225 offset:16384
    v_mfma_f32_16x16x32_bf16 v[64:67], v[164:167], a[132:135], v[64:67]
    s_add_u32 s35, s22, 12288
    v_exp_f32 v98, v98
    v_mfma_f32_16x16x32_bf16 v[72:75], v[164:167], a[148:151], v[72:75]
    ds_read_b64_tr_b16 a[198:199], v225 offset:20480
    buffer_load_dwordx4 v232, s[8:11], s35 offen nt lds
    v_mfma_f32_16x16x32_bf16 v[80:83], v[164:167], a[164:167], v[80:83]
    v_exp_f32 v99, v99
    v_mfma_f32_16x16x32_bf16 v[88:91], v[164:167], a[180:183], v[88:91]
    v_cvt_pk_bf16_f32 v145, v98, v99
    ds_read_b64_tr_b16 a[200:201], v226 offset:16384
    v_mfma_f32_16x16x32_bf16 v[64:67], v[168:171], a[136:139], v[64:67]
    v_exp_f32 v100, v100
    ds_read_b64_tr_b16 a[202:203], v226 offset:20480
    v_mfma_f32_16x16x32_bf16 v[72:75], v[168:171], a[152:155], v[72:75]
    ds_read_b64_tr_b16 a[204:205], v227 offset:16384
    v_mfma_f32_16x16x32_bf16 v[80:83], v[168:171], a[168:171], v[80:83]
    v_exp_f32 v101, v101
    v_mfma_f32_16x16x32_bf16 v[88:91], v[168:171], a[184:187], v[88:91]
    v_cvt_pk_bf16_f32 v146, v100, v101
    ds_read_b64_tr_b16 a[206:207], v227 offset:20480
    v_mfma_f32_16x16x32_bf16 v[64:67], v[172:175], a[140:143], v[64:67]
    v_exp_f32 v102, v102
    v_mfma_f32_16x16x32_bf16 v[72:75], v[172:175], a[156:159], v[72:75]
    ds_read_b64_tr_b16 a[208:209], v228 offset:16384
    v_mfma_f32_16x16x32_bf16 v[80:83], v[172:175], a[172:175], v[80:83]
    v_exp_f32 v103, v103
    ds_read_b64_tr_b16 a[210:211], v228 offset:20480
    v_mfma_f32_16x16x32_bf16 v[88:91], v[172:175], a[188:191], v[88:91]
    v_cvt_pk_bf16_f32 v147, v102, v103
    ds_read_b64_tr_b16 a[212:213], v229 offset:16384
    v_mfma_f32_16x16x32_bf16 v[68:71], v[176:179], a[128:131], 0
    v_exp_f32 v104, v104
    v_mfma_f32_16x16x32_bf16 v[76:79], v[176:179], a[144:147], 0
    ds_read_b64_tr_b16 a[214:215], v229 offset:20480
    v_mfma_f32_16x16x32_bf16 v[84:87], v[176:179], a[160:163], 0
    v_exp_f32 v105, v105
    ds_read_b64_tr_b16 a[216:217], v230 offset:16384
    v_mfma_f32_16x16x32_bf16 v[92:95], v[176:179], a[176:179], 0
    ds_read_b64_tr_b16 a[218:219], v230 offset:20480
    buffer_load_dwordx4 v233, s[8:11], s35 offen offset:1024 nt lds
    v_cvt_pk_bf16_f32 v148, v104, v105
    v_mfma_f32_16x16x32_bf16 v[68:71], v[180:183], a[132:135], v[68:71]
    v_exp_f32 v106, v106
    v_mfma_f32_16x16x32_bf16 v[76:79], v[180:183], a[148:151], v[76:79]
    ds_read_b64_tr_b16 a[220:221], v231 offset:16384
    v_mfma_f32_16x16x32_bf16 v[84:87], v[180:183], a[164:167], v[84:87]
    v_exp_f32 v107, v107
    v_mfma_f32_16x16x32_bf16 v[92:95], v[180:183], a[180:183], v[92:95]
    v_cvt_pk_bf16_f32 v149, v106, v107
    ds_read_b64_tr_b16 a[222:223], v231 offset:20480
    v_mfma_f32_16x16x32_bf16 v[68:71], v[184:187], a[136:139], v[68:71]
    v_exp_f32 v108, v108
    ds_read_b128 v[192:195], v215 offset:14336
    v_mfma_f32_16x16x32_bf16 v[76:79], v[184:187], a[152:155], v[76:79]
    ds_read_b128 v[196:199], v215 offset:15360
    v_mfma_f32_16x16x32_bf16 v[84:87], v[184:187], a[168:171], v[84:87]
    v_exp_f32 v109, v109
    v_mfma_f32_16x16x32_bf16 v[92:95], v[184:187], a[184:187], v[92:95]
    v_cvt_pk_bf16_f32 v150, v108, v109
    v_mfma_f32_16x16x32_bf16 v[68:71], v[188:191], a[140:143], v[68:71]
    v_mfma_f32_16x16x32_bf16 v[76:79], v[188:191], a[156:159], v[76:79]
    v_mfma_f32_16x16x32_bf16 v[84:87], v[188:191], a[172:175], v[84:87]
    v_exp_f32 v110, v110
    v_exp_f32 v111, v111
    v_mfma_f32_16x16x32_bf16 v[92:95], v[188:191], a[188:191], v[92:95]
    v_cvt_pk_bf16_f32 v151, v110, v111
    s_waitcnt vmcnt(12) lgkmcnt(0)
    s_barrier
    v_mfma_f32_16x16x32_bf16 a[224:227], a[240:243], v[128:131], a[224:227]
    v_exp_f32 v112, v112
    v_mfma_f32_16x16x32_bf16 a[228:231], a[240:243], v[132:135], a[228:231]
    ds_read_b128 v[160:163], v216 offset:8192
    v_mfma_f32_16x16x32_bf16 a[232:235], a[240:243], v[136:139], a[232:235]
    s_add_u32 s35, s24, 22528
    v_exp_f32 v113, v113
    v_max3_f32 v220, v64, v65, v66
    v_mfma_f32_16x16x32_bf16 a[236:239], a[240:243], v[140:143], a[236:239]
    buffer_store_dwordx4 v[192:195], v236, s[16:19], s35 offen sc1
    v_cvt_pk_bf16_f32 v152, v112, v113
    v_mfma_f32_16x16x32_bf16 v[0:3], a[192:195], v[128:131], v[0:3]
    v_exp_f32 v114, v114
    v_max3_f32 v221, v72, v73, v74
    v_mfma_f32_16x16x32_bf16 v[4:7], a[192:195], v[132:135], v[4:7]
    v_max3_f32 v222, v80, v81, v82
    v_max3_f32 v223, v88, v89, v90
    ds_read_b128 v[164:167], v217 offset:8192
    v_mfma_f32_16x16x32_bf16 a[0:3], a[192:195], v[136:139], a[0:3]
    v_exp_f32 v115, v115
    v_max3_f32 v220, v220, v67, v68
    v_mfma_f32_16x16x32_bf16 a[4:7], a[192:195], v[140:143], a[4:7]
    v_cvt_pk_bf16_f32 v153, v114, v115
    v_max3_f32 v221, v221, v75, v76
    ds_read_b128 v[168:171], v218 offset:8192
    v_mfma_f32_16x16x32_bf16 v[8:11], a[196:199], v[128:131], v[8:11]
    v_exp_f32 v116, v116
    v_max3_f32 v222, v222, v83, v84
    v_mfma_f32_16x16x32_bf16 v[12:15], a[196:199], v[132:135], v[12:15]
    buffer_store_dwordx4 v[196:199], v237, s[16:19], s35 offen offset:1024 sc1
    v_mfma_f32_16x16x32_bf16 a[8:11], a[196:199], v[136:139], a[8:11]
    v_exp_f32 v117, v117
    v_max3_f32 v223, v223, v91, v92
    v_mfma_f32_16x16x32_bf16 a[12:15], a[196:199], v[140:143], a[12:15]
    s_add_u32 m0, s29, 16384
    v_cvt_pk_bf16_f32 v154, v116, v117
    v_max3_f32 v220, v220, v69, v70
    ds_read_b128 v[172:175], v219 offset:8192
    v_mfma_f32_16x16x32_bf16 v[16:19], a[200:203], v[128:131], v[16:19]
    s_add_u32 s35, s23, 0
    v_exp_f32 v118, v118
    v_max3_f32 v221, v221, v77, v78
    v_mfma_f32_16x16x32_bf16 v[20:23], a[200:203], v[132:135], v[20:23]
    buffer_load_dwordx4 v236, s[4:7], s35 offen nt lds
    v_mfma_f32_16x16x32_bf16 a[16:19], a[200:203], v[136:139], a[16:19]
    v_exp_f32 v119, v119
    v_max3_f32 v222, v222, v85, v86
    v_mfma_f32_16x16x32_bf16 a[20:23], a[200:203], v[140:143], a[20:23]
    v_cvt_pk_bf16_f32 v155, v118, v119
    v_max3_f32 v223, v223, v93, v94
    v_mfma_f32_16x16x32_bf16 v[24:27], a[204:207], v[128:131], v[24:27]
    v_exp_f32 v120, v120
    v_mfma_f32_16x16x32_bf16 v[28:31], a[204:207], v[132:135], v[28:31]
    v_max3_f32 v220, v220, v71, v71
    v_max3_f32 v221, v221, v79, v79
    ds_read_b128 v[176:179], v216 offset:12288
    v_mfma_f32_16x16x32_bf16 a[24:27], a[204:207], v[136:139], a[24:27]
    v_exp_f32 v121, v121
    v_max3_f32 v222, v222, v87, v87
    v_mfma_f32_16x16x32_bf16 a[28:31], a[204:207], v[140:143], a[28:31]
    buffer_load_dwordx4 v237, s[4:7], s35 offen offset:1024 nt lds
    v_cvt_pk_bf16_f32 v156, v120, v121
    v_mfma_f32_16x16x32_bf16 v[32:35], a[208:211], v[128:131], v[32:35]
    v_exp_f32 v122, v122
    v_max3_f32 v223, v223, v95, v95
    v_mfma_f32_16x16x32_bf16 v[36:39], a[208:211], v[132:135], v[36:39]
    s_nop 0
    v_permlane32_swap_b32 v220, v221
    v_permlane32_swap_b32 v222, v223
    ds_read_b128 v[180:183], v217 offset:12288
    v_mfma_f32_16x16x32_bf16 a[32:35], a[208:211], v[136:139], a[32:35]
    v_exp_f32 v123, v123
    v_max_f32 v220, v220, v221
    v_mfma_f32_16x16x32_bf16 a[36:39], a[208:211], v[140:143], a[36:39]
    s_add_u32 m0, s25, 49152
    v_cvt_pk_bf16_f32 v157, v122, v123
    v_max_f32 v222, v222, v223
    ds_read_b128 v[184:187], v218 offset:12288
    v_mfma_f32_16x16x32_bf16 v[40:43], a[212:215], v[128:131], v[40:43]
    s_add_u32 s35, s22, 8192
    v_exp_f32 v124, v124
    s_nop 1
    v_permlane16_swap_b32 v220, v222
    v_mfma_f32_16x16x32_bf16 v[44:47], a[212:215], v[132:135], v[44:47]
    buffer_load_dwordx4 v234, s[12:15], s35 offen nt lds
    v_mfma_f32_16x16x32_bf16 a[40:43], a[212:215], v[136:139], a[40:43]
    v_exp_f32 v125, v125
    v_max_f32 v220, v220, v222
    v_mfma_f32_16x16x32_bf16 a[44:47], a[212:215], v[140:143], a[44:47]
    v_cvt_pk_bf16_f32 v158, v124, v125
    v_mul_f32 v220, s26, v220
    ds_read_b128 v[188:191], v219 offset:12288
    v_mfma_f32_16x16x32_bf16 v[48:51], a[216:219], v[128:131], v[48:51]
    v_exp_f32 v126, v126
    v_sub_f32 v244, s27, v220
    v_mfma_f32_16x16x32_bf16 v[52:55], a[216:219], v[132:135], v[52:55]
    buffer_load_dwordx4 v235, s[12:15], s35 offen offset:1024 nt lds
    v_mfma_f32_16x16x32_bf16 a[48:51], a[216:219], v[136:139], a[48:51]
    s_lshr_b32 s24, s21, 1
    v_exp_f32 v127, v127
    v_sub_f32 v246, s27, v220
    v_mfma_f32_16x16x32_bf16 a[52:55], a[216:219], v[140:143], a[52:55]
    s_mov_b32 s21, s22
    v_cvt_pk_bf16_f32 v159, v126, v127
    s_nop 1
    v_permlane16_swap_b32 v244, v246
    v_mfma_f32_16x16x32_bf16 v[56:59], a[220:223], v[128:131], v[56:59]
    s_add_u32 s20, s20, 131072
    v_mov_b32 v245, v244
    v_mfma_f32_16x16x32_bf16 v[60:63], a[220:223], v[132:135], v[60:63]
    s_add_u32 s22, s20, 131072
    v_mov_b32 v247, v246
    v_mfma_f32_16x16x32_bf16 a[56:59], a[220:223], v[136:139], a[56:59]
    s_xor_b32 s22, s22, s32
    s_nop 0
    v_permlane32_swap_b32 v244, v245
    v_permlane32_swap_b32 v246, v247
    v_mfma_f32_16x16x32_bf16 a[60:63], a[220:223], v[140:143], a[60:63]
    s_add_u32 s33, s33, 1
    s_cmp_lt_u32 s33, 2
    s_cbranch_scc1 L_head
L_lastpass:
    s_waitcnt lgkmcnt(0)
    v_pk_fma_f32 v[64:65], v[64:65], s[26:27], v[244:245] op_sel:[0,0,0] op_sel_hi:[1,0,0]
    v_pk_fma_f32 v[66:67], v[66:67], s[26:27], v[244:245] op_sel:[0,0,0] op_sel_hi:[1,0,0]
    v_pk_fma_f32 v[68:69], v[68:69], s[26:27], v[244:245] op_sel:[0,0,0] op_sel_hi:[1,0,0]
    v_pk_fma_f32 v[70:71], v[70:71], s[26:27], v[244:245] op_sel:[0,0,0] op_sel_hi:[1,0,0]
    v_pk_fma_f32 v[72:73], v[72:73], s[26:27], v[244:245] op_sel:[0,0,1] op_sel_hi:[1,0,1]
    v_pk_fma_f32 v[74:75], v[74:75], s[26:27], v[244:245] op_sel:[0,0,1] op_sel_hi:[1,0,1]
    v_pk_fma_f32 v[76:77], v[76:77], s[26:27], v[244:245] op_sel:[0,0,1] op_sel_hi:[1,0,1]
    v_pk_fma_f32 v[78:79], v[78:79], s[26:27], v[244:245] op_sel:[0,0,1] op_sel_hi:[1,0,1]
    v_pk_fma_f32 v[80:81], v[80:81], s[26:27], v[246:247] op_sel:[0,0,0] op_sel_hi:[1,0,0]
    v_pk_fma_f32 v[82:83], v[82:83], s[26:27], v[246:247] op_sel:[0,0,0] op_sel_hi:[1,0,0]
    v_pk_fma_f32 v[84:85], v[84:85], s[26:27], v[246:247] op_sel:[0,0,0] op_sel_hi:[1,0,0]
    v_pk_fma_f32 v[86:87], v[86:87], s[26:27], v[246:247] op_sel:[0,0,0] op_sel_hi:[1,0,0]
    v_pk_fma_f32 v[88:89], v[88:89], s[26:27], v[246:247] op_sel:[0,0,1] op_sel_hi:[1,0,1]
    v_pk_fma_f32 v[90:91], v[90:91], s[26:27], v[246:247] op_sel:[0,0,1] op_sel_hi:[1,0,1]
    v_pk_fma_f32 v[92:93], v[92:93], s[26:27], v[246:247] op_sel:[0,0,1] op_sel_hi:[1,0,1]
    v_pk_fma_f32 v[94:95], v[94:95], s[26:27], v[246:247] op_sel:[0,0,1] op_sel_hi:[1,0,1]
    s_nop 1
    v_mfma_f32_16x16x32_bf16 v[96:99], v[160:163], a[128:131], 0
    v_exp_f32 v64, v64
    v_mfma_f32_16x16x32_bf16 v[104:107], v[160:163], a[144:147], 0
    ds_read_b64_tr_b16 a[192:193], v224 offset:24576
    v_mfma_f32_16x16x32_bf16 v[112:115], v[160:163], a[160:163], 0
    v_exp_f32 v65, v65
    v_mfma_f32_16x16x32_bf16 v[120:123], v[160:163], a[176:179], 0
    s_add_u32 m0, s25, 0
    ds_read_b64_tr_b16 a[194:195], v224 offset:28672
    v_cvt_pk_bf16_f32 v128, v64, v65
    v_mfma_f32_16x16x32_bf16 v[96:99], v[164:167], a[132:135], v[96:99]
    s_add_u32 s35, s21, 16384
    ds_read_b64_tr_b16 a[196:197], v225 offset:24576
    v_exp_f32 v66, v66
    v_mfma_f32_16x16x32_bf16 v[104:107], v[164:167], a[148:151], v[104:107]
    ds_read_b64_tr_b16 a[198:199], v225 offset:28672
    buffer_load_dwordx4 v232, s[8:11], s35 offen nt lds
    v_mfma_f32_16x16x32_bf16 v[112:115], v[164:167], a[164:167], v[112:115]
    v_exp_f32 v67, v67
    v_mfma_f32_16x16x32_bf16 v[120:123], v[164:167], a[180:183], v[120:123]
    ds_read_b64_tr_b16 a[200:201], v226 offset:24576
    v_cvt_pk_bf16_f32 v129, v66, v67
    v_mfma_f32_16x16x32_bf16 v[96:99], v[168:171], a[136:139], v[96:99]
    v_exp_f32 v68, v68
    v_mfma_f32_16x16x32_bf16 v[104:107], v[168:171], a[152:155], v[104:107]
    ds_read_b64_tr_b16 a[202:203], v226 offset:28672
    v_mfma_f32_16x16x32_bf16 v[112:115], v[168:171], a[168:171], v[112:115]
    v_exp_f32 v69, v69
    v_mfma_f32_16x16x32_bf16 v[120:123], v[168:171], a[184:187], v[120:123]
    ds_read_b64_tr_b16 a[204:205], v227 offset:24576
    v_cvt_pk_bf16_f32 v130, v68, v69
    v_mfma_f32_16x16x32_bf16 v[96:99], v[172:175], a[140:143], v[96:99]
    v_exp_f32 v70, v70
    v_mfma_f32_16x16x32_bf16 v[104:107], v[172:175], a[156:159], v[104:107]
    ds_read_b64_tr_b16 a[206:207], v227 offset:28672
    v_mfma_f32_16x16x32_bf16 v[112:115], v[172:175], a[172:175], v[112:115]
    ds_read_b64_tr_b16 a[208:209], v228 offset:24576
    v_exp_f32 v71, v71
    v_mfma_f32_16x16x32_bf16 v[120:123], v[172:175], a[188:191], v[120:123]
    ds_read_b64_tr_b16 a[210:211], v228 offset:28672
    v_cvt_pk_bf16_f32 v131, v70, v71
    v_mfma_f32_16x16x32_bf16 v[100:103], v[176:179], a[128:131], 0
    v_exp_f32 v72, v72
    v_mfma_f32_16x16x32_bf16 v[108:111], v[176:179], a[144:147], 0
    ds_read_b64_tr_b16 a[212:213], v229 offset:24576
    v_mfma_f32_16x16x32_bf16 v[116:119], v[176:179], a[160:163], 0
    buffer_load_dwordx4 v233, s[8:11], s35 offen offset:1024 nt lds
    v_exp_f32 v73, v73
    v_mfma_f32_16x16x32_bf16 v[124:127], v[176:179], a[176:179], 0
    ds_read_b64_tr_b16 a[214:215], v229 offset:28672
    v_cvt_pk_bf16_f32 v132, v72, v73
    v_mfma_f32_16x16x32_bf16 v[100:103], v[180:183], a[132:135], v[100:103]
    v_exp_f32 v74, v74
    v_mfma_f32_16x16x32_bf16 v[108:111], v[180:183], a[148:151], v[108:111]
    ds_read_b64_tr_b16 a[216:217], v230 offset:24576
    v_mfma_f32_16x16x32_bf16 v[116:119], v[180:183], a[164:167], v[116:119]
    ds_read_b64_tr_b16 a[218:219], v230 offset:28672
    v_exp_f32 v75, v75
    v_mfma_f32_16x16x32_bf16 v[124:127], v[180:183], a[180:183], v[124:127]
    ds_read_b64_tr_b16 a[220:221], v231 offset:24576
    v_cvt_pk_bf16_f32 v133, v74, v75
    v_mfma_f32_16x16x32_bf16 v[100:103], v[184:187], a[136:139], v[100:103]
    v_exp_f32 v76, v76
    v_mfma_f32_16x16x32_bf16 v[108:111], v[184:187], a[152:155], v[108:111]
    ds_read_b64_tr_b16 a[222:223], v231 offset:28672
    v_mfma_f32_16x16x32_bf16 v[116:119], v[184:187], a[168:171], v[116:119]
    v_exp_f32 v77, v77
    v_mfma_f32_16x16x32_bf16 v[124:127], v[184:187], a[184:187], v[124:127]
    v_cvt_pk_bf16_f32 v134, v76, v77
    v_mfma_f32_16x16x32_bf16 v[100:103], v[188:191], a[140:143], v[100:103]
    v_exp_f32 v78, v78
    v_mfma_f32_16x16x32_bf16 v[108:111], v[188:191], a[156:159], v[108:111]
    v_mfma_f32_16x16x32_bf16 v[116:119], v[188:191], a[172:175], v[116:119]
    v_exp_f32 v79, v79
    v_mfma_f32_16x16x32_bf16 v[124:127], v[188:191], a[188:191], v[124:127]
    v_cvt_pk_bf16_f32 v135, v78, v79
    s_waitcnt vmcnt(14) lgkmcnt(0)
    s_barrier
    v_mfma_f32_16x16x32_bf16 a[224:227], a[240:243], v[144:147], a[224:227]
    v_exp_f32 v80, v80
    v_mfma_f32_16x16x32_bf16 a[228:231], a[240:243], v[148:151], a[228:231]
    s_add_u32 m0, s25, 57344
    ds_read_b128 v[160:163], v216 offset:16384
    v_mfma_f32_16x16x32_bf16 a[232:235], a[240:243], v[152:155], a[232:235]
    s_add_u32 s35, s21, 12288
    v_exp_f32 v81, v81
    v_mfma_f32_16x16x32_bf16 a[236:239], a[240:243], v[156:159], a[236:239]
    buffer_load_dwordx4 v234, s[12:15], s35 offen nt lds
    v_cvt_pk_bf16_f32 v136, v80, v81
    v_mfma_f32_16x16x32_bf16 v[0:3], a[192:195], v[144:147], v[0:3]
    v_exp_f32 v82, v82
    v_mfma_f32_16x16x32_bf16 v[4:7], a[192:195], v[148:151], v[4:7]
    ds_read_b128 v[164:167], v217 offset:16384
    v_mfma_f32_16x16x32_bf16 a[64:67], a[192:195], v[152:155], a[0:3]
    v_exp_f32 v83, v83
    v_mfma_f32_16x16x32_bf16 a[68:71], a[192:195], v[156:159], a[4:7]
    v_cvt_pk_bf16_f32 v137, v82, v83
    v_accvgpr_read_b32 v248, a224
    v_accvgpr_read_b32 v249, a228
    v_mfma_f32_16x16x32_bf16 v[8:11], a[196:199], v[144:147], v[8:11]
    v_exp_f32 v84, v84
    v_accvgpr_read_b32 v250, a232
    v_accvgpr_read_b32 v251, a236
    v_add_f32 v214, v248, v249
    v_mfma_f32_16x16x32_bf16 v[12:15], a[196:199], v[148:151], v[12:15]
    ds_read_b128 v[168:171], v218 offset:16384
    v_add_f32 v214, v214, v250
    v_add_f32 v214, v214, v251
    v_mfma_f32_16x16x32_bf16 a[72:75], a[196:199], v[152:155], a[8:11]
    v_exp_f32 v85, v85
    v_cmp_nge_f32 vcc, s39, v214
    v_rcp_f32 v248, v248
    v_rcp_f32 v249, v249
    v_mfma_f32_16x16x32_bf16 a[76:79], a[196:199], v[156:159], a[12:15]
    v_cvt_pk_bf16_f32 v138, v84, v85
    v_rcp_f32 v250, v250
    v_rcp_f32 v251, v251
    s_nop 0
    v_mfma_f32_16x16x32_bf16 v[16:19], a[200:203], v[144:147], v[16:19]
    v_exp_f32 v86, v86
    v_mfma_f32_16x16x32_bf16 v[20:23], a[200:203], v[148:151], v[20:23]
    ds_read_b128 v[172:175], v219 offset:16384
    v_mul_f32 v0, v0, v248
    v_mul_f32 v1, v1, v248
    v_mfma_f32_16x16x32_bf16 a[80:83], a[200:203], v[152:155], a[16:19]
    v_exp_f32 v87, v87
    v_mul_f32 v2, v2, v248
    v_mfma_f32_16x16x32_bf16 a[84:87], a[200:203], v[156:159], a[20:23]
    s_cmp_lg_u64 vcc, 0
    s_addc_u32 s38, s38, s38
    v_cvt_pk_bf16_f32 v139, v86, v87
    v_mul_f32 v3, v3, v248
    v_mfma_f32_16x16x32_bf16 v[24:27], a[204:207], v[144:147], v[24:27]
    v_exp_f32 v88, v88
    v_cvt_pk_bf16_f32 v0, v0, v1
    v_mfma_f32_16x16x32_bf16 v[28:31], a[204:207], v[148:151], v[28:31]
    ds_read_b128 v[176:179], v216 offset:20480
    v_cvt_pk_bf16_f32 v1, v2, v3
    v_mfma_f32_16x16x32_bf16 a[88:91], a[204:207], v[152:155], a[24:27]
    ds_write_b64 v240, v[0:1] offset:0
    v_exp_f32 v89, v89
    v_mul_f32 v4, v4, v249
    v_mfma_f32_16x16x32_bf16 a[92:95], a[204:207], v[156:159], a[28:31]
    buffer_load_dwordx4 v235, s[12:15], s35 offen offset:1024 nt lds
    v_cvt_pk_bf16_f32 v140, v88, v89
    v_mul_f32 v5, v5, v249
    v_mfma_f32_16x16x32_bf16 v[32:35], a[208:211], v[144:147], v[32:35]
    v_exp_f32 v90, v90
    v_mul_f32 v6, v6, v249
    v_mfma_f32_16x16x32_bf16 v[36:39], a[208:211], v[148:151], v[36:39]
    ds_read_b128 v[180:183], v217 offset:20480
    v_mul_f32 v7, v7, v249
    v_cvt_pk_bf16_f32 v4, v4, v5
    v_mfma_f32_16x16x32_bf16 a[96:99], a[208:211], v[152:155], a[32:35]
    v_exp_f32 v91, v91
    v_cvt_pk_bf16_f32 v5, v6, v7
    v_mfma_f32_16x16x32_bf16 a[100:103], a[208:211], v[156:159], a[36:39]
    ds_read_b128 v[184:187], v218 offset:20480
    ds_write_b64 v240, v[4:5] offset:4096
    v_cvt_pk_bf16_f32 v141, v90, v91
    v_mfma_f32_16x16x32_bf16 v[40:43], a[212:215], v[144:147], v[40:43]
    v_exp_f32 v92, v92
    v_mul_f32 v8, v8, v248
    v_mfma_f32_16x16x32_bf16 v[44:47], a[212:215], v[148:151], v[44:47]
    ds_read_b128 v[188:191], v219 offset:20480
    v_mul_f32 v9, v9, v248
    v_mul_f32 v10, v10, v248
    v_mfma_f32_16x16x32_bf16 a[104:107], a[212:215], v[152:155], a[40:43]
    v_exp_f32 v93, v93
    v_mul_f32 v11, v11, v248
    v_mfma_f32_16x16x32_bf16 a[108:111], a[212:215], v[156:159], a[44:47]
    v_cvt_pk_bf16_f32 v142, v92, v93
    v_cvt_pk_bf16_f32 v8, v8, v9
    v_cvt_pk_bf16_f32 v9, v10, v11
    v_mfma_f32_16x16x32_bf16 v[48:51], a[216:219], v[144:147], v[48:51]
    ds_write_b64 v241, v[8:9] offset:0
    v_exp_f32 v94, v94
    v_mfma_f32_16x16x32_bf16 v[52:55], a[216:219], v[148:151], v[52:55]
    v_mul_f32 v12, v12, v249
    v_mul_f32 v13, v13, v249
    v_mfma_f32_16x16x32_bf16 a[112:115], a[216:219], v[152:155], a[48:51]
    v_exp_f32 v95, v95
    v_mfma_f32_16x16x32_bf16 a[116:119], a[216:219], v[156:159], a[52:55]
    v_cvt_pk_bf16_f32 v143, v94, v95
    v_mul_f32 v14, v14, v249
    v_mul_f32 v15, v15, v249
    v_mfma_f32_16x16x32_bf16 v[56:59], a[220:223], v[144:147], v[56:59]
    v_cvt_pk_bf16_f32 v12, v12, v13
    v_mfma_f32_16x16x32_bf16 v[60:63], a[220:223], v[148:151], v[60:63]
    v_cvt_pk_bf16_f32 v13, v14, v15
    v_mfma_f32_16x16x32_bf16 a[120:123], a[220:223], v[152:155], a[56:59]
    v_mfma_f32_16x16x32_bf16 a[124:127], a[220:223], v[156:159], a[60:63]
    s_waitcnt lgkmcnt(0)
    v_pk_fma_f32 v[96:97], v[96:97], s[26:27], v[244:245] op_sel:[0,0,0] op_sel_hi:[1,0,0]
    v_pk_fma_f32 v[98:99], v[98:99], s[26:27], v[244:245] op_sel:[0,0,0] op_sel_hi:[1,0,0]
    v_pk_fma_f32 v[100:101], v[100:101], s[26:27], v[244:245] op_sel:[0,0,0] op_sel_hi:[1,0,0]
    v_pk_fma_f32 v[102:103], v[102:103], s[26:27], v[244:245] op_sel:[0,0,0] op_sel_hi:[1,0,0]
    v_pk_fma_f32 v[104:105], v[104:105], s[26:27], v[244:245] op_sel:[0,0,1] op_sel_hi:[1,0,1]
    v_pk_fma_f32 v[106:107], v[106:107], s[26:27], v[244:245] op_sel:[0,0,1] op_sel_hi:[1,0,1]
    v_pk_fma_f32 v[108:109], v[108:109], s[26:27], v[244:245] op_sel:[0,0,1] op_sel_hi:[1,0,1]
    v_pk_fma_f32 v[110:111], v[110:111], s[26:27], v[244:245] op_sel:[0,0,1] op_sel_hi:[1,0,1]
    v_pk_fma_f32 v[112:113], v[112:113], s[26:27], v[246:247] op_sel:[0,0,0] op_sel_hi:[1,0,0]
    v_pk_fma_f32 v[114:115], v[114:115], s[26:27], v[246:247] op_sel:[0,0,0] op_sel_hi:[1,0,0]
    v_pk_fma_f32 v[116:117], v[116:117], s[26:27], v[246:247] op_sel:[0,0,0] op_sel_hi:[1,0,0]
    v_pk_fma_f32 v[118:119], v[118:119], s[26:27], v[246:247] op_sel:[0,0,0] op_sel_hi:[1,0,0]
    v_pk_fma_f32 v[120:121], v[120:121], s[26:27], v[246:247] op_sel:[0,0,1] op_sel_hi:[1,0,1]
    v_pk_fma_f32 v[122:123], v[122:123], s[26:27], v[246:247] op_sel:[0,0,1] op_sel_hi:[1,0,1]
    v_pk_fma_f32 v[124:125], v[124:125], s[26:27], v[246:247] op_sel:[0,0,1] op_sel_hi:[1,0,1]
    v_pk_fma_f32 v[126:127], v[126:127], s[26:27], v[246:247] op_sel:[0,0,1] op_sel_hi:[1,0,1]
    s_nop 1
    v_mfma_f32_16x16x32_bf16 v[64:67], v[160:163], a[128:131], 0
    ds_write_b64 v241, v[12:13] offset:4096
    v_exp_f32 v96, v96
    v_mul_f32 v16, v16, v248
    v_mul_f32 v17, v17, v248
    v_mul_f32 v18, v18, v248
    v_mfma_f32_16x16x32_bf16 v[72:75], v[160:163], a[144:147], 0
    ds_read_b64_tr_b16 a[192:193], v224 offset:0
    v_mul_f32 v19, v19, v248
    v_cvt_pk_bf16_f32 v16, v16, v17
    v_mfma_f32_16x16x32_bf16 v[80:83], v[160:163], a[160:163], 0
    v_exp_f32 v97, v97
    v_cvt_pk_bf16_f32 v17, v18, v19
    v_mfma_f32_16x16x32_bf16 v[88:91], v[160:163], a[176:179], 0
    s_add_u32 m0, s25, 8192
    ds_read_b64_tr_b16 a[194:195], v224 offset:4096
    ds_write_b64 v242, v[16:17] offset:0
    v_cvt_pk_bf16_f32 v144, v96, v97
    v_mfma_f32_16x16x32_bf16 v[64:67], v[164:167], a[132:135], v[64:67]
    s_add_u32 s35, s21, 20480
    ds_read_b64_tr_b16 a[196:197], v225 offset:0
    v_exp_f32 v98, v98
    v_mul_f32 v20, v20, v249
    v_mul_f32 v21, v21, v249
    v_mul_f32 v22, v22, v249
    v_mfma_f32_16x16x32_bf16 v[72:75], v[164:167], a[148:151], v[72:75]
    ds_read_b64_tr_b16 a[198:199], v225 offset:4096
    buffer_load_dwordx4 v232, s[8:11], s35 offen nt lds
    v_mfma_f32_16x16x32_bf16 v[80:83], v[164:167], a[164:167], v[80:83]
    v_exp_f32 v99, v99
    v_mul_f32 v23, v23, v249
    v_mfma_f32_16x16x32_bf16 v[88:91], v[164:167], a[180:183], v[88:91]
    ds_read_b64_tr_b16 a[200:201], v226 offset:0
    v_cvt_pk_bf16_f32 v145, v98, v99
    v_cvt_pk_bf16_f32 v20, v20, v21
    v_mfma_f32_16x16x32_bf16 v[64:67], v[168:171], a[136:139], v[64:67]
    v_exp_f32 v100, v100
    v_cvt_pk_bf16_f32 v21, v22, v23
    v_mfma_f32_16x16x32_bf16 v[72:75], v[168:171], a[152:155], v[72:75]
    ds_read_b64_tr_b16 a[202:203], v226 offset:4096
    ds_write_b64 v242, v[20:21] offset:4096
    v_mul_f32 v24, v24, v248
    v_mfma_f32_16x16x32_bf16 v[80:83], v[168:171], a[168:171], v[80:83]
    v_exp_f32 v101, v101
    v_mul_f32 v25, v25, v248
    v_mfma_f32_16x16x32_bf16 v[88:91], v[168:171], a[184:187], v[88:91]
    ds_read_b64_tr_b16 a[204:205], v227 offset:0
    v_cvt_pk_bf16_f32 v146, v100, v101
    v_mul_f32 v26, v26, v248
    v_mul_f32 v27, v27, v248
    v_mfma_f32_16x16x32_bf16 v[64:67], v[172:175], a[140:143], v[64:67]
    v_exp_f32 v102, v102
    v_cvt_pk_bf16_f32 v24, v24, v25
    v_mfma_f32_16x16x32_bf16 v[72:75], v[172:175], a[156:159], v[72:75]
    ds_read_b64_tr_b16 a[206:207], v227 offset:4096
    v_cvt_pk_bf16_f32 v25, v26, v27
    v_mfma_f32_16x16x32_bf16 v[80:83], v[172:175], a[172:175], v[80:83]
    ds_read_b64_tr_b16 a[208:209], v228 offset:0
    ds_write_b64 v243, v[24:25] offset:0
    v_exp_f32 v103, v103
    v_mul_f32 v28, v28, v249
    v_mfma_f32_16x16x32_bf16 v[88:91], v[172:175], a[188:191], v[88:91]
    ds_read_b64_tr_b16 a[210:211], v228 offset:4096
    v_cvt_pk_bf16_f32 v147, v102, v103
    v_mul_f32 v29, v29, v249
    v_mfma_f32_16x16x32_bf16 v[68:71], v[176:179], a[128:131], 0
    v_exp_f32 v104, v104
    v_mul_f32 v30, v30, v249
    v_mfma_f32_16x16x32_bf16 v[76:79], v[176:179], a[144:147], 0
    ds_read_b64_tr_b16 a[212:213], v229 offset:0
    v_mul_f32 v31, v31, v249
    v_cvt_pk_bf16_f32 v28, v28, v29
    v_cvt_pk_bf16_f32 v29, v30, v31
    v_mfma_f32_16x16x32_bf16 v[84:87], v[176:179], a[160:163], 0
    buffer_load_dwordx4 v233, s[8:11], s35 offen offset:1024 nt lds
    v_exp_f32 v105, v105
    v_mfma_f32_16x16x32_bf16 v[92:95], v[176:179], a[176:179], 0
    ds_read_b64_tr_b16 a[214:215], v229 offset:4096
    ds_write_b64 v243, v[28:29] offset:4096
    v_cvt_pk_bf16_f32 v148, v104, v105
    v_mfma_f32_16x16x32_bf16 v[68:71], v[180:183], a[132:135], v[68:71]
    v_exp_f32 v106, v106
    v_mul_f32 v32, v32, v248
    v_mfma_f32_16x16x32_bf16 v[76:79], v[180:183], a[148:151], v[76:79]
    ds_read_b64_tr_b16 a[216:217], v230 offset:0
    v_mul_f32 v33, v33, v248
    v_mul_f32 v34, v34, v248
    v_mul_f32 v35, v35, v248
    v_mfma_f32_16x16x32_bf16 v[84:87], v[180:183], a[164:167], v[84:87]
    ds_read_b64_tr_b16 a[218:219], v230 offset:4096
    v_exp_f32 v107, v107
    v_mfma_f32_16x16x32_bf16 v[92:95], v[180:183], a[180:183], v[92:95]
    ds_read_b64_tr_b16 a[220:221], v231 offset:0
    v_cvt_pk_bf16_f32 v149, v106, v107
    v_cvt_pk_bf16_f32 v32, v32, v33
    v_mfma_f32_16x16x32_bf16 v[68:71], v[184:187], a[136:139], v[68:71]
    v_exp_f32 v108, v108
    v_cvt_pk_bf16_f32 v33, v34, v35
    v_mfma_f32_16x16x32_bf16 v[76:79], v[184:187], a[152:155], v[76:79]
    ds_read_b64_tr_b16 a[222:223], v231 offset:4096
    ds_write_b64 v240, v[32:33] offset:128
    v_mul_f32 v36, v36, v249
    v_mfma_f32_16x16x32_bf16 v[84:87], v[184:187], a[168:171], v[84:87]
    v_exp_f32 v109, v109
    v_mul_f32 v37, v37, v249
    v_mfma_f32_16x16x32_bf16 v[92:95], v[184:187], a[184:187], v[92:95]
    v_cvt_pk_bf16_f32 v150, v108, v109
    v_mul_f32 v38, v38, v249
    v_mul_f32 v39, v39, v249
    v_mfma_f32_16x16x32_bf16 v[68:71], v[188:191], a[140:143], v[68:71]
    v_exp_f32 v110, v110
    v_cvt_pk_bf16_f32 v36, v36, v37
    v_mfma_f32_16x16x32_bf16 v[76:79], v[188:191], a[156:159], v[76:79]
    v_cvt_pk_bf16_f32 v37, v38, v39
    v_mfma_f32_16x16x32_bf16 v[84:87], v[188:191], a[172:175], v[84:87]
    v_exp_f32 v111, v111
    v_mfma_f32_16x16x32_bf16 v[92:95], v[188:191], a[188:191], v[92:95]
    v_cvt_pk_bf16_f32 v151, v110, v111
    s_waitcnt vmcnt(12) lgkmcnt(0)
    s_barrier
    v_mfma_f32_16x16x32_bf16 a[224:227], a[240:243], v[128:131], 0
    ds_write_b64 v240, v[36:37] offset:4224
    v_exp_f32 v112, v112
    v_mul_f32 v40, v40, v248
    v_mul_f32 v41, v41, v248
    v_mul_f32 v42, v42, v248
    v_mfma_f32_16x16x32_bf16 a[228:231], a[240:243], v[132:135], 0
    s_add_u32 m0, s25, 32768
    ds_read_b128 v[160:163], v216 offset:24576
    v_mul_f32 v43, v43, v248
    v_cvt_pk_bf16_f32 v40, v40, v41
    v_mfma_f32_16x16x32_bf16 a[232:235], a[240:243], v[136:139], 0
    s_add_u32 s35, s21, 16384
    v_exp_f32 v113, v113
    v_cvt_pk_bf16_f32 v41, v42, v43
    v_mfma_f32_16x16x32_bf16 a[236:239], a[240:243], v[140:143], 0
    buffer_load_dwordx4 v234, s[12:15], s35 offen nt lds
    ds_write_b64 v241, v[40:41] offset:128
    v_cvt_pk_bf16_f32 v152, v112, v113
    v_mfma_f32_16x16x32_bf16 v[0:3], a[192:195], v[128:131], 0
    v_exp_f32 v114, v114
    v_mul_f32 v44, v44, v249
    v_mul_f32 v45, v45, v249
    v_mfma_f32_16x16x32_bf16 v[4:7], a[192:195], v[132:135], 0
    ds_read_b128 v[164:167], v217 offset:24576
    v_mul_f32 v46, v46, v249
    v_mul_f32 v47, v47, v249
    v_mfma_f32_16x16x32_bf16 a[0:3], a[192:195], v[136:139], 0
    v_exp_f32 v115, v115
    v_mfma_f32_16x16x32_bf16 a[4:7], a[192:195], v[140:143], 0
    v_cvt_pk_bf16_f32 v153, v114, v115
    v_cvt_pk_bf16_f32 v44, v44, v45
    v_cvt_pk_bf16_f32 v45, v46, v47
    v_mfma_f32_16x16x32_bf16 v[8:11], a[196:199], v[128:131], 0
    ds_write_b64 v241, v[44:45] offset:4224
    v_exp_f32 v116, v116
    v_mfma_f32_16x16x32_bf16 v[12:15], a[196:199], v[132:135], 0
    ds_read_b128 v[168:171], v218 offset:24576
    v_mul_f32 v48, v48, v248
    v_mul_f32 v49, v49, v248
    v_mfma_f32_16x16x32_bf16 a[8:11], a[196:199], v[136:139], 0
    v_exp_f32 v117, v117
    v_mfma_f32_16x16x32_bf16 a[12:15], a[196:199], v[140:143], 0
    v_cvt_pk_bf16_f32 v154, v116, v117
    v_mul_f32 v50, v50, v248
    v_mul_f32 v51, v51, v248
    v_mfma_f32_16x16x32_bf16 v[16:19], a[200:203], v[128:131], 0
    v_exp_f32 v118, v118
    v_cvt_pk_bf16_f32 v48, v48, v49
    v_mfma_f32_16x16x32_bf16 v[20:23], a[200:203], v[132:135], 0
    ds_read_b128 v[172:175], v219 offset:24576
    v_cvt_pk_bf16_f32 v49, v50, v51
    v_mfma_f32_16x16x32_bf16 a[16:19], a[200:203], v[136:139], 0
    ds_write_b64 v242, v[48:49] offset:128
    v_exp_f32 v119, v119
    v_mul_f32 v52, v52, v249
    v_mfma_f32_16x16x32_bf16 a[20:23], a[200:203], v[140:143], 0
    v_cvt_pk_bf16_f32 v155, v118, v119
    v_mul_f32 v53, v53, v249
    v_mul_f32 v54, v54, v249
    v_mfma_f32_16x16x32_bf16 v[24:27], a[204:207], v[128:131], 0
    v_exp_f32 v120, v120
    v_mfma_f32_16x16x32_bf16 v[28:31], a[204:207], v[132:135], 0
    ds_read_b128 v[176:179], v216 offset:28672
    v_mul_f32 v55, v55, v249
    v_cvt_pk_bf16_f32 v52, v52, v53
    v_mfma_f32_16x16x32_bf16 a[24:27], a[204:207], v[136:139], 0
    v_exp_f32 v121, v121
    v_cvt_pk_bf16_f32 v53, v54, v55
    v_mfma_f32_16x16x32_bf16 a[28:31], a[204:207], v[140:143], 0
    buffer_load_dwordx4 v235, s[12:15], s35 offen offset:1024 nt lds
    ds_write_b64 v242, v[52:53] offset:4224
    v_cvt_pk_bf16_f32 v156, v120, v121
    v_mfma_f32_16x16x32_bf16 v[32:35], a[208:211], v[128:131], 0
    v_exp_f32 v122, v122
    v_mul_f32 v56, v56, v248
    v_mul_f32 v57, v57, v248
    v_mfma_f32_16x16x32_bf16 v[36:39], a[208:211], v[132:135], 0
    ds_read_b128 v[180:183], v217 offset:28672
    v_mul_f32 v58, v58, v248
    v_mul_f32 v59, v59, v248
    v_mfma_f32_16x16x32_bf16 a[32:35], a[208:211], v[136:139], 0
    v_exp_f32 v123, v123
    v_cvt_pk_bf16_f32 v56, v56, v57
    v_mfma_f32_16x16x32_bf16 a[36:39], a[208:211], v[140:143], 0
    ds_read_b128 v[184:187], v218 offset:28672
    v_cvt_pk_bf16_f32 v157, v122, v123
    v_cvt_pk_bf16_f32 v57, v58, v59
    v_mfma_f32_16x16x32_bf16 v[40:43], a[212:215], v[128:131], 0
    ds_write_b64 v243, v[56:57] offset:128
    v_exp_f32 v124, v124
    v_mfma_f32_16x16x32_bf16 v[44:47], a[212:215], v[132:135], 0
    ds_read_b128 v[188:191], v219 offset:28672
    v_mul_f32 v60, v60, v249
    v_mul_f32 v61, v61, v249
    v_mfma_f32_16x16x32_bf16 a[40:43], a[212:215], v[136:139], 0
    v_exp_f32 v125, v125
    v_mul_f32 v62, v62, v249
    v_mfma_f32_16x16x32_bf16 a[44:47], a[212:215], v[140:143], 0
    v_cvt_pk_bf16_f32 v158, v124, v125
    v_mul_f32 v63, v63, v249
    v_cvt_pk_bf16_f32 v60, v60, v61
    v_mfma_f32_16x16x32_bf16 v[48:51], a[216:219], v[128:131], 0
    v_exp_f32 v126, v126
    v_mfma_f32_16x16x32_bf16 v[52:55], a[216:219], v[132:135], 0
    v_cvt_pk_bf16_f32 v61, v62, v63
    v_mfma_f32_16x16x32_bf16 a[48:51], a[216:219], v[136:139], 0
    ds_write_b64 v243, v[60:61] offset:4224
    v_exp_f32 v127, v127
    v_mfma_f32_16x16x32_bf16 a[52:55], a[216:219], v[140:143], 0
    v_cvt_pk_bf16_f32 v159, v126, v127
    v_mfma_f32_16x16x32_bf16 v[56:59], a[220:223], v[128:131], 0
    v_mfma_f32_16x16x32_bf16 v[60:63], a[220:223], v[132:135], 0
    v_mfma_f32_16x16x32_bf16 a[56:59], a[220:223], v[136:139], 0
    v_mfma_f32_16x16x32_bf16 a[60:63], a[220:223], v[140:143], 0
    s_waitcnt lgkmcnt(0)
    v_pk_fma_f32 v[64:65], v[64:65], s[26:27], v[244:245] op_sel:[0,0,0] op_sel_hi:[1,0,0]
    v_pk_fma_f32 v[66:67], v[66:67], s[26:27], v[244:245] op_sel:[0,0,0] op_sel_hi:[1,0,0]
    v_pk_fma_f32 v[68:69], v[68:69], s[26:27], v[244:245] op_sel:[0,0,0] op_sel_hi:[1,0,0]
    v_pk_fma_f32 v[70:71], v[70:71], s[26:27], v[244:245] op_sel:[0,0,0] op_sel_hi:[1,0,0]
    v_pk_fma_f32 v[72:73], v[72:73], s[26:27], v[244:245] op_sel:[0,0,1] op_sel_hi:[1,0,1]
    v_pk_fma_f32 v[74:75], v[74:75], s[26:27], v[244:245] op_sel:[0,0,1] op_sel_hi:[1,0,1]
    v_pk_fma_f32 v[76:77], v[76:77], s[26:27], v[244:245] op_sel:[0,0,1] op_sel_hi:[1,0,1]
    v_pk_fma_f32 v[78:79], v[78:79], s[26:27], v[244:245] op_sel:[0,0,1] op_sel_hi:[1,0,1]
    v_pk_fma_f32 v[80:81], v[80:81], s[26:27], v[246:247] op_sel:[0,0,0] op_sel_hi:[1,0,0]
    v_pk_fma_f32 v[82:83], v[82:83], s[26:27], v[246:247] op_sel:[0,0,0] op_sel_hi:[1,0,0]
    v_pk_fma_f32 v[84:85], v[84:85], s[26:27], v[246:247] op_sel:[0,0,0] op_sel_hi:[1,0,0]
    v_pk_fma_f32 v[86:87], v[86:87], s[26:27], v[246:247] op_sel:[0,0,0] op_sel_hi:[1,0,0]
    v_pk_fma_f32 v[88:89], v[88:89], s[26:27], v[246:247] op_sel:[0,0,1] op_sel_hi:[1,0,1]
    v_pk_fma_f32 v[90:91], v[90:91], s[26:27], v[246:247] op_sel:[0,0,1] op_sel_hi:[1,0,1]
    v_pk_fma_f32 v[92:93], v[92:93], s[26:27], v[246:247] op_sel:[0,0,1] op_sel_hi:[1,0,1]
    v_pk_fma_f32 v[94:95], v[94:95], s[26:27], v[246:247] op_sel:[0,0,1] op_sel_hi:[1,0,1]
    s_nop 1
    v_mfma_f32_16x16x32_bf16 v[96:99], v[160:163], a[128:131], 0
    v_exp_f32 v64, v64
    v_mfma_f32_16x16x32_bf16 v[104:107], v[160:163], a[144:147], 0
    ds_read_b64_tr_b16 a[192:193], v224 offset:8192
    v_accvgpr_read_b32 v200, a64
    v_accvgpr_read_b32 v201, a65
    v_mfma_f32_16x16x32_bf16 v[112:115], v[160:163], a[160:163], 0
    ds_read_b64_tr_b16 a[194:195], v224 offset:12288
    v_exp_f32 v65, v65
    v_mfma_f32_16x16x32_bf16 v[120:123], v[160:163], a[176:179], 0
    s_add_u32 m0, s25, 16384
    ds_read_b64_tr_b16 a[196:197], v225 offset:8192
    v_cvt_pk_bf16_f32 v128, v64, v65
    v_mfma_f32_16x16x32_bf16 v[96:99], v[164:167], a[132:135], v[96:99]
    s_add_u32 s35, s21, 24576
    v_exp_f32 v66, v66
    v_accvgpr_read_b32 v202, a66
    v_mfma_f32_16x16x32_bf16 v[104:107], v[164:167], a[148:151], v[104:107]
    ds_read_b64_tr_b16 a[198:199], v225 offset:12288
    buffer_load_dwordx4 v232, s[8:11], s35 offen nt lds
    v_mfma_f32_16x16x32_bf16 v[112:115], v[164:167], a[164:167], v[112:115]
    v_exp_f32 v67, v67
    v_mfma_f32_16x16x32_bf16 v[120:123], v[164:167], a[180:183], v[120:123]
    ds_read_b64_tr_b16 a[200:201], v226 offset:8192
    v_cvt_pk_bf16_f32 v129, v66, v67
    v_mfma_f32_16x16x32_bf16 v[96:99], v[168:171], a[136:139], v[96:99]
    ds_read_b64_tr_b16 a[202:203], v226 offset:12288
    v_exp_f32 v68, v68
    v_mfma_f32_16x16x32_bf16 v[104:107], v[168:171], a[152:155], v[104:107]
    ds_read_b64_tr_b16 a[204:205], v227 offset:8192
    v_accvgpr_read_b32 v203, a67
    v_mfma_f32_16x16x32_bf16 v[112:115], v[168:171], a[168:171], v[112:115]
    v_exp_f32 v69, v69
    v_mfma_f32_16x16x32_bf16 v[120:123], v[168:171], a[184:187], v[120:123]
    ds_read_b64_tr_b16 a[206:207], v227 offset:12288
    v_cvt_pk_bf16_f32 v130, v68, v69
    v_mfma_f32_16x16x32_bf16 v[96:99], v[172:175], a[140:143], v[96:99]
    v_exp_f32 v70, v70
    v_mfma_f32_16x16x32_bf16 v[104:107], v[172:175], a[156:159], v[104:107]
    ds_read_b64_tr_b16 a[208:209], v228 offset:8192
    v_mul_f32 v200, v200, v250
    v_mul_f32 v201, v201, v250
    v_mfma_f32_16x16x32_bf16 v[112:115], v[172:175], a[172:175], v[112:115]
    ds_read_b64_tr_b16 a[210:211], v228 offset:12288
    v_exp_f32 v71, v71
    v_mfma_f32_16x16x32_bf16 v[120:123], v[172:175], a[188:191], v[120:123]
    ds_read_b64_tr_b16 a[212:213], v229 offset:8192
    v_cvt_pk_bf16_f32 v131, v70, v71
    v_mfma_f32_16x16x32_bf16 v[100:103], v[176:179], a[128:131], 0
    v_exp_f32 v72, v72
    v_mfma_f32_16x16x32_bf16 v[108:111], v[176:179], a[144:147], 0
    ds_read_b64_tr_b16 a[214:215], v229 offset:12288
    v_mul_f32 v202, v202, v250
    v_mfma_f32_16x16x32_bf16 v[116:119], v[176:179], a[160:163], 0
    ds_read_b64_tr_b16 a[216:217], v230 offset:8192
    v_exp_f32 v73, v73
    v_mfma_f32_16x16x32_bf16 v[124:127], v[176:179], a[176:179], 0
    ds_read_b64_tr_b16 a[218:219], v230 offset:12288
    buffer_load_dwordx4 v233, s[8:11], s35 offen offset:1024 nt lds
    v_cvt_pk_bf16_f32 v132, v72, v73
    v_mfma_f32_16x16x32_bf16 v[100:103], v[180:183], a[132:135], v[100:103]
    v_exp_f32 v74, v74
    v_mfma_f32_16x16x32_bf16 v[108:111], v[180:183], a[148:151], v[108:111]
    ds_read_b64_tr_b16 a[220:221], v231 offset:8192
    v_mul_f32 v203, v203, v250
    v_cvt_pk_bf16_f32 v200, v200, v201
    v_mfma_f32_16x16x32_bf16 v[116:119], v[180:183], a[164:167], v[116:119]
    v_exp_f32 v75, v75
    v_mfma_f32_16x16x32_bf16 v[124:127], v[180:183], a[180:183], v[124:127]
    ds_read_b64_tr_b16 a[222:223], v231 offset:12288
    v_cvt_pk_bf16_f32 v133, v74, v75
    v_mfma_f32_16x16x32_bf16 v[100:103], v[184:187], a[136:139], v[100:103]
    ds_read_b128 v[192:195], v215 offset:0
    v_exp_f32 v76, v76
    v_mfma_f32_16x16x32_bf16 v[108:111], v[184:187], a[152:155], v[108:111]
    ds_read_b128 v[196:199], v215 offset:1024
    v_cvt_pk_bf16_f32 v201, v202, v203
    v_mfma_f32_16x16x32_bf16 v[116:119], v[184:187], a[168:171], v[116:119]
    v_exp_f32 v77, v77
    v_mfma_f32_16x16x32_bf16 v[124:127], v[184:187], a[184:187], v[124:127]
    ds_write_b64 v240, v[200:201] offset:8192
    v_cvt_pk_bf16_f32 v134, v76, v77
    v_mfma_f32_16x16x32_bf16 v[100:103], v[188:191], a[140:143], v[100:103]
    v_exp_f32 v78, v78
    v_mfma_f32_16x16x32_bf16 v[108:111], v[188:191], a[156:159], v[108:111]
    v_accvgpr_read_b32 v204, a72
    v_mfma_f32_16x16x32_bf16 v[116:119], v[188:191], a[172:175], v[116:119]
    v_exp_f32 v79, v79
    v_mfma_f32_16x16x32_bf16 v[124:127], v[188:191], a[188:191], v[124:127]
    v_cvt_pk_bf16_f32 v135, v78, v79
    v_accvgpr_read_b32 v205, a73
    s_waitcnt vmcnt(8) lgkmcnt(0)
    s_barrier
    v_mfma_f32_16x16x32_bf16 a[224:227], a[240:243], v[144:147], a[224:227]
    v_exp_f32 v80, v80
    v_mfma_f32_16x16x32_bf16 a[228:231], a[240:243], v[148:151], a[228:231]
    ds_read_b128 v[160:163], v216 offset:0
    v_mfma_f32_16x16x32_bf16 a[232:235], a[240:243], v[152:155], a[232:235]
    s_add_u32 s35, s24, 0
    v_exp_f32 v81, v81
    v_mfma_f32_16x16x32_bf16 a[236:239], a[240:243], v[156:159], a[236:239]
    buffer_store_dwordx4 v[192:195], v236, s[16:19], s35 offen sc1
    v_cvt_pk_bf16_f32 v136, v80, v81
    v_mfma_f32_16x16x32_bf16 v[0:3], a[192:195], v[144:147], v[0:3]
    v_exp_f32 v82, v82
    v_mfma_f32_16x16x32_bf16 v[4:7], a[192:195], v[148:151], v[4:7]
    ds_read_b128 v[164:167], v217 offset:0
    v_accvgpr_read_b32 v206, a74
    v_mfma_f32_16x16x32_bf16 a[0:3], a[192:195], v[152:155], a[0:3]
    v_exp_f32 v83, v83
    v_mfma_f32_16x16x32_bf16 a[4:7], a[192:195], v[156:159], a[4:7]
    v_cvt_pk_bf16_f32 v137, v82, v83
    v_accvgpr_read_b32 v207, a75
    v_mfma_f32_16x16x32_bf16 v[8:11], a[196:199], v[144:147], v[8:11]
    v_exp_f32 v84, v84
    v_mfma_f32_16x16x32_bf16 v[12:15], a[196:199], v[148:151], v[12:15]
    ds_read_b128 v[168:171], v218 offset:0
    v_mul_f32 v204, v204, v250
    v_mfma_f32_16x16x32_bf16 a[8:11], a[196:199], v[152:155], a[8:11]
    v_exp_f32 v85, v85
    v_mfma_f32_16x16x32_bf16 a[12:15], a[196:199], v[156:159], a[12:15]
    buffer_store_dwordx4 v[196:199], v237, s[16:19], s35 offen offset:1024 sc1
    v_cvt_pk_bf16_f32 v138, v84, v85
    v_mfma_f32_16x16x32_bf16 v[16:19], a[200:203], v[144:147], v[16:19]
    v_exp_f32 v86, v86
    v_mfma_f32_16x16x32_bf16 v[20:23], a[200:203], v[148:151], v[20:23]
    ds_read_b128 v[172:175], v219 offset:0
    v_mul_f32 v205, v205, v250
    v_mfma_f32_16x16x32_bf16 a[16:19], a[200:203], v[152:155], a[16:19]
    v_exp_f32 v87, v87
    v_mfma_f32_16x16x32_bf16 a[20:23], a[200:203], v[156:159], a[20:23]
    v_cvt_pk_bf16_f32 v139, v86, v87
    v_mul_f32 v206, v206, v250
    v_mfma_f32_16x16x32_bf16 v[24:27], a[204:207], v[144:147], v[24:27]
    v_exp_f32 v88, v88
    v_mfma_f32_16x16x32_bf16 v[28:31], a[204:207], v[148:151], v[28:31]
    s_add_u32 m0, s25, 40960
    ds_read_b128 v[176:179], v216 offset:4096
    v_mul_f32 v207, v207, v250
    v_mfma_f32_16x16x32_bf16 a[24:27], a[204:207], v[152:155], a[24:27]
    s_add_u32 s35, s21, 20480
    v_exp_f32 v89, v89
    v_mfma_f32_16x16x32_bf16 a[28:31], a[204:207], v[156:159], a[28:31]
    buffer_load_dwordx4 v234, s[12:15], s35 offen nt lds
    v_cvt_pk_bf16_f32 v140, v88, v89
    v_mfma_f32_16x16x32_bf16 v[32:35], a[208:211], v[144:147], v[32:35]
    v_exp_f32 v90, v90
    v_mfma_f32_16x16x32_bf16 v[36:39], a[208:211], v[148:151], v[36:39]
    ds_read_b128 v[180:183], v217 offset:4096
    v_cvt_pk_bf16_f32 v204, v204, v205
    v_mfma_f32_16x16x32_bf16 a[32:35], a[208:211], v[152:155], a[32:35]
    v_exp_f32 v91, v91
    v_mfma_f32_16x16x32_bf16 a[36:39], a[208:211], v[156:159], a[36:39]
    ds_read_b128 v[184:187], v218 offset:4096
    v_cvt_pk_bf16_f32 v141, v90, v91
    v_mfma_f32_16x16x32_bf16 v[40:43], a[212:215], v[144:147], v[40:43]
    v_exp_f32 v92, v92
    v_mfma_f32_16x16x32_bf16 v[44:47], a[212:215], v[148:151], v[44:47]
    ds_read_b128 v[188:191], v219 offset:4096
    v_cvt_pk_bf16_f32 v205, v206, v207
    v_mfma_f32_16x16x32_bf16 a[40:43], a[212:215], v[152:155], a[40:43]
    ds_write_b64 v241, v[204:205] offset:8192
    v_exp_f32 v93, v93
    v_mfma_f32_16x16x32_bf16 a[44:47], a[212:215], v[156:159], a[44:47]
    buffer_load_dwordx4 v235, s[12:15], s35 offen offset:1024 nt lds
    v_cvt_pk_bf16_f32 v142, v92, v93
    v_mfma_f32_16x16x32_bf16 v[48:51], a[216:219], v[144:147], v[48:51]
    v_exp_f32 v94, v94
    v_mfma_f32_16x16x32_bf16 v[52:55], a[216:219], v[148:151], v[52:55]
    v_mfma_f32_16x16x32_bf16 a[48:51], a[216:219], v[152:155], a[48:51]
    v_exp_f32 v95, v95
    v_mfma_f32_16x16x32_bf16 a[52:55], a[216:219], v[156:159], a[52:55]
    v_cvt_pk_bf16_f32 v143, v94, v95
    v_mfma_f32_16x16x32_bf16 v[56:59], a[220:223], v[144:147], v[56:59]
    v_mfma_f32_16x16x32_bf16 v[60:63], a[220:223], v[148:151], v[60:63]
    v_mfma_f32_16x16x32_bf16 a[56:59], a[220:223], v[152:155], a[56:59]
    v_mfma_f32_16x16x32_bf16 a[60:63], a[220:223], v[156:159], a[60:63]
    s_waitcnt lgkmcnt(0)
    v_pk_fma_f32 v[96:97], v[96:97], s[26:27], v[244:245] op_sel:[0,0,0] op_sel_hi:[1,0,0]
    v_pk_fma_f32 v[98:99], v[98:99], s[26:27], v[244:245] op_sel:[0,0,0] op_sel_hi:[1,0,0]
    v_pk_fma_f32 v[100:101], v[100:101], s[26:27], v[244:245] op_sel:[0,0,0] op_sel_hi:[1,0,0]
    v_pk_fma_f32 v[102:103], v[102:103], s[26:27], v[244:245] op_sel:[0,0,0] op_sel_hi:[1,0,0]
    v_pk_fma_f32 v[104:105], v[104:105], s[26:27], v[244:245] op_sel:[0,0,1] op_sel_hi:[1,0,1]
    v_pk_fma_f32 v[106:107], v[106:107], s[26:27], v[244:245] op_sel:[0,0,1] op_sel_hi:[1,0,1]
    v_pk_fma_f32 v[108:109], v[108:109], s[26:27], v[244:245] op_sel:[0,0,1] op_sel_hi:[1,0,1]
    v_pk_fma_f32 v[110:111], v[110:111], s[26:27], v[244:245] op_sel:[0,0,1] op_sel_hi:[1,0,1]
    v_pk_fma_f32 v[112:113], v[112:113], s[26:27], v[246:247] op_sel:[0,0,0] op_sel_hi:[1,0,0]
    v_pk_fma_f32 v[114:115], v[114:115], s[26:27], v[246:247] op_sel:[0,0,0] op_sel_hi:[1,0,0]
    v_pk_fma_f32 v[116:117], v[116:117], s[26:27], v[246:247] op_sel:[0,0,0] op_sel_hi:[1,0,0]
    v_pk_fma_f32 v[118:119], v[118:119], s[26:27], v[246:247] op_sel:[0,0,0] op_sel_hi:[1,0,0]
    v_pk_fma_f32 v[120:121], v[120:121], s[26:27], v[246:247] op_sel:[0,0,1] op_sel_hi:[1,0,1]
    v_pk_fma_f32 v[122:123], v[122:123], s[26:27], v[246:247] op_sel:[0,0,1] op_sel_hi:[1,0,1]
    v_pk_fma_f32 v[124:125], v[124:125], s[26:27], v[246:247] op_sel:[0,0,1] op_sel_hi:[1,0,1]
    v_pk_fma_f32 v[126:127], v[126:127], s[26:27], v[246:247] op_sel:[0,0,1] op_sel_hi:[1,0,1]
    s_nop 1
    v_mfma_f32_16x16x32_bf16 v[64:67], v[160:163], a[128:131], 0
    v_exp_f32 v96, v96
    v_mfma_f32_16x16x32_bf16 v[72:75], v[160:163], a[144:147], 0
    ds_read_b64_tr_b16 a[192:193], v224 offset:16384
    v_accvgpr_read_b32 v200, a80
    v_mfma_f32_16x16x32_bf16 v[80:83], v[160:163], a[160:163], 0
    v_exp_f32 v97, v97
    v_mfma_f32_16x16x32_bf16 v[88:91], v[160:163], a[176:179], 0
    s_add_u32 m0, s25, 24576
    ds_read_b64_tr_b16 a[194:195], v224 offset:20480
    v_cvt_pk_bf16_f32 v144, v96, v97
    v_mfma_f32_16x16x32_bf16 v[64:67], v[164:167], a[132:135], v[64:67]
    s_add_u32 s35, s21, 28672
    ds_read_b64_tr_b16 a[196:197], v225 offset:16384
    v_exp_f32 v98, v98
    v_mfma_f32_16x16x32_bf16 v[72:75], v[164:167], a[148:151], v[72:75]
    ds_read_b64_tr_b16 a[198:199], v225 offset:20480
    buffer_load_dwordx4 v232, s[8:11], s35 offen nt lds
    v_mfma_f32_16x16x32_bf16 v[80:83], v[164:167], a[164:167], v[80:83]
    v_exp_f32 v99, v99
    v_mfma_f32_16x16x32_bf16 v[88:91], v[164:167], a[180:183], v[88:91]
    ds_read_b64_tr_b16 a[200:201], v226 offset:16384
    v_cvt_pk_bf16_f32 v145, v98, v99
    v_mfma_f32_16x16x32_bf16 v[64:67], v[168:171], a[136:139], v[64:67]
    v_exp_f32 v100, v100
    v_mfma_f32_16x16x32_bf16 v[72:75], v[168:171], a[152:155], v[72:75]
    ds_read_b64_tr_b16 a[202:203], v226 offset:20480
    v_accvgpr_read_b32 v201, a81
    v_mfma_f32_16x16x32_bf16 v[80:83], v[168:171], a[168:171], v[80:83]
    v_exp_f32 v101, v101
    v_mfma_f32_16x16x32_bf16 v[88:91], v[168:171], a[184:187], v[88:91]
    ds_read_b64_tr_b16 a[204:205], v227 offset:16384
    v_cvt_pk_bf16_f32 v146, v100, v101
    v_mfma_f32_16x16x32_bf16 v[64:67], v[172:175], a[140:143], v[64:67]
    v_exp_f32 v102, v102
    v_mfma_f32_16x16x32_bf16 v[72:75], v[172:175], a[156:159], v[72:75]
    ds_read_b64_tr_b16 a[206:207], v227 offset:20480
    v_accvgpr_read_b32 v202, a82
    v_mfma_f32_16x16x32_bf16 v[80:83], v[172:175], a[172:175], v[80:83]
    ds_read_b64_tr_b16 a[208:209], v228 offset:16384
    v_exp_f32 v103, v103
    v_mfma_f32_16x16x32_bf16 v[88:91], v[172:175], a[188:191], v[88:91]
    ds_read_b64_tr_b16 a[210:211], v228 offset:20480
    v_cvt_pk_bf16_f32 v147, v102, v103
    v_mfma_f32_16x16x32_bf16 v[68:71], v[176:179], a[128:131], 0
    v_exp_f32 v104, v104
    v_mfma_f32_16x16x32_bf16 v[76:79], v[176:179], a[144:147], 0
    ds_read_b64_tr_b16 a[212:213], v229 offset:16384
    v_accvgpr_read_b32 v203, a83
    v_mfma_f32_16x16x32_bf16 v[84:87], v[176:179], a[160:163], 0
    buffer_load_dwordx4 v233, s[8:11], s35 offen offset:1024 nt lds
    v_exp_f32 v105, v105
    v_mfma_f32_16x16x32_bf16 v[92:95], v[176:179], a[176:179], 0
    ds_read_b64_tr_b16 a[214:215], v229 offset:20480
    v_cvt_pk_bf16_f32 v148, v104, v105
    v_mfma_f32_16x16x32_bf16 v[68:71], v[180:183], a[132:135], v[68:71]
    v_exp_f32 v106, v106
    v_mfma_f32_16x16x32_bf16 v[76:79], v[180:183], a[148:151], v[76:79]
    ds_read_b64_tr_b16 a[216:217], v230 offset:16384
    v_mul_f32 v200, v200, v250
    v_mfma_f32_16x16x32_bf16 v[84:87], v[180:183], a[164:167], v[84:87]
    ds_read_b64_tr_b16 a[218:219], v230 offset:20480
    v_exp_f32 v107, v107
    v_mfma_f32_16x16x32_bf16 v[92:95], v[180:183], a[180:183], v[92:95]
    ds_read_b64_tr_b16 a[220:221], v231 offset:16384
    v_cvt_pk_bf16_f32 v149, v106, v107
    v_mfma_f32_16x16x32_bf16 v[68:71], v[184:187], a[136:139], v[68:71]
    v_exp_f32 v108, v108
    v_mfma_f32_16x16x32_bf16 v[76:79], v[184:187], a[152:155], v[76:79]
    ds_read_b64_tr_b16 a[222:223], v231 offset:20480
    v_mfma_f32_16x16x32_bf16 v[84:87], v[184:187], a[168:171], v[84:87]
    v_exp_f32 v109, v109
    v_mfma_f32_16x16x32_bf16 v[92:95], v[184:187], a[184:187], v[92:95]
    v_cvt_pk_bf16_f32 v150, v108, v109
    v_mfma_f32_16x16x32_bf16 v[68:71], v[188:191], a[140:143], v[68:71]
    v_exp_f32 v110, v110
    v_mfma_f32_16x16x32_bf16 v[76:79], v[188:191], a[156:159], v[76:79]
    v_mul_f32 v201, v201, v250
    v_mfma_f32_16x16x32_bf16 v[84:87], v[188:191], a[172:175], v[84:87]
    v_exp_f32 v111, v111
    v_mfma_f32_16x16x32_bf16 v[92:95], v[188:191], a[188:191], v[92:95]
    v_cvt_pk_bf16_f32 v151, v110, v111
    v_mul_f32 v202, v202, v250
    s_waitcnt vmcnt(10) lgkmcnt(0)
    s_barrier
    v_mfma_f32_16x16x32_bf16 a[224:227], a[240:243], v[128:131], a[224:227]
    v_exp_f32 v112, v112
    v_mfma_f32_16x16x32_bf16 a[228:231], a[240:243], v[132:135], a[228:231]
    s_add_u32 m0, s25, 49152
    ds_read_b128 v[160:163], v216 offset:8192
    v_mfma_f32_16x16x32_bf16 a[232:235], a[240:243], v[136:139], a[232:235]
    s_add_u32 s35, s21, 24576
    v_exp_f32 v113, v113
    v_mfma_f32_16x16x32_bf16 a[236:239], a[240:243], v[140:143], a[236:239]
    buffer_load_dwordx4 v234, s[12:15], s35 offen nt lds
    v_cvt_pk_bf16_f32 v152, v112, v113
    v_mfma_f32_16x16x32_bf16 v[0:3], a[192:195], v[128:131], v[0:3]
    v_exp_f32 v114, v114
    v_mfma_f32_16x16x32_bf16 v[4:7], a[192:195], v[132:135], v[4:7]
    ds_read_b128 v[164:167], v217 offset:8192
    v_mul_f32 v203, v203, v250
    v_mfma_f32_16x16x32_bf16 a[0:3], a[192:195], v[136:139], a[0:3]
    v_exp_f32 v115, v115
    v_mfma_f32_16x16x32_bf16 a[4:7], a[192:195], v[140:143], a[4:7]
    v_cvt_pk_bf16_f32 v153, v114, v115
    v_mfma_f32_16x16x32_bf16 v[8:11], a[196:199], v[128:131], v[8:11]
    v_exp_f32 v116, v116
    v_mfma_f32_16x16x32_bf16 v[12:15], a[196:199], v[132:135], v[12:15]
    ds_read_b128 v[168:171], v218 offset:8192
    v_mfma_f32_16x16x32_bf16 a[8:11], a[196:199], v[136:139], a[8:11]
    v_exp_f32 v117, v117
    v_mfma_f32_16x16x32_bf16 a[12:15], a[196:199], v[140:143], a[12:15]
    v_cvt_pk_bf16_f32 v154, v116, v117
    v_cvt_pk_bf16_f32 v200, v200, v201
    v_mfma_f32_16x16x32_bf16 v[16:19], a[200:203], v[128:131], v[16:19]
    v_exp_f32 v118, v118
    v_mfma_f32_16x16x32_bf16 v[20:23], a[200:203], v[132:135], v[20:23]
    ds_read_b128 v[172:175], v219 offset:8192
    v_mfma_f32_16x16x32_bf16 a[16:19], a[200:203], v[136:139], a[16:19]
    v_exp_f32 v119, v119
    v_mfma_f32_16x16x32_bf16 a[20:23], a[200:203], v[140:143], a[20:23]
    v_cvt_pk_bf16_f32 v155, v118, v119
    v_mfma_f32_16x16x32_bf16 v[24:27], a[204:207], v[128:131], v[24:27]
    v_exp_f32 v120, v120
    v_mfma_f32_16x16x32_bf16 v[28:31], a[204:207], v[132:135], v[28:31]
    ds_read_b128 v[176:179], v216 offset:12288
    v_cvt_pk_bf16_f32 v201, v202, v203
    v_mfma_f32_16x16x32_bf16 a[24:27], a[204:207], v[136:139], a[24:27]
    v_exp_f32 v121, v121
    v_mfma_f32_16x16x32_bf16 a[28:31], a[204:207], v[140:143], a[28:31]
    buffer_load_dwordx4 v235, s[12:15], s35 offen offset:1024 nt lds
    v_cvt_pk_bf16_f32 v156, v120, v121
    v_mfma_f32_16x16x32_bf16 v[32:35], a[208:211], v[128:131], v[32:35]
    v_exp_f32 v122, v122
    v_mfma_f32_16x16x32_bf16 v[36:39], a[208:211], v[132:135], v[36:39]
    ds_read_b128 v[180:183], v217 offset:12288
    v_mfma_f32_16x16x32_bf16 a[32:35], a[208:211], v[136:139], a[32:35]
    v_exp_f32 v123, v123
    v_mfma_f32_16x16x32_bf16 a[36:39], a[208:211], v[140:143], a[36:39]
    ds_read_b128 v[184:187], v218 offset:12288
    v_cvt_pk_bf16_f32 v157, v122, v123
    v_mfma_f32_16x16x32_bf16 v[40:43], a[212:215], v[128:131], v[40:43]
    v_exp_f32 v124, v124
    v_mfma_f32_16x16x32_bf16 v[44:47], a[212:215], v[132:135], v[44:47]
    ds_read_b128 v[188:191], v219 offset:12288
    v_mfma_f32_16x16x32_bf16 a[40:43], a[212:215], v[136:139], a[40:43]
    v_exp_f32 v125, v125
    v_mfma_f32_16x16x32_bf16 a[44:47], a[212:215], v[140:143], a[44:47]
    ds_write_b64 v242, v[200:201] offset:8192
    v_cvt_pk_bf16_f32 v158, v124, v125
    v_mfma_f32_16x16x32_bf16 v[48:51], a[216:219], v[128:131], v[48:51]
    v_exp_f32 v126, v126
    v_mfma_f32_16x16x32_bf16 v[52:55], a[216:219], v[132:135], v[52:55]
    v_mfma_f32_16x16x32_bf16 a[48:51], a[216:219], v[136:139], a[48:51]
    v_exp_f32 v127, v127
    v_mfma_f32_16x16x32_bf16 a[52:55], a[216:219], v[140:143], a[52:55]
    v_cvt_pk_bf16_f32 v159, v126, v127
    v_mfma_f32_16x16x32_bf16 v[56:59], a[220:223], v[128:131], v[56:59]
    v_mfma_f32_16x16x32_bf16 v[60:63], a[220:223], v[132:135], v[60:63]
    v_mfma_f32_16x16x32_bf16 a[56:59], a[220:223], v[136:139], a[56:59]
    v_mfma_f32_16x16x32_bf16 a[60:63], a[220:223], v[140:143], a[60:63]
    s_waitcnt lgkmcnt(0)
    v_pk_fma_f32 v[64:65], v[64:65], s[26:27], v[244:245] op_sel:[0,0,0] op_sel_hi:[1,0,0]
    v_pk_fma_f32 v[66:67], v[66:67], s[26:27], v[244:245] op_sel:[0,0,0] op_sel_hi:[1,0,0]
    v_pk_fma_f32 v[68:69], v[68:69], s[26:27], v[244:245] op_sel:[0,0,0] op_sel_hi:[1,0,0]
    v_pk_fma_f32 v[70:71], v[70:71], s[26:27], v[244:245] op_sel:[0,0,0] op_sel_hi:[1,0,0]
    v_pk_fma_f32 v[72:73], v[72:73], s[26:27], v[244:245] op_sel:[0,0,1] op_sel_hi:[1,0,1]
    v_pk_fma_f32 v[74:75], v[74:75], s[26:27], v[244:245] op_sel:[0,0,1] op_sel_hi:[1,0,1]
    v_pk_fma_f32 v[76:77], v[76:77], s[26:27], v[244:245] op_sel:[0,0,1] op_sel_hi:[1,0,1]
    v_pk_fma_f32 v[78:79], v[78:79], s[26:27], v[244:245] op_sel:[0,0,1] op_sel_hi:[1,0,1]
    v_pk_fma_f32 v[80:81], v[80:81], s[26:27], v[246:247] op_sel:[0,0,0] op_sel_hi:[1,0,0]
    v_pk_fma_f32 v[82:83], v[82:83], s[26:27], v[246:247] op_sel:[0,0,0] op_sel_hi:[1,0,0]
    v_pk_fma_f32 v[84:85], v[84:85], s[26:27], v[246:247] op_sel:[0,0,0] op_sel_hi:[1,0,0]
    v_pk_fma_f32 v[86:87], v[86:87], s[26:27], v[246:247] op_sel:[0,0,0] op_sel_hi:[1,0,0]
    v_pk_fma_f32 v[88:89], v[88:89], s[26:27], v[246:247] op_sel:[0,0,1] op_sel_hi:[1,0,1]
    v_pk_fma_f32 v[90:91], v[90:91], s[26:27], v[246:247] op_sel:[0,0,1] op_sel_hi:[1,0,1]
    v_pk_fma_f32 v[92:93], v[92:93], s[26:27], v[246:247] op_sel:[0,0,1] op_sel_hi:[1,0,1]
    v_pk_fma_f32 v[94:95], v[94:95], s[26:27], v[246:247] op_sel:[0,0,1] op_sel_hi:[1,0,1]
    s_nop 1
    v_mfma_f32_16x16x32_bf16 v[96:99], v[160:163], a[128:131], 0
    v_exp_f32 v64, v64
    v_mfma_f32_16x16x32_bf16 v[104:107], v[160:163], a[144:147], 0
    ds_read_b64_tr_b16 a[192:193], v224 offset:24576
    v_accvgpr_read_b32 v204, a88
    v_accvgpr_read_b32 v205, a89
    v_mfma_f32_16x16x32_bf16 v[112:115], v[160:163], a[160:163], 0
    ds_read_b64_tr_b16 a[194:195], v224 offset:28672
    v_exp_f32 v65, v65
    v_mfma_f32_16x16x32_bf16 v[120:123], v[160:163], a[176:179], 0
    s_add_u32 m0, s25, 0
    ds_read_b64_tr_b16 a[196:197], v225 offset:24576
    v_cvt_pk_bf16_f32 v128, v64, v65
    v_mfma_f32_16x16x32_bf16 v[96:99], v[164:167], a[132:135], v[96:99]
    s_add_u32 s35, s21, 32768
    v_exp_f32 v66, v66
    v_accvgpr_read_b32 v206, a90
    v_mfma_f32_16x16x32_bf16 v[104:107], v[164:167], a[148:151], v[104:107]
    ds_read_b64_tr_b16 a[198:199], v225 offset:28672
    buffer_load_dwordx4 v232, s[8:11], s35 offen nt lds
    v_mfma_f32_16x16x32_bf16 v[112:115], v[164:167], a[164:167], v[112:115]
    v_exp_f32 v67, v67
    v_mfma_f32_16x16x32_bf16 v[120:123], v[164:167], a[180:183], v[120:123]
    ds_read_b64_tr_b16 a[200:201], v226 offset:24576
    v_cvt_pk_bf16_f32 v129, v66, v67
    v_mfma_f32_16x16x32_bf16 v[96:99], v[168:171], a[136:139], v[96:99]
    ds_read_b64_tr_b16 a[202:203], v226 offset:28672
    v_exp_f32 v68, v68
    v_mfma_f32_16x16x32_bf16 v[104:107], v[168:171], a[152:155], v[104:107]
    ds_read_b64_tr_b16 a[204:205], v227 offset:24576
    v_accvgpr_read_b32 v207, a91
    v_mfma_f32_16x16x32_bf16 v[112:115], v[168:171], a[168:171], v[112:115]
    v_exp_f32 v69, v69
    v_mfma_f32_16x16x32_bf16 v[120:123], v[168:171], a[184:187], v[120:123]
    ds_read_b64_tr_b16 a[206:207], v227 offset:28672
    v_cvt_pk_bf16_f32 v130, v68, v69
    v_mfma_f32_16x16x32_bf16 v[96:99], v[172:175], a[140:143], v[96:99]
    v_exp_f32 v70, v70
    v_mfma_f32_16x16x32_bf16 v[104:107], v[172:175], a[156:159], v[104:107]
    ds_read_b64_tr_b16 a[208:209], v228 offset:24576
    v_mul_f32 v204, v204, v250
    v_mul_f32 v205, v205, v250
    v_mfma_f32_16x16x32_bf16 v[112:115], v[172:175], a[172:175], v[112:115]
    ds_read_b64_tr_b16 a[210:211], v228 offset:28672
    v_exp_f32 v71, v71
    v_mfma_f32_16x16x32_bf16 v[120:123], v[172:175], a[188:191], v[120:123]
    ds_read_b64_tr_b16 a[212:213], v229 offset:24576
    v_cvt_pk_bf16_f32 v131, v70, v71
    v_mfma_f32_16x16x32_bf16 v[100:103], v[176:179], a[128:131], 0
    v_exp_f32 v72, v72
    v_mfma_f32_16x16x32_bf16 v[108:111], v[176:179], a[144:147], 0
    ds_read_b64_tr_b16 a[214:215], v229 offset:28672
    v_mul_f32 v206, v206, v250
    v_mfma_f32_16x16x32_bf16 v[116:119], v[176:179], a[160:163], 0
    ds_read_b64_tr_b16 a[216:217], v230 offset:24576
    v_exp_f32 v73, v73
    v_mfma_f32_16x16x32_bf16 v[124:127], v[176:179], a[176:179], 0
    ds_read_b64_tr_b16 a[218:219], v230 offset:28672
    buffer_load_dwordx4 v233, s[8:11], s35 offen offset:1024 nt lds
    v_cvt_pk_bf16_f32 v132, v72, v73
    v_mfma_f32_16x16x32_bf16 v[100:103], v[180:183], a[132:135], v[100:103]
    v_exp_f32 v74, v74
    v_mfma_f32_16x16x32_bf16 v[108:111], v[180:183], a[148:151], v[108:111]
    ds_read_b64_tr_b16 a[220:221], v231 offset:24576
    v_mul_f32 v207, v207, v250
    v_cvt_pk_bf16_f32 v204, v204, v205
    v_mfma_f32_16x16x32_bf16 v[116:119], v[180:183], a[164:167], v[116:119]
    v_exp_f32 v75, v75
    v_mfma_f32_16x16x32_bf16 v[124:127], v[180:183], a[180:183], v[124:127]
    ds_read_b64_tr_b16 a[222:223], v231 offset:28672
    v_cvt_pk_bf16_f32 v133, v74, v75
    v_mfma_f32_16x16x32_bf16 v[100:103], v[184:187], a[136:139], v[100:103]
    ds_read_b128 v[192:195], v215 offset:2048
    v_exp_f32 v76, v76
    v_mfma_f32_16x16x32_bf16 v[108:111], v[184:187], a[152:155], v[108:111]
    ds_read_b128 v[196:199], v215 offset:3072
    v_cvt_pk_bf16_f32 v205, v206, v207
    v_mfma_f32_16x16x32_bf16 v[116:119], v[184:187], a[168:171], v[116:119]
    v_exp_f32 v77, v77
    v_mfma_f32_16x16x32_bf16 v[124:127], v[184:187], a[184:187], v[124:127]
    ds_write_b64 v243, v[204:205] offset:8192
    v_cvt_pk_bf16_f32 v134, v76, v77
    v_mfma_f32_16x16x32_bf16 v[100:103], v[188:191], a[140:143], v[100:103]
    v_exp_f32 v78, v78
    v_mfma_f32_16x16x32_bf16 v[108:111], v[188:191], a[156:159], v[108:111]
    v_accvgpr_read_b32 v200, a96
    v_mfma_f32_16x16x32_bf16 v[116:119], v[188:191], a[172:175], v[116:119]
    v_exp_f32 v79, v79
    v_mfma_f32_16x16x32_bf16 v[124:127], v[188:191], a[188:191], v[124:127]
    v_cvt_pk_bf16_f32 v135, v78, v79
    v_accvgpr_read_b32 v201, a97
    s_waitcnt vmcnt(10) lgkmcnt(0)
    s_barrier
    v_mfma_f32_16x16x32_bf16 a[224:227], a[240:243], v[144:147], a[224:227]
    v_exp_f32 v80, v80
    v_mfma_f32_16x16x32_bf16 a[228:231], a[240:243], v[148:151], a[228:231]
    ds_read_b128 v[160:163], v216 offset:16384
    v_mfma_f32_16x16x32_bf16 a[232:235], a[240:243], v[152:155], a[232:235]
    s_add_u32 s35, s24, 2048
    v_exp_f32 v81, v81
    v_mfma_f32_16x16x32_bf16 a[236:239], a[240:243], v[156:159], a[236:239]
    buffer_store_dwordx4 v[192:195], v236, s[16:19], s35 offen sc1
    v_cvt_pk_bf16_f32 v136, v80, v81
    v_mfma_f32_16x16x32_bf16 v[0:3], a[192:195], v[144:147], v[0:3]
    v_exp_f32 v82, v82
    v_mfma_f32_16x16x32_bf16 v[4:7], a[192:195], v[148:151], v[4:7]
    ds_read_b128 v[164:167], v217 offset:16384
    v_accvgpr_read_b32 v202, a98
    v_mfma_f32_16x16x32_bf16 a[0:3], a[192:195], v[152:155], a[0:3]
    v_exp_f32 v83, v83
    v_mfma_f32_16x16x32_bf16 a[4:7], a[192:195], v[156:159], a[4:7]
    v_cvt_pk_bf16_f32 v137, v82, v83
    v_accvgpr_read_b32 v203, a99
    v_mfma_f32_16x16x32_bf16 v[8:11], a[196:199], v[144:147], v[8:11]
    v_exp_f32 v84, v84
    v_mfma_f32_16x16x32_bf16 v[12:15], a[196:199], v[148:151], v[12:15]
    ds_read_b128 v[168:171], v218 offset:16384
    v_mul_f32 v200, v200, v250
    v_mfma_f32_16x16x32_bf16 a[8:11], a[196:199], v[152:155], a[8:11]
    v_exp_f32 v85, v85
    v_mfma_f32_16x16x32_bf16 a[12:15], a[196:199], v[156:159], a[12:15]
    buffer_store_dwordx4 v[196:199], v237, s[16:19], s35 offen offset:1024 sc1
    v_cvt_pk_bf16_f32 v138, v84, v85
    v_mfma_f32_16x16x32_bf16 v[16:19], a[200:203], v[144:147], v[16:19]
    v_exp_f32 v86, v86
    v_mfma_f32_16x16x32_bf16 v[20:23], a[200:203], v[148:151], v[20:23]
    ds_read_b128 v[172:175], v219 offset:16384
    v_mul_f32 v201, v201, v250
    v_mfma_f32_16x16x32_bf16 a[16:19], a[200:203], v[152:155], a[16:19]
    v_exp_f32 v87, v87
    v_mfma_f32_16x16x32_bf16 a[20:23], a[200:203], v[156:159], a[20:23]
    v_cvt_pk_bf16_f32 v139, v86, v87
    v_mul_f32 v202, v202, v250
    v_mfma_f32_16x16x32_bf16 v[24:27], a[204:207], v[144:147], v[24:27]
    v_exp_f32 v88, v88
    v_mfma_f32_16x16x32_bf16 v[28:31], a[204:207], v[148:151], v[28:31]
    s_add_u32 m0, s25, 57344
    ds_read_b128 v[176:179], v216 offset:20480
    v_mul_f32 v203, v203, v250
    v_mfma_f32_16x16x32_bf16 a[24:27], a[204:207], v[152:155], a[24:27]
    s_add_u32 s35, s21, 28672
    v_exp_f32 v89, v89
    v_mfma_f32_16x16x32_bf16 a[28:31], a[204:207], v[156:159], a[28:31]
    buffer_load_dwordx4 v234, s[12:15], s35 offen nt lds
    v_cvt_pk_bf16_f32 v140, v88, v89
    v_mfma_f32_16x16x32_bf16 v[32:35], a[208:211], v[144:147], v[32:35]
    v_exp_f32 v90, v90
    v_mfma_f32_16x16x32_bf16 v[36:39], a[208:211], v[148:151], v[36:39]
    ds_read_b128 v[180:183], v217 offset:20480
    v_cvt_pk_bf16_f32 v200, v200, v201
    v_mfma_f32_16x16x32_bf16 a[32:35], a[208:211], v[152:155], a[32:35]
    v_exp_f32 v91, v91
    v_mfma_f32_16x16x32_bf16 a[36:39], a[208:211], v[156:159], a[36:39]
    ds_read_b128 v[184:187], v218 offset:20480
    v_cvt_pk_bf16_f32 v141, v90, v91
    v_mfma_f32_16x16x32_bf16 v[40:43], a[212:215], v[144:147], v[40:43]
    v_exp_f32 v92, v92
    v_mfma_f32_16x16x32_bf16 v[44:47], a[212:215], v[148:151], v[44:47]
    ds_read_b128 v[188:191], v219 offset:20480
    v_cvt_pk_bf16_f32 v201, v202, v203
    v_mfma_f32_16x16x32_bf16 a[40:43], a[212:215], v[152:155], a[40:43]
    ds_write_b64 v240, v[200:201] offset:8320
    v_exp_f32 v93, v93
    v_mfma_f32_16x16x32_bf16 a[44:47], a[212:215], v[156:159], a[44:47]
    buffer_load_dwordx4 v235, s[12:15], s35 offen offset:1024 nt lds
    v_cvt_pk_bf16_f32 v142, v92, v93
    v_mfma_f32_16x16x32_bf16 v[48:51], a[216:219], v[144:147], v[48:51]
    v_exp_f32 v94, v94
    v_mfma_f32_16x16x32_bf16 v[52:55], a[216:219], v[148:151], v[52:55]
    v_mfma_f32_16x16x32_bf16 a[48:51], a[216:219], v[152:155], a[48:51]
    v_exp_f32 v95, v95
    v_mfma_f32_16x16x32_bf16 a[52:55], a[216:219], v[156:159], a[52:55]
    v_cvt_pk_bf16_f32 v143, v94, v95
    v_mfma_f32_16x16x32_bf16 v[56:59], a[220:223], v[144:147], v[56:59]
    v_mfma_f32_16x16x32_bf16 v[60:63], a[220:223], v[148:151], v[60:63]
    v_mfma_f32_16x16x32_bf16 a[56:59], a[220:223], v[152:155], a[56:59]
    v_mfma_f32_16x16x32_bf16 a[60:63], a[220:223], v[156:159], a[60:63]
    s_waitcnt lgkmcnt(0)
    v_pk_fma_f32 v[96:97], v[96:97], s[26:27], v[244:245] op_sel:[0,0,0] op_sel_hi:[1,0,0]
    v_pk_fma_f32 v[98:99], v[98:99], s[26:27], v[244:245] op_sel:[0,0,0] op_sel_hi:[1,0,0]
    v_pk_fma_f32 v[100:101], v[100:101], s[26:27], v[244:245] op_sel:[0,0,0] op_sel_hi:[1,0,0]
    v_pk_fma_f32 v[102:103], v[102:103], s[26:27], v[244:245] op_sel:[0,0,0] op_sel_hi:[1,0,0]
    v_pk_fma_f32 v[104:105], v[104:105], s[26:27], v[244:245] op_sel:[0,0,1] op_sel_hi:[1,0,1]
    v_pk_fma_f32 v[106:107], v[106:107], s[26:27], v[244:245] op_sel:[0,0,1] op_sel_hi:[1,0,1]
    v_pk_fma_f32 v[108:109], v[108:109], s[26:27], v[244:245] op_sel:[0,0,1] op_sel_hi:[1,0,1]
    v_pk_fma_f32 v[110:111], v[110:111], s[26:27], v[244:245] op_sel:[0,0,1] op_sel_hi:[1,0,1]
    v_pk_fma_f32 v[112:113], v[112:113], s[26:27], v[246:247] op_sel:[0,0,0] op_sel_hi:[1,0,0]
    v_pk_fma_f32 v[114:115], v[114:115], s[26:27], v[246:247] op_sel:[0,0,0] op_sel_hi:[1,0,0]
    v_pk_fma_f32 v[116:117], v[116:117], s[26:27], v[246:247] op_sel:[0,0,0] op_sel_hi:[1,0,0]
    v_pk_fma_f32 v[118:119], v[118:119], s[26:27], v[246:247] op_sel:[0,0,0] op_sel_hi:[1,0,0]
    v_pk_fma_f32 v[120:121], v[120:121], s[26:27], v[246:247] op_sel:[0,0,1] op_sel_hi:[1,0,1]
    v_pk_fma_f32 v[122:123], v[122:123], s[26:27], v[246:247] op_sel:[0,0,1] op_sel_hi:[1,0,1]
    v_pk_fma_f32 v[124:125], v[124:125], s[26:27], v[246:247] op_sel:[0,0,1] op_sel_hi:[1,0,1]
    v_pk_fma_f32 v[126:127], v[126:127], s[26:27], v[246:247] op_sel:[0,0,1] op_sel_hi:[1,0,1]
    s_nop 1
    v_mfma_f32_16x16x32_bf16 v[64:67], v[160:163], a[128:131], 0
    v_exp_f32 v96, v96
    v_mfma_f32_16x16x32_bf16 v[72:75], v[160:163], a[144:147], 0
    ds_read_b64_tr_b16 a[192:193], v224 offset:0
    v_accvgpr_read_b32 v204, a104
    v_mfma_f32_16x16x32_bf16 v[80:83], v[160:163], a[160:163], 0
    v_exp_f32 v97, v97
    v_mfma_f32_16x16x32_bf16 v[88:91], v[160:163], a[176:179], 0
    s_add_u32 m0, s25, 8192
    ds_read_b64_tr_b16 a[194:195], v224 offset:4096
    v_cvt_pk_bf16_f32 v144, v96, v97
    v_mfma_f32_16x16x32_bf16 v[64:67], v[164:167], a[132:135], v[64:67]
    s_add_u32 s35, s21, 36864
    ds_read_b64_tr_b16 a[196:197], v225 offset:0
    v_exp_f32 v98, v98
    v_mfma_f32_16x16x32_bf16 v[72:75], v[164:167], a[148:151], v[72:75]
    ds_read_b64_tr_b16 a[198:199], v225 offset:4096
    buffer_load_dwordx4 v232, s[8:11], s35 offen nt lds
    v_mfma_f32_16x16x32_bf16 v[80:83], v[164:167], a[164:167], v[80:83]
    v_exp_f32 v99, v99
    v_mfma_f32_16x16x32_bf16 v[88:91], v[164:167], a[180:183], v[88:91]
    ds_read_b64_tr_b16 a[200:201], v226 offset:0
    v_cvt_pk_bf16_f32 v145, v98, v99
    v_mfma_f32_16x16x32_bf16 v[64:67], v[168:171], a[136:139], v[64:67]
    v_exp_f32 v100, v100
    v_mfma_f32_16x16x32_bf16 v[72:75], v[168:171], a[152:155], v[72:75]
    ds_read_b64_tr_b16 a[202:203], v226 offset:4096
    v_accvgpr_read_b32 v205, a105
    v_mfma_f32_16x16x32_bf16 v[80:83], v[168:171], a[168:171], v[80:83]
    v_exp_f32 v101, v101
    v_mfma_f32_16x16x32_bf16 v[88:91], v[168:171], a[184:187], v[88:91]
    ds_read_b64_tr_b16 a[204:205], v227 offset:0
    v_cvt_pk_bf16_f32 v146, v100, v101
    v_mfma_f32_16x16x32_bf16 v[64:67], v[172:175], a[140:143], v[64:67]
    v_exp_f32 v102, v102
    v_mfma_f32_16x16x32_bf16 v[72:75], v[172:175], a[156:159], v[72:75]
    ds_read_b64_tr_b16 a[206:207], v227 offset:4096
    v_accvgpr_read_b32 v206, a106
    v_mfma_f32_16x16x32_bf16 v[80:83], v[172:175], a[172:175], v[80:83]
    ds_read_b64_tr_b16 a[208:209], v228 offset:0
    v_exp_f32 v103, v103
    v_mfma_f32_16x16x32_bf16 v[88:91], v[172:175], a[188:191], v[88:91]
    ds_read_b64_tr_b16 a[210:211], v228 offset:4096
    v_cvt_pk_bf16_f32 v147, v102, v103
    v_mfma_f32_16x16x32_bf16 v[68:71], v[176:179], a[128:131], 0
    v_exp_f32 v104, v104
    v_mfma_f32_16x16x32_bf16 v[76:79], v[176:179], a[144:147], 0
    ds_read_b64_tr_b16 a[212:213], v229 offset:0
    v_accvgpr_read_b32 v207, a107
    v_mfma_f32_16x16x32_bf16 v[84:87], v[176:179], a[160:163], 0
    buffer_load_dwordx4 v233, s[8:11], s35 offen offset:1024 nt lds
    v_exp_f32 v105, v105
    v_mfma_f32_16x16x32_bf16 v[92:95], v[176:179], a[176:179], 0
    ds_read_b64_tr_b16 a[214:215], v229 offset:4096
    v_cvt_pk_bf16_f32 v148, v104, v105
    v_mfma_f32_16x16x32_bf16 v[68:71], v[180:183], a[132:135], v[68:71]
    v_exp_f32 v106, v106
    v_mfma_f32_16x16x32_bf16 v[76:79], v[180:183], a[148:151], v[76:79]
    ds_read_b64_tr_b16 a[216:217], v230 offset:0
    v_mul_f32 v204, v204, v250
    v_mfma_f32_16x16x32_bf16 v[84:87], v[180:183], a[164:167], v[84:87]
    ds_read_b64_tr_b16 a[218:219], v230 offset:4096
    v_exp_f32 v107, v107
    v_mfma_f32_16x16x32_bf16 v[92:95], v[180:183], a[180:183], v[92:95]
    ds_read_b64_tr_b16 a[220:221], v231 offset:0
    v_cvt_pk_bf16_f32 v149, v106, v107
    v_mfma_f32_16x16x32_bf16 v[68:71], v[184:187], a[136:139], v[68:71]
    v_exp_f32 v108, v108
    v_mfma_f32_16x16x32_bf16 v[76:79], v[184:187], a[152:155], v[76:79]
    ds_read_b64_tr_b16 a[222:223], v231 offset:4096
    v_mfma_f32_16x16x32_bf16 v[84:87], v[184:187], a[168:171], v[84:87]
    v_exp_f32 v109, v109
    v_mfma_f32_16x16x32_bf16 v[92:95], v[184:187], a[184:187], v[92:95]
    v_cvt_pk_bf16_f32 v150, v108, v109
    v_mfma_f32_16x16x32_bf16 v[68:71], v[188:191], a[140:143], v[68:71]
    v_exp_f32 v110, v110
    v_mfma_f32_16x16x32_bf16 v[76:79], v[188:191], a[156:159], v[76:79]
    v_mul_f32 v205, v205, v250
    v_mfma_f32_16x16x32_bf16 v[84:87], v[188:191], a[172:175], v[84:87]
    v_exp_f32 v111, v111
    v_mfma_f32_16x16x32_bf16 v[92:95], v[188:191], a[188:191], v[92:95]
    v_cvt_pk_bf16_f32 v151, v110, v111
    v_mul_f32 v206, v206, v250
    s_waitcnt vmcnt(10) lgkmcnt(0)
    s_barrier
    v_mfma_f32_16x16x32_bf16 a[224:227], a[240:243], v[128:131], a[224:227]
    v_exp_f32 v112, v112
    v_mfma_f32_16x16x32_bf16 a[228:231], a[240:243], v[132:135], a[228:231]
    s_add_u32 m0, s25, 32768
    ds_read_b128 v[160:163], v216 offset:24576
    v_mfma_f32_16x16x32_bf16 a[232:235], a[240:243], v[136:139], a[232:235]
    s_add_u32 s35, s21, 32768
    v_exp_f32 v113, v113
    v_mfma_f32_16x16x32_bf16 a[236:239], a[240:243], v[140:143], a[236:239]
    buffer_load_dwordx4 v234, s[12:15], s35 offen nt lds
    v_cvt_pk_bf16_f32 v152, v112, v113
    v_mfma_f32_16x16x32_bf16 v[0:3], a[192:195], v[128:131], v[0:3]
    v_exp_f32 v114, v114
    v_mfma_f32_16x16x32_bf16 v[4:7], a[192:195], v[132:135], v[4:7]
    ds_read_b128 v[164:167], v217 offset:24576
    v_mul_f32 v207, v207, v250
    v_mfma_f32_16x16x32_bf16 a[0:3], a[192:195], v[136:139], a[0:3]
    v_exp_f32 v115, v115
    v_mfma_f32_16x16x32_bf16 a[4:7], a[192:195], v[140:143], a[4:7]
    v_cvt_pk_bf16_f32 v153, v114, v115
    v_mfma_f32_16x16x32_bf16 v[8:11], a[196:199], v[128:131], v[8:11]
    v_exp_f32 v116, v116
    v_mfma_f32_16x16x32_bf16 v[12:15], a[196:199], v[132:135], v[12:15]
    ds_read_b128 v[168:171], v218 offset:24576
    v_mfma_f32_16x16x32_bf16 a[8:11], a[196:199], v[136:139], a[8:11]
    v_exp_f32 v117, v117
    v_mfma_f32_16x16x32_bf16 a[12:15], a[196:199], v[140:143], a[12:15]
    buffer_load_dwordx4 v235, s[12:15], s35 offen offset:1024 nt lds
    v_cvt_pk_bf16_f32 v154, v116, v117
    v_mfma_f32_16x16x32_bf16 v[16:19], a[200:203], v[128:131], v[16:19]
    v_exp_f32 v118, v118
    v_mfma_f32_16x16x32_bf16 v[20:23], a[200:203], v[132:135], v[20:23]
    ds_read_b128 v[172:175], v219 offset:24576
    v_cvt_pk_bf16_f32 v204, v204, v205
    v_mfma_f32_16x16x32_bf16 a[16:19], a[200:203], v[136:139], a[16:19]
    v_exp_f32 v119, v119
    v_mfma_f32_16x16x32_bf16 a[20:23], a[200:203], v[140:143], a[20:23]
    v_cvt_pk_bf16_f32 v155, v118, v119
    v_mfma_f32_16x16x32_bf16 v[24:27], a[204:207], v[128:131], v[24:27]
    v_exp_f32 v120, v120
    v_mfma_f32_16x16x32_bf16 v[28:31], a[204:207], v[132:135], v[28:31]
    s_add_u32 m0, s25, 81920
    ds_read_b128 v[176:179], v216 offset:28672
    v_cvt_pk_bf16_f32 v205, v206, v207
    v_mfma_f32_16x16x32_bf16 a[24:27], a[204:207], v[136:139], a[24:27]
    s_add_u32 s35, s21, 57344
    v_exp_f32 v121, v121
    v_mfma_f32_16x16x32_bf16 a[28:31], a[204:207], v[140:143], a[28:31]
    buffer_load_dwordx4 v232, s[8:11], s35 offen nt lds
    v_cvt_pk_bf16_f32 v156, v120, v121
    v_mfma_f32_16x16x32_bf16 v[32:35], a[208:211], v[128:131], v[32:35]
    v_exp_f32 v122, v122
    v_mfma_f32_16x16x32_bf16 v[36:39], a[208:211], v[132:135], v[36:39]
    ds_read_b128 v[180:183], v217 offset:28672
    ds_write_b64 v241, v[204:205] offset:8320
    v_mfma_f32_16x16x32_bf16 a[32:35], a[208:211], v[136:139], a[32:35]
    v_exp_f32 v123, v123
    v_mfma_f32_16x16x32_bf16 a[36:39], a[208:211], v[140:143], a[36:39]
    ds_read_b128 v[184:187], v218 offset:28672
    v_cvt_pk_bf16_f32 v157, v122, v123
    v_mfma_f32_16x16x32_bf16 v[40:43], a[212:215], v[128:131], v[40:43]
    v_exp_f32 v124, v124
    v_mfma_f32_16x16x32_bf16 v[44:47], a[212:215], v[132:135], v[44:47]
    ds_read_b128 v[188:191], v219 offset:28672
    v_mfma_f32_16x16x32_bf16 a[40:43], a[212:215], v[136:139], a[40:43]
    v_exp_f32 v125, v125
    v_mfma_f32_16x16x32_bf16 a[44:47], a[212:215], v[140:143], a[44:47]
    buffer_load_dwordx4 v233, s[8:11], s35 offen offset:1024 nt lds
    v_cvt_pk_bf16_f32 v158, v124, v125
    v_mfma_f32_16x16x32_bf16 v[48:51], a[216:219], v[128:131], v[48:51]
    v_exp_f32 v126, v126
    v_mfma_f32_16x16x32_bf16 v[52:55], a[216:219], v[132:135], v[52:55]
    v_mfma_f32_16x16x32_bf16 a[48:51], a[216:219], v[136:139], a[48:51]
    v_exp_f32 v127, v127
    v_mfma_f32_16x16x32_bf16 a[52:55], a[216:219], v[140:143], a[52:55]
    v_cvt_pk_bf16_f32 v159, v126, v127
    v_mfma_f32_16x16x32_bf16 v[56:59], a[220:223], v[128:131], v[56:59]
    v_mfma_f32_16x16x32_bf16 v[60:63], a[220:223], v[132:135], v[60:63]
    v_mfma_f32_16x16x32_bf16 a[56:59], a[220:223], v[136:139], a[56:59]
    v_mfma_f32_16x16x32_bf16 a[60:63], a[220:223], v[140:143], a[60:63]
    s_waitcnt lgkmcnt(0)
    v_pk_fma_f32 v[64:65], v[64:65], s[26:27], v[244:245] op_sel:[0,0,0] op_sel_hi:[1,0,0]
    v_pk_fma_f32 v[66:67], v[66:67], s[26:27], v[244:245] op_sel:[0,0,0] op_sel_hi:[1,0,0]
    v_pk_fma_f32 v[68:69], v[68:69], s[26:27], v[244:245] op_sel:[0,0,0] op_sel_hi:[1,0,0]
    v_pk_fma_f32 v[70:71], v[70:71], s[26:27], v[244:245] op_sel:[0,0,0] op_sel_hi:[1,0,0]
    v_pk_fma_f32 v[72:73], v[72:73], s[26:27], v[244:245] op_sel:[0,0,1] op_sel_hi:[1,0,1]
    v_pk_fma_f32 v[74:75], v[74:75], s[26:27], v[244:245] op_sel:[0,0,1] op_sel_hi:[1,0,1]
    v_pk_fma_f32 v[76:77], v[76:77], s[26:27], v[244:245] op_sel:[0,0,1] op_sel_hi:[1,0,1]
    v_pk_fma_f32 v[78:79], v[78:79], s[26:27], v[244:245] op_sel:[0,0,1] op_sel_hi:[1,0,1]
    v_pk_fma_f32 v[80:81], v[80:81], s[26:27], v[246:247] op_sel:[0,0,0] op_sel_hi:[1,0,0]
    v_pk_fma_f32 v[82:83], v[82:83], s[26:27], v[246:247] op_sel:[0,0,0] op_sel_hi:[1,0,0]
    v_pk_fma_f32 v[84:85], v[84:85], s[26:27], v[246:247] op_sel:[0,0,0] op_sel_hi:[1,0,0]
    v_pk_fma_f32 v[86:87], v[86:87], s[26:27], v[246:247] op_sel:[0,0,0] op_sel_hi:[1,0,0]
    v_pk_fma_f32 v[88:89], v[88:89], s[26:27], v[246:247] op_sel:[0,0,1] op_sel_hi:[1,0,1]
    v_pk_fma_f32 v[90:91], v[90:91], s[26:27], v[246:247] op_sel:[0,0,1] op_sel_hi:[1,0,1]
    v_pk_fma_f32 v[92:93], v[92:93], s[26:27], v[246:247] op_sel:[0,0,1] op_sel_hi:[1,0,1]
    v_pk_fma_f32 v[94:95], v[94:95], s[26:27], v[246:247] op_sel:[0,0,1] op_sel_hi:[1,0,1]
    s_nop 1
    v_mfma_f32_16x16x32_bf16 v[96:99], v[160:163], a[128:131], 0
    v_exp_f32 v64, v64
    v_mfma_f32_16x16x32_bf16 v[104:107], v[160:163], a[144:147], 0
    ds_read_b64_tr_b16 a[192:193], v224 offset:8192
    v_accvgpr_read_b32 v200, a112
    v_accvgpr_read_b32 v201, a113
    v_mfma_f32_16x16x32_bf16 v[112:115], v[160:163], a[160:163], 0
    ds_read_b64_tr_b16 a[194:195], v224 offset:12288
    v_exp_f32 v65, v65
    v_mfma_f32_16x16x32_bf16 v[120:123], v[160:163], a[176:179], 0
    s_add_u32 m0, s25, 16384
    ds_read_b64_tr_b16 a[196:197], v225 offset:8192
    v_cvt_pk_bf16_f32 v128, v64, v65
    v_mfma_f32_16x16x32_bf16 v[96:99], v[164:167], a[132:135], v[96:99]
    s_add_u32 s35, s21, 40960
    v_exp_f32 v66, v66
    v_accvgpr_read_b32 v202, a114
    v_mfma_f32_16x16x32_bf16 v[104:107], v[164:167], a[148:151], v[104:107]
    ds_read_b64_tr_b16 a[198:199], v225 offset:12288
    buffer_load_dwordx4 v232, s[8:11], s35 offen nt lds
    v_mfma_f32_16x16x32_bf16 v[112:115], v[164:167], a[164:167], v[112:115]
    v_exp_f32 v67, v67
    v_mfma_f32_16x16x32_bf16 v[120:123], v[164:167], a[180:183], v[120:123]
    ds_read_b64_tr_b16 a[200:201], v226 offset:8192
    v_cvt_pk_bf16_f32 v129, v66, v67
    v_mfma_f32_16x16x32_bf16 v[96:99], v[168:171], a[136:139], v[96:99]
    ds_read_b64_tr_b16 a[202:203], v226 offset:12288
    v_exp_f32 v68, v68
    v_mfma_f32_16x16x32_bf16 v[104:107], v[168:171], a[152:155], v[104:107]
    ds_read_b64_tr_b16 a[204:205], v227 offset:8192
    v_accvgpr_read_b32 v203, a115
    v_mfma_f32_16x16x32_bf16 v[112:115], v[168:171], a[168:171], v[112:115]
    v_exp_f32 v69, v69
    v_mfma_f32_16x16x32_bf16 v[120:123], v[168:171], a[184:187], v[120:123]
    ds_read_b64_tr_b16 a[206:207], v227 offset:12288
    v_cvt_pk_bf16_f32 v130, v68, v69
    v_mfma_f32_16x16x32_bf16 v[96:99], v[172:175], a[140:143], v[96:99]
    v_exp_f32 v70, v70
    v_mfma_f32_16x16x32_bf16 v[104:107], v[172:175], a[156:159], v[104:107]
    ds_read_b64_tr_b16 a[208:209], v228 offset:8192
    v_mul_f32 v200, v200, v250
    v_mul_f32 v201, v201, v250
    v_mfma_f32_16x16x32_bf16 v[112:115], v[172:175], a[172:175], v[112:115]
    ds_read_b64_tr_b16 a[210:211], v228 offset:12288
    v_exp_f32 v71, v71
    v_mfma_f32_16x16x32_bf16 v[120:123], v[172:175], a[188:191], v[120:123]
    ds_read_b64_tr_b16 a[212:213], v229 offset:8192
    v_cvt_pk_bf16_f32 v131, v70, v71
    v_mfma_f32_16x16x32_bf16 v[100:103], v[176:179], a[128:131], 0
    v_exp_f32 v72, v72
    v_mfma_f32_16x16x32_bf16 v[108:111], v[176:179], a[144:147], 0
    ds_read_b64_tr_b16 a[214:215], v229 offset:12288
    v_mul_f32 v202, v202, v250
    v_mfma_f32_16x16x32_bf16 v[116:119], v[176:179], a[160:163], 0
    ds_read_b64_tr_b16 a[216:217], v230 offset:8192
    v_exp_f32 v73, v73
    v_mfma_f32_16x16x32_bf16 v[124:127], v[176:179], a[176:179], 0
    ds_read_b64_tr_b16 a[218:219], v230 offset:12288
    buffer_load_dwordx4 v233, s[8:11], s35 offen offset:1024 nt lds
    v_cvt_pk_bf16_f32 v132, v72, v73
    v_mfma_f32_16x16x32_bf16 v[100:103], v[180:183], a[132:135], v[100:103]
    v_exp_f32 v74, v74
    v_mfma_f32_16x16x32_bf16 v[108:111], v[180:183], a[148:151], v[108:111]
    ds_read_b64_tr_b16 a[220:221], v231 offset:8192
    v_mul_f32 v203, v203, v250
    v_cvt_pk_bf16_f32 v200, v200, v201
    v_mfma_f32_16x16x32_bf16 v[116:119], v[180:183], a[164:167], v[116:119]
    v_exp_f32 v75, v75
    v_mfma_f32_16x16x32_bf16 v[124:127], v[180:183], a[180:183], v[124:127]
    ds_read_b64_tr_b16 a[222:223], v231 offset:12288
    v_cvt_pk_bf16_f32 v133, v74, v75
    v_mfma_f32_16x16x32_bf16 v[100:103], v[184:187], a[136:139], v[100:103]
    ds_read_b128 v[192:195], v215 offset:4096
    v_exp_f32 v76, v76
    v_mfma_f32_16x16x32_bf16 v[108:111], v[184:187], a[152:155], v[108:111]
    ds_read_b128 v[196:199], v215 offset:5120
    v_cvt_pk_bf16_f32 v201, v202, v203
    v_mfma_f32_16x16x32_bf16 v[116:119], v[184:187], a[168:171], v[116:119]
    v_exp_f32 v77, v77
    v_mfma_f32_16x16x32_bf16 v[124:127], v[184:187], a[184:187], v[124:127]
    ds_write_b64 v242, v[200:201] offset:8320
    v_cvt_pk_bf16_f32 v134, v76, v77
    v_mfma_f32_16x16x32_bf16 v[100:103], v[188:191], a[140:143], v[100:103]
    v_exp_f32 v78, v78
    v_mfma_f32_16x16x32_bf16 v[108:111], v[188:191], a[156:159], v[108:111]
    v_accvgpr_read_b32 v204, a120
    v_mfma_f32_16x16x32_bf16 v[116:119], v[188:191], a[172:175], v[116:119]
    v_exp_f32 v79, v79
    v_mfma_f32_16x16x32_bf16 v[124:127], v[188:191], a[188:191], v[124:127]
    v_cvt_pk_bf16_f32 v135, v78, v79
    v_accvgpr_read_b32 v205, a121
    s_waitcnt vmcnt(12) lgkmcnt(0)
    s_barrier
    v_mfma_f32_16x16x32_bf16 a[224:227], a[240:243], v[144:147], a[224:227]
    v_exp_f32 v80, v80
    v_mfma_f32_16x16x32_bf16 a[228:231], a[240:243], v[148:151], a[228:231]
    ds_read_b128 v[160:163], v216 offset:0
    v_mfma_f32_16x16x32_bf16 a[232:235], a[240:243], v[152:155], a[232:235]
    s_add_u32 s35, s24, 4096
    v_exp_f32 v81, v81
    v_mfma_f32_16x16x32_bf16 a[236:239], a[240:243], v[156:159], a[236:239]
    buffer_store_dwordx4 v[192:195], v236, s[16:19], s35 offen sc1
    v_cvt_pk_bf16_f32 v136, v80, v81
    v_mfma_f32_16x16x32_bf16 v[0:3], a[192:195], v[144:147], v[0:3]
    v_exp_f32 v82, v82
    v_mfma_f32_16x16x32_bf16 v[4:7], a[192:195], v[148:151], v[4:7]
    ds_read_b128 v[164:167], v217 offset:0
    v_accvgpr_read_b32 v206, a122
    v_mfma_f32_16x16x32_bf16 a[0:3], a[192:195], v[152:155], a[0:3]
    v_exp_f32 v83, v83
    v_mfma_f32_16x16x32_bf16 a[4:7], a[192:195], v[156:159], a[4:7]
    v_cvt_pk_bf16_f32 v137, v82, v83
    v_accvgpr_read_b32 v207, a123
    v_mfma_f32_16x16x32_bf16 v[8:11], a[196:199], v[144:147], v[8:11]
    v_exp_f32 v84, v84
    v_mfma_f32_16x16x32_bf16 v[12:15], a[196:199], v[148:151], v[12:15]
    ds_read_b128 v[168:171], v218 offset:0
    v_mul_f32 v204, v204, v250
    v_mfma_f32_16x16x32_bf16 a[8:11], a[196:199], v[152:155], a[8:11]
    v_exp_f32 v85, v85
    v_mfma_f32_16x16x32_bf16 a[12:15], a[196:199], v[156:159], a[12:15]
    buffer_store_dwordx4 v[196:199], v237, s[16:19], s35 offen offset:1024 sc1
    v_cvt_pk_bf16_f32 v138, v84, v85
    v_mfma_f32_16x16x32_bf16 v[16:19], a[200:203], v[144:147], v[16:19]
    v_exp_f32 v86, v86
    v_mfma_f32_16x16x32_bf16 v[20:23], a[200:203], v[148:151], v[20:23]
    ds_read_b128 v[172:175], v219 offset:0
    v_mul_f32 v205, v205, v250
    v_mfma_f32_16x16x32_bf16 a[16:19], a[200:203], v[152:155], a[16:19]
    v_exp_f32 v87, v87
    v_mfma_f32_16x16x32_bf16 a[20:23], a[200:203], v[156:159], a[20:23]
    v_cvt_pk_bf16_f32 v139, v86, v87
    v_mul_f32 v206, v206, v250
    v_mfma_f32_16x16x32_bf16 v[24:27], a[204:207], v[144:147], v[24:27]
    v_exp_f32 v88, v88
    v_mfma_f32_16x16x32_bf16 v[28:31], a[204:207], v[148:151], v[28:31]
    s_add_u32 m0, s25, 40960
    ds_read_b128 v[176:179], v216 offset:4096
    v_mul_f32 v207, v207, v250
    v_mfma_f32_16x16x32_bf16 a[24:27], a[204:207], v[152:155], a[24:27]
    s_add_u32 s35, s21, 36864
    v_exp_f32 v89, v89
    v_mfma_f32_16x16x32_bf16 a[28:31], a[204:207], v[156:159], a[28:31]
    buffer_load_dwordx4 v234, s[12:15], s35 offen nt lds
    v_cvt_pk_bf16_f32 v140, v88, v89
    v_mfma_f32_16x16x32_bf16 v[32:35], a[208:211], v[144:147], v[32:35]
    v_exp_f32 v90, v90
    v_mfma_f32_16x16x32_bf16 v[36:39], a[208:211], v[148:151], v[36:39]
    ds_read_b128 v[180:183], v217 offset:4096
    v_cvt_pk_bf16_f32 v204, v204, v205
    v_mfma_f32_16x16x32_bf16 a[32:35], a[208:211], v[152:155], a[32:35]
    v_exp_f32 v91, v91
    v_mfma_f32_16x16x32_bf16 a[36:39], a[208:211], v[156:159], a[36:39]
    ds_read_b128 v[184:187], v218 offset:4096
    v_cvt_pk_bf16_f32 v141, v90, v91
    v_mfma_f32_16x16x32_bf16 v[40:43], a[212:215], v[144:147], v[40:43]
    v_exp_f32 v92, v92
    v_mfma_f32_16x16x32_bf16 v[44:47], a[212:215], v[148:151], v[44:47]
    ds_read_b128 v[188:191], v219 offset:4096
    v_cvt_pk_bf16_f32 v205, v206, v207
    v_mfma_f32_16x16x32_bf16 a[40:43], a[212:215], v[152:155], a[40:43]
    ds_write_b64 v243, v[204:205] offset:8320
    v_exp_f32 v93, v93
    v_mfma_f32_16x16x32_bf16 a[44:47], a[212:215], v[156:159], a[44:47]
    buffer_load_dwordx4 v235, s[12:15], s35 offen offset:1024 nt lds
    v_cvt_pk_bf16_f32 v142, v92, v93
    v_mfma_f32_16x16x32_bf16 v[48:51], a[216:219], v[144:147], v[48:51]
    v_exp_f32 v94, v94
    v_mfma_f32_16x16x32_bf16 v[52:55], a[216:219], v[148:151], v[52:55]
    v_mfma_f32_16x16x32_bf16 a[48:51], a[216:219], v[152:155], a[48:51]
    v_exp_f32 v95, v95
    v_mfma_f32_16x16x32_bf16 a[52:55], a[216:219], v[156:159], a[52:55]
    v_cvt_pk_bf16_f32 v143, v94, v95
    v_mfma_f32_16x16x32_bf16 v[56:59], a[220:223], v[144:147], v[56:59]
    v_mfma_f32_16x16x32_bf16 v[60:63], a[220:223], v[148:151], v[60:63]
    v_mfma_f32_16x16x32_bf16 a[56:59], a[220:223], v[152:155], a[56:59]
    v_mfma_f32_16x16x32_bf16 a[60:63], a[220:223], v[156:159], a[60:63]
    s_waitcnt lgkmcnt(0)
    v_pk_fma_f32 v[96:97], v[96:97], s[26:27], v[244:245] op_sel:[0,0,0] op_sel_hi:[1,0,0]
    v_pk_fma_f32 v[98:99], v[98:99], s[26:27], v[244:245] op_sel:[0,0,0] op_sel_hi:[1,0,0]
    v_pk_fma_f32 v[100:101], v[100:101], s[26:27], v[244:245] op_sel:[0,0,0] op_sel_hi:[1,0,0]
    v_pk_fma_f32 v[102:103], v[102:103], s[26:27], v[244:245] op_sel:[0,0,0] op_sel_hi:[1,0,0]
    v_pk_fma_f32 v[104:105], v[104:105], s[26:27], v[244:245] op_sel:[0,0,1] op_sel_hi:[1,0,1]
    v_pk_fma_f32 v[106:107], v[106:107], s[26:27], v[244:245] op_sel:[0,0,1] op_sel_hi:[1,0,1]
    v_pk_fma_f32 v[108:109], v[108:109], s[26:27], v[244:245] op_sel:[0,0,1] op_sel_hi:[1,0,1]
    v_pk_fma_f32 v[110:111], v[110:111], s[26:27], v[244:245] op_sel:[0,0,1] op_sel_hi:[1,0,1]
    v_pk_fma_f32 v[112:113], v[112:113], s[26:27], v[246:247] op_sel:[0,0,0] op_sel_hi:[1,0,0]
    v_pk_fma_f32 v[114:115], v[114:115], s[26:27], v[246:247] op_sel:[0,0,0] op_sel_hi:[1,0,0]
    v_pk_fma_f32 v[116:117], v[116:117], s[26:27], v[246:247] op_sel:[0,0,0] op_sel_hi:[1,0,0]
    v_pk_fma_f32 v[118:119], v[118:119], s[26:27], v[246:247] op_sel:[0,0,0] op_sel_hi:[1,0,0]
    v_pk_fma_f32 v[120:121], v[120:121], s[26:27], v[246:247] op_sel:[0,0,1] op_sel_hi:[1,0,1]
    v_pk_fma_f32 v[122:123], v[122:123], s[26:27], v[246:247] op_sel:[0,0,1] op_sel_hi:[1,0,1]
    v_pk_fma_f32 v[124:125], v[124:125], s[26:27], v[246:247] op_sel:[0,0,1] op_sel_hi:[1,0,1]
    v_pk_fma_f32 v[126:127], v[126:127], s[26:27], v[246:247] op_sel:[0,0,1] op_sel_hi:[1,0,1]
    s_nop 1
    v_mfma_f32_16x16x32_bf16 v[64:67], v[160:163], a[128:131], 0
    v_exp_f32 v96, v96
    v_mfma_f32_16x16x32_bf16 v[72:75], v[160:163], a[144:147], 0
    ds_read_b64_tr_b16 a[192:193], v224 offset:16384
    v_accvgpr_read_b32 v200, a68
    v_mfma_f32_16x16x32_bf16 v[80:83], v[160:163], a[160:163], 0
    v_exp_f32 v97, v97
    v_mfma_f32_16x16x32_bf16 v[88:91], v[160:163], a[176:179], 0
    s_add_u32 m0, s25, 24576
    ds_read_b64_tr_b16 a[194:195], v224 offset:20480
    v_cvt_pk_bf16_f32 v144, v96, v97
    v_mfma_f32_16x16x32_bf16 v[64:67], v[164:167], a[132:135], v[64:67]
    s_add_u32 s35, s21, 45056
    ds_read_b64_tr_b16 a[196:197], v225 offset:16384
    v_exp_f32 v98, v98
    v_mfma_f32_16x16x32_bf16 v[72:75], v[164:167], a[148:151], v[72:75]
    ds_read_b64_tr_b16 a[198:199], v225 offset:20480
    buffer_load_dwordx4 v232, s[8:11], s35 offen nt lds
    v_mfma_f32_16x16x32_bf16 v[80:83], v[164:167], a[164:167], v[80:83]
    v_exp_f32 v99, v99
    v_mfma_f32_16x16x32_bf16 v[88:91], v[164:167], a[180:183], v[88:91]
    ds_read_b64_tr_b16 a[200:201], v226 offset:16384
    v_cvt_pk_bf16_f32 v145, v98, v99
    v_mfma_f32_16x16x32_bf16 v[64:67], v[168:171], a[136:139], v[64:67]
    v_exp_f32 v100, v100
    v_mfma_f32_16x16x32_bf16 v[72:75], v[168:171], a[152:155], v[72:75]
    ds_read_b64_tr_b16 a[202:203], v226 offset:20480
    v_accvgpr_read_b32 v201, a69
    v_mfma_f32_16x16x32_bf16 v[80:83], v[168:171], a[168:171], v[80:83]
    v_exp_f32 v101, v101
    v_mfma_f32_16x16x32_bf16 v[88:91], v[168:171], a[184:187], v[88:91]
    ds_read_b64_tr_b16 a[204:205], v227 offset:16384
    v_cvt_pk_bf16_f32 v146, v100, v101
    v_mfma_f32_16x16x32_bf16 v[64:67], v[172:175], a[140:143], v[64:67]
    v_exp_f32 v102, v102
    v_mfma_f32_16x16x32_bf16 v[72:75], v[172:175], a[156:159], v[72:75]
    ds_read_b64_tr_b16 a[206:207], v227 offset:20480
    v_accvgpr_read_b32 v202, a70
    v_mfma_f32_16x16x32_bf16 v[80:83], v[172:175], a[172:175], v[80:83]
    ds_read_b64_tr_b16 a[208:209], v228 offset:16384
    v_exp_f32 v103, v103
    v_mfma_f32_16x16x32_bf16 v[88:91], v[172:175], a[188:191], v[88:91]
    ds_read_b64_tr_b16 a[210:211], v228 offset:20480
    v_cvt_pk_bf16_f32 v147, v102, v103
    v_mfma_f32_16x16x32_bf16 v[68:71], v[176:179], a[128:131], 0
    v_exp_f32 v104, v104
    v_mfma_f32_16x16x32_bf16 v[76:79], v[176:179], a[144:147], 0
    ds_read_b64_tr_b16 a[212:213], v229 offset:16384
    v_accvgpr_read_b32 v203, a71
    v_mfma_f32_16x16x32_bf16 v[84:87], v[176:179], a[160:163], 0
    buffer_load_dwordx4 v233, s[8:11], s35 offen offset:1024 nt lds
    v_exp_f32 v105, v105
    v_mfma_f32_16x16x32_bf16 v[92:95], v[176:179], a[176:179], 0
    ds_read_b64_tr_b16 a[214:215], v229 offset:20480
    v_cvt_pk_bf16_f32 v148, v104, v105
    v_mfma_f32_16x16x32_bf16 v[68:71], v[180:183], a[132:135], v[68:71]
    v_exp_f32 v106, v106
    v_mfma_f32_16x16x32_bf16 v[76:79], v[180:183], a[148:151], v[76:79]
    ds_read_b64_tr_b16 a[216:217], v230 offset:16384
    v_mul_f32 v200, v200, v251
    v_mfma_f32_16x16x32_bf16 v[84:87], v[180:183], a[164:167], v[84:87]
    ds_read_b64_tr_b16 a[218:219], v230 offset:20480
    v_exp_f32 v107, v107
    v_mfma_f32_16x16x32_bf16 v[92:95], v[180:183], a[180:183], v[92:95]
    ds_read_b64_tr_b16 a[220:221], v231 offset:16384
    v_cvt_pk_bf16_f32 v149, v106, v107
    v_mfma_f32_16x16x32_bf16 v[68:71], v[184:187], a[136:139], v[68:71]
    v_exp_f32 v108, v108
    v_mfma_f32_16x16x32_bf16 v[76:79], v[184:187], a[152:155], v[76:79]
    ds_read_b64_tr_b16 a[222:223], v231 offset:20480
    v_mfma_f32_16x16x32_bf16 v[84:87], v[184:187], a[168:171], v[84:87]
    v_exp_f32 v109, v109
    v_mfma_f32_16x16x32_bf16 v[92:95], v[184:187], a[184:187], v[92:95]
    v_cvt_pk_bf16_f32 v150, v108, v109
    v_mfma_f32_16x16x32_bf16 v[68:71], v[188:191], a[140:143], v[68:71]
    v_exp_f32 v110, v110
    v_mfma_f32_16x16x32_bf16 v[76:79], v[188:191], a[156:159], v[76:79]
    v_mul_f32 v201, v201, v251
    v_mfma_f32_16x16x32_bf16 v[84:87], v[188:191], a[172:175], v[84:87]
    v_exp_f32 v111, v111
    v_mfma_f32_16x16x32_bf16 v[92:95], v[188:191], a[188:191], v[92:95]
    v_cvt_pk_bf16_f32 v151, v110, v111
    v_mul_f32 v202, v202, v251
    s_waitcnt vmcnt(12) lgkmcnt(0)
    s_barrier
    v_mfma_f32_16x16x32_bf16 a[224:227], a[240:243], v[128:131], a[224:227]
    v_exp_f32 v112, v112
    v_mfma_f32_16x16x32_bf16 a[228:231], a[240:243], v[132:135], a[228:231]
    s_add_u32 m0, s25, 49152
    ds_read_b128 v[160:163], v216 offset:8192
    v_mfma_f32_16x16x32_bf16 a[232:235], a[240:243], v[136:139], a[232:235]
    s_add_u32 s35, s21, 40960
    v_exp_f32 v113, v113
    v_mfma_f32_16x16x32_bf16 a[236:239], a[240:243], v[140:143], a[236:239]
    buffer_load_dwordx4 v234, s[12:15], s35 offen nt lds
    v_cvt_pk_bf16_f32 v152, v112, v113
    v_mfma_f32_16x16x32_bf16 v[0:3], a[192:195], v[128:131], v[0:3]
    v_exp_f32 v114, v114
    v_mfma_f32_16x16x32_bf16 v[4:7], a[192:195], v[132:135], v[4:7]
    ds_read_b128 v[164:167], v217 offset:8192
    v_mul_f32 v203, v203, v251
    v_mfma_f32_16x16x32_bf16 a[0:3], a[192:195], v[136:139], a[0:3]
    v_exp_f32 v115, v115
    v_mfma_f32_16x16x32_bf16 a[4:7], a[192:195], v[140:143], a[4:7]
    v_cvt_pk_bf16_f32 v153, v114, v115
    v_mfma_f32_16x16x32_bf16 v[8:11], a[196:199], v[128:131], v[8:11]
    v_exp_f32 v116, v116
    v_mfma_f32_16x16x32_bf16 v[12:15], a[196:199], v[132:135], v[12:15]
    ds_read_b128 v[168:171], v218 offset:8192
    v_mfma_f32_16x16x32_bf16 a[8:11], a[196:199], v[136:139], a[8:11]
    v_exp_f32 v117, v117
    v_mfma_f32_16x16x32_bf16 a[12:15], a[196:199], v[140:143], a[12:15]
    buffer_load_dwordx4 v235, s[12:15], s35 offen offset:1024 nt lds
    v_cvt_pk_bf16_f32 v154, v116, v117
    v_mfma_f32_16x16x32_bf16 v[16:19], a[200:203], v[128:131], v[16:19]
    v_exp_f32 v118, v118
    v_mfma_f32_16x16x32_bf16 v[20:23], a[200:203], v[132:135], v[20:23]
    ds_read_b128 v[172:175], v219 offset:8192
    v_cvt_pk_bf16_f32 v200, v200, v201
    v_mfma_f32_16x16x32_bf16 a[16:19], a[200:203], v[136:139], a[16:19]
    v_exp_f32 v119, v119
    v_mfma_f32_16x16x32_bf16 a[20:23], a[200:203], v[140:143], a[20:23]
    v_cvt_pk_bf16_f32 v155, v118, v119
    v_mfma_f32_16x16x32_bf16 v[24:27], a[204:207], v[128:131], v[24:27]
    v_exp_f32 v120, v120
    v_mfma_f32_16x16x32_bf16 v[28:31], a[204:207], v[132:135], v[28:31]
    s_add_u32 m0, s25, 106496
    ds_read_b128 v[176:179], v216 offset:12288
    v_cvt_pk_bf16_f32 v201, v202, v203
    v_mfma_f32_16x16x32_bf16 a[24:27], a[204:207], v[136:139], a[24:27]
    s_add_u32 s35, s21, 61440
    v_exp_f32 v121, v121
    v_mfma_f32_16x16x32_bf16 a[28:31], a[204:207], v[140:143], a[28:31]
    buffer_load_dwordx4 v232, s[8:11], s35 offen nt lds
    v_cvt_pk_bf16_f32 v156, v120, v121
    v_mfma_f32_16x16x32_bf16 v[32:35], a[208:211], v[128:131], v[32:35]
    v_exp_f32 v122, v122
    v_mfma_f32_16x16x32_bf16 v[36:39], a[208:211], v[132:135], v[36:39]
    ds_read_b128 v[180:183], v217 offset:12288
    ds_write_b64 v240, v[200:201] offset:12288
    v_mfma_f32_16x16x32_bf16 a[32:35], a[208:211], v[136:139], a[32:35]
    v_exp_f32 v123, v123
    v_mfma_f32_16x16x32_bf16 a[36:39], a[208:211], v[140:143], a[36:39]
    ds_read_b128 v[184:187], v218 offset:12288
    v_cvt_pk_bf16_f32 v157, v122, v123
    v_mfma_f32_16x16x32_bf16 v[40:43], a[212:215], v[128:131], v[40:43]
    v_exp_f32 v124, v124
    v_mfma_f32_16x16x32_bf16 v[44:47], a[212:215], v[132:135], v[44:47]
    ds_read_b128 v[188:191], v219 offset:12288
    v_mfma_f32_16x16x32_bf16 a[40:43], a[212:215], v[136:139], a[40:43]
    v_exp_f32 v125, v125
    v_mfma_f32_16x16x32_bf16 a[44:47], a[212:215], v[140:143], a[44:47]
    buffer_load_dwordx4 v233, s[8:11], s35 offen offset:1024 nt lds
    v_cvt_pk_bf16_f32 v158, v124, v125
    v_mfma_f32_16x16x32_bf16 v[48:51], a[216:219], v[128:131], v[48:51]
    v_exp_f32 v126, v126
    v_mfma_f32_16x16x32_bf16 v[52:55], a[216:219], v[132:135], v[52:55]
    v_mfma_f32_16x16x32_bf16 a[48:51], a[216:219], v[136:139], a[48:51]
    v_exp_f32 v127, v127
    v_mfma_f32_16x16x32_bf16 a[52:55], a[216:219], v[140:143], a[52:55]
    v_cvt_pk_bf16_f32 v159, v126, v127
    v_mfma_f32_16x16x32_bf16 v[56:59], a[220:223], v[128:131], v[56:59]
    v_mfma_f32_16x16x32_bf16 v[60:63], a[220:223], v[132:135], v[60:63]
    v_mfma_f32_16x16x32_bf16 a[56:59], a[220:223], v[136:139], a[56:59]
    v_mfma_f32_16x16x32_bf16 a[60:63], a[220:223], v[140:143], a[60:63]
    s_waitcnt lgkmcnt(0)
    v_pk_fma_f32 v[64:65], v[64:65], s[26:27], v[244:245] op_sel:[0,0,0] op_sel_hi:[1,0,0]
    v_pk_fma_f32 v[66:67], v[66:67], s[26:27], v[244:245] op_sel:[0,0,0] op_sel_hi:[1,0,0]
    v_pk_fma_f32 v[68:69], v[68:69], s[26:27], v[244:245] op_sel:[0,0,0] op_sel_hi:[1,0,0]
    v_pk_fma_f32 v[70:71], v[70:71], s[26:27], v[244:245] op_sel:[0,0,0] op_sel_hi:[1,0,0]
    v_pk_fma_f32 v[72:73], v[72:73], s[26:27], v[244:245] op_sel:[0,0,1] op_sel_hi:[1,0,1]
    v_pk_fma_f32 v[74:75], v[74:75], s[26:27], v[244:245] op_sel:[0,0,1] op_sel_hi:[1,0,1]
    v_pk_fma_f32 v[76:77], v[76:77], s[26:27], v[244:245] op_sel:[0,0,1] op_sel_hi:[1,0,1]
    v_pk_fma_f32 v[78:79], v[78:79], s[26:27], v[244:245] op_sel:[0,0,1] op_sel_hi:[1,0,1]
    v_pk_fma_f32 v[80:81], v[80:81], s[26:27], v[246:247] op_sel:[0,0,0] op_sel_hi:[1,0,0]
    v_pk_fma_f32 v[82:83], v[82:83], s[26:27], v[246:247] op_sel:[0,0,0] op_sel_hi:[1,0,0]
    v_pk_fma_f32 v[84:85], v[84:85], s[26:27], v[246:247] op_sel:[0,0,0] op_sel_hi:[1,0,0]
    v_pk_fma_f32 v[86:87], v[86:87], s[26:27], v[246:247] op_sel:[0,0,0] op_sel_hi:[1,0,0]
    v_pk_fma_f32 v[88:89], v[88:89], s[26:27], v[246:247] op_sel:[0,0,1] op_sel_hi:[1,0,1]
    v_pk_fma_f32 v[90:91], v[90:91], s[26:27], v[246:247] op_sel:[0,0,1] op_sel_hi:[1,0,1]
    v_pk_fma_f32 v[92:93], v[92:93], s[26:27], v[246:247] op_sel:[0,0,1] op_sel_hi:[1,0,1]
    v_pk_fma_f32 v[94:95], v[94:95], s[26:27], v[246:247] op_sel:[0,0,1] op_sel_hi:[1,0,1]
    s_nop 1
    v_mfma_f32_16x16x32_bf16 v[96:99], v[160:163], a[128:131], 0
    v_exp_f32 v64, v64
    v_mfma_f32_16x16x32_bf16 v[104:107], v[160:163], a[144:147], 0
    ds_read_b64_tr_b16 a[192:193], v224 offset:24576
    v_accvgpr_read_b32 v204, a76
    v_accvgpr_read_b32 v205, a77
    v_mfma_f32_16x16x32_bf16 v[112:115], v[160:163], a[160:163], 0
    ds_read_b64_tr_b16 a[194:195], v224 offset:28672
    v_exp_f32 v65, v65
    v_mfma_f32_16x16x32_bf16 v[120:123], v[160:163], a[176:179], 0
    s_add_u32 m0, s25, 0
    ds_read_b64_tr_b16 a[196:197], v225 offset:24576
    v_cvt_pk_bf16_f32 v128, v64, v65
    v_mfma_f32_16x16x32_bf16 v[96:99], v[164:167], a[132:135], v[96:99]
    s_add_u32 s35, s21, 49152
    v_exp_f32 v66, v66
    v_accvgpr_read_b32 v206, a78
    v_mfma_f32_16x16x32_bf16 v[104:107], v[164:167], a[148:151], v[104:107]
    ds_read_b64_tr_b16 a[198:199], v225 offset:28672
    buffer_load_dwordx4 v232, s[8:11], s35 offen nt lds
    v_mfma_f32_16x16x32_bf16 v[112:115], v[164:167], a[164:167], v[112:115]
    v_exp_f32 v67, v67
    v_mfma_f32_16x16x32_bf16 v[120:123], v[164:167], a[180:183], v[120:123]
    ds_read_b64_tr_b16 a[200:201], v226 offset:24576
    v_cvt_pk_bf16_f32 v129, v66, v67
    v_mfma_f32_16x16x32_bf16 v[96:99], v[168:171], a[136:139], v[96:99]
    ds_read_b64_tr_b16 a[202:203], v226 offset:28672
    v_exp_f32 v68, v68
    v_mfma_f32_16x16x32_bf16 v[104:107], v[168:171], a[152:155], v[104:107]
    ds_read_b64_tr_b16 a[204:205], v227 offset:24576
    v_accvgpr_read_b32 v207, a79
    v_mfma_f32_16x16x32_bf16 v[112:115], v[168:171], a[168:171], v[112:115]
    v_exp_f32 v69, v69
    v_mfma_f32_16x16x32_bf16 v[120:123], v[168:171], a[184:187], v[120:123]
    ds_read_b64_tr_b16 a[206:207], v227 offset:28672
    v_cvt_pk_bf16_f32 v130, v68, v69
    v_mfma_f32_16x16x32_bf16 v[96:99], v[172:175], a[140:143], v[96:99]
    v_exp_f32 v70, v70
    v_mfma_f32_16x16x32_bf16 v[104:107], v[172:175], a[156:159], v[104:107]
    ds_read_b64_tr_b16 a[208:209], v228 offset:24576
    v_mul_f32 v204, v204, v251
    v_mul_f32 v205, v205, v251
    v_mfma_f32_16x16x32_bf16 v[112:115], v[172:175], a[172:175], v[112:115]
    ds_read_b64_tr_b16 a[210:211], v228 offset:28672
    v_exp_f32 v71, v71
    v_mfma_f32_16x16x32_bf16 v[120:123], v[172:175], a[188:191], v[120:123]
    ds_read_b64_tr_b16 a[212:213], v229 offset:24576
    v_cvt_pk_bf16_f32 v131, v70, v71
    v_mfma_f32_16x16x32_bf16 v[100:103], v[176:179], a[128:131], 0
    v_exp_f32 v72, v72
    v_mfma_f32_16x16x32_bf16 v[108:111], v[176:179], a[144:147], 0
    ds_read_b64_tr_b16 a[214:215], v229 offset:28672
    v_mul_f32 v206, v206, v251
    v_mfma_f32_16x16x32_bf16 v[116:119], v[176:179], a[160:163], 0
    ds_read_b64_tr_b16 a[216:217], v230 offset:24576
    v_exp_f32 v73, v73
    v_mfma_f32_16x16x32_bf16 v[124:127], v[176:179], a[176:179], 0
    ds_read_b64_tr_b16 a[218:219], v230 offset:28672
    buffer_load_dwordx4 v233, s[8:11], s35 offen offset:1024 nt lds
    v_cvt_pk_bf16_f32 v132, v72, v73
    v_mfma_f32_16x16x32_bf16 v[100:103], v[180:183], a[132:135], v[100:103]
    v_exp_f32 v74, v74
    v_mfma_f32_16x16x32_bf16 v[108:111], v[180:183], a[148:151], v[108:111]
    ds_read_b64_tr_b16 a[220:221], v231 offset:24576
    v_mul_f32 v207, v207, v251
    v_cvt_pk_bf16_f32 v204, v204, v205
    v_mfma_f32_16x16x32_bf16 v[116:119], v[180:183], a[164:167], v[116:119]
    v_exp_f32 v75, v75
    v_mfma_f32_16x16x32_bf16 v[124:127], v[180:183], a[180:183], v[124:127]
    ds_read_b64_tr_b16 a[222:223], v231 offset:28672
    v_cvt_pk_bf16_f32 v133, v74, v75
    v_mfma_f32_16x16x32_bf16 v[100:103], v[184:187], a[136:139], v[100:103]
    ds_read_b128 v[192:195], v215 offset:6144
    v_exp_f32 v76, v76
    v_mfma_f32_16x16x32_bf16 v[108:111], v[184:187], a[152:155], v[108:111]
    ds_read_b128 v[196:199], v215 offset:7168
    v_cvt_pk_bf16_f32 v205, v206, v207
    v_mfma_f32_16x16x32_bf16 v[116:119], v[184:187], a[168:171], v[116:119]
    v_exp_f32 v77, v77
    v_mfma_f32_16x16x32_bf16 v[124:127], v[184:187], a[184:187], v[124:127]
    ds_write_b64 v241, v[204:205] offset:12288
    v_cvt_pk_bf16_f32 v134, v76, v77
    v_mfma_f32_16x16x32_bf16 v[100:103], v[188:191], a[140:143], v[100:103]
    v_exp_f32 v78, v78
    v_mfma_f32_16x16x32_bf16 v[108:111], v[188:191], a[156:159], v[108:111]
    v_accvgpr_read_b32 v200, a84
    v_mfma_f32_16x16x32_bf16 v[116:119], v[188:191], a[172:175], v[116:119]
    v_exp_f32 v79, v79
    v_mfma_f32_16x16x32_bf16 v[124:127], v[188:191], a[188:191], v[124:127]
    v_cvt_pk_bf16_f32 v135, v78, v79
    v_accvgpr_read_b32 v201, a85
    s_waitcnt vmcnt(12) lgkmcnt(0)
    s_barrier
    v_mfma_f32_16x16x32_bf16 a[224:227], a[240:243], v[144:147], a[224:227]
    v_exp_f32 v80, v80
    v_mfma_f32_16x16x32_bf16 a[228:231], a[240:243], v[148:151], a[228:231]
    ds_read_b128 v[160:163], v216 offset:16384
    v_mfma_f32_16x16x32_bf16 a[232:235], a[240:243], v[152:155], a[232:235]
    s_add_u32 s35, s24, 6144
    v_exp_f32 v81, v81
    v_mfma_f32_16x16x32_bf16 a[236:239], a[240:243], v[156:159], a[236:239]
    buffer_store_dwordx4 v[192:195], v236, s[16:19], s35 offen sc1
    v_cvt_pk_bf16_f32 v136, v80, v81
    v_mfma_f32_16x16x32_bf16 v[0:3], a[192:195], v[144:147], v[0:3]
    v_exp_f32 v82, v82
    v_mfma_f32_16x16x32_bf16 v[4:7], a[192:195], v[148:151], v[4:7]
    ds_read_b128 v[164:167], v217 offset:16384
    v_accvgpr_read_b32 v202, a86
    v_mfma_f32_16x16x32_bf16 a[0:3], a[192:195], v[152:155], a[0:3]
    v_exp_f32 v83, v83
    v_mfma_f32_16x16x32_bf16 a[4:7], a[192:195], v[156:159], a[4:7]
    v_cvt_pk_bf16_f32 v137, v82, v83
    v_accvgpr_read_b32 v203, a87
    v_mfma_f32_16x16x32_bf16 v[8:11], a[196:199], v[144:147], v[8:11]
    v_exp_f32 v84, v84
    v_mfma_f32_16x16x32_bf16 v[12:15], a[196:199], v[148:151], v[12:15]
    ds_read_b128 v[168:171], v218 offset:16384
    v_mul_f32 v200, v200, v251
    v_mfma_f32_16x16x32_bf16 a[8:11], a[196:199], v[152:155], a[8:11]
    v_exp_f32 v85, v85
    v_mfma_f32_16x16x32_bf16 a[12:15], a[196:199], v[156:159], a[12:15]
    buffer_store_dwordx4 v[196:199], v237, s[16:19], s35 offen offset:1024 sc1
    v_cvt_pk_bf16_f32 v138, v84, v85
    v_mfma_f32_16x16x32_bf16 v[16:19], a[200:203], v[144:147], v[16:19]
    v_exp_f32 v86, v86
    v_mfma_f32_16x16x32_bf16 v[20:23], a[200:203], v[148:151], v[20:23]
    ds_read_b128 v[172:175], v219 offset:16384
    v_mul_f32 v201, v201, v251
    v_mfma_f32_16x16x32_bf16 a[16:19], a[200:203], v[152:155], a[16:19]
    v_exp_f32 v87, v87
    v_mfma_f32_16x16x32_bf16 a[20:23], a[200:203], v[156:159], a[20:23]
    v_cvt_pk_bf16_f32 v139, v86, v87
    v_mul_f32 v202, v202, v251
    v_mfma_f32_16x16x32_bf16 v[24:27], a[204:207], v[144:147], v[24:27]
    v_exp_f32 v88, v88
    v_mfma_f32_16x16x32_bf16 v[28:31], a[204:207], v[148:151], v[28:31]
    s_add_u32 m0, s25, 57344
    ds_read_b128 v[176:179], v216 offset:20480
    v_mul_f32 v203, v203, v251
    v_mfma_f32_16x16x32_bf16 a[24:27], a[204:207], v[152:155], a[24:27]
    s_add_u32 s35, s21, 45056
    v_exp_f32 v89, v89
    v_mfma_f32_16x16x32_bf16 a[28:31], a[204:207], v[156:159], a[28:31]
    buffer_load_dwordx4 v234, s[12:15], s35 offen nt lds
    v_cvt_pk_bf16_f32 v140, v88, v89
    v_mfma_f32_16x16x32_bf16 v[32:35], a[208:211], v[144:147], v[32:35]
    v_exp_f32 v90, v90
    v_mfma_f32_16x16x32_bf16 v[36:39], a[208:211], v[148:151], v[36:39]
    ds_read_b128 v[180:183], v217 offset:20480
    v_cvt_pk_bf16_f32 v200, v200, v201
    v_mfma_f32_16x16x32_bf16 a[32:35], a[208:211], v[152:155], a[32:35]
    v_exp_f32 v91, v91
    v_mfma_f32_16x16x32_bf16 a[36:39], a[208:211], v[156:159], a[36:39]
    ds_read_b128 v[184:187], v218 offset:20480
    v_cvt_pk_bf16_f32 v141, v90, v91
    v_mfma_f32_16x16x32_bf16 v[40:43], a[212:215], v[144:147], v[40:43]
    v_exp_f32 v92, v92
    v_mfma_f32_16x16x32_bf16 v[44:47], a[212:215], v[148:151], v[44:47]
    ds_read_b128 v[188:191], v219 offset:20480
    v_cvt_pk_bf16_f32 v201, v202, v203
    v_mfma_f32_16x16x32_bf16 a[40:43], a[212:215], v[152:155], a[40:43]
    ds_write_b64 v242, v[200:201] offset:12288
    v_exp_f32 v93, v93
    v_mfma_f32_16x16x32_bf16 a[44:47], a[212:215], v[156:159], a[44:47]
    buffer_load_dwordx4 v235, s[12:15], s35 offen offset:1024 nt lds
    v_cvt_pk_bf16_f32 v142, v92, v93
    v_mfma_f32_16x16x32_bf16 v[48:51], a[216:219], v[144:147], v[48:51]
    v_exp_f32 v94, v94
    v_mfma_f32_16x16x32_bf16 v[52:55], a[216:219], v[148:151], v[52:55]
    v_mfma_f32_16x16x32_bf16 a[48:51], a[216:219], v[152:155], a[48:51]
    v_exp_f32 v95, v95
    v_mfma_f32_16x16x32_bf16 a[52:55], a[216:219], v[156:159], a[52:55]
    v_cvt_pk_bf16_f32 v143, v94, v95
    v_mfma_f32_16x16x32_bf16 v[56:59], a[220:223], v[144:147], v[56:59]
    v_mfma_f32_16x16x32_bf16 v[60:63], a[220:223], v[148:151], v[60:63]
    v_mfma_f32_16x16x32_bf16 a[56:59], a[220:223], v[152:155], a[56:59]
    v_mfma_f32_16x16x32_bf16 a[60:63], a[220:223], v[156:159], a[60:63]
    s_waitcnt lgkmcnt(0)
    v_pk_fma_f32 v[96:97], v[96:97], s[26:27], v[244:245] op_sel:[0,0,0] op_sel_hi:[1,0,0]
    v_pk_fma_f32 v[98:99], v[98:99], s[26:27], v[244:245] op_sel:[0,0,0] op_sel_hi:[1,0,0]
    v_pk_fma_f32 v[100:101], v[100:101], s[26:27], v[244:245] op_sel:[0,0,0] op_sel_hi:[1,0,0]
    v_pk_fma_f32 v[102:103], v[102:103], s[26:27], v[244:245] op_sel:[0,0,0] op_sel_hi:[1,0,0]
    v_pk_fma_f32 v[104:105], v[104:105], s[26:27], v[244:245] op_sel:[0,0,1] op_sel_hi:[1,0,1]
    v_pk_fma_f32 v[106:107], v[106:107], s[26:27], v[244:245] op_sel:[0,0,1] op_sel_hi:[1,0,1]
    v_pk_fma_f32 v[108:109], v[108:109], s[26:27], v[244:245] op_sel:[0,0,1] op_sel_hi:[1,0,1]
    v_pk_fma_f32 v[110:111], v[110:111], s[26:27], v[244:245] op_sel:[0,0,1] op_sel_hi:[1,0,1]
    v_pk_fma_f32 v[112:113], v[112:113], s[26:27], v[246:247] op_sel:[0,0,0] op_sel_hi:[1,0,0]
    v_pk_fma_f32 v[114:115], v[114:115], s[26:27], v[246:247] op_sel:[0,0,0] op_sel_hi:[1,0,0]
    v_pk_fma_f32 v[116:117], v[116:117], s[26:27], v[246:247] op_sel:[0,0,0] op_sel_hi:[1,0,0]
    v_pk_fma_f32 v[118:119], v[118:119], s[26:27], v[246:247] op_sel:[0,0,0] op_sel_hi:[1,0,0]
    v_pk_fma_f32 v[120:121], v[120:121], s[26:27], v[246:247] op_sel:[0,0,1] op_sel_hi:[1,0,1]
    v_pk_fma_f32 v[122:123], v[122:123], s[26:27], v[246:247] op_sel:[0,0,1] op_sel_hi:[1,0,1]
    v_pk_fma_f32 v[124:125], v[124:125], s[26:27], v[246:247] op_sel:[0,0,1] op_sel_hi:[1,0,1]
    v_pk_fma_f32 v[126:127], v[126:127], s[26:27], v[246:247] op_sel:[0,0,1] op_sel_hi:[1,0,1]
    s_nop 1
    v_mfma_f32_16x16x32_bf16 v[64:67], v[160:163], a[128:131], 0
    v_exp_f32 v96, v96
    v_mfma_f32_16x16x32_bf16 v[72:75], v[160:163], a[144:147], 0
    ds_read_b64_tr_b16 a[192:193], v224 offset:0
    v_accvgpr_read_b32 v204, a92
    v_mfma_f32_16x16x32_bf16 v[80:83], v[160:163], a[160:163], 0
    v_exp_f32 v97, v97
    v_mfma_f32_16x16x32_bf16 v[88:91], v[160:163], a[176:179], 0
    s_add_u32 m0, s25, 8192
    ds_read_b64_tr_b16 a[194:195], v224 offset:4096
    v_cvt_pk_bf16_f32 v144, v96, v97
    v_mfma_f32_16x16x32_bf16 v[64:67], v[164:167], a[132:135], v[64:67]
    s_add_u32 s35, s21, 53248
    ds_read_b64_tr_b16 a[196:197], v225 offset:0
    v_exp_f32 v98, v98
    v_mfma_f32_16x16x32_bf16 v[72:75], v[164:167], a[148:151], v[72:75]
    ds_read_b64_tr_b16 a[198:199], v225 offset:4096
    buffer_load_dwordx4 v232, s[8:11], s35 offen nt lds
    v_mfma_f32_16x16x32_bf16 v[80:83], v[164:167], a[164:167], v[80:83]
    v_exp_f32 v99, v99
    v_mfma_f32_16x16x32_bf16 v[88:91], v[164:167], a[180:183], v[88:91]
    ds_read_b64_tr_b16 a[200:201], v226 offset:0
    v_cvt_pk_bf16_f32 v145, v98, v99
    v_mfma_f32_16x16x32_bf16 v[64:67], v[168:171], a[136:139], v[64:67]
    v_exp_f32 v100, v100
    v_mfma_f32_16x16x32_bf16 v[72:75], v[168:171], a[152:155], v[72:75]
    ds_read_b64_tr_b16 a[202:203], v226 offset:4096
    v_accvgpr_read_b32 v205, a93
    v_mfma_f32_16x16x32_bf16 v[80:83], v[168:171], a[168:171], v[80:83]
    v_exp_f32 v101, v101
    v_mfma_f32_16x16x32_bf16 v[88:91], v[168:171], a[184:187], v[88:91]
    ds_read_b64_tr_b16 a[204:205], v227 offset:0
    v_cvt_pk_bf16_f32 v146, v100, v101
    v_mfma_f32_16x16x32_bf16 v[64:67], v[172:175], a[140:143], v[64:67]
    v_exp_f32 v102, v102
    v_mfma_f32_16x16x32_bf16 v[72:75], v[172:175], a[156:159], v[72:75]
    ds_read_b64_tr_b16 a[206:207], v227 offset:4096
    v_accvgpr_read_b32 v206, a94
    v_mfma_f32_16x16x32_bf16 v[80:83], v[172:175], a[172:175], v[80:83]
    ds_read_b64_tr_b16 a[208:209], v228 offset:0
    v_exp_f32 v103, v103
    v_mfma_f32_16x16x32_bf16 v[88:91], v[172:175], a[188:191], v[88:91]
    ds_read_b64_tr_b16 a[210:211], v228 offset:4096
    v_cvt_pk_bf16_f32 v147, v102, v103
    v_mfma_f32_16x16x32_bf16 v[68:71], v[176:179], a[128:131], 0
    v_exp_f32 v104, v104
    v_mfma_f32_16x16x32_bf16 v[76:79], v[176:179], a[144:147], 0
    ds_read_b64_tr_b16 a[212:213], v229 offset:0
    v_accvgpr_read_b32 v207, a95
    v_mfma_f32_16x16x32_bf16 v[84:87], v[176:179], a[160:163], 0
    buffer_load_dwordx4 v233, s[8:11], s35 offen offset:1024 nt lds
    v_exp_f32 v105, v105
    v_mfma_f32_16x16x32_bf16 v[92:95], v[176:179], a[176:179], 0
    ds_read_b64_tr_b16 a[214:215], v229 offset:4096
    v_cvt_pk_bf16_f32 v148, v104, v105
    v_mfma_f32_16x16x32_bf16 v[68:71], v[180:183], a[132:135], v[68:71]
    v_exp_f32 v106, v106
    v_mfma_f32_16x16x32_bf16 v[76:79], v[180:183], a[148:151], v[76:79]
    ds_read_b64_tr_b16 a[216:217], v230 offset:0
    v_mul_f32 v204, v204, v251
    v_mfma_f32_16x16x32_bf16 v[84:87], v[180:183], a[164:167], v[84:87]
    ds_read_b64_tr_b16 a[218:219], v230 offset:4096
    v_exp_f32 v107, v107
    v_mfma_f32_16x16x32_bf16 v[92:95], v[180:183], a[180:183], v[92:95]
    ds_read_b64_tr_b16 a[220:221], v231 offset:0
    v_cvt_pk_bf16_f32 v149, v106, v107
    v_mfma_f32_16x16x32_bf16 v[68:71], v[184:187], a[136:139], v[68:71]
    v_exp_f32 v108, v108
    v_mfma_f32_16x16x32_bf16 v[76:79], v[184:187], a[152:155], v[76:79]
    ds_read_b64_tr_b16 a[222:223], v231 offset:4096
    v_mfma_f32_16x16x32_bf16 v[84:87], v[184:187], a[168:171], v[84:87]
    v_exp_f32 v109, v109
    v_mfma_f32_16x16x32_bf16 v[92:95], v[184:187], a[184:187], v[92:95]
    v_cvt_pk_bf16_f32 v150, v108, v109
    v_mfma_f32_16x16x32_bf16 v[68:71], v[188:191], a[140:143], v[68:71]
    v_exp_f32 v110, v110
    v_mfma_f32_16x16x32_bf16 v[76:79], v[188:191], a[156:159], v[76:79]
    v_mul_f32 v205, v205, v251
    v_mfma_f32_16x16x32_bf16 v[84:87], v[188:191], a[172:175], v[84:87]
    v_exp_f32 v111, v111
    v_mfma_f32_16x16x32_bf16 v[92:95], v[188:191], a[188:191], v[92:95]
    v_cvt_pk_bf16_f32 v151, v110, v111
    v_mul_f32 v206, v206, v251
    s_waitcnt vmcnt(12) lgkmcnt(0)
    s_barrier
    v_mfma_f32_16x16x32_bf16 a[224:227], a[240:243], v[128:131], a[224:227]
    v_exp_f32 v112, v112
    v_mfma_f32_16x16x32_bf16 a[228:231], a[240:243], v[132:135], a[228:231]
    s_add_u32 m0, s25, 32768
    ds_read_b128 v[160:163], v216 offset:24576
    v_mfma_f32_16x16x32_bf16 a[232:235], a[240:243], v[136:139], a[232:235]
    s_add_u32 s35, s21, 49152
    v_exp_f32 v113, v113
    v_mfma_f32_16x16x32_bf16 a[236:239], a[240:243], v[140:143], a[236:239]
    buffer_load_dwordx4 v234, s[12:15], s35 offen nt lds
    v_cvt_pk_bf16_f32 v152, v112, v113
    v_mfma_f32_16x16x32_bf16 v[0:3], a[192:195], v[128:131], v[0:3]
    v_exp_f32 v114, v114
    v_mfma_f32_16x16x32_bf16 v[4:7], a[192:195], v[132:135], v[4:7]
    ds_read_b128 v[164:167], v217 offset:24576
    v_mul_f32 v207, v207, v251
    v_mfma_f32_16x16x32_bf16 a[0:3], a[192:195], v[136:139], a[0:3]
    v_exp_f32 v115, v115
    v_mfma_f32_16x16x32_bf16 a[4:7], a[192:195], v[140:143], a[4:7]
    v_cvt_pk_bf16_f32 v153, v114, v115
    v_mfma_f32_16x16x32_bf16 v[8:11], a[196:199], v[128:131], v[8:11]
    v_exp_f32 v116, v116
    v_mfma_f32_16x16x32_bf16 v[12:15], a[196:199], v[132:135], v[12:15]
    ds_read_b128 v[168:171], v218 offset:24576
    v_mfma_f32_16x16x32_bf16 a[8:11], a[196:199], v[136:139], a[8:11]
    v_exp_f32 v117, v117
    v_mfma_f32_16x16x32_bf16 a[12:15], a[196:199], v[140:143], a[12:15]
    buffer_load_dwordx4 v235, s[12:15], s35 offen offset:1024 nt lds
    v_cvt_pk_bf16_f32 v154, v116, v117
    v_mfma_f32_16x16x32_bf16 v[16:19], a[200:203], v[128:131], v[16:19]
    v_exp_f32 v118, v118
    v_mfma_f32_16x16x32_bf16 v[20:23], a[200:203], v[132:135], v[20:23]
    ds_read_b128 v[172:175], v219 offset:24576
    v_cvt_pk_bf16_f32 v204, v204, v205
    v_mfma_f32_16x16x32_bf16 a[16:19], a[200:203], v[136:139], a[16:19]
    v_exp_f32 v119, v119
    v_mfma_f32_16x16x32_bf16 a[20:23], a[200:203], v[140:143], a[20:23]
    v_cvt_pk_bf16_f32 v155, v118, v119
    v_mfma_f32_16x16x32_bf16 v[24:27], a[204:207], v[128:131], v[24:27]
    v_exp_f32 v120, v120
    v_mfma_f32_16x16x32_bf16 v[28:31], a[204:207], v[132:135], v[28:31]
    s_add_u32 m0, s25, 131072
    ds_read_b128 v[176:179], v216 offset:28672
    v_cvt_pk_bf16_f32 v205, v206, v207
    v_mfma_f32_16x16x32_bf16 a[24:27], a[204:207], v[136:139], a[24:27]
    s_add_u32 s35, s21, 57344
    v_exp_f32 v121, v121
    v_mfma_f32_16x16x32_bf16 a[28:31], a[204:207], v[140:143], a[28:31]
    buffer_load_dwordx4 v234, s[12:15], s35 offen nt lds
    v_cvt_pk_bf16_f32 v156, v120, v121
    v_mfma_f32_16x16x32_bf16 v[32:35], a[208:211], v[128:131], v[32:35]
    v_exp_f32 v122, v122
    v_mfma_f32_16x16x32_bf16 v[36:39], a[208:211], v[132:135], v[36:39]
    ds_read_b128 v[180:183], v217 offset:28672
    ds_write_b64 v243, v[204:205] offset:12288
    v_mfma_f32_16x16x32_bf16 a[32:35], a[208:211], v[136:139], a[32:35]
    v_exp_f32 v123, v123
    v_mfma_f32_16x16x32_bf16 a[36:39], a[208:211], v[140:143], a[36:39]
    ds_read_b128 v[184:187], v218 offset:28672
    v_cvt_pk_bf16_f32 v157, v122, v123
    v_mfma_f32_16x16x32_bf16 v[40:43], a[212:215], v[128:131], v[40:43]
    v_exp_f32 v124, v124
    v_mfma_f32_16x16x32_bf16 v[44:47], a[212:215], v[132:135], v[44:47]
    ds_read_b128 v[188:191], v219 offset:28672
    v_mfma_f32_16x16x32_bf16 a[40:43], a[212:215], v[136:139], a[40:43]
    v_exp_f32 v125, v125
    v_mfma_f32_16x16x32_bf16 a[44:47], a[212:215], v[140:143], a[44:47]
    buffer_load_dwordx4 v235, s[12:15], s35 offen offset:1024 nt lds
    v_cvt_pk_bf16_f32 v158, v124, v125
    v_mfma_f32_16x16x32_bf16 v[48:51], a[216:219], v[128:131], v[48:51]
    v_exp_f32 v126, v126
    v_mfma_f32_16x16x32_bf16 v[52:55], a[216:219], v[132:135], v[52:55]
    v_mfma_f32_16x16x32_bf16 a[48:51], a[216:219], v[136:139], a[48:51]
    v_exp_f32 v127, v127
    v_mfma_f32_16x16x32_bf16 a[52:55], a[216:219], v[140:143], a[52:55]
    v_cvt_pk_bf16_f32 v159, v126, v127
    v_mfma_f32_16x16x32_bf16 v[56:59], a[220:223], v[128:131], v[56:59]
    v_mfma_f32_16x16x32_bf16 v[60:63], a[220:223], v[132:135], v[60:63]
    v_mfma_f32_16x16x32_bf16 a[56:59], a[220:223], v[136:139], a[56:59]
    v_mfma_f32_16x16x32_bf16 a[60:63], a[220:223], v[140:143], a[60:63]
    s_waitcnt lgkmcnt(0)
    v_pk_fma_f32 v[64:65], v[64:65], s[26:27], v[244:245] op_sel:[0,0,0] op_sel_hi:[1,0,0]
    v_pk_fma_f32 v[66:67], v[66:67], s[26:27], v[244:245] op_sel:[0,0,0] op_sel_hi:[1,0,0]
    v_pk_fma_f32 v[68:69], v[68:69], s[26:27], v[244:245] op_sel:[0,0,0] op_sel_hi:[1,0,0]
    v_pk_fma_f32 v[70:71], v[70:71], s[26:27], v[244:245] op_sel:[0,0,0] op_sel_hi:[1,0,0]
    v_pk_fma_f32 v[72:73], v[72:73], s[26:27], v[244:245] op_sel:[0,0,1] op_sel_hi:[1,0,1]
    v_pk_fma_f32 v[74:75], v[74:75], s[26:27], v[244:245] op_sel:[0,0,1] op_sel_hi:[1,0,1]
    v_pk_fma_f32 v[76:77], v[76:77], s[26:27], v[244:245] op_sel:[0,0,1] op_sel_hi:[1,0,1]
    v_pk_fma_f32 v[78:79], v[78:79], s[26:27], v[244:245] op_sel:[0,0,1] op_sel_hi:[1,0,1]
    v_pk_fma_f32 v[80:81], v[80:81], s[26:27], v[246:247] op_sel:[0,0,0] op_sel_hi:[1,0,0]
    v_pk_fma_f32 v[82:83], v[82:83], s[26:27], v[246:247] op_sel:[0,0,0] op_sel_hi:[1,0,0]
    v_pk_fma_f32 v[84:85], v[84:85], s[26:27], v[246:247] op_sel:[0,0,0] op_sel_hi:[1,0,0]
    v_pk_fma_f32 v[86:87], v[86:87], s[26:27], v[246:247] op_sel:[0,0,0] op_sel_hi:[1,0,0]
    v_pk_fma_f32 v[88:89], v[88:89], s[26:27], v[246:247] op_sel:[0,0,1] op_sel_hi:[1,0,1]
    v_pk_fma_f32 v[90:91], v[90:91], s[26:27], v[246:247] op_sel:[0,0,1] op_sel_hi:[1,0,1]
    v_pk_fma_f32 v[92:93], v[92:93], s[26:27], v[246:247] op_sel:[0,0,1] op_sel_hi:[1,0,1]
    v_pk_fma_f32 v[94:95], v[94:95], s[26:27], v[246:247] op_sel:[0,0,1] op_sel_hi:[1,0,1]
    s_nop 1
    v_mfma_f32_16x16x32_bf16 v[96:99], v[160:163], a[128:131], 0
    v_exp_f32 v64, v64
    v_mfma_f32_16x16x32_bf16 v[104:107], v[160:163], a[144:147], 0
    ds_read_b64_tr_b16 a[192:193], v224 offset:8192
    v_accvgpr_read_b32 v200, a100
    v_mfma_f32_16x16x32_bf16 v[112:115], v[160:163], a[160:163], 0
    v_exp_f32 v65, v65
    v_mfma_f32_16x16x32_bf16 v[120:123], v[160:163], a[176:179], 0
    ds_read_b64_tr_b16 a[194:195], v224 offset:12288
    v_cvt_pk_bf16_f32 v128, v64, v65
    v_mfma_f32_16x16x32_bf16 v[96:99], v[164:167], a[132:135], v[96:99]
    ds_read_b64_tr_b16 a[196:197], v225 offset:8192
    v_exp_f32 v66, v66
    v_mfma_f32_16x16x32_bf16 v[104:107], v[164:167], a[148:151], v[104:107]
    ds_read_b64_tr_b16 a[198:199], v225 offset:12288
    v_accvgpr_read_b32 v201, a101
    v_accvgpr_read_b32 v202, a102
    v_mfma_f32_16x16x32_bf16 v[112:115], v[164:167], a[164:167], v[112:115]
    v_exp_f32 v67, v67
    v_mfma_f32_16x16x32_bf16 v[120:123], v[164:167], a[180:183], v[120:123]
    ds_read_b64_tr_b16 a[200:201], v226 offset:8192
    v_cvt_pk_bf16_f32 v129, v66, v67
    v_mfma_f32_16x16x32_bf16 v[96:99], v[168:171], a[136:139], v[96:99]
    v_exp_f32 v68, v68
    v_mfma_f32_16x16x32_bf16 v[104:107], v[168:171], a[152:155], v[104:107]
    ds_read_b64_tr_b16 a[202:203], v226 offset:12288
    v_accvgpr_read_b32 v203, a103
    v_mfma_f32_16x16x32_bf16 v[112:115], v[168:171], a[168:171], v[112:115]
    v_exp_f32 v69, v69
    v_mfma_f32_16x16x32_bf16 v[120:123], v[168:171], a[184:187], v[120:123]
    ds_read_b64_tr_b16 a[204:205], v227 offset:8192
    v_cvt_pk_bf16_f32 v130, v68, v69
    v_mfma_f32_16x16x32_bf16 v[96:99], v[172:175], a[140:143], v[96:99]
    v_exp_f32 v70, v70
    v_mfma_f32_16x16x32_bf16 v[104:107], v[172:175], a[156:159], v[104:107]
    ds_read_b64_tr_b16 a[206:207], v227 offset:12288
    v_mul_f32 v200, v200, v251
    v_mul_f32 v201, v201, v251
    v_mfma_f32_16x16x32_bf16 v[112:115], v[172:175], a[172:175], v[112:115]
    ds_read_b64_tr_b16 a[208:209], v228 offset:8192
    v_exp_f32 v71, v71
    v_mfma_f32_16x16x32_bf16 v[120:123], v[172:175], a[188:191], v[120:123]
    ds_read_b64_tr_b16 a[210:211], v228 offset:12288
    v_cvt_pk_bf16_f32 v131, v70, v71
    v_mfma_f32_16x16x32_bf16 v[100:103], v[176:179], a[128:131], 0
    v_exp_f32 v72, v72
    v_mfma_f32_16x16x32_bf16 v[108:111], v[176:179], a[144:147], 0
    ds_read_b64_tr_b16 a[212:213], v229 offset:8192
    v_mul_f32 v202, v202, v251
    v_mfma_f32_16x16x32_bf16 v[116:119], v[176:179], a[160:163], 0
    v_exp_f32 v73, v73
    v_mfma_f32_16x16x32_bf16 v[124:127], v[176:179], a[176:179], 0
    ds_read_b64_tr_b16 a[214:215], v229 offset:12288
    v_cvt_pk_bf16_f32 v132, v72, v73
    v_mfma_f32_16x16x32_bf16 v[100:103], v[180:183], a[132:135], v[100:103]
    v_exp_f32 v74, v74
    v_mfma_f32_16x16x32_bf16 v[108:111], v[180:183], a[148:151], v[108:111]
    ds_read_b64_tr_b16 a[216:217], v230 offset:8192
    v_mul_f32 v203, v203, v251
    v_cvt_pk_bf16_f32 v200, v200, v201
    v_mfma_f32_16x16x32_bf16 v[116:119], v[180:183], a[164:167], v[116:119]
    ds_read_b64_tr_b16 a[218:219], v230 offset:12288
    v_exp_f32 v75, v75
    v_mfma_f32_16x16x32_bf16 v[124:127], v[180:183], a[180:183], v[124:127]
    ds_read_b64_tr_b16 a[220:221], v231 offset:8192
    v_cvt_pk_bf16_f32 v133, v74, v75
    v_mfma_f32_16x16x32_bf16 v[100:103], v[184:187], a[136:139], v[100:103]
    v_exp_f32 v76, v76
    v_mfma_f32_16x16x32_bf16 v[108:111], v[184:187], a[152:155], v[108:111]
    ds_read_b64_tr_b16 a[222:223], v231 offset:12288
    v_cvt_pk_bf16_f32 v201, v202, v203
    v_mfma_f32_16x16x32_bf16 v[116:119], v[184:187], a[168:171], v[116:119]
    v_exp_f32 v77, v77
    v_mfma_f32_16x16x32_bf16 v[124:127], v[184:187], a[184:187], v[124:127]
    ds_write_b64 v240, v[200:201] offset:12416
    v_cvt_pk_bf16_f32 v134, v76, v77
    v_mfma_f32_16x16x32_bf16 v[100:103], v[188:191], a[140:143], v[100:103]
    v_exp_f32 v78, v78
    v_mfma_f32_16x16x32_bf16 v[108:111], v[188:191], a[156:159], v[108:111]
    v_accvgpr_read_b32 v204, a108
    v_mfma_f32_16x16x32_bf16 v[116:119], v[188:191], a[172:175], v[116:119]
    v_exp_f32 v79, v79
    v_mfma_f32_16x16x32_bf16 v[124:127], v[188:191], a[188:191], v[124:127]
    v_cvt_pk_bf16_f32 v135, v78, v79
    v_accvgpr_read_b32 v205, a109
    s_waitcnt vmcnt(10) lgkmcnt(0)
    s_barrier
    v_mfma_f32_16x16x32_bf16 a[224:227], a[240:243], v[144:147], a[224:227]
    v_exp_f32 v80, v80
    v_mfma_f32_16x16x32_bf16 a[228:231], a[240:243], v[148:151], a[228:231]
    s_add_u32 m0, s25, 40960
    ds_read_b128 v[160:163], v216 offset:0
    v_mfma_f32_16x16x32_bf16 a[232:235], a[240:243], v[152:155], a[232:235]
    s_add_u32 s35, s21, 53248
    v_exp_f32 v81, v81
    v_mfma_f32_16x16x32_bf16 a[236:239], a[240:243], v[156:159], a[236:239]
    buffer_load_dwordx4 v234, s[12:15], s35 offen nt lds
    v_cvt_pk_bf16_f32 v136, v80, v81
    v_mfma_f32_16x16x32_bf16 v[0:3], a[192:195], v[144:147], v[0:3]
    v_exp_f32 v82, v82
    v_mfma_f32_16x16x32_bf16 v[4:7], a[192:195], v[148:151], v[4:7]
    ds_read_b128 v[164:167], v217 offset:0
    v_accvgpr_read_b32 v206, a110
    v_mfma_f32_16x16x32_bf16 a[0:3], a[192:195], v[152:155], a[0:3]
    v_exp_f32 v83, v83
    v_mfma_f32_16x16x32_bf16 a[4:7], a[192:195], v[156:159], a[4:7]
    v_cvt_pk_bf16_f32 v137, v82, v83
    v_accvgpr_read_b32 v207, a111
    v_mfma_f32_16x16x32_bf16 v[8:11], a[196:199], v[144:147], v[8:11]
    v_exp_f32 v84, v84
    v_mfma_f32_16x16x32_bf16 v[12:15], a[196:199], v[148:151], v[12:15]
    ds_read_b128 v[168:171], v218 offset:0
    v_mul_f32 v204, v204, v251
    v_mfma_f32_16x16x32_bf16 a[8:11], a[196:199], v[152:155], a[8:11]
    v_exp_f32 v85, v85
    v_mfma_f32_16x16x32_bf16 a[12:15], a[196:199], v[156:159], a[12:15]
    buffer_load_dwordx4 v235, s[12:15], s35 offen offset:1024 nt lds
    v_cvt_pk_bf16_f32 v138, v84, v85
    v_mfma_f32_16x16x32_bf16 v[16:19], a[200:203], v[144:147], v[16:19]
    v_exp_f32 v86, v86
    v_mfma_f32_16x16x32_bf16 v[20:23], a[200:203], v[148:151], v[20:23]
    ds_read_b128 v[172:175], v219 offset:0
    v_mul_f32 v205, v205, v251
    v_mfma_f32_16x16x32_bf16 a[16:19], a[200:203], v[152:155], a[16:19]
    v_exp_f32 v87, v87
    v_mfma_f32_16x16x32_bf16 a[20:23], a[200:203], v[156:159], a[20:23]
    v_cvt_pk_bf16_f32 v139, v86, v87
    v_mul_f32 v206, v206, v251
    v_mfma_f32_16x16x32_bf16 v[24:27], a[204:207], v[144:147], v[24:27]
    v_exp_f32 v88, v88
    v_mfma_f32_16x16x32_bf16 v[28:31], a[204:207], v[148:151], v[28:31]
    s_add_u32 m0, s25, 155648
    ds_read_b128 v[176:179], v216 offset:4096
    v_mul_f32 v207, v207, v251
    v_mfma_f32_16x16x32_bf16 a[24:27], a[204:207], v[152:155], a[24:27]
    s_add_u32 s35, s21, 61440
    v_exp_f32 v89, v89
    v_mfma_f32_16x16x32_bf16 a[28:31], a[204:207], v[156:159], a[28:31]
    buffer_load_dwordx4 v234, s[12:15], s35 offen nt lds
    v_cvt_pk_bf16_f32 v140, v88, v89
    v_mfma_f32_16x16x32_bf16 v[32:35], a[208:211], v[144:147], v[32:35]
    v_exp_f32 v90, v90
    v_mfma_f32_16x16x32_bf16 v[36:39], a[208:211], v[148:151], v[36:39]
    ds_read_b128 v[180:183], v217 offset:4096
    v_cvt_pk_bf16_f32 v204, v204, v205
    v_mfma_f32_16x16x32_bf16 a[32:35], a[208:211], v[152:155], a[32:35]
    v_exp_f32 v91, v91
    v_mfma_f32_16x16x32_bf16 a[36:39], a[208:211], v[156:159], a[36:39]
    ds_read_b128 v[184:187], v218 offset:4096
    v_cvt_pk_bf16_f32 v141, v90, v91
    v_mfma_f32_16x16x32_bf16 v[40:43], a[212:215], v[144:147], v[40:43]
    v_exp_f32 v92, v92
    v_mfma_f32_16x16x32_bf16 v[44:47], a[212:215], v[148:151], v[44:47]
    ds_read_b128 v[188:191], v219 offset:4096
    v_cvt_pk_bf16_f32 v205, v206, v207
    v_mfma_f32_16x16x32_bf16 a[40:43], a[212:215], v[152:155], a[40:43]
    ds_write_b64 v241, v[204:205] offset:12416
    v_exp_f32 v93, v93
    v_mfma_f32_16x16x32_bf16 a[44:47], a[212:215], v[156:159], a[44:47]
    buffer_load_dwordx4 v235, s[12:15], s35 offen offset:1024 nt lds
    v_cvt_pk_bf16_f32 v142, v92, v93
    v_mfma_f32_16x16x32_bf16 v[48:51], a[216:219], v[144:147], v[48:51]
    v_exp_f32 v94, v94
    v_mfma_f32_16x16x32_bf16 v[52:55], a[216:219], v[148:151], v[52:55]
    v_mfma_f32_16x16x32_bf16 a[48:51], a[216:219], v[152:155], a[48:51]
    v_exp_f32 v95, v95
    v_mfma_f32_16x16x32_bf16 a[52:55], a[216:219], v[156:159], a[52:55]
    v_cvt_pk_bf16_f32 v143, v94, v95
    v_mfma_f32_16x16x32_bf16 v[56:59], a[220:223], v[144:147], v[56:59]
    v_mfma_f32_16x16x32_bf16 v[60:63], a[220:223], v[148:151], v[60:63]
    v_mfma_f32_16x16x32_bf16 a[56:59], a[220:223], v[152:155], a[56:59]
    v_mfma_f32_16x16x32_bf16 a[60:63], a[220:223], v[156:159], a[60:63]
    s_waitcnt lgkmcnt(0)
    v_pk_fma_f32 v[96:97], v[96:97], s[26:27], v[244:245] op_sel:[0,0,0] op_sel_hi:[1,0,0]
    v_pk_fma_f32 v[98:99], v[98:99], s[26:27], v[244:245] op_sel:[0,0,0] op_sel_hi:[1,0,0]
    v_pk_fma_f32 v[100:101], v[100:101], s[26:27], v[244:245] op_sel:[0,0,0] op_sel_hi:[1,0,0]
    v_pk_fma_f32 v[102:103], v[102:103], s[26:27], v[244:245] op_sel:[0,0,0] op_sel_hi:[1,0,0]
    v_pk_fma_f32 v[104:105], v[104:105], s[26:27], v[244:245] op_sel:[0,0,1] op_sel_hi:[1,0,1]
    v_pk_fma_f32 v[106:107], v[106:107], s[26:27], v[244:245] op_sel:[0,0,1] op_sel_hi:[1,0,1]
    v_pk_fma_f32 v[108:109], v[108:109], s[26:27], v[244:245] op_sel:[0,0,1] op_sel_hi:[1,0,1]
    v_pk_fma_f32 v[110:111], v[110:111], s[26:27], v[244:245] op_sel:[0,0,1] op_sel_hi:[1,0,1]
    v_pk_fma_f32 v[112:113], v[112:113], s[26:27], v[246:247] op_sel:[0,0,0] op_sel_hi:[1,0,0]
    v_pk_fma_f32 v[114:115], v[114:115], s[26:27], v[246:247] op_sel:[0,0,0] op_sel_hi:[1,0,0]
    v_pk_fma_f32 v[116:117], v[116:117], s[26:27], v[246:247] op_sel:[0,0,0] op_sel_hi:[1,0,0]
    v_pk_fma_f32 v[118:119], v[118:119], s[26:27], v[246:247] op_sel:[0,0,0] op_sel_hi:[1,0,0]
    v_pk_fma_f32 v[120:121], v[120:121], s[26:27], v[246:247] op_sel:[0,0,1] op_sel_hi:[1,0,1]
    v_pk_fma_f32 v[122:123], v[122:123], s[26:27], v[246:247] op_sel:[0,0,1] op_sel_hi:[1,0,1]
    v_pk_fma_f32 v[124:125], v[124:125], s[26:27], v[246:247] op_sel:[0,0,1] op_sel_hi:[1,0,1]
    v_pk_fma_f32 v[126:127], v[126:127], s[26:27], v[246:247] op_sel:[0,0,1] op_sel_hi:[1,0,1]
    s_nop 1
    v_mfma_f32_16x16x32_bf16 v[64:67], v[160:163], a[128:131], 0
    v_exp_f32 v96, v96
    v_mfma_f32_16x16x32_bf16 v[72:75], v[160:163], a[144:147], 0
    ds_read_b64_tr_b16 a[192:193], v224 offset:16384
    v_accvgpr_read_b32 v200, a116
    v_mfma_f32_16x16x32_bf16 v[80:83], v[160:163], a[160:163], 0
    ds_read_b64_tr_b16 a[194:195], v224 offset:20480
    v_exp_f32 v97, v97
    v_mfma_f32_16x16x32_bf16 v[88:91], v[160:163], a[176:179], 0
    ds_read_b64_tr_b16 a[196:197], v225 offset:16384
    v_cvt_pk_bf16_f32 v144, v96, v97
    v_mfma_f32_16x16x32_bf16 v[64:67], v[164:167], a[132:135], v[64:67]
    v_exp_f32 v98, v98
    v_mfma_f32_16x16x32_bf16 v[72:75], v[164:167], a[148:151], v[72:75]
    ds_read_b64_tr_b16 a[198:199], v225 offset:20480
    v_accvgpr_read_b32 v201, a117
    v_mfma_f32_16x16x32_bf16 v[80:83], v[164:167], a[164:167], v[80:83]
    v_exp_f32 v99, v99
    v_mfma_f32_16x16x32_bf16 v[88:91], v[164:167], a[180:183], v[88:91]
    ds_read_b64_tr_b16 a[200:201], v226 offset:16384
    v_cvt_pk_bf16_f32 v145, v98, v99
    v_mfma_f32_16x16x32_bf16 v[64:67], v[168:171], a[136:139], v[64:67]
    ds_read_b64_tr_b16 a[202:203], v226 offset:20480
    v_exp_f32 v100, v100
    v_mfma_f32_16x16x32_bf16 v[72:75], v[168:171], a[152:155], v[72:75]
    ds_read_b64_tr_b16 a[204:205], v227 offset:16384
    v_accvgpr_read_b32 v202, a118
    v_mfma_f32_16x16x32_bf16 v[80:83], v[168:171], a[168:171], v[80:83]
    v_exp_f32 v101, v101
    v_mfma_f32_16x16x32_bf16 v[88:91], v[168:171], a[184:187], v[88:91]
    ds_read_b64_tr_b16 a[206:207], v227 offset:20480
    v_cvt_pk_bf16_f32 v146, v100, v101
    v_mfma_f32_16x16x32_bf16 v[64:67], v[172:175], a[140:143], v[64:67]
    v_exp_f32 v102, v102
    v_mfma_f32_16x16x32_bf16 v[72:75], v[172:175], a[156:159], v[72:75]
    ds_read_b64_tr_b16 a[208:209], v228 offset:16384
    v_mfma_f32_16x16x32_bf16 v[80:83], v[172:175], a[172:175], v[80:83]
    ds_read_b64_tr_b16 a[210:211], v228 offset:20480
    v_exp_f32 v103, v103
    v_mfma_f32_16x16x32_bf16 v[88:91], v[172:175], a[188:191], v[88:91]
    ds_read_b64_tr_b16 a[212:213], v229 offset:16384
    v_cvt_pk_bf16_f32 v147, v102, v103
    v_mfma_f32_16x16x32_bf16 v[68:71], v[176:179], a[128:131], 0
    v_exp_f32 v104, v104
    v_mfma_f32_16x16x32_bf16 v[76:79], v[176:179], a[144:147], 0
    ds_read_b64_tr_b16 a[214:215], v229 offset:20480
    v_accvgpr_read_b32 v203, a119
    v_mfma_f32_16x16x32_bf16 v[84:87], v[176:179], a[160:163], 0
    ds_read_b64_tr_b16 a[216:217], v230 offset:16384
    v_exp_f32 v105, v105
    v_mfma_f32_16x16x32_bf16 v[92:95], v[176:179], a[176:179], 0
    ds_read_b64_tr_b16 a[218:219], v230 offset:20480
    v_cvt_pk_bf16_f32 v148, v104, v105
    v_mfma_f32_16x16x32_bf16 v[68:71], v[180:183], a[132:135], v[68:71]
    v_exp_f32 v106, v106
    v_mfma_f32_16x16x32_bf16 v[76:79], v[180:183], a[148:151], v[76:79]
    ds_read_b64_tr_b16 a[220:221], v231 offset:16384
    v_mul_f32 v200, v200, v251
    v_mfma_f32_16x16x32_bf16 v[84:87], v[180:183], a[164:167], v[84:87]
    v_exp_f32 v107, v107
    v_mfma_f32_16x16x32_bf16 v[92:95], v[180:183], a[180:183], v[92:95]
    ds_read_b64_tr_b16 a[222:223], v231 offset:20480
    v_cvt_pk_bf16_f32 v149, v106, v107
    v_mfma_f32_16x16x32_bf16 v[68:71], v[184:187], a[136:139], v[68:71]
    ds_read_b128 v[192:195], v215 offset:8192
    v_exp_f32 v108, v108
    v_mfma_f32_16x16x32_bf16 v[76:79], v[184:187], a[152:155], v[76:79]
    ds_read_b128 v[196:199], v215 offset:9216
    v_mfma_f32_16x16x32_bf16 v[84:87], v[184:187], a[168:171], v[84:87]
    v_exp_f32 v109, v109
    v_mfma_f32_16x16x32_bf16 v[92:95], v[184:187], a[184:187], v[92:95]
    v_cvt_pk_bf16_f32 v150, v108, v109
    v_mfma_f32_16x16x32_bf16 v[68:71], v[188:191], a[140:143], v[68:71]
    v_exp_f32 v110, v110
    v_mfma_f32_16x16x32_bf16 v[76:79], v[188:191], a[156:159], v[76:79]
    v_mul_f32 v201, v201, v251
    v_mfma_f32_16x16x32_bf16 v[84:87], v[188:191], a[172:175], v[84:87]
    v_exp_f32 v111, v111
    v_mfma_f32_16x16x32_bf16 v[92:95], v[188:191], a[188:191], v[92:95]
    v_cvt_pk_bf16_f32 v151, v110, v111
    v_mul_f32 v202, v202, v251
    s_waitcnt vmcnt(8) lgkmcnt(0)
    s_barrier
    v_mfma_f32_16x16x32_bf16 a[224:227], a[240:243], v[128:131], a[224:227]
    v_exp_f32 v112, v112
    v_mfma_f32_16x16x32_bf16 a[228:231], a[240:243], v[132:135], a[228:231]
    ds_read_b128 v[160:163], v216 offset:8192
    v_mfma_f32_16x16x32_bf16 a[232:235], a[240:243], v[136:139], a[232:235]
    s_add_u32 s35, s24, 16384
    v_exp_f32 v113, v113
    v_mfma_f32_16x16x32_bf16 a[236:239], a[240:243], v[140:143], a[236:239]
    buffer_store_dwordx4 v[192:195], v236, s[16:19], s35 offen sc1
    v_cvt_pk_bf16_f32 v152, v112, v113
    v_mfma_f32_16x16x32_bf16 v[0:3], a[192:195], v[128:131], v[0:3]
    v_exp_f32 v114, v114
    v_mfma_f32_16x16x32_bf16 v[4:7], a[192:195], v[132:135], v[4:7]
    ds_read_b128 v[164:167], v217 offset:8192
    v_mul_f32 v203, v203, v251
    v_mfma_f32_16x16x32_bf16 a[0:3], a[192:195], v[136:139], a[0:3]
    v_exp_f32 v115, v115
    v_mfma_f32_16x16x32_bf16 a[4:7], a[192:195], v[140:143], a[4:7]
    v_cvt_pk_bf16_f32 v153, v114, v115
    v_mfma_f32_16x16x32_bf16 v[8:11], a[196:199], v[128:131], v[8:11]
    v_exp_f32 v116, v116
    v_mfma_f32_16x16x32_bf16 v[12:15], a[196:199], v[132:135], v[12:15]
    ds_read_b128 v[168:171], v218 offset:8192
    v_mfma_f32_16x16x32_bf16 a[8:11], a[196:199], v[136:139], a[8:11]
    v_exp_f32 v117, v117
    v_mfma_f32_16x16x32_bf16 a[12:15], a[196:199], v[140:143], a[12:15]
    v_cvt_pk_bf16_f32 v154, v116, v117
    v_cvt_pk_bf16_f32 v200, v200, v201
    v_mfma_f32_16x16x32_bf16 v[16:19], a[200:203], v[128:131], v[16:19]
    v_exp_f32 v118, v118
    v_mfma_f32_16x16x32_bf16 v[20:23], a[200:203], v[132:135], v[20:23]
    ds_read_b128 v[172:175], v219 offset:8192
    v_mfma_f32_16x16x32_bf16 a[16:19], a[200:203], v[136:139], a[16:19]
    v_exp_f32 v119, v119
    v_mfma_f32_16x16x32_bf16 a[20:23], a[200:203], v[140:143], a[20:23]
    v_cvt_pk_bf16_f32 v155, v118, v119
    v_mfma_f32_16x16x32_bf16 v[24:27], a[204:207], v[128:131], v[24:27]
    v_exp_f32 v120, v120
    v_mfma_f32_16x16x32_bf16 v[28:31], a[204:207], v[132:135], v[28:31]
    ds_read_b128 v[176:179], v216 offset:12288
    v_cvt_pk_bf16_f32 v201, v202, v203
    v_mfma_f32_16x16x32_bf16 a[24:27], a[204:207], v[136:139], a[24:27]
    v_exp_f32 v121, v121
    v_mfma_f32_16x16x32_bf16 a[28:31], a[204:207], v[140:143], a[28:31]
    buffer_store_dwordx4 v[196:199], v237, s[16:19], s35 offen offset:1024 sc1
    v_cvt_pk_bf16_f32 v156, v120, v121
    v_mfma_f32_16x16x32_bf16 v[32:35], a[208:211], v[128:131], v[32:35]
    v_exp_f32 v122, v122
    v_mfma_f32_16x16x32_bf16 v[36:39], a[208:211], v[132:135], v[36:39]
    ds_read_b128 v[180:183], v217 offset:12288
    v_mfma_f32_16x16x32_bf16 a[32:35], a[208:211], v[136:139], a[32:35]
    v_exp_f32 v123, v123
    v_mfma_f32_16x16x32_bf16 a[36:39], a[208:211], v[140:143], a[36:39]
    ds_read_b128 v[184:187], v218 offset:12288
    v_cvt_pk_bf16_f32 v157, v122, v123
    v_mfma_f32_16x16x32_bf16 v[40:43], a[212:215], v[128:131], v[40:43]
    v_exp_f32 v124, v124
    v_mfma_f32_16x16x32_bf16 v[44:47], a[212:215], v[132:135], v[44:47]
    ds_read_b128 v[188:191], v219 offset:12288
    v_mfma_f32_16x16x32_bf16 a[40:43], a[212:215], v[136:139], a[40:43]
    v_exp_f32 v125, v125
    v_mfma_f32_16x16x32_bf16 a[44:47], a[212:215], v[140:143], a[44:47]
    ds_write_b64 v242, v[200:201] offset:12416
    v_cvt_pk_bf16_f32 v158, v124, v125
    v_mfma_f32_16x16x32_bf16 v[48:51], a[216:219], v[128:131], v[48:51]
    v_exp_f32 v126, v126
    v_mfma_f32_16x16x32_bf16 v[52:55], a[216:219], v[132:135], v[52:55]
    v_mfma_f32_16x16x32_bf16 a[48:51], a[216:219], v[136:139], a[48:51]
    v_exp_f32 v127, v127
    v_mfma_f32_16x16x32_bf16 a[52:55], a[216:219], v[140:143], a[52:55]
    v_cvt_pk_bf16_f32 v159, v126, v127
    v_mfma_f32_16x16x32_bf16 v[56:59], a[220:223], v[128:131], v[56:59]
    v_mfma_f32_16x16x32_bf16 v[60:63], a[220:223], v[132:135], v[60:63]
    v_mfma_f32_16x16x32_bf16 a[56:59], a[220:223], v[136:139], a[56:59]
    v_mfma_f32_16x16x32_bf16 a[60:63], a[220:223], v[140:143], a[60:63]
    s_waitcnt lgkmcnt(0)
    v_pk_fma_f32 v[64:65], v[64:65], s[26:27], v[244:245] op_sel:[0,0,0] op_sel_hi:[1,0,0]
    v_pk_fma_f32 v[66:67], v[66:67], s[26:27], v[244:245] op_sel:[0,0,0] op_sel_hi:[1,0,0]
    v_pk_fma_f32 v[68:69], v[68:69], s[26:27], v[244:245] op_sel:[0,0,0] op_sel_hi:[1,0,0]
    v_pk_fma_f32 v[70:71], v[70:71], s[26:27], v[244:245] op_sel:[0,0,0] op_sel_hi:[1,0,0]
    v_pk_fma_f32 v[72:73], v[72:73], s[26:27], v[244:245] op_sel:[0,0,1] op_sel_hi:[1,0,1]
    v_pk_fma_f32 v[74:75], v[74:75], s[26:27], v[244:245] op_sel:[0,0,1] op_sel_hi:[1,0,1]
    v_pk_fma_f32 v[76:77], v[76:77], s[26:27], v[244:245] op_sel:[0,0,1] op_sel_hi:[1,0,1]
    v_pk_fma_f32 v[78:79], v[78:79], s[26:27], v[244:245] op_sel:[0,0,1] op_sel_hi:[1,0,1]
    v_pk_fma_f32 v[80:81], v[80:81], s[26:27], v[246:247] op_sel:[0,0,0] op_sel_hi:[1,0,0]
    v_pk_fma_f32 v[82:83], v[82:83], s[26:27], v[246:247] op_sel:[0,0,0] op_sel_hi:[1,0,0]
    v_pk_fma_f32 v[84:85], v[84:85], s[26:27], v[246:247] op_sel:[0,0,0] op_sel_hi:[1,0,0]
    v_pk_fma_f32 v[86:87], v[86:87], s[26:27], v[246:247] op_sel:[0,0,0] op_sel_hi:[1,0,0]
    v_pk_fma_f32 v[88:89], v[88:89], s[26:27], v[246:247] op_sel:[0,0,1] op_sel_hi:[1,0,1]
    v_pk_fma_f32 v[90:91], v[90:91], s[26:27], v[246:247] op_sel:[0,0,1] op_sel_hi:[1,0,1]
    v_pk_fma_f32 v[92:93], v[92:93], s[26:27], v[246:247] op_sel:[0,0,1] op_sel_hi:[1,0,1]
    v_pk_fma_f32 v[94:95], v[94:95], s[26:27], v[246:247] op_sel:[0,0,1] op_sel_hi:[1,0,1]
    s_nop 1
    v_mfma_f32_16x16x32_bf16 v[96:99], v[160:163], a[128:131], 0
    v_exp_f32 v64, v64
    v_mfma_f32_16x16x32_bf16 v[104:107], v[160:163], a[144:147], 0
    ds_read_b64_tr_b16 a[192:193], v224 offset:24576
    v_accvgpr_read_b32 v204, a124
    v_mfma_f32_16x16x32_bf16 v[112:115], v[160:163], a[160:163], 0
    ds_read_b64_tr_b16 a[194:195], v224 offset:28672
    v_exp_f32 v65, v65
    v_mfma_f32_16x16x32_bf16 v[120:123], v[160:163], a[176:179], 0
    ds_read_b64_tr_b16 a[196:197], v225 offset:24576
    v_cvt_pk_bf16_f32 v128, v64, v65
    v_mfma_f32_16x16x32_bf16 v[96:99], v[164:167], a[132:135], v[96:99]
    v_exp_f32 v66, v66
    v_accvgpr_read_b32 v205, a125
    v_mfma_f32_16x16x32_bf16 v[104:107], v[164:167], a[148:151], v[104:107]
    ds_read_b64_tr_b16 a[198:199], v225 offset:28672
    v_add_u32 v216, 81920, v216
    v_mfma_f32_16x16x32_bf16 v[112:115], v[164:167], a[164:167], v[112:115]
    v_exp_f32 v67, v67
    v_mfma_f32_16x16x32_bf16 v[120:123], v[164:167], a[180:183], v[120:123]
    ds_read_b64_tr_b16 a[200:201], v226 offset:24576
    v_cvt_pk_bf16_f32 v129, v66, v67
    v_mfma_f32_16x16x32_bf16 v[96:99], v[168:171], a[136:139], v[96:99]
    ds_read_b64_tr_b16 a[202:203], v226 offset:28672
    v_exp_f32 v68, v68
    v_mfma_f32_16x16x32_bf16 v[104:107], v[168:171], a[152:155], v[104:107]
    ds_read_b64_tr_b16 a[204:205], v227 offset:24576
    v_add_u32 v217, 81920, v217
    v_mfma_f32_16x16x32_bf16 v[112:115], v[168:171], a[168:171], v[112:115]
    v_exp_f32 v69, v69
    v_mfma_f32_16x16x32_bf16 v[120:123], v[168:171], a[184:187], v[120:123]
    ds_read_b64_tr_b16 a[206:207], v227 offset:28672
    v_cvt_pk_bf16_f32 v130, v68, v69
    v_mfma_f32_16x16x32_bf16 v[96:99], v[172:175], a[140:143], v[96:99]
    v_exp_f32 v70, v70
    v_mfma_f32_16x16x32_bf16 v[104:107], v[172:175], a[156:159], v[104:107]
    ds_read_b64_tr_b16 a[208:209], v228 offset:24576
    v_accvgpr_read_b32 v206, a126
    v_mfma_f32_16x16x32_bf16 v[112:115], v[172:175], a[172:175], v[112:115]
    ds_read_b64_tr_b16 a[210:211], v228 offset:28672
    v_exp_f32 v71, v71
    v_mfma_f32_16x16x32_bf16 v[120:123], v[172:175], a[188:191], v[120:123]
    ds_read_b64_tr_b16 a[212:213], v229 offset:24576
    v_cvt_pk_bf16_f32 v131, v70, v71
    v_mfma_f32_16x16x32_bf16 v[100:103], v[176:179], a[128:131], 0
    v_exp_f32 v72, v72
    v_mfma_f32_16x16x32_bf16 v[108:111], v[176:179], a[144:147], 0
    ds_read_b64_tr_b16 a[214:215], v229 offset:28672
    v_add_u32 v218, 81920, v218
    v_mfma_f32_16x16x32_bf16 v[116:119], v[176:179], a[160:163], 0
    ds_read_b64_tr_b16 a[216:217], v230 offset:24576
    v_exp_f32 v73, v73
    v_mfma_f32_16x16x32_bf16 v[124:127], v[176:179], a[176:179], 0
    ds_read_b64_tr_b16 a[218:219], v230 offset:28672
    v_cvt_pk_bf16_f32 v132, v72, v73
    v_mfma_f32_16x16x32_bf16 v[100:103], v[180:183], a[132:135], v[100:103]
    v_exp_f32 v74, v74
    v_mfma_f32_16x16x32_bf16 v[108:111], v[180:183], a[148:151], v[108:111]
    ds_read_b64_tr_b16 a[220:221], v231 offset:24576
    v_accvgpr_read_b32 v207, a127
    v_mfma_f32_16x16x32_bf16 v[116:119], v[180:183], a[164:167], v[116:119]
    v_exp_f32 v75, v75
    v_mfma_f32_16x16x32_bf16 v[124:127], v[180:183], a[180:183], v[124:127]
    ds_read_b64_tr_b16 a[222:223], v231 offset:28672
    v_cvt_pk_bf16_f32 v133, v74, v75
    v_mfma_f32_16x16x32_bf16 v[100:103], v[184:187], a[136:139], v[100:103]
    ds_read_b128 v[192:195], v215 offset:10240
    v_exp_f32 v76, v76
    v_mfma_f32_16x16x32_bf16 v[108:111], v[184:187], a[152:155], v[108:111]
    ds_read_b128 v[196:199], v215 offset:11264
    v_mul_f32 v204, v204, v251
    v_mfma_f32_16x16x32_bf16 v[116:119], v[184:187], a[168:171], v[116:119]
    v_exp_f32 v77, v77
    v_mfma_f32_16x16x32_bf16 v[124:127], v[184:187], a[184:187], v[124:127]
    v_cvt_pk_bf16_f32 v134, v76, v77
    v_mul_f32 v205, v205, v251
    v_mfma_f32_16x16x32_bf16 v[100:103], v[188:191], a[140:143], v[100:103]
    v_exp_f32 v78, v78
    v_mfma_f32_16x16x32_bf16 v[108:111], v[188:191], a[156:159], v[108:111]
    v_add_u32 v219, 81920, v219
    v_mfma_f32_16x16x32_bf16 v[116:119], v[188:191], a[172:175], v[116:119]
    v_exp_f32 v79, v79
    v_mfma_f32_16x16x32_bf16 v[124:127], v[188:191], a[188:191], v[124:127]
    v_cvt_pk_bf16_f32 v135, v78, v79
    v_mul_f32 v206, v206, v251
    s_waitcnt vmcnt(8) lgkmcnt(0)
    s_barrier
    v_mfma_f32_16x16x32_bf16 a[224:227], a[240:243], v[144:147], a[224:227]
    v_exp_f32 v80, v80
    v_mfma_f32_16x16x32_bf16 a[228:231], a[240:243], v[148:151], a[228:231]
    ds_read_b128 v[160:163], v216 offset:0
    v_mfma_f32_16x16x32_bf16 a[232:235], a[240:243], v[152:155], a[232:235]
    s_add_u32 s35, s24, 18432
    v_exp_f32 v81, v81
    v_mfma_f32_16x16x32_bf16 a[236:239], a[240:243], v[156:159], a[236:239]
    buffer_store_dwordx4 v[192:195], v236, s[16:19], s35 offen sc1
    v_cvt_pk_bf16_f32 v136, v80, v81
    v_mfma_f32_16x16x32_bf16 v[0:3], a[192:195], v[144:147], v[0:3]
    v_exp_f32 v82, v82
    v_mfma_f32_16x16x32_bf16 v[4:7], a[192:195], v[148:151], v[4:7]
    ds_read_b128 v[164:167], v217 offset:0
    v_mul_f32 v207, v207, v251
    v_mfma_f32_16x16x32_bf16 a[0:3], a[192:195], v[152:155], a[0:3]
    v_exp_f32 v83, v83
    v_mfma_f32_16x16x32_bf16 a[4:7], a[192:195], v[156:159], a[4:7]
    v_cvt_pk_bf16_f32 v137, v82, v83
    v_mfma_f32_16x16x32_bf16 v[8:11], a[196:199], v[144:147], v[8:11]
    v_exp_f32 v84, v84
    v_mfma_f32_16x16x32_bf16 v[12:15], a[196:199], v[148:151], v[12:15]
    ds_read_b128 v[168:171], v218 offset:0
    v_mfma_f32_16x16x32_bf16 a[8:11], a[196:199], v[152:155], a[8:11]
    v_exp_f32 v85, v85
    v_mfma_f32_16x16x32_bf16 a[12:15], a[196:199], v[156:159], a[12:15]
    v_cvt_pk_bf16_f32 v138, v84, v85
    v_cvt_pk_bf16_f32 v204, v204, v205
    v_mfma_f32_16x16x32_bf16 v[16:19], a[200:203], v[144:147], v[16:19]
    v_exp_f32 v86, v86
    v_mfma_f32_16x16x32_bf16 v[20:23], a[200:203], v[148:151], v[20:23]
    ds_read_b128 v[172:175], v219 offset:0
    v_mfma_f32_16x16x32_bf16 a[16:19], a[200:203], v[152:155], a[16:19]
    v_exp_f32 v87, v87
    v_mfma_f32_16x16x32_bf16 a[20:23], a[200:203], v[156:159], a[20:23]
    v_cvt_pk_bf16_f32 v139, v86, v87
    v_mfma_f32_16x16x32_bf16 v[24:27], a[204:207], v[144:147], v[24:27]
    v_exp_f32 v88, v88
    v_mfma_f32_16x16x32_bf16 v[28:31], a[204:207], v[148:151], v[28:31]
    ds_read_b128 v[176:179], v216 offset:4096
    v_cvt_pk_bf16_f32 v205, v206, v207
    v_mfma_f32_16x16x32_bf16 a[24:27], a[204:207], v[152:155], a[24:27]
    v_exp_f32 v89, v89
    v_mfma_f32_16x16x32_bf16 a[28:31], a[204:207], v[156:159], a[28:31]
    buffer_store_dwordx4 v[196:199], v237, s[16:19], s35 offen offset:1024 sc1
    v_cvt_pk_bf16_f32 v140, v88, v89
    v_mfma_f32_16x16x32_bf16 v[32:35], a[208:211], v[144:147], v[32:35]
    v_exp_f32 v90, v90
    v_mfma_f32_16x16x32_bf16 v[36:39], a[208:211], v[148:151], v[36:39]
    ds_read_b128 v[180:183], v217 offset:4096
    v_mfma_f32_16x16x32_bf16 a[32:35], a[208:211], v[152:155], a[32:35]
    v_exp_f32 v91, v91
    v_mfma_f32_16x16x32_bf16 a[36:39], a[208:211], v[156:159], a[36:39]
    ds_read_b128 v[184:187], v218 offset:4096
    v_cvt_pk_bf16_f32 v141, v90, v91
    v_mfma_f32_16x16x32_bf16 v[40:43], a[212:215], v[144:147], v[40:43]
    v_exp_f32 v92, v92
    v_mfma_f32_16x16x32_bf16 v[44:47], a[212:215], v[148:151], v[44:47]
    ds_read_b128 v[188:191], v219 offset:4096
    v_mfma_f32_16x16x32_bf16 a[40:43], a[212:215], v[152:155], a[40:43]
    v_exp_f32 v93, v93
    v_mfma_f32_16x16x32_bf16 a[44:47], a[212:215], v[156:159], a[44:47]
    ds_write_b64 v243, v[204:205] offset:12416
    v_cvt_pk_bf16_f32 v142, v92, v93
    v_mfma_f32_16x16x32_bf16 v[48:51], a[216:219], v[144:147], v[48:51]
    v_exp_f32 v94, v94
    v_mfma_f32_16x16x32_bf16 v[52:55], a[216:219], v[148:151], v[52:55]
    v_mfma_f32_16x16x32_bf16 a[48:51], a[216:219], v[152:155], a[48:51]
    v_exp_f32 v95, v95
    v_mfma_f32_16x16x32_bf16 a[52:55], a[216:219], v[156:159], a[52:55]
    v_cvt_pk_bf16_f32 v143, v94, v95
    v_mfma_f32_16x16x32_bf16 v[56:59], a[220:223], v[144:147], v[56:59]
    v_mfma_f32_16x16x32_bf16 v[60:63], a[220:223], v[148:151], v[60:63]
    v_mfma_f32_16x16x32_bf16 a[56:59], a[220:223], v[152:155], a[56:59]
    v_mfma_f32_16x16x32_bf16 a[60:63], a[220:223], v[156:159], a[60:63]
    s_waitcnt lgkmcnt(0)
    v_pk_fma_f32 v[96:97], v[96:97], s[26:27], v[244:245] op_sel:[0,0,0] op_sel_hi:[1,0,0]
    v_pk_fma_f32 v[98:99], v[98:99], s[26:27], v[244:245] op_sel:[0,0,0] op_sel_hi:[1,0,0]
    v_pk_fma_f32 v[100:101], v[100:101], s[26:27], v[244:245] op_sel:[0,0,0] op_sel_hi:[1,0,0]
    v_pk_fma_f32 v[102:103], v[102:103], s[26:27], v[244:245] op_sel:[0,0,0] op_sel_hi:[1,0,0]
    v_pk_fma_f32 v[104:105], v[104:105], s[26:27], v[244:245] op_sel:[0,0,1] op_sel_hi:[1,0,1]
    v_pk_fma_f32 v[106:107], v[106:107], s[26:27], v[244:245] op_sel:[0,0,1] op_sel_hi:[1,0,1]
    v_pk_fma_f32 v[108:109], v[108:109], s[26:27], v[244:245] op_sel:[0,0,1] op_sel_hi:[1,0,1]
    v_pk_fma_f32 v[110:111], v[110:111], s[26:27], v[244:245] op_sel:[0,0,1] op_sel_hi:[1,0,1]
    v_pk_fma_f32 v[112:113], v[112:113], s[26:27], v[246:247] op_sel:[0,0,0] op_sel_hi:[1,0,0]
    v_pk_fma_f32 v[114:115], v[114:115], s[26:27], v[246:247] op_sel:[0,0,0] op_sel_hi:[1,0,0]
    v_pk_fma_f32 v[116:117], v[116:117], s[26:27], v[246:247] op_sel:[0,0,0] op_sel_hi:[1,0,0]
    v_pk_fma_f32 v[118:119], v[118:119], s[26:27], v[246:247] op_sel:[0,0,0] op_sel_hi:[1,0,0]
    v_pk_fma_f32 v[120:121], v[120:121], s[26:27], v[246:247] op_sel:[0,0,1] op_sel_hi:[1,0,1]
    v_pk_fma_f32 v[122:123], v[122:123], s[26:27], v[246:247] op_sel:[0,0,1] op_sel_hi:[1,0,1]
    v_pk_fma_f32 v[124:125], v[124:125], s[26:27], v[246:247] op_sel:[0,0,1] op_sel_hi:[1,0,1]
    v_pk_fma_f32 v[126:127], v[126:127], s[26:27], v[246:247] op_sel:[0,0,1] op_sel_hi:[1,0,1]
    s_nop 1
    v_mfma_f32_16x16x32_bf16 v[64:67], v[160:163], a[128:131], 0
    v_exp_f32 v96, v96
    v_mfma_f32_16x16x32_bf16 v[72:75], v[160:163], a[144:147], 0
    ds_read_b64_tr_b16 a[192:193], v224 offset:0
    v_mfma_f32_16x16x32_bf16 v[80:83], v[160:163], a[160:163], 0
    ds_read_b64_tr_b16 a[194:195], v224 offset:4096
    v_exp_f32 v97, v97
    v_mfma_f32_16x16x32_bf16 v[88:91], v[160:163], a[176:179], 0
    ds_read_b64_tr_b16 a[196:197], v225 offset:0
    v_cvt_pk_bf16_f32 v144, v96, v97
    v_mfma_f32_16x16x32_bf16 v[64:67], v[164:167], a[132:135], v[64:67]
    v_exp_f32 v98, v98
    v_mfma_f32_16x16x32_bf16 v[72:75], v[164:167], a[148:151], v[72:75]
    ds_read_b64_tr_b16 a[198:199], v225 offset:4096
    v_mfma_f32_16x16x32_bf16 v[80:83], v[164:167], a[164:167], v[80:83]
    v_exp_f32 v99, v99
    v_mfma_f32_16x16x32_bf16 v[88:91], v[164:167], a[180:183], v[88:91]
    ds_read_b64_tr_b16 a[200:201], v226 offset:0
    v_cvt_pk_bf16_f32 v145, v98, v99
    v_mfma_f32_16x16x32_bf16 v[64:67], v[168:171], a[136:139], v[64:67]
    ds_read_b64_tr_b16 a[202:203], v226 offset:4096
    v_exp_f32 v100, v100
    v_mfma_f32_16x16x32_bf16 v[72:75], v[168:171], a[152:155], v[72:75]
    ds_read_b64_tr_b16 a[204:205], v227 offset:0
    v_mfma_f32_16x16x32_bf16 v[80:83], v[168:171], a[168:171], v[80:83]
    v_exp_f32 v101, v101
    v_mfma_f32_16x16x32_bf16 v[88:91], v[168:171], a[184:187], v[88:91]
    ds_read_b64_tr_b16 a[206:207], v227 offset:4096
    v_cvt_pk_bf16_f32 v146, v100, v101
    v_mfma_f32_16x16x32_bf16 v[64:67], v[172:175], a[140:143], v[64:67]
    v_exp_f32 v102, v102
    v_mfma_f32_16x16x32_bf16 v[72:75], v[172:175], a[156:159], v[72:75]
    ds_read_b64_tr_b16 a[208:209], v228 offset:0
    v_mfma_f32_16x16x32_bf16 v[80:83], v[172:175], a[172:175], v[80:83]
    ds_read_b64_tr_b16 a[210:211], v228 offset:4096
    v_exp_f32 v103, v103
    v_mfma_f32_16x16x32_bf16 v[88:91], v[172:175], a[188:191], v[88:91]
    ds_read_b64_tr_b16 a[212:213], v229 offset:0
    v_cvt_pk_bf16_f32 v147, v102, v103
    v_mfma_f32_16x16x32_bf16 v[68:71], v[176:179], a[128:131], 0
    v_exp_f32 v104, v104
    v_mfma_f32_16x16x32_bf16 v[76:79], v[176:179], a[144:147], 0
    ds_read_b64_tr_b16 a[214:215], v229 offset:4096
    v_mfma_f32_16x16x32_bf16 v[84:87], v[176:179], a[160:163], 0
    ds_read_b64_tr_b16 a[216:217], v230 offset:0
    v_exp_f32 v105, v105
    v_mfma_f32_16x16x32_bf16 v[92:95], v[176:179], a[176:179], 0
    ds_read_b64_tr_b16 a[218:219], v230 offset:4096
    v_cvt_pk_bf16_f32 v148, v104, v105
    v_mfma_f32_16x16x32_bf16 v[68:71], v[180:183], a[132:135], v[68:71]
    v_exp_f32 v106, v106
    v_mfma_f32_16x16x32_bf16 v[76:79], v[180:183], a[148:151], v[76:79]
    ds_read_b64_tr_b16 a[220:221], v231 offset:0
    v_mfma_f32_16x16x32_bf16 v[84:87], v[180:183], a[164:167], v[84:87]
    v_exp_f32 v107, v107
    v_mfma_f32_16x16x32_bf16 v[92:95], v[180:183], a[180:183], v[92:95]
    ds_read_b64_tr_b16 a[222:223], v231 offset:4096
    v_cvt_pk_bf16_f32 v149, v106, v107
    v_mfma_f32_16x16x32_bf16 v[68:71], v[184:187], a[136:139], v[68:71]
    ds_read_b128 v[192:195], v215 offset:12288
    v_exp_f32 v108, v108
    v_mfma_f32_16x16x32_bf16 v[76:79], v[184:187], a[152:155], v[76:79]
    ds_read_b128 v[196:199], v215 offset:13312
    v_mfma_f32_16x16x32_bf16 v[84:87], v[184:187], a[168:171], v[84:87]
    v_exp_f32 v109, v109
    v_mfma_f32_16x16x32_bf16 v[92:95], v[184:187], a[184:187], v[92:95]
    v_cvt_pk_bf16_f32 v150, v108, v109
    v_mfma_f32_16x16x32_bf16 v[68:71], v[188:191], a[140:143], v[68:71]
    v_exp_f32 v110, v110
    v_mfma_f32_16x16x32_bf16 v[76:79], v[188:191], a[156:159], v[76:79]
    v_mfma_f32_16x16x32_bf16 v[84:87], v[188:191], a[172:175], v[84:87]
    v_exp_f32 v111, v111
    v_mfma_f32_16x16x32_bf16 v[92:95], v[188:191], a[188:191], v[92:95]
    v_cvt_pk_bf16_f32 v151, v110, v111
    s_waitcnt vmcnt(6) lgkmcnt(0)
    s_barrier
    v_mfma_f32_16x16x32_bf16 a[224:227], a[240:243], v[128:131], a[224:227]
    v_exp_f32 v112, v112
    v_mfma_f32_16x16x32_bf16 a[228:231], a[240:243], v[132:135], a[228:231]
    ds_read_b128 v[160:163], v216 offset:24576
    v_mfma_f32_16x16x32_bf16 a[232:235], a[240:243], v[136:139], a[232:235]
    s_add_u32 s35, s24, 20480
    v_exp_f32 v113, v113
    v_mfma_f32_16x16x32_bf16 a[236:239], a[240:243], v[140:143], a[236:239]
    buffer_store_dwordx4 v[192:195], v236, s[16:19], s35 offen sc1
    v_cvt_pk_bf16_f32 v152, v112, v113
    v_mfma_f32_16x16x32_bf16 v[0:3], a[192:195], v[128:131], v[0:3]
    v_exp_f32 v114, v114
    v_mfma_f32_16x16x32_bf16 v[4:7], a[192:195], v[132:135], v[4:7]
    ds_read_b128 v[164:167], v217 offset:24576
    v_mfma_f32_16x16x32_bf16 a[0:3], a[192:195], v[136:139], a[0:3]
    v_exp_f32 v115, v115
    v_mfma_f32_16x16x32_bf16 a[4:7], a[192:195], v[140:143], a[4:7]
    v_cvt_pk_bf16_f32 v153, v114, v115
    v_mfma_f32_16x16x32_bf16 v[8:11], a[196:199], v[128:131], v[8:11]
    v_exp_f32 v116, v116
    v_mfma_f32_16x16x32_bf16 v[12:15], a[196:199], v[132:135], v[12:15]
    ds_read_b128 v[168:171], v218 offset:24576
    v_mfma_f32_16x16x32_bf16 a[8:11], a[196:199], v[136:139], a[8:11]
    v_exp_f32 v117, v117
    v_mfma_f32_16x16x32_bf16 a[12:15], a[196:199], v[140:143], a[12:15]
    v_cvt_pk_bf16_f32 v154, v116, v117
    v_mfma_f32_16x16x32_bf16 v[16:19], a[200:203], v[128:131], v[16:19]
    v_exp_f32 v118, v118
    v_mfma_f32_16x16x32_bf16 v[20:23], a[200:203], v[132:135], v[20:23]
    ds_read_b128 v[172:175], v219 offset:24576
    v_mfma_f32_16x16x32_bf16 a[16:19], a[200:203], v[136:139], a[16:19]
    v_exp_f32 v119, v119
    v_mfma_f32_16x16x32_bf16 a[20:23], a[200:203], v[140:143], a[20:23]
    v_cvt_pk_bf16_f32 v155, v118, v119
    v_mfma_f32_16x16x32_bf16 v[24:27], a[204:207], v[128:131], v[24:27]
    v_exp_f32 v120, v120
    v_mfma_f32_16x16x32_bf16 v[28:31], a[204:207], v[132:135], v[28:31]
    ds_read_b128 v[176:179], v216 offset:28672
    v_mfma_f32_16x16x32_bf16 a[24:27], a[204:207], v[136:139], a[24:27]
    v_exp_f32 v121, v121
    v_mfma_f32_16x16x32_bf16 a[28:31], a[204:207], v[140:143], a[28:31]
    buffer_store_dwordx4 v[196:199], v237, s[16:19], s35 offen offset:1024 sc1
    v_cvt_pk_bf16_f32 v156, v120, v121
    v_mfma_f32_16x16x32_bf16 v[32:35], a[208:211], v[128:131], v[32:35]
    v_exp_f32 v122, v122
    v_mfma_f32_16x16x32_bf16 v[36:39], a[208:211], v[132:135], v[36:39]
    ds_read_b128 v[180:183], v217 offset:28672
    v_mfma_f32_16x16x32_bf16 a[32:35], a[208:211], v[136:139], a[32:35]
    v_exp_f32 v123, v123
    v_mfma_f32_16x16x32_bf16 a[36:39], a[208:211], v[140:143], a[36:39]
    ds_read_b128 v[184:187], v218 offset:28672
    v_cvt_pk_bf16_f32 v157, v122, v123
    v_mfma_f32_16x16x32_bf16 v[40:43], a[212:215], v[128:131], v[40:43]
    v_exp_f32 v124, v124
    v_mfma_f32_16x16x32_bf16 v[44:47], a[212:215], v[132:135], v[44:47]
    ds_read_b128 v[188:191], v219 offset:28672
    v_mfma_f32_16x16x32_bf16 a[40:43], a[212:215], v[136:139], a[40:43]
    v_exp_f32 v125, v125
    v_mfma_f32_16x16x32_bf16 a[44:47], a[212:215], v[140:143], a[44:47]
    v_cvt_pk_bf16_f32 v158, v124, v125
    v_mfma_f32_16x16x32_bf16 v[48:51], a[216:219], v[128:131], v[48:51]
    v_exp_f32 v126, v126
    v_mfma_f32_16x16x32_bf16 v[52:55], a[216:219], v[132:135], v[52:55]
    v_mfma_f32_16x16x32_bf16 a[48:51], a[216:219], v[136:139], a[48:51]
    v_exp_f32 v127, v127
    v_mfma_f32_16x16x32_bf16 a[52:55], a[216:219], v[140:143], a[52:55]
    v_cvt_pk_bf16_f32 v159, v126, v127
    v_mfma_f32_16x16x32_bf16 v[56:59], a[220:223], v[128:131], v[56:59]
    v_mfma_f32_16x16x32_bf16 v[60:63], a[220:223], v[132:135], v[60:63]
    v_mfma_f32_16x16x32_bf16 a[56:59], a[220:223], v[136:139], a[56:59]
    v_mfma_f32_16x16x32_bf16 a[60:63], a[220:223], v[140:143], a[60:63]
    s_waitcnt lgkmcnt(0)
    v_pk_fma_f32 v[64:65], v[64:65], s[26:27], v[244:245] op_sel:[0,0,0] op_sel_hi:[1,0,0]
    v_pk_fma_f32 v[66:67], v[66:67], s[26:27], v[244:245] op_sel:[0,0,0] op_sel_hi:[1,0,0]
    v_pk_fma_f32 v[68:69], v[68:69], s[26:27], v[244:245] op_sel:[0,0,0] op_sel_hi:[1,0,0]
    v_pk_fma_f32 v[70:71], v[70:71], s[26:27], v[244:245] op_sel:[0,0,0] op_sel_hi:[1,0,0]
    v_pk_fma_f32 v[72:73], v[72:73], s[26:27], v[244:245] op_sel:[0,0,1] op_sel_hi:[1,0,1]
    v_pk_fma_f32 v[74:75], v[74:75], s[26:27], v[244:245] op_sel:[0,0,1] op_sel_hi:[1,0,1]
    v_pk_fma_f32 v[76:77], v[76:77], s[26:27], v[244:245] op_sel:[0,0,1] op_sel_hi:[1,0,1]
    v_pk_fma_f32 v[78:79], v[78:79], s[26:27], v[244:245] op_sel:[0,0,1] op_sel_hi:[1,0,1]
    v_pk_fma_f32 v[80:81], v[80:81], s[26:27], v[246:247] op_sel:[0,0,0] op_sel_hi:[1,0,0]
    v_pk_fma_f32 v[82:83], v[82:83], s[26:27], v[246:247] op_sel:[0,0,0] op_sel_hi:[1,0,0]
    v_pk_fma_f32 v[84:85], v[84:85], s[26:27], v[246:247] op_sel:[0,0,0] op_sel_hi:[1,0,0]
    v_pk_fma_f32 v[86:87], v[86:87], s[26:27], v[246:247] op_sel:[0,0,0] op_sel_hi:[1,0,0]
    v_pk_fma_f32 v[88:89], v[88:89], s[26:27], v[246:247] op_sel:[0,0,1] op_sel_hi:[1,0,1]
    v_pk_fma_f32 v[90:91], v[90:91], s[26:27], v[246:247] op_sel:[0,0,1] op_sel_hi:[1,0,1]
    v_pk_fma_f32 v[92:93], v[92:93], s[26:27], v[246:247] op_sel:[0,0,1] op_sel_hi:[1,0,1]
    v_pk_fma_f32 v[94:95], v[94:95], s[26:27], v[246:247] op_sel:[0,0,1] op_sel_hi:[1,0,1]
    s_nop 1
    v_mfma_f32_16x16x32_bf16 v[96:99], v[160:163], a[128:131], 0
    v_exp_f32 v64, v64
    v_mfma_f32_16x16x32_bf16 v[104:107], v[160:163], a[144:147], 0
    ds_read_b64_tr_b16 a[192:193], v224 offset:8192
    v_mfma_f32_16x16x32_bf16 v[112:115], v[160:163], a[160:163], 0
    ds_read_b64_tr_b16 a[194:195], v224 offset:12288
    v_exp_f32 v65, v65
    v_mfma_f32_16x16x32_bf16 v[120:123], v[160:163], a[176:179], 0
    ds_read_b64_tr_b16 a[196:197], v225 offset:8192
    v_cvt_pk_bf16_f32 v128, v64, v65
    v_mfma_f32_16x16x32_bf16 v[96:99], v[164:167], a[132:135], v[96:99]
    v_exp_f32 v66, v66
    v_mfma_f32_16x16x32_bf16 v[104:107], v[164:167], a[148:151], v[104:107]
    ds_read_b64_tr_b16 a[198:199], v225 offset:12288
    v_mfma_f32_16x16x32_bf16 v[112:115], v[164:167], a[164:167], v[112:115]
    v_exp_f32 v67, v67
    v_mfma_f32_16x16x32_bf16 v[120:123], v[164:167], a[180:183], v[120:123]
    ds_read_b64_tr_b16 a[200:201], v226 offset:8192
    v_cvt_pk_bf16_f32 v129, v66, v67
    v_mfma_f32_16x16x32_bf16 v[96:99], v[168:171], a[136:139], v[96:99]
    ds_read_b64_tr_b16 a[202:203], v226 offset:12288
    v_exp_f32 v68, v68
    v_mfma_f32_16x16x32_bf16 v[104:107], v[168:171], a[152:155], v[104:107]
    ds_read_b64_tr_b16 a[204:205], v227 offset:8192
    v_mfma_f32_16x16x32_bf16 v[112:115], v[168:171], a[168:171], v[112:115]
    v_exp_f32 v69, v69
    v_mfma_f32_16x16x32_bf16 v[120:123], v[168:171], a[184:187], v[120:123]
    ds_read_b64_tr_b16 a[206:207], v227 offset:12288
    v_cvt_pk_bf16_f32 v130, v68, v69
    v_mfma_f32_16x16x32_bf16 v[96:99], v[172:175], a[140:143], v[96:99]
    v_exp_f32 v70, v70
    v_mfma_f32_16x16x32_bf16 v[104:107], v[172:175], a[156:159], v[104:107]
    ds_read_b64_tr_b16 a[208:209], v228 offset:8192
    v_mfma_f32_16x16x32_bf16 v[112:115], v[172:175], a[172:175], v[112:115]
    ds_read_b64_tr_b16 a[210:211], v228 offset:12288
    v_exp_f32 v71, v71
    v_mfma_f32_16x16x32_bf16 v[120:123], v[172:175], a[188:191], v[120:123]
    ds_read_b64_tr_b16 a[212:213], v229 offset:8192
    v_cvt_pk_bf16_f32 v131, v70, v71
    v_mfma_f32_16x16x32_bf16 v[100:103], v[176:179], a[128:131], 0
    v_exp_f32 v72, v72
    v_mfma_f32_16x16x32_bf16 v[108:111], v[176:179], a[144:147], 0
    ds_read_b64_tr_b16 a[214:215], v229 offset:12288
    v_mfma_f32_16x16x32_bf16 v[116:119], v[176:179], a[160:163], 0
    ds_read_b64_tr_b16 a[216:217], v230 offset:8192
    v_exp_f32 v73, v73
    v_mfma_f32_16x16x32_bf16 v[124:127], v[176:179], a[176:179], 0
    ds_read_b64_tr_b16 a[218:219], v230 offset:12288
    v_cvt_pk_bf16_f32 v132, v72, v73
    v_mfma_f32_16x16x32_bf16 v[100:103], v[180:183], a[132:135], v[100:103]
    v_exp_f32 v74, v74
    v_mfma_f32_16x16x32_bf16 v[108:111], v[180:183], a[148:151], v[108:111]
    ds_read_b64_tr_b16 a[220:221], v231 offset:8192
    v_mfma_f32_16x16x32_bf16 v[116:119], v[180:183], a[164:167], v[116:119]
    v_exp_f32 v75, v75
    v_mfma_f32_16x16x32_bf16 v[124:127], v[180:183], a[180:183], v[124:127]
    ds_read_b64_tr_b16 a[222:223], v231 offset:12288
    v_cvt_pk_bf16_f32 v133, v74, v75
    v_mfma_f32_16x16x32_bf16 v[100:103], v[184:187], a[136:139], v[100:103]
    ds_read_b128 v[192:195], v215 offset:14336
    v_exp_f32 v76, v76
    v_mfma_f32_16x16x32_bf16 v[108:111], v[184:187], a[152:155], v[108:111]
    ds_read_b128 v[196:199], v215 offset:15360
    v_mfma_f32_16x16x32_bf16 v[116:119], v[184:187], a[168:171], v[116:119]
    v_exp_f32 v77, v77
    v_mfma_f32_16x16x32_bf16 v[124:127], v[184:187], a[184:187], v[124:127]
    v_cvt_pk_bf16_f32 v134, v76, v77
    v_mfma_f32_16x16x32_bf16 v[100:103], v[188:191], a[140:143], v[100:103]
    v_exp_f32 v78, v78
    v_mfma_f32_16x16x32_bf16 v[108:111], v[188:191], a[156:159], v[108:111]
    v_mfma_f32_16x16x32_bf16 v[116:119], v[188:191], a[172:175], v[116:119]
    v_exp_f32 v79, v79
    v_add_u32 v224, 98304, v224
    v_add_u32 v225, 98304, v225
    v_add_u32 v226, 98304, v226
    v_add_u32 v227, 98304, v227
    v_mfma_f32_16x16x32_bf16 v[124:127], v[188:191], a[188:191], v[124:127]
    v_cvt_pk_bf16_f32 v135, v78, v79
    v_add_u32 v228, 98304, v228
    v_add_u32 v229, 98304, v229
    v_add_u32 v230, 98304, v230
    v_add_u32 v231, 98304, v231
    s_waitcnt vmcnt(6) lgkmcnt(0)
    s_barrier
    v_mfma_f32_16x16x32_bf16 a[224:227], a[240:243], v[144:147], a[224:227]
    v_exp_f32 v80, v80
    v_mfma_f32_16x16x32_bf16 a[228:231], a[240:243], v[148:151], a[228:231]
    s_add_u32 s35, s24, 22528
    ds_read_b64_tr_b16 v[160:161], v224 offset:0
    v_mfma_f32_16x16x32_bf16 a[232:235], a[240:243], v[152:155], a[232:235]
    v_exp_f32 v81, v81
    v_mfma_f32_16x16x32_bf16 a[236:239], a[240:243], v[156:159], a[236:239]
    ds_read_b64_tr_b16 v[162:163], v224 offset:4096
    v_cvt_pk_bf16_f32 v136, v80, v81
    v_mfma_f32_16x16x32_bf16 v[0:3], a[192:195], v[144:147], v[0:3]
    ds_read_b64_tr_b16 v[164:165], v225 offset:0
    v_exp_f32 v82, v82
    v_mfma_f32_16x16x32_bf16 v[4:7], a[192:195], v[148:151], v[4:7]
    buffer_store_dwordx4 v[192:195], v236, s[16:19], s35 offen sc1
    v_mfma_f32_16x16x32_bf16 a[0:3], a[192:195], v[152:155], a[0:3]
    v_exp_f32 v83, v83
    v_mfma_f32_16x16x32_bf16 a[4:7], a[192:195], v[156:159], a[4:7]
    ds_read_b64_tr_b16 v[166:167], v225 offset:4096
    v_cvt_pk_bf16_f32 v137, v82, v83
    v_mfma_f32_16x16x32_bf16 v[8:11], a[196:199], v[144:147], v[8:11]
    ds_read_b64_tr_b16 v[168:169], v226 offset:0
    v_exp_f32 v84, v84
    v_mfma_f32_16x16x32_bf16 v[12:15], a[196:199], v[148:151], v[12:15]
    buffer_store_dwordx4 v[196:199], v237, s[16:19], s35 offen offset:1024 sc1
    v_mfma_f32_16x16x32_bf16 a[8:11], a[196:199], v[152:155], a[8:11]
    ds_read_b64_tr_b16 v[170:171], v226 offset:4096
    v_exp_f32 v85, v85
    v_mfma_f32_16x16x32_bf16 a[12:15], a[196:199], v[156:159], a[12:15]
    ds_read_b64_tr_b16 v[172:173], v227 offset:0
    v_cvt_pk_bf16_f32 v138, v84, v85
    v_mfma_f32_16x16x32_bf16 v[16:19], a[200:203], v[144:147], v[16:19]
    v_exp_f32 v86, v86
    v_mfma_f32_16x16x32_bf16 v[20:23], a[200:203], v[148:151], v[20:23]
    ds_read_b64_tr_b16 v[174:175], v227 offset:4096
    v_mfma_f32_16x16x32_bf16 a[16:19], a[200:203], v[152:155], a[16:19]
    v_exp_f32 v87, v87
    v_mfma_f32_16x16x32_bf16 a[20:23], a[200:203], v[156:159], a[20:23]
    ds_read_b64_tr_b16 v[176:177], v228 offset:0
    v_cvt_pk_bf16_f32 v139, v86, v87
    v_mfma_f32_16x16x32_bf16 v[24:27], a[204:207], v[144:147], v[24:27]
    v_exp_f32 v88, v88
    v_mfma_f32_16x16x32_bf16 v[28:31], a[204:207], v[148:151], v[28:31]
    ds_read_b64_tr_b16 v[178:179], v228 offset:4096
    v_mfma_f32_16x16x32_bf16 a[24:27], a[204:207], v[152:155], a[24:27]
    v_exp_f32 v89, v89
    v_mfma_f32_16x16x32_bf16 a[28:31], a[204:207], v[156:159], a[28:31]
    ds_read_b64_tr_b16 v[180:181], v229 offset:0
    v_cvt_pk_bf16_f32 v140, v88, v89
    v_mfma_f32_16x16x32_bf16 v[32:35], a[208:211], v[144:147], v[32:35]
    v_exp_f32 v90, v90
    v_mfma_f32_16x16x32_bf16 v[36:39], a[208:211], v[148:151], v[36:39]
    ds_read_b64_tr_b16 v[182:183], v229 offset:4096
    v_mfma_f32_16x16x32_bf16 a[32:35], a[208:211], v[152:155], a[32:35]
    ds_read_b64_tr_b16 v[184:185], v230 offset:0
    v_exp_f32 v91, v91
    v_mfma_f32_16x16x32_bf16 a[36:39], a[208:211], v[156:159], a[36:39]
    ds_read_b64_tr_b16 v[186:187], v230 offset:4096
    v_cvt_pk_bf16_f32 v141, v90, v91
    v_mfma_f32_16x16x32_bf16 v[40:43], a[212:215], v[144:147], v[40:43]
    v_exp_f32 v92, v92
    v_mfma_f32_16x16x32_bf16 v[44:47], a[212:215], v[148:151], v[44:47]
    ds_read_b64_tr_b16 v[188:189], v231 offset:0
    v_mfma_f32_16x16x32_bf16 a[40:43], a[212:215], v[152:155], a[40:43]
    v_exp_f32 v93, v93
    v_mfma_f32_16x16x32_bf16 a[44:47], a[212:215], v[156:159], a[44:47]
    ds_read_b64_tr_b16 v[190:191], v231 offset:4096
    v_cvt_pk_bf16_f32 v142, v92, v93
    v_mfma_f32_16x16x32_bf16 v[48:51], a[216:219], v[144:147], v[48:51]
    v_exp_f32 v94, v94
    v_mfma_f32_16x16x32_bf16 v[52:55], a[216:219], v[148:151], v[52:55]
    v_mfma_f32_16x16x32_bf16 a[48:51], a[216:219], v[152:155], a[48:51]
    v_exp_f32 v95, v95
    v_mfma_f32_16x16x32_bf16 a[52:55], a[216:219], v[156:159], a[52:55]
    v_cvt_pk_bf16_f32 v143, v94, v95
    v_mfma_f32_16x16x32_bf16 v[56:59], a[220:223], v[144:147], v[56:59]
    v_mfma_f32_16x16x32_bf16 v[60:63], a[220:223], v[148:151], v[60:63]
    v_mfma_f32_16x16x32_bf16 a[56:59], a[220:223], v[152:155], a[56:59]
    v_mfma_f32_16x16x32_bf16 a[60:63], a[220:223], v[156:159], a[60:63]
    s_waitcnt lgkmcnt(0)
    v_pk_fma_f32 v[96:97], v[96:97], s[26:27], v[244:245] op_sel:[0,0,0] op_sel_hi:[1,0,0]
    v_pk_fma_f32 v[98:99], v[98:99], s[26:27], v[244:245] op_sel:[0,0,0] op_sel_hi:[1,0,0]
    v_pk_fma_f32 v[100:101], v[100:101], s[26:27], v[244:245] op_sel:[0,0,0] op_sel_hi:[1,0,0]
    v_pk_fma_f32 v[102:103], v[102:103], s[26:27], v[244:245] op_sel:[0,0,0] op_sel_hi:[1,0,0]
    v_pk_fma_f32 v[104:105], v[104:105], s[26:27], v[244:245] op_sel:[0,0,1] op_sel_hi:[1,0,1]
    v_pk_fma_f32 v[106:107], v[106:107], s[26:27], v[244:245] op_sel:[0,0,1] op_sel_hi:[1,0,1]
    v_pk_fma_f32 v[108:109], v[108:109], s[26:27], v[244:245] op_sel:[0,0,1] op_sel_hi:[1,0,1]
    v_pk_fma_f32 v[110:111], v[110:111], s[26:27], v[244:245] op_sel:[0,0,1] op_sel_hi:[1,0,1]
    v_pk_fma_f32 v[112:113], v[112:113], s[26:27], v[246:247] op_sel:[0,0,0] op_sel_hi:[1,0,0]
    v_pk_fma_f32 v[114:115], v[114:115], s[26:27], v[246:247] op_sel:[0,0,0] op_sel_hi:[1,0,0]
    v_pk_fma_f32 v[116:117], v[116:117], s[26:27], v[246:247] op_sel:[0,0,0] op_sel_hi:[1,0,0]
    v_pk_fma_f32 v[118:119], v[118:119], s[26:27], v[246:247] op_sel:[0,0,0] op_sel_hi:[1,0,0]
    v_pk_fma_f32 v[120:121], v[120:121], s[26:27], v[246:247] op_sel:[0,0,1] op_sel_hi:[1,0,1]
    v_pk_fma_f32 v[122:123], v[122:123], s[26:27], v[246:247] op_sel:[0,0,1] op_sel_hi:[1,0,1]
    v_pk_fma_f32 v[124:125], v[124:125], s[26:27], v[246:247] op_sel:[0,0,1] op_sel_hi:[1,0,1]
    v_pk_fma_f32 v[126:127], v[126:127], s[26:27], v[246:247] op_sel:[0,0,1] op_sel_hi:[1,0,1]
    s_nop 1
    v_mfma_f32_16x16x32_bf16 a[224:227], a[240:243], v[128:131], a[224:227]
    ds_read_b64_tr_b16 a[192:193], v224 offset:24576
    v_exp_f32 v96, v96
    v_mfma_f32_16x16x32_bf16 a[228:231], a[240:243], v[132:135], a[228:231]
    ds_read_b64_tr_b16 a[194:195], v224 offset:28672
    v_exp_f32 v97, v97
    v_mfma_f32_16x16x32_bf16 a[232:235], a[240:243], v[136:139], a[232:235]
    ds_read_b64_tr_b16 a[196:197], v225 offset:24576
    v_exp_f32 v98, v98
    v_cvt_pk_bf16_f32 v144, v96, v97
    v_mfma_f32_16x16x32_bf16 a[236:239], a[240:243], v[140:143], a[236:239]
    ds_read_b64_tr_b16 a[198:199], v225 offset:28672
    v_exp_f32 v99, v99
    v_mfma_f32_16x16x32_bf16 v[0:3], v[160:163], v[128:131], v[0:3]
    v_exp_f32 v100, v100
    v_mfma_f32_16x16x32_bf16 v[4:7], v[160:163], v[132:135], v[4:7]
    ds_read_b64_tr_b16 a[200:201], v226 offset:24576
    v_cvt_pk_bf16_f32 v145, v98, v99
    v_exp_f32 v101, v101
    v_mfma_f32_16x16x32_bf16 a[0:3], v[160:163], v[136:139], a[0:3]
    v_exp_f32 v102, v102
    v_mfma_f32_16x16x32_bf16 a[4:7], v[160:163], v[140:143], a[4:7]
    ds_read_b64_tr_b16 a[202:203], v226 offset:28672
    v_cvt_pk_bf16_f32 v146, v100, v101
    v_mfma_f32_16x16x32_bf16 v[8:11], v[164:167], v[128:131], v[8:11]
    ds_read_b64_tr_b16 a[204:205], v227 offset:24576
    v_exp_f32 v103, v103
    v_exp_f32 v104, v104
    v_mfma_f32_16x16x32_bf16 v[12:15], v[164:167], v[132:135], v[12:15]
    v_cvt_pk_bf16_f32 v147, v102, v103
    v_exp_f32 v105, v105
    v_mfma_f32_16x16x32_bf16 a[8:11], v[164:167], v[136:139], a[8:11]
    ds_read_b64_tr_b16 a[206:207], v227 offset:28672
    v_mfma_f32_16x16x32_bf16 a[12:15], v[164:167], v[140:143], a[12:15]
    v_exp_f32 v106, v106
    v_cvt_pk_bf16_f32 v148, v104, v105
    v_mfma_f32_16x16x32_bf16 v[16:19], v[168:171], v[128:131], v[16:19]
    ds_read_b64_tr_b16 a[208:209], v228 offset:24576
    v_exp_f32 v107, v107
    v_mfma_f32_16x16x32_bf16 v[20:23], v[168:171], v[132:135], v[20:23]
    ds_read_b64_tr_b16 a[210:211], v228 offset:28672
    v_exp_f32 v108, v108
    v_cvt_pk_bf16_f32 v149, v106, v107
    v_mfma_f32_16x16x32_bf16 a[16:19], v[168:171], v[136:139], a[16:19]
    s_lshr_b32 s24, s21, 1
    v_exp_f32 v109, v109
    v_mfma_f32_16x16x32_bf16 a[20:23], v[168:171], v[140:143], a[20:23]
    ds_read_b64_tr_b16 a[212:213], v229 offset:24576
    v_exp_f32 v110, v110
    v_mfma_f32_16x16x32_bf16 v[24:27], v[172:175], v[128:131], v[24:27]
    ds_read_b64_tr_b16 a[214:215], v229 offset:28672
    v_cvt_pk_bf16_f32 v150, v108, v109
    v_exp_f32 v111, v111
    v_mfma_f32_16x16x32_bf16 v[28:31], v[172:175], v[132:135], v[28:31]
    v_exp_f32 v112, v112
    v_mfma_f32_16x16x32_bf16 a[24:27], v[172:175], v[136:139], a[24:27]
    ds_read_b64_tr_b16 a[216:217], v230 offset:24576
    v_cvt_pk_bf16_f32 v151, v110, v111
    v_mfma_f32_16x16x32_bf16 a[28:31], v[172:175], v[140:143], a[28:31]
    v_exp_f32 v113, v113
    v_exp_f32 v114, v114
    v_mfma_f32_16x16x32_bf16 v[32:35], v[176:179], v[128:131], v[32:35]
    ds_read_b64_tr_b16 a[218:219], v230 offset:28672
    v_cvt_pk_bf16_f32 v152, v112, v113
    v_mfma_f32_16x16x32_bf16 v[36:39], v[176:179], v[132:135], v[36:39]
    ds_read_b64_tr_b16 a[220:221], v231 offset:24576
    v_exp_f32 v115, v115
    v_mfma_f32_16x16x32_bf16 a[32:35], v[176:179], v[136:139], a[32:35]
    v_exp_f32 v116, v116
    v_cvt_pk_bf16_f32 v153, v114, v115
    v_mfma_f32_16x16x32_bf16 a[36:39], v[176:179], v[140:143], a[36:39]
    ds_read_b64_tr_b16 a[222:223], v231 offset:28672
    v_exp_f32 v117, v117
    v_mfma_f32_16x16x32_bf16 v[40:43], v[180:183], v[128:131], v[40:43]
    v_exp_f32 v118, v118
    v_cvt_pk_bf16_f32 v154, v116, v117
    v_mfma_f32_16x16x32_bf16 v[44:47], v[180:183], v[132:135], v[44:47]
    v_exp_f32 v119, v119
    v_mfma_f32_16x16x32_bf16 a[40:43], v[180:183], v[136:139], a[40:43]
    v_exp_f32 v120, v120
    v_mfma_f32_16x16x32_bf16 a[44:47], v[180:183], v[140:143], a[44:47]
    v_cvt_pk_bf16_f32 v155, v118, v119
    v_exp_f32 v121, v121
    v_mfma_f32_16x16x32_bf16 v[48:51], v[184:187], v[128:131], v[48:51]
    v_exp_f32 v122, v122
    v_mfma_f32_16x16x32_bf16 v[52:55], v[184:187], v[132:135], v[52:55]
    v_cvt_pk_bf16_f32 v156, v120, v121
    v_mfma_f32_16x16x32_bf16 a[48:51], v[184:187], v[136:139], a[48:51]
    v_exp_f32 v123, v123
    v_exp_f32 v124, v124
    v_mfma_f32_16x16x32_bf16 a[52:55], v[184:187], v[140:143], a[52:55]
    v_cvt_pk_bf16_f32 v157, v122, v123
    v_mfma_f32_16x16x32_bf16 v[56:59], v[188:191], v[128:131], v[56:59]
    v_exp_f32 v125, v125
    v_mfma_f32_16x16x32_bf16 v[60:63], v[188:191], v[132:135], v[60:63]
    v_exp_f32 v126, v126
    v_cvt_pk_bf16_f32 v158, v124, v125
    v_mfma_f32_16x16x32_bf16 a[56:59], v[188:191], v[136:139], a[56:59]
    v_exp_f32 v127, v127
    v_mfma_f32_16x16x32_bf16 a[60:63], v[188:191], v[140:143], a[60:63]
    s_nop 0
    v_cvt_pk_bf16_f32 v159, v126, v127
L_tail:
    s_waitcnt lgkmcnt(0)
    v_mfma_f32_16x16x32_bf16 a[224:227], a[240:243], v[144:147], a[224:227]
    v_mfma_f32_16x16x32_bf16 v[0:3], a[192:195], v[144:147], v[0:3]
    v_mfma_f32_16x16x32_bf16 v[8:11], a[196:199], v[144:147], v[8:11]
    v_mfma_f32_16x16x32_bf16 v[16:19], a[200:203], v[144:147], v[16:19]
    v_mfma_f32_16x16x32_bf16 v[24:27], a[204:207], v[144:147], v[24:27]
    v_mfma_f32_16x16x32_bf16 v[32:35], a[208:211], v[144:147], v[32:35]
    v_mfma_f32_16x16x32_bf16 v[40:43], a[212:215], v[144:147], v[40:43]
    v_mfma_f32_16x16x32_bf16 v[48:51], a[216:219], v[144:147], v[48:51]
    v_mfma_f32_16x16x32_bf16 v[56:59], a[220:223], v[144:147], v[56:59]
    v_mfma_f32_16x16x32_bf16 a[228:231], a[240:243], v[148:151], a[228:231]
    v_mfma_f32_16x16x32_bf16 v[4:7], a[192:195], v[148:151], v[4:7]
    v_mfma_f32_16x16x32_bf16 v[12:15], a[196:199], v[148:151], v[12:15]
    v_accvgpr_read_b32 v248, a224
    v_rcp_f32 v248, v248
    s_nop 0
    v_mfma_f32_16x16x32_bf16 v[20:23], a[200:203], v[148:151], v[20:23]
    v_mul_f32 v0, v0, v248
    v_mul_f32 v1, v1, v248
    v_mfma_f32_16x16x32_bf16 v[28:31], a[204:207], v[148:151], v[28:31]
    v_mul_f32 v2, v2, v248
    v_mul_f32 v3, v3, v248
    v_mfma_f32_16x16x32_bf16 v[36:39], a[208:211], v[148:151], v[36:39]
    v_cvt_pk_bf16_f32 v0, v0, v1
    v_cvt_pk_bf16_f32 v1, v2, v3
    v_mfma_f32_16x16x32_bf16 v[44:47], a[212:215], v[148:151], v[44:47]
    ds_write_b64 v240, v[0:1] offset:0
    v_mul_f32 v8, v8, v248
    v_mul_f32 v9, v9, v248
    v_mfma_f32_16x16x32_bf16 v[52:55], a[216:219], v[148:151], v[52:55]
    v_mul_f32 v10, v10, v248
    v_mul_f32 v11, v11, v248
    v_mfma_f32_16x16x32_bf16 v[60:63], a[220:223], v[148:151], v[60:63]
    v_cvt_pk_bf16_f32 v8, v8, v9
    v_cvt_pk_bf16_f32 v9, v10, v11
    v_mfma_f32_16x16x32_bf16 a[232:235], a[240:243], v[152:155], a[232:235]
    ds_write_b64 v241, v[8:9] offset:0
    v_mul_f32 v16, v16, v248
    v_mul_f32 v17, v17, v248
    v_mfma_f32_16x16x32_bf16 a[0:3], a[192:195], v[152:155], a[0:3]
    v_mul_f32 v18, v18, v248
    v_mul_f32 v19, v19, v248
    v_mfma_f32_16x16x32_bf16 a[8:11], a[196:199], v[152:155], a[8:11]
    v_cvt_pk_bf16_f32 v16, v16, v17
    v_cvt_pk_bf16_f32 v17, v18, v19
    v_mfma_f32_16x16x32_bf16 a[16:19], a[200:203], v[152:155], a[16:19]
    ds_write_b64 v242, v[16:17] offset:0
    v_mul_f32 v24, v24, v248
    v_mul_f32 v25, v25, v248
    v_mfma_f32_16x16x32_bf16 a[24:27], a[204:207], v[152:155], a[24:27]
    v_mul_f32 v26, v26, v248
    v_mul_f32 v27, v27, v248
    v_mfma_f32_16x16x32_bf16 a[32:35], a[208:211], v[152:155], a[32:35]
    v_cvt_pk_bf16_f32 v24, v24, v25
    v_cvt_pk_bf16_f32 v25, v26, v27
    v_mfma_f32_16x16x32_bf16 a[40:43], a[212:215], v[152:155], a[40:43]
    ds_write_b64 v243, v[24:25] offset:0
    v_mul_f32 v32, v32, v248
    v_mul_f32 v33, v33, v248
    v_mfma_f32_16x16x32_bf16 a[48:51], a[216:219], v[152:155], a[48:51]
    v_mul_f32 v34, v34, v248
    v_mul_f32 v35, v35, v248
    v_mfma_f32_16x16x32_bf16 a[56:59], a[220:223], v[152:155], a[56:59]
    v_cvt_pk_bf16_f32 v32, v32, v33
    v_cvt_pk_bf16_f32 v33, v34, v35
    v_mfma_f32_16x16x32_bf16 a[236:239], a[240:243], v[156:159], a[236:239]
    ds_write_b64 v240, v[32:33] offset:128
    v_mul_f32 v40, v40, v248
    v_mul_f32 v41, v41, v248
    v_mfma_f32_16x16x32_bf16 a[4:7], a[192:195], v[156:159], a[4:7]
    v_mul_f32 v42, v42, v248
    v_mul_f32 v43, v43, v248
    v_mfma_f32_16x16x32_bf16 a[12:15], a[196:199], v[156:159], a[12:15]
    v_cvt_pk_bf16_f32 v40, v40, v41
    v_cvt_pk_bf16_f32 v41, v42, v43
    v_mfma_f32_16x16x32_bf16 a[20:23], a[200:203], v[156:159], a[20:23]
    ds_write_b64 v241, v[40:41] offset:128
    v_mul_f32 v48, v48, v248
    v_mul_f32 v49, v49, v248
    v_mfma_f32_16x16x32_bf16 a[28:31], a[204:207], v[156:159], a[28:31]
    v_mul_f32 v50, v50, v248
    v_mul_f32 v51, v51, v248
    v_mfma_f32_16x16x32_bf16 a[36:39], a[208:211], v[156:159], a[36:39]
    v_cvt_pk_bf16_f32 v48, v48, v49
    v_cvt_pk_bf16_f32 v49, v50, v51
    v_mfma_f32_16x16x32_bf16 a[44:47], a[212:215], v[156:159], a[44:47]
    ds_write_b64 v242, v[48:49] offset:128
    v_mul_f32 v56, v56, v248
    v_mul_f32 v57, v57, v248
    v_mfma_f32_16x16x32_bf16 a[52:55], a[216:219], v[156:159], a[52:55]
    v_mul_f32 v58, v58, v248
    v_mul_f32 v59, v59, v248
    v_mfma_f32_16x16x32_bf16 a[60:63], a[220:223], v[156:159], a[60:63]
    v_cvt_pk_bf16_f32 v56, v56, v57
    v_cvt_pk_bf16_f32 v57, v58, v59
    ds_write_b64 v243, v[56:57] offset:128
    ds_read_b128 v[64:67], v215 offset:0
    ds_read_b128 v[68:71], v215 offset:1024
    ds_read_b128 v[72:75], v215 offset:2048
    ds_read_b128 v[76:79], v215 offset:3072
    v_accvgpr_read_b32 v249, a228
    v_rcp_f32 v249, v249
    s_nop 0
    v_pk_mul_f32 v[4:5], v[4:5], v[248:249] op_sel:[0,1] op_sel_hi:[1,1]
    v_pk_mul_f32 v[6:7], v[6:7], v[248:249] op_sel:[0,1] op_sel_hi:[1,1]
    v_cvt_pk_bf16_f32 v4, v4, v5
    v_cvt_pk_bf16_f32 v5, v6, v7
    v_pk_mul_f32 v[12:13], v[12:13], v[248:249] op_sel:[0,1] op_sel_hi:[1,1]
    v_pk_mul_f32 v[14:15], v[14:15], v[248:249] op_sel:[0,1] op_sel_hi:[1,1]
    v_cvt_pk_bf16_f32 v12, v12, v13
    v_cvt_pk_bf16_f32 v13, v14, v15
    v_pk_mul_f32 v[20:21], v[20:21], v[248:249] op_sel:[0,1] op_sel_hi:[1,1]
    v_pk_mul_f32 v[22:23], v[22:23], v[248:249] op_sel:[0,1] op_sel_hi:[1,1]
    v_cvt_pk_bf16_f32 v20, v20, v21
    v_cvt_pk_bf16_f32 v21, v22, v23
    v_pk_mul_f32 v[28:29], v[28:29], v[248:249] op_sel:[0,1] op_sel_hi:[1,1]
    v_pk_mul_f32 v[30:31], v[30:31], v[248:249] op_sel:[0,1] op_sel_hi:[1,1]
    v_cvt_pk_bf16_f32 v28, v28, v29
    v_cvt_pk_bf16_f32 v29, v30, v31
    s_add_u32 s35, s24, 0
    s_waitcnt lgkmcnt(3)
    buffer_store_dwordx4 v[64:67], v236, s[16:19], s35 offen offset:0 sc1
    s_waitcnt lgkmcnt(2)
    buffer_store_dwordx4 v[68:71], v237, s[16:19], s35 offen offset:1024 sc1
    s_add_u32 s35, s24, 2048
    s_waitcnt lgkmcnt(1)
    buffer_store_dwordx4 v[72:75], v236, s[16:19], s35 offen offset:0 sc1
    s_waitcnt lgkmcnt(0)
    buffer_store_dwordx4 v[76:79], v237, s[16:19], s35 offen offset:1024 sc1
    ds_write_b64 v240, v[4:5] offset:4096
    ds_write_b64 v241, v[12:13] offset:4096
    ds_write_b64 v242, v[20:21] offset:4096
    ds_write_b64 v243, v[28:29] offset:4096
    v_pk_mul_f32 v[36:37], v[36:37], v[248:249] op_sel:[0,1] op_sel_hi:[1,1]
    v_pk_mul_f32 v[38:39], v[38:39], v[248:249] op_sel:[0,1] op_sel_hi:[1,1]
    v_cvt_pk_bf16_f32 v36, v36, v37
    v_cvt_pk_bf16_f32 v37, v38, v39
    v_pk_mul_f32 v[44:45], v[44:45], v[248:249] op_sel:[0,1] op_sel_hi:[1,1]
    v_pk_mul_f32 v[46:47], v[46:47], v[248:249] op_sel:[0,1] op_sel_hi:[1,1]
    v_cvt_pk_bf16_f32 v44, v44, v45
    v_cvt_pk_bf16_f32 v45, v46, v47
    v_pk_mul_f32 v[52:53], v[52:53], v[248:249] op_sel:[0,1] op_sel_hi:[1,1]
    v_pk_mul_f32 v[54:55], v[54:55], v[248:249] op_sel:[0,1] op_sel_hi:[1,1]
    v_cvt_pk_bf16_f32 v52, v52, v53
    v_cvt_pk_bf16_f32 v53, v54, v55
    v_pk_mul_f32 v[60:61], v[60:61], v[248:249] op_sel:[0,1] op_sel_hi:[1,1]
    v_pk_mul_f32 v[62:63], v[62:63], v[248:249] op_sel:[0,1] op_sel_hi:[1,1]
    v_cvt_pk_bf16_f32 v60, v60, v61
    v_cvt_pk_bf16_f32 v61, v62, v63
    ds_write_b64 v240, v[36:37] offset:4224
    ds_write_b64 v241, v[44:45] offset:4224
    ds_write_b64 v242, v[52:53] offset:4224
    ds_write_b64 v243, v[60:61] offset:4224
    ds_read_b128 v[80:83], v215 offset:4096
    ds_read_b128 v[84:87], v215 offset:5120
    ds_read_b128 v[88:91], v215 offset:6144
    ds_read_b128 v[92:95], v215 offset:7168
    v_accvgpr_read_b32 v250, a232
    v_rcp_f32 v250, v250
    s_nop 0
    v_accvgpr_read_b32 v160, a0
    v_accvgpr_read_b32 v161, a1
    v_accvgpr_read_b32 v162, a2
    v_accvgpr_read_b32 v163, a3
    v_pk_mul_f32 v[160:161], v[160:161], v[250:251] op_sel:[0,0] op_sel_hi:[1,0]
    v_pk_mul_f32 v[162:163], v[162:163], v[250:251] op_sel:[0,0] op_sel_hi:[1,0]
    v_cvt_pk_bf16_f32 v160, v160, v161
    v_cvt_pk_bf16_f32 v161, v162, v163
    v_accvgpr_read_b32 v164, a8
    v_accvgpr_read_b32 v165, a9
    v_accvgpr_read_b32 v166, a10
    v_accvgpr_read_b32 v167, a11
    v_pk_mul_f32 v[164:165], v[164:165], v[250:251] op_sel:[0,0] op_sel_hi:[1,0]
    v_pk_mul_f32 v[166:167], v[166:167], v[250:251] op_sel:[0,0] op_sel_hi:[1,0]
    v_cvt_pk_bf16_f32 v164, v164, v165
    v_cvt_pk_bf16_f32 v165, v166, v167
    v_accvgpr_read_b32 v168, a16
    v_accvgpr_read_b32 v169, a17
    v_accvgpr_read_b32 v170, a18
    v_accvgpr_read_b32 v171, a19
    v_pk_mul_f32 v[168:169], v[168:169], v[250:251] op_sel:[0,0] op_sel_hi:[1,0]
    v_pk_mul_f32 v[170:171], v[170:171], v[250:251] op_sel:[0,0] op_sel_hi:[1,0]
    v_cvt_pk_bf16_f32 v168, v168, v169
    v_cvt_pk_bf16_f32 v169, v170, v171
    v_accvgpr_read_b32 v172, a24
    v_accvgpr_read_b32 v173, a25
    v_accvgpr_read_b32 v174, a26
    v_accvgpr_read_b32 v175, a27
    v_pk_mul_f32 v[172:173], v[172:173], v[250:251] op_sel:[0,0] op_sel_hi:[1,0]
    v_pk_mul_f32 v[174:175], v[174:175], v[250:251] op_sel:[0,0] op_sel_hi:[1,0]
    v_cvt_pk_bf16_f32 v172, v172, v173
    v_cvt_pk_bf16_f32 v173, v174, v175
    s_add_u32 s35, s24, 4096
    s_waitcnt lgkmcnt(3)
    buffer_store_dwordx4 v[80:83], v236, s[16:19], s35 offen offset:0 sc1
    s_waitcnt lgkmcnt(2)
    buffer_store_dwordx4 v[84:87], v237, s[16:19], s35 offen offset:1024 sc1
    s_add_u32 s35, s24, 6144
    s_waitcnt lgkmcnt(1)
    buffer_store_dwordx4 v[88:91], v236, s[16:19], s35 offen offset:0 sc1
    s_waitcnt lgkmcnt(0)
    buffer_store_dwordx4 v[92:95], v237, s[16:19], s35 offen offset:1024 sc1
    ds_write_b64 v240, v[160:161] offset:8192
    ds_write_b64 v241, v[164:165] offset:8192
    ds_write_b64 v242, v[168:169] offset:8192
    ds_write_b64 v243, v[172:173] offset:8192
    v_accvgpr_read_b32 v176, a32
    v_accvgpr_read_b32 v177, a33
    v_accvgpr_read_b32 v178, a34
    v_accvgpr_read_b32 v179, a35
    v_pk_mul_f32 v[176:177], v[176:177], v[250:251] op_sel:[0,0] op_sel_hi:[1,0]
    v_pk_mul_f32 v[178:179], v[178:179], v[250:251] op_sel:[0,0] op_sel_hi:[1,0]
    v_cvt_pk_bf16_f32 v176, v176, v177
    v_cvt_pk_bf16_f32 v177, v178, v179
    v_accvgpr_read_b32 v180, a40
    v_accvgpr_read_b32 v181, a41
    v_accvgpr_read_b32 v182, a42
    v_accvgpr_read_b32 v183, a43
    v_pk_mul_f32 v[180:181], v[180:181], v[250:251] op_sel:[0,0] op_sel_hi:[1,0]
    v_pk_mul_f32 v[182:183], v[182:183], v[250:251] op_sel:[0,0] op_sel_hi:[1,0]
    v_cvt_pk_bf16_f32 v180, v180, v181
    v_cvt_pk_bf16_f32 v181, v182, v183
    v_accvgpr_read_b32 v184, a48
    v_accvgpr_read_b32 v185, a49
    v_accvgpr_read_b32 v186, a50
    v_accvgpr_read_b32 v187, a51
    v_pk_mul_f32 v[184:185], v[184:185], v[250:251] op_sel:[0,0] op_sel_hi:[1,0]
    v_pk_mul_f32 v[186:187], v[186:187], v[250:251] op_sel:[0,0] op_sel_hi:[1,0]
    v_cvt_pk_bf16_f32 v184, v184, v185
    v_cvt_pk_bf16_f32 v185, v186, v187
    v_accvgpr_read_b32 v188, a56
    v_accvgpr_read_b32 v189, a57
    v_accvgpr_read_b32 v190, a58
    v_accvgpr_read_b32 v191, a59
    v_pk_mul_f32 v[188:189], v[188:189], v[250:251] op_sel:[0,0] op_sel_hi:[1,0]
    v_pk_mul_f32 v[190:191], v[190:191], v[250:251] op_sel:[0,0] op_sel_hi:[1,0]
    v_cvt_pk_bf16_f32 v188, v188, v189
    v_cvt_pk_bf16_f32 v189, v190, v191
    ds_write_b64 v240, v[176:177] offset:8320
    ds_write_b64 v241, v[180:181] offset:8320
    ds_write_b64 v242, v[184:185] offset:8320
    ds_write_b64 v243, v[188:189] offset:8320
    ds_read_b128 v[96:99], v215 offset:8192
    ds_read_b128 v[100:103], v215 offset:9216
    ds_read_b128 v[104:107], v215 offset:10240
    ds_read_b128 v[108:111], v215 offset:11264
    v_accvgpr_read_b32 v251, a236
    v_rcp_f32 v251, v251
    s_nop 0
    v_accvgpr_read_b32 v160, a4
    v_accvgpr_read_b32 v161, a5
    v_accvgpr_read_b32 v162, a6
    v_accvgpr_read_b32 v163, a7
    v_pk_mul_f32 v[160:161], v[160:161], v[250:251] op_sel:[0,1] op_sel_hi:[1,1]
    v_pk_mul_f32 v[162:163], v[162:163], v[250:251] op_sel:[0,1] op_sel_hi:[1,1]
    v_cvt_pk_bf16_f32 v160, v160, v161
    v_cvt_pk_bf16_f32 v161, v162, v163
    v_accvgpr_read_b32 v164, a12
    v_accvgpr_read_b32 v165, a13
    v_accvgpr_read_b32 v166, a14
    v_accvgpr_read_b32 v167, a15
    v_pk_mul_f32 v[164:165], v[164:165], v[250:251] op_sel:[0,1] op_sel_hi:[1,1]
    v_pk_mul_f32 v[166:167], v[166:167], v[250:251] op_sel:[0,1] op_sel_hi:[1,1]
    v_cvt_pk_bf16_f32 v164, v164, v165
    v_cvt_pk_bf16_f32 v165, v166, v167
    v_accvgpr_read_b32 v168, a20
    v_accvgpr_read_b32 v169, a21
    v_accvgpr_read_b32 v170, a22
    v_accvgpr_read_b32 v171, a23
    v_pk_mul_f32 v[168:169], v[168:169], v[250:251] op_sel:[0,1] op_sel_hi:[1,1]
    v_pk_mul_f32 v[170:171], v[170:171], v[250:251] op_sel:[0,1] op_sel_hi:[1,1]
    v_cvt_pk_bf16_f32 v168, v168, v169
    v_cvt_pk_bf16_f32 v169, v170, v171
    v_accvgpr_read_b32 v172, a28
    v_accvgpr_read_b32 v173, a29
    v_accvgpr_read_b32 v174, a30
    v_accvgpr_read_b32 v175, a31
    v_pk_mul_f32 v[172:173], v[172:173], v[250:251] op_sel:[0,1] op_sel_hi:[1,1]
    v_pk_mul_f32 v[174:175], v[174:175], v[250:251] op_sel:[0,1] op_sel_hi:[1,1]
    v_cvt_pk_bf16_f32 v172, v172, v173
    v_cvt_pk_bf16_f32 v173, v174, v175
    s_add_u32 s35, s24, 16384
    s_waitcnt lgkmcnt(3)
    buffer_store_dwordx4 v[96:99], v236, s[16:19], s35 offen offset:0 sc1
    s_waitcnt lgkmcnt(2)
    buffer_store_dwordx4 v[100:103], v237, s[16:19], s35 offen offset:1024 sc1
    s_add_u32 s35, s24, 18432
    s_waitcnt lgkmcnt(1)
    buffer_store_dwordx4 v[104:107], v236, s[16:19], s35 offen offset:0 sc1
    s_waitcnt lgkmcnt(0)
    buffer_store_dwordx4 v[108:111], v237, s[16:19], s35 offen offset:1024 sc1
    ds_write_b64 v240, v[160:161] offset:12288
    ds_write_b64 v241, v[164:165] offset:12288
    ds_write_b64 v242, v[168:169] offset:12288
    ds_write_b64 v243, v[172:173] offset:12288
    v_accvgpr_read_b32 v176, a36
    v_accvgpr_read_b32 v177, a37
    v_accvgpr_read_b32 v178, a38
    v_accvgpr_read_b32 v179, a39
    v_pk_mul_f32 v[176:177], v[176:177], v[250:251] op_sel:[0,1] op_sel_hi:[1,1]
    v_pk_mul_f32 v[178:179], v[178:179], v[250:251] op_sel:[0,1] op_sel_hi:[1,1]
    v_cvt_pk_bf16_f32 v176, v176, v177
    v_cvt_pk_bf16_f32 v177, v178, v179
    v_accvgpr_read_b32 v180, a44
    v_accvgpr_read_b32 v181, a45
    v_accvgpr_read_b32 v182, a46
    v_accvgpr_read_b32 v183, a47
    v_pk_mul_f32 v[180:181], v[180:181], v[250:251] op_sel:[0,1] op_sel_hi:[1,1]
    v_pk_mul_f32 v[182:183], v[182:183], v[250:251] op_sel:[0,1] op_sel_hi:[1,1]
    v_cvt_pk_bf16_f32 v180, v180, v181
    v_cvt_pk_bf16_f32 v181, v182, v183
    v_accvgpr_read_b32 v184, a52
    v_accvgpr_read_b32 v185, a53
    v_accvgpr_read_b32 v186, a54
    v_accvgpr_read_b32 v187, a55
    v_pk_mul_f32 v[184:185], v[184:185], v[250:251] op_sel:[0,1] op_sel_hi:[1,1]
    v_pk_mul_f32 v[186:187], v[186:187], v[250:251] op_sel:[0,1] op_sel_hi:[1,1]
    v_cvt_pk_bf16_f32 v184, v184, v185
    v_cvt_pk_bf16_f32 v185, v186, v187
    v_accvgpr_read_b32 v188, a60
    v_accvgpr_read_b32 v189, a61
    v_accvgpr_read_b32 v190, a62
    v_accvgpr_read_b32 v191, a63
    v_pk_mul_f32 v[188:189], v[188:189], v[250:251] op_sel:[0,1] op_sel_hi:[1,1]
    v_pk_mul_f32 v[190:191], v[190:191], v[250:251] op_sel:[0,1] op_sel_hi:[1,1]
    v_cvt_pk_bf16_f32 v188, v188, v189
    v_cvt_pk_bf16_f32 v189, v190, v191
    ds_write_b64 v240, v[176:177] offset:12416
    ds_write_b64 v241, v[180:181] offset:12416
    ds_write_b64 v242, v[184:185] offset:12416
    ds_write_b64 v243, v[188:189] offset:12416
    ds_read_b128 v[112:115], v215 offset:12288
    ds_read_b128 v[116:119], v215 offset:13312
    ds_read_b128 v[120:123], v215 offset:14336
    ds_read_b128 v[124:127], v215 offset:15360
    s_add_u32 s35, s24, 20480
    s_waitcnt lgkmcnt(3)
    buffer_store_dwordx4 v[112:115], v236, s[16:19], s35 offen offset:0 sc1
    s_waitcnt lgkmcnt(2)
    buffer_store_dwordx4 v[116:119], v237, s[16:19], s35 offen offset:1024 sc1
    s_add_u32 s35, s24, 22528
    s_waitcnt lgkmcnt(1)
    buffer_store_dwordx4 v[120:123], v236, s[16:19], s35 offen offset:0 sc1
    s_waitcnt lgkmcnt(0)
    buffer_store_dwordx4 v[124:127], v237, s[16:19], s35 offen offset:1024 sc1
    s_cmp_lg_u32 s40, 0
    s_cbranch_scc1 L_redo
    v_accvgpr_read_b32 v200, a224
    v_accvgpr_read_b32 v201, a228
    v_accvgpr_read_b32 v202, a232
    v_accvgpr_read_b32 v203, a236
    v_add_f32 v214, v200, v201
    v_add_f32 v214, v214, v202
    v_add_f32 v214, v214, v203
    v_cmp_nge_f32 vcc, s39, v214
    s_nop 4
    s_cmp_lg_u64 vcc, 0
    s_addc_u32 s38, s38, s38
    s_cmp_lg_u32 s38, 0
    s_cbranch_scc1 L_redo0
L_end:
    s_endpgm
L_redo0:
    s_mov_b32 s40, 1
    s_add_u32 s20, s20, 131072
    v_and_b32 v216, 0xfff, v216
    v_add_u32 v216, s29, v216
    v_and_b32 v192, 0x3ff, v236
    v_and_b32 v217, 0xfff, v217
    v_add_u32 v217, s29, v217
    v_and_b32 v193, 0x3ff, v237
    v_and_b32 v218, 0xfff, v218
    v_add_u32 v218, s29, v218
    v_and_b32 v194, 0x3ff, v238
    v_and_b32 v219, 0xfff, v219
    v_add_u32 v219, s29, v219
    v_and_b32 v195, 0x3ff, v239
    v_and_b32 v224, 0xfff, v224
    v_add_u32 v224, s29, v224
    v_and_b32 v225, 0xfff, v225
    v_add_u32 v225, s29, v225
    v_and_b32 v226, 0xfff, v226
    v_add_u32 v226, s29, v226
    v_and_b32 v227, 0xfff, v227
    v_add_u32 v227, s29, v227
    v_and_b32 v228, 0xfff, v228
    v_add_u32 v228, s29, v228
    v_and_b32 v229, 0xfff, v229
    v_add_u32 v229, s29, v229
    v_and_b32 v230, 0xfff, v230
    v_add_u32 v230, s29, v230
    v_and_b32 v231, 0xfff, v231
    v_add_u32 v231, s29, v231
    v_and_b32 v196, 0x3ff, v234
    v_and_b32 v197, 0x3ff, v235
L_redo:
    s_cmp_eq_u32 s38, 0
    s_cbranch_scc1 L_end
    s_sub_u32 s20, s20, 131072
    s_and_b32 s35, s38, 1
    s_lshr_b32 s38, s38, 1
    s_cmp_eq_u32 s35, 0
    s_cbranch_scc1 L_redo
    s_xor_b32 s21, s20, s32
    s_lshr_b32 s23, s21, 1
    s_mov_b32 s24, s23
    s_waitcnt vmcnt(0) lgkmcnt(0)
    s_add_u32 m0, s29, 8192
    s_add_u32 s35, s23, 0
    buffer_load_dwordx4 v236, s[4:7], s35 offen nt lds
    buffer_load_dwordx4 v237, s[4:7], s35 offen offset:1024 nt lds
    s_add_u32 m0, s29, 10240
    s_add_u32 s35, s23, 2048
    buffer_load_dwordx4 v238, s[4:7], s35 offen nt lds
    buffer_load_dwordx4 v239, s[4:7], s35 offen offset:1024 nt lds
    s_add_u32 m0, s29, 12288
    s_add_u32 s35, s23, 4096
    buffer_load_dwordx4 v236, s[4:7], s35 offen nt lds
    buffer_load_dwordx4 v237, s[4:7], s35 offen offset:1024 nt lds
    s_add_u32 m0, s29, 14336
    s_add_u32 s35, s23, 6144
    buffer_load_dwordx4 v238, s[4:7], s35 offen nt lds
    buffer_load_dwordx4 v239, s[4:7], s35 offen offset:1024 nt lds
    s_add_u32 m0, s29, 0
    s_add_u32 s35, s23, 16384
    buffer_load_dwordx4 v236, s[4:7], s35 offen nt lds
    buffer_load_dwordx4 v237, s[4:7], s35 offen offset:1024 nt lds
    s_add_u32 m0, s29, 2048
    s_add_u32 s35, s23, 18432
    buffer_load_dwordx4 v238, s[4:7], s35 offen nt lds
    buffer_load_dwordx4 v239, s[4:7], s35 offen offset:1024 nt lds
    s_add_u32 m0, s29, 4096
    s_add_u32 s35, s23, 20480
    buffer_load_dwordx4 v236, s[4:7], s35 offen nt lds
    buffer_load_dwordx4 v237, s[4:7], s35 offen offset:1024 nt lds
    s_add_u32 m0, s29, 6144
    s_add_u32 s35, s23, 22528
    buffer_load_dwordx4 v238, s[4:7], s35 offen nt lds
    buffer_load_dwordx4 v239, s[4:7], s35 offen offset:1024 nt lds
    v_mov_b32 v0, 0
    v_mov_b32 v1, 0
    v_mov_b32 v2, 0
    v_mov_b32 v3, 0
    v_mov_b32 v4, 0
    v_mov_b32 v5, 0
    v_mov_b32 v6, 0
    v_mov_b32 v7, 0
    v_mov_b32 v8, 0
    v_mov_b32 v9, 0
    v_mov_b32 v10, 0
    v_mov_b32 v11, 0
    v_mov_b32 v12, 0
    v_mov_b32 v13, 0
    v_mov_b32 v14, 0
    v_mov_b32 v15, 0
    v_mov_b32 v16, 0
    v_mov_b32 v17, 0
    v_mov_b32 v18, 0
    v_mov_b32 v19, 0
    v_mov_b32 v20, 0
    v_mov_b32 v21, 0
    v_mov_b32 v22, 0
    v_mov_b32 v23, 0
    v_mov_b32 v24, 0
    v_mov_b32 v25, 0
    v_mov_b32 v26, 0
    v_mov_b32 v27, 0
    v_mov_b32 v28, 0
    v_mov_b32 v29, 0
    v_mov_b32 v30, 0
    v_mov_b32 v31, 0
    v_mov_b32 v32, 0
    v_mov_b32 v33, 0
    v_mov_b32 v34, 0
    v_mov_b32 v35, 0
    v_mov_b32 v36, 0
    v_mov_b32 v37, 0
    v_mov_b32 v38, 0
    v_mov_b32 v39, 0
    v_mov_b32 v40, 0
    v_mov_b32 v41, 0
    v_mov_b32 v42, 0
    v_mov_b32 v43, 0
    v_mov_b32 v44, 0
    v_mov_b32 v45, 0
    v_mov_b32 v46, 0
    v_mov_b32 v47, 0
    v_mov_b32 v48, 0
    v_mov_b32 v49, 0
    v_mov_b32 v50, 0
    v_mov_b32 v51, 0
    v_mov_b32 v52, 0
    v_mov_b32 v53, 0
    v_mov_b32 v54, 0
    v_mov_b32 v55, 0
    v_mov_b32 v56, 0
    v_mov_b32 v57, 0
    v_mov_b32 v58, 0
    v_mov_b32 v59, 0
    v_mov_b32 v60, 0
    v_mov_b32 v61, 0
    v_mov_b32 v62, 0
    v_mov_b32 v63, 0
    v_accvgpr_write_b32 a0, 0
    v_accvgpr_write_b32 a1, 0
    v_accvgpr_write_b32 a2, 0
    v_accvgpr_write_b32 a3, 0
    v_accvgpr_write_b32 a4, 0
    v_accvgpr_write_b32 a5, 0
    v_accvgpr_write_b32 a6, 0
    v_accvgpr_write_b32 a7, 0
    v_accvgpr_write_b32 a8, 0
    v_accvgpr_write_b32 a9, 0
    v_accvgpr_write_b32 a10, 0
    v_accvgpr_write_b32 a11, 0
    v_accvgpr_write_b32 a12, 0
    v_accvgpr_write_b32 a13, 0
    v_accvgpr_write_b32 a14, 0
    v_accvgpr_write_b32 a15, 0
    v_accvgpr_write_b32 a16, 0
    v_accvgpr_write_b32 a17, 0
    v_accvgpr_write_b32 a18, 0
    v_accvgpr_write_b32 a19, 0
    v_accvgpr_write_b32 a20, 0
    v_accvgpr_write_b32 a21, 0
    v_accvgpr_write_b32 a22, 0
    v_accvgpr_write_b32 a23, 0
    v_accvgpr_write_b32 a24, 0
    v_accvgpr_write_b32 a25, 0
    v_accvgpr_write_b32 a26, 0
    v_accvgpr_write_b32 a27, 0
    v_accvgpr_write_b32 a28, 0
    v_accvgpr_write_b32 a29, 0
    v_accvgpr_write_b32 a30, 0
    v_accvgpr_write_b32 a31, 0
    v_accvgpr_write_b32 a32, 0
    v_accvgpr_write_b32 a33, 0
    v_accvgpr_write_b32 a34, 0
    v_accvgpr_write_b32 a35, 0
    v_accvgpr_write_b32 a36, 0
    v_accvgpr_write_b32 a37, 0
    v_accvgpr_write_b32 a38, 0
    v_accvgpr_write_b32 a39, 0
    v_accvgpr_write_b32 a40, 0
    v_accvgpr_write_b32 a41, 0
    v_accvgpr_write_b32 a42, 0
    v_accvgpr_write_b32 a43, 0
    v_accvgpr_write_b32 a44, 0
    v_accvgpr_write_b32 a45, 0
    v_accvgpr_write_b32 a46, 0
    v_accvgpr_write_b32 a47, 0
    v_accvgpr_write_b32 a48, 0
    v_accvgpr_write_b32 a49, 0
    v_accvgpr_write_b32 a50, 0
    v_accvgpr_write_b32 a51, 0
    v_accvgpr_write_b32 a52, 0
    v_accvgpr_write_b32 a53, 0
    v_accvgpr_write_b32 a54, 0
    v_accvgpr_write_b32 a55, 0
    v_accvgpr_write_b32 a56, 0
    v_accvgpr_write_b32 a57, 0
    v_accvgpr_write_b32 a58, 0
    v_accvgpr_write_b32 a59, 0
    v_accvgpr_write_b32 a60, 0
    v_accvgpr_write_b32 a61, 0
    v_accvgpr_write_b32 a62, 0
    v_accvgpr_write_b32 a63, 0
    v_accvgpr_write_b32 a224, 0
    v_accvgpr_write_b32 a225, 0
    v_accvgpr_write_b32 a226, 0
    v_accvgpr_write_b32 a227, 0
    v_accvgpr_write_b32 a228, 0
    v_accvgpr_write_b32 a229, 0
    v_accvgpr_write_b32 a230, 0
    v_accvgpr_write_b32 a231, 0
    v_accvgpr_write_b32 a232, 0
    v_accvgpr_write_b32 a233, 0
    v_accvgpr_write_b32 a234, 0
    v_accvgpr_write_b32 a235, 0
    v_accvgpr_write_b32 a236, 0
    v_accvgpr_write_b32 a237, 0
    v_accvgpr_write_b32 a238, 0
    v_accvgpr_write_b32 a239, 0
    v_mov_b32 v244, 0x7f000000
    v_mov_b32 v245, 0x7f000000
    v_mov_b32 v246, 0x7f000000
    v_mov_b32 v247, 0x7f000000
    s_waitcnt vmcnt(0)
    ds_read_b128 a[128:131], v216 offset:8192
    ds_read_b128 a[132:135], v217 offset:8192
    ds_read_b128 a[136:139], v218 offset:8192
    ds_read_b128 a[140:143], v219 offset:8192
    s_waitcnt lgkmcnt(0)
    ds_read_b128 a[144:147], v216 offset:12288
    ds_read_b128 a[148:151], v217 offset:12288
    ds_read_b128 a[152:155], v218 offset:12288
    ds_read_b128 a[156:159], v219 offset:12288
    s_waitcnt lgkmcnt(0)
    ds_read_b128 a[160:163], v216 offset:0
    ds_read_b128 a[164:167], v217 offset:0
    ds_read_b128 a[168:171], v218 offset:0
    ds_read_b128 a[172:175], v219 offset:0
    s_waitcnt lgkmcnt(0)
    ds_read_b128 a[176:179], v216 offset:4096
    ds_read_b128 a[180:183], v217 offset:4096
    ds_read_b128 a[184:187], v218 offset:4096
    ds_read_b128 a[188:191], v219 offset:4096
    s_waitcnt lgkmcnt(0)
    s_mov_b32 s41, 0
L_redo_blk:
    s_add_u32 m0, s29, 0
    s_add_u32 s35, s21, 0
    buffer_load_dwordx4 v192, s[8:11], s35 offen offset:0 lds
    buffer_load_dwordx4 v193, s[8:11], s35 offen offset:1024 lds
    buffer_load_dwordx4 v194, s[8:11], s35 offen offset:2048 lds
    buffer_load_dwordx4 v195, s[8:11], s35 offen offset:3072 lds
    s_add_u32 m0, s29, 4096
    s_add_u32 s35, s21, 4096
    buffer_load_dwordx4 v192, s[8:11], s35 offen offset:0 lds
    buffer_load_dwordx4 v193, s[8:11], s35 offen offset:1024 lds
    buffer_load_dwordx4 v194, s[8:11], s35 offen offset:2048 lds
    buffer_load_dwordx4 v195, s[8:11], s35 offen offset:3072 lds
    s_add_u32 m0, s29, 8192
    s_add_u32 s35, s21, 0
    buffer_load_dwordx4 v196, s[12:15], s35 offen offset:0 lds
    buffer_load_dwordx4 v197, s[12:15], s35 offen offset:1024 lds
    buffer_load_dwordx4 v196, s[12:15], s35 offen offset:2048 lds
    buffer_load_dwordx4 v197, s[12:15], s35 offen offset:3072 lds
    s_add_u32 m0, s29, 12288
    s_add_u32 s35, s21, 4096
    buffer_load_dwordx4 v196, s[12:15], s35 offen offset:0 lds
    buffer_load_dwordx4 v197, s[12:15], s35 offen offset:1024 lds
    buffer_load_dwordx4 v196, s[12:15], s35 offen offset:2048 lds
    buffer_load_dwordx4 v197, s[12:15], s35 offen offset:3072 lds
    s_add_u32 s21, s21, 8192
    s_waitcnt vmcnt(0)
    ds_read_b128 v[160:163], v216 offset:0
    ds_read_b128 v[164:167], v217 offset:0
    ds_read_b128 v[168:171], v218 offset:0
    ds_read_b128 v[172:175], v219 offset:0
    ds_read_b128 v[176:179], v216 offset:4096
    ds_read_b128 v[180:183], v217 offset:4096
    ds_read_b128 v[184:187], v218 offset:4096
    ds_read_b128 v[188:191], v219 offset:4096
    s_waitcnt lgkmcnt(0)
    ds_read_b64_tr_b16 a[192:193], v224 offset:8192
    ds_read_b64_tr_b16 a[194:195], v224 offset:12288
    ds_read_b64_tr_b16 a[196:197], v225 offset:8192
    ds_read_b64_tr_b16 a[198:199], v225 offset:12288
    ds_read_b64_tr_b16 a[200:201], v226 offset:8192
    ds_read_b64_tr_b16 a[202:203], v226 offset:12288
    ds_read_b64_tr_b16 a[204:205], v227 offset:8192
    ds_read_b64_tr_b16 a[206:207], v227 offset:12288
    ds_read_b64_tr_b16 a[208:209], v228 offset:8192
    ds_read_b64_tr_b16 a[210:211], v228 offset:12288
    ds_read_b64_tr_b16 a[212:213], v229 offset:8192
    ds_read_b64_tr_b16 a[214:215], v229 offset:12288
    ds_read_b64_tr_b16 a[216:217], v230 offset:8192
    ds_read_b64_tr_b16 a[218:219], v230 offset:12288
    ds_read_b64_tr_b16 a[220:221], v231 offset:8192
    ds_read_b64_tr_b16 a[222:223], v231 offset:12288
    v_mfma_f32_16x16x32_bf16 v[96:99], v[160:163], a[128:131], 0
    v_mfma_f32_16x16x32_bf16 v[104:107], v[160:163], a[144:147], 0
    v_mfma_f32_16x16x32_bf16 v[112:115], v[160:163], a[160:163], 0
    v_mfma_f32_16x16x32_bf16 v[120:123], v[160:163], a[176:179], 0
    v_mfma_f32_16x16x32_bf16 v[96:99], v[164:167], a[132:135], v[96:99]
    v_mfma_f32_16x16x32_bf16 v[104:107], v[164:167], a[148:151], v[104:107]
    v_mfma_f32_16x16x32_bf16 v[112:115], v[164:167], a[164:167], v[112:115]
    v_mfma_f32_16x16x32_bf16 v[120:123], v[164:167], a[180:183], v[120:123]
    v_mfma_f32_16x16x32_bf16 v[96:99], v[168:171], a[136:139], v[96:99]
    v_mfma_f32_16x16x32_bf16 v[104:107], v[168:171], a[152:155], v[104:107]
    v_mfma_f32_16x16x32_bf16 v[112:115], v[168:171], a[168:171], v[112:115]
    v_mfma_f32_16x16x32_bf16 v[120:123], v[168:171], a[184:187], v[120:123]
    v_mfma_f32_16x16x32_bf16 v[96:99], v[172:175], a[140:143], v[96:99]
    v_mfma_f32_16x16x32_bf16 v[104:107], v[172:175], a[156:159], v[104:107]
    v_mfma_f32_16x16x32_bf16 v[112:115], v[172:175], a[172:175], v[112:115]
    v_mfma_f32_16x16x32_bf16 v[120:123], v[172:175], a[188:191], v[120:123]
    v_mfma_f32_16x16x32_bf16 v[100:103], v[176:179], a[128:131], 0
    v_mfma_f32_16x16x32_bf16 v[108:111], v[176:179], a[144:147], 0
    v_mfma_f32_16x16x32_bf16 v[116:119], v[176:179], a[160:163], 0
    v_mfma_f32_16x16x32_bf16 v[124:127], v[176:179], a[176:179], 0
    v_mfma_f32_16x16x32_bf16 v[100:103], v[180:183], a[132:135], v[100:103]
    v_mfma_f32_16x16x32_bf16 v[108:111], v[180:183], a[148:151], v[108:111]
    v_mfma_f32_16x16x32_bf16 v[116:119], v[180:183], a[164:167], v[116:119]
    v_mfma_f32_16x16x32_bf16 v[124:127], v[180:183], a[180:183], v[124:127]
    v_mfma_f32_16x16x32_bf16 v[100:103], v[184:187], a[136:139], v[100:103]
    v_mfma_f32_16x16x32_bf16 v[108:111], v[184:187], a[152:155], v[108:111]
    v_mfma_f32_16x16x32_bf16 v[116:119], v[184:187], a[168:171], v[116:119]
    v_mfma_f32_16x16x32_bf16 v[124:127], v[184:187], a[184:187], v[124:127]
    v_mfma_f32_16x16x32_bf16 v[100:103], v[188:191], a[140:143], v[100:103]
    v_mfma_f32_16x16x32_bf16 v[108:111], v[188:191], a[156:159], v[108:111]
    v_mfma_f32_16x16x32_bf16 v[116:119], v[188:191], a[172:175], v[116:119]
    v_mfma_f32_16x16x32_bf16 v[124:127], v[188:191], a[188:191], v[124:127]
    s_nop 15
    v_max3_f32 v200, v96, v97, v98
    v_max3_f32 v200, v200, v99, v100
    v_max3_f32 v200, v200, v101, v102
    v_max_f32 v200, v200, v103
    v_mov_b32 v201, v200
    s_nop 1
    v_permlane32_swap_b32 v200, v201
    v_max_f32 v200, v200, v201
    v_mov_b32 v201, v200
    s_nop 1
    v_permlane16_swap_b32 v200, v201
    v_max_f32 v200, v200, v201
    v_mul_f32 v200, s26, v200
    v_sub_f32 v200, 0, v200
    v_min_f32 v200, v200, v244
    v_sub_f32 v201, v200, v244
    v_exp_f32 v201, v201
    v_mov_b32 v244, v200
    v_mul_f32 v0, v0, v201
    v_mul_f32 v1, v1, v201
    v_mul_f32 v2, v2, v201
    v_mul_f32 v3, v3, v201
    v_mul_f32 v8, v8, v201
    v_mul_f32 v9, v9, v201
    v_mul_f32 v10, v10, v201
    v_mul_f32 v11, v11, v201
    v_mul_f32 v16, v16, v201
    v_mul_f32 v17, v17, v201
    v_mul_f32 v18, v18, v201
    v_mul_f32 v19, v19, v201
    v_mul_f32 v24, v24, v201
    v_mul_f32 v25, v25, v201
    v_mul_f32 v26, v26, v201
    v_mul_f32 v27, v27, v201
    v_mul_f32 v32, v32, v201
    v_mul_f32 v33, v33, v201
    v_mul_f32 v34, v34, v201
    v_mul_f32 v35, v35, v201
    v_mul_f32 v40, v40, v201
    v_mul_f32 v41, v41, v201
    v_mul_f32 v42, v42, v201
    v_mul_f32 v43, v43, v201
    v_mul_f32 v48, v48, v201
    v_mul_f32 v49, v49, v201
    v_mul_f32 v50, v50, v201
    v_mul_f32 v51, v51, v201
    v_mul_f32 v56, v56, v201
    v_mul_f32 v57, v57, v201
    v_mul_f32 v58, v58, v201
    v_mul_f32 v59, v59, v201
    v_accvgpr_read_b32 v202, a224
    v_mul_f32 v202, v202, v201
    v_accvgpr_write_b32 a224, v202
    v_accvgpr_read_b32 v202, a225
    v_mul_f32 v202, v202, v201
    v_accvgpr_write_b32 a225, v202
    v_accvgpr_read_b32 v202, a226
    v_mul_f32 v202, v202, v201
    v_accvgpr_write_b32 a226, v202
    v_accvgpr_read_b32 v202, a227
    v_mul_f32 v202, v202, v201
    v_accvgpr_write_b32 a227, v202
    v_max3_f32 v200, v104, v105, v106
    v_max3_f32 v200, v200, v107, v108
    v_max3_f32 v200, v200, v109, v110
    v_max_f32 v200, v200, v111
    v_mov_b32 v201, v200
    s_nop 1
    v_permlane32_swap_b32 v200, v201
    v_max_f32 v200, v200, v201
    v_mov_b32 v201, v200
    s_nop 1
    v_permlane16_swap_b32 v200, v201
    v_max_f32 v200, v200, v201
    v_mul_f32 v200, s26, v200
    v_sub_f32 v200, 0, v200
    v_min_f32 v200, v200, v245
    v_sub_f32 v201, v200, v245
    v_exp_f32 v201, v201
    v_mov_b32 v245, v200
    v_mul_f32 v4, v4, v201
    v_mul_f32 v5, v5, v201
    v_mul_f32 v6, v6, v201
    v_mul_f32 v7, v7, v201
    v_mul_f32 v12, v12, v201
    v_mul_f32 v13, v13, v201
    v_mul_f32 v14, v14, v201
    v_mul_f32 v15, v15, v201
    v_mul_f32 v20, v20, v201
    v_mul_f32 v21, v21, v201
    v_mul_f32 v22, v22, v201
    v_mul_f32 v23, v23, v201
    v_mul_f32 v28, v28, v201
    v_mul_f32 v29, v29, v201
    v_mul_f32 v30, v30, v201
    v_mul_f32 v31, v31, v201
    v_mul_f32 v36, v36, v201
    v_mul_f32 v37, v37, v201
    v_mul_f32 v38, v38, v201
    v_mul_f32 v39, v39, v201
    v_mul_f32 v44, v44, v201
    v_mul_f32 v45, v45, v201
    v_mul_f32 v46, v46, v201
    v_mul_f32 v47, v47, v201
    v_mul_f32 v52, v52, v201
    v_mul_f32 v53, v53, v201
    v_mul_f32 v54, v54, v201
    v_mul_f32 v55, v55, v201
    v_mul_f32 v60, v60, v201
    v_mul_f32 v61, v61, v201
    v_mul_f32 v62, v62, v201
    v_mul_f32 v63, v63, v201
    v_accvgpr_read_b32 v202, a228
    v_mul_f32 v202, v202, v201
    v_accvgpr_write_b32 a228, v202
    v_accvgpr_read_b32 v202, a229
    v_mul_f32 v202, v202, v201
    v_accvgpr_write_b32 a229, v202
    v_accvgpr_read_b32 v202, a230
    v_mul_f32 v202, v202, v201
    v_accvgpr_write_b32 a230, v202
    v_accvgpr_read_b32 v202, a231
    v_mul_f32 v202, v202, v201
    v_accvgpr_write_b32 a231, v202
    v_max3_f32 v200, v112, v113, v114
    v_max3_f32 v200, v200, v115, v116
    v_max3_f32 v200, v200, v117, v118
    v_max_f32 v200, v200, v119
    v_mov_b32 v201, v200
    s_nop 1
    v_permlane32_swap_b32 v200, v201
    v_max_f32 v200, v200, v201
    v_mov_b32 v201, v200
    s_nop 1
    v_permlane16_swap_b32 v200, v201
    v_max_f32 v200, v200, v201
    v_mul_f32 v200, s26, v200
    v_sub_f32 v200, 0, v200
    v_min_f32 v200, v200, v246
    v_sub_f32 v201, v200, v246
    v_exp_f32 v201, v201
    v_mov_b32 v246, v200
    v_accvgpr_read_b32 v202, a0
    v_mul_f32 v202, v202, v201
    v_accvgpr_write_b32 a0, v202
    v_accvgpr_read_b32 v202, a1
    v_mul_f32 v202, v202, v201
    v_accvgpr_write_b32 a1, v202
    v_accvgpr_read_b32 v202, a2
    v_mul_f32 v202, v202, v201
    v_accvgpr_write_b32 a2, v202
    v_accvgpr_read_b32 v202, a3
    v_mul_f32 v202, v202, v201
    v_accvgpr_write_b32 a3, v202
    v_accvgpr_read_b32 v202, a8
    v_mul_f32 v202, v202, v201
    v_accvgpr_write_b32 a8, v202
    v_accvgpr_read_b32 v202, a9
    v_mul_f32 v202, v202, v201
    v_accvgpr_write_b32 a9, v202
    v_accvgpr_read_b32 v202, a10
    v_mul_f32 v202, v202, v201
    v_accvgpr_write_b32 a10, v202
    v_accvgpr_read_b32 v202, a11
    v_mul_f32 v202, v202, v201
    v_accvgpr_write_b32 a11, v202
    v_accvgpr_read_b32 v202, a16
    v_mul_f32 v202, v202, v201
    v_accvgpr_write_b32 a16, v202
    v_accvgpr_read_b32 v202, a17
    v_mul_f32 v202, v202, v201
    v_accvgpr_write_b32 a17, v202
    v_accvgpr_read_b32 v202, a18
    v_mul_f32 v202, v202, v201
    v_accvgpr_write_b32 a18, v202
    v_accvgpr_read_b32 v202, a19
    v_mul_f32 v202, v202, v201
    v_accvgpr_write_b32 a19, v202
    v_accvgpr_read_b32 v202, a24
    v_mul_f32 v202, v202, v201
    v_accvgpr_write_b32 a24, v202
    v_accvgpr_read_b32 v202, a25
    v_mul_f32 v202, v202, v201
    v_accvgpr_write_b32 a25, v202
    v_accvgpr_read_b32 v202, a26
    v_mul_f32 v202, v202, v201
    v_accvgpr_write_b32 a26, v202
    v_accvgpr_read_b32 v202, a27
    v_mul_f32 v202, v202, v201
    v_accvgpr_write_b32 a27, v202
    v_accvgpr_read_b32 v202, a32
    v_mul_f32 v202, v202, v201
    v_accvgpr_write_b32 a32, v202
    v_accvgpr_read_b32 v202, a33
    v_mul_f32 v202, v202, v201
    v_accvgpr_write_b32 a33, v202
    v_accvgpr_read_b32 v202, a34
    v_mul_f32 v202, v202, v201
    v_accvgpr_write_b32 a34, v202
    v_accvgpr_read_b32 v202, a35
    v_mul_f32 v202, v202, v201
    v_accvgpr_write_b32 a35, v202
    v_accvgpr_read_b32 v202, a40
    v_mul_f32 v202, v202, v201
    v_accvgpr_write_b32 a40, v202
    v_accvgpr_read_b32 v202, a41
    v_mul_f32 v202, v202, v201
    v_accvgpr_write_b32 a41, v202
    v_accvgpr_read_b32 v202, a42
    v_mul_f32 v202, v202, v201
    v_accvgpr_write_b32 a42, v202
    v_accvgpr_read_b32 v202, a43
    v_mul_f32 v202, v202, v201
    v_accvgpr_write_b32 a43, v202
    v_accvgpr_read_b32 v202, a48
    v_mul_f32 v202, v202, v201
    v_accvgpr_write_b32 a48, v202
    v_accvgpr_read_b32 v202, a49
    v_mul_f32 v202, v202, v201
    v_accvgpr_write_b32 a49, v202
    v_accvgpr_read_b32 v202, a50
    v_mul_f32 v202, v202, v201
    v_accvgpr_write_b32 a50, v202
    v_accvgpr_read_b32 v202, a51
    v_mul_f32 v202, v202, v201
    v_accvgpr_write_b32 a51, v202
    v_accvgpr_read_b32 v202, a56
    v_mul_f32 v202, v202, v201
    v_accvgpr_write_b32 a56, v202
    v_accvgpr_read_b32 v202, a57
    v_mul_f32 v202, v202, v201
    v_accvgpr_write_b32 a57, v202
    v_accvgpr_read_b32 v202, a58
    v_mul_f32 v202, v202, v201
    v_accvgpr_write_b32 a58, v202
    v_accvgpr_read_b32 v202, a59
    v_mul_f32 v202, v202, v201
    v_accvgpr_write_b32 a59, v202
    v_accvgpr_read_b32 v202, a232
    v_mul_f32 v202, v202, v201
    v_accvgpr_write_b32 a232, v202
    v_accvgpr_read_b32 v202, a233
    v_mul_f32 v202, v202, v201
    v_accvgpr_write_b32 a233, v202
    v_accvgpr_read_b32 v202, a234
    v_mul_f32 v202, v202, v201
    v_accvgpr_write_b32 a234, v202
    v_accvgpr_read_b32 v202, a235
    v_mul_f32 v202, v202, v201
    v_accvgpr_write_b32 a235, v202
    v_max3_f32 v200, v120, v121, v122
    v_max3_f32 v200, v200, v123, v124
    v_max3_f32 v200, v200, v125, v126
    v_max_f32 v200, v200, v127
    v_mov_b32 v201, v200
    s_nop 1
    v_permlane32_swap_b32 v200, v201
    v_max_f32 v200, v200, v201
    v_mov_b32 v201, v200
    s_nop 1
    v_permlane16_swap_b32 v200, v201
    v_max_f32 v200, v200, v201
    v_mul_f32 v200, s26, v200
    v_sub_f32 v200, 0, v200
    v_min_f32 v200, v200, v247
    v_sub_f32 v201, v200, v247
    v_exp_f32 v201, v201
    v_mov_b32 v247, v200
    v_accvgpr_read_b32 v202, a4
    v_mul_f32 v202, v202, v201
    v_accvgpr_write_b32 a4, v202
    v_accvgpr_read_b32 v202, a5
    v_mul_f32 v202, v202, v201
    v_accvgpr_write_b32 a5, v202
    v_accvgpr_read_b32 v202, a6
    v_mul_f32 v202, v202, v201
    v_accvgpr_write_b32 a6, v202
    v_accvgpr_read_b32 v202, a7
    v_mul_f32 v202, v202, v201
    v_accvgpr_write_b32 a7, v202
    v_accvgpr_read_b32 v202, a12
    v_mul_f32 v202, v202, v201
    v_accvgpr_write_b32 a12, v202
    v_accvgpr_read_b32 v202, a13
    v_mul_f32 v202, v202, v201
    v_accvgpr_write_b32 a13, v202
    v_accvgpr_read_b32 v202, a14
    v_mul_f32 v202, v202, v201
    v_accvgpr_write_b32 a14, v202
    v_accvgpr_read_b32 v202, a15
    v_mul_f32 v202, v202, v201
    v_accvgpr_write_b32 a15, v202
    v_accvgpr_read_b32 v202, a20
    v_mul_f32 v202, v202, v201
    v_accvgpr_write_b32 a20, v202
    v_accvgpr_read_b32 v202, a21
    v_mul_f32 v202, v202, v201
    v_accvgpr_write_b32 a21, v202
    v_accvgpr_read_b32 v202, a22
    v_mul_f32 v202, v202, v201
    v_accvgpr_write_b32 a22, v202
    v_accvgpr_read_b32 v202, a23
    v_mul_f32 v202, v202, v201
    v_accvgpr_write_b32 a23, v202
    v_accvgpr_read_b32 v202, a28
    v_mul_f32 v202, v202, v201
    v_accvgpr_write_b32 a28, v202
    v_accvgpr_read_b32 v202, a29
    v_mul_f32 v202, v202, v201
    v_accvgpr_write_b32 a29, v202
    v_accvgpr_read_b32 v202, a30
    v_mul_f32 v202, v202, v201
    v_accvgpr_write_b32 a30, v202
    v_accvgpr_read_b32 v202, a31
    v_mul_f32 v202, v202, v201
    v_accvgpr_write_b32 a31, v202
    v_accvgpr_read_b32 v202, a36
    v_mul_f32 v202, v202, v201
    v_accvgpr_write_b32 a36, v202
    v_accvgpr_read_b32 v202, a37
    v_mul_f32 v202, v202, v201
    v_accvgpr_write_b32 a37, v202
    v_accvgpr_read_b32 v202, a38
    v_mul_f32 v202, v202, v201
    v_accvgpr_write_b32 a38, v202
    v_accvgpr_read_b32 v202, a39
    v_mul_f32 v202, v202, v201
    v_accvgpr_write_b32 a39, v202
    v_accvgpr_read_b32 v202, a44
    v_mul_f32 v202, v202, v201
    v_accvgpr_write_b32 a44, v202
    v_accvgpr_read_b32 v202, a45
    v_mul_f32 v202, v202, v201
    v_accvgpr_write_b32 a45, v202
    v_accvgpr_read_b32 v202, a46
    v_mul_f32 v202, v202, v201
    v_accvgpr_write_b32 a46, v202
    v_accvgpr_read_b32 v202, a47
    v_mul_f32 v202, v202, v201
    v_accvgpr_write_b32 a47, v202
    v_accvgpr_read_b32 v202, a52
    v_mul_f32 v202, v202, v201
    v_accvgpr_write_b32 a52, v202
    v_accvgpr_read_b32 v202, a53
    v_mul_f32 v202, v202, v201
    v_accvgpr_write_b32 a53, v202
    v_accvgpr_read_b32 v202, a54
    v_mul_f32 v202, v202, v201
    v_accvgpr_write_b32 a54, v202
    v_accvgpr_read_b32 v202, a55
    v_mul_f32 v202, v202, v201
    v_accvgpr_write_b32 a55, v202
    v_accvgpr_read_b32 v202, a60
    v_mul_f32 v202, v202, v201
    v_accvgpr_write_b32 a60, v202
    v_accvgpr_read_b32 v202, a61
    v_mul_f32 v202, v202, v201
    v_accvgpr_write_b32 a61, v202
    v_accvgpr_read_b32 v202, a62
    v_mul_f32 v202, v202, v201
    v_accvgpr_write_b32 a62, v202
    v_accvgpr_read_b32 v202, a63
    v_mul_f32 v202, v202, v201
    v_accvgpr_write_b32 a63, v202
    v_accvgpr_read_b32 v202, a236
    v_mul_f32 v202, v202, v201
    v_accvgpr_write_b32 a236, v202
    v_accvgpr_read_b32 v202, a237
    v_mul_f32 v202, v202, v201
    v_accvgpr_write_b32 a237, v202
    v_accvgpr_read_b32 v202, a238
    v_mul_f32 v202, v202, v201
    v_accvgpr_write_b32 a238, v202
    v_accvgpr_read_b32 v202, a239
    v_mul_f32 v202, v202, v201
    v_accvgpr_write_b32 a239, v202
    v_pk_fma_f32 v[96:97], v[96:97], s[26:27], v[244:245] op_sel:[0,0,0] op_sel_hi:[1,0,0]
    v_pk_fma_f32 v[98:99], v[98:99], s[26:27], v[244:245] op_sel:[0,0,0] op_sel_hi:[1,0,0]
    v_pk_fma_f32 v[100:101], v[100:101], s[26:27], v[244:245] op_sel:[0,0,0] op_sel_hi:[1,0,0]
    v_pk_fma_f32 v[102:103], v[102:103], s[26:27], v[244:245] op_sel:[0,0,0] op_sel_hi:[1,0,0]
    v_pk_fma_f32 v[104:105], v[104:105], s[26:27], v[244:245] op_sel:[0,0,1] op_sel_hi:[1,0,1]
    v_pk_fma_f32 v[106:107], v[106:107], s[26:27], v[244:245] op_sel:[0,0,1] op_sel_hi:[1,0,1]
    v_pk_fma_f32 v[108:109], v[108:109], s[26:27], v[244:245] op_sel:[0,0,1] op_sel_hi:[1,0,1]
    v_pk_fma_f32 v[110:111], v[110:111], s[26:27], v[244:245] op_sel:[0,0,1] op_sel_hi:[1,0,1]
    v_pk_fma_f32 v[112:113], v[112:113], s[26:27], v[246:247] op_sel:[0,0,0] op_sel_hi:[1,0,0]
    v_pk_fma_f32 v[114:115], v[114:115], s[26:27], v[246:247] op_sel:[0,0,0] op_sel_hi:[1,0,0]
    v_pk_fma_f32 v[116:117], v[116:117], s[26:27], v[246:247] op_sel:[0,0,0] op_sel_hi:[1,0,0]
    v_pk_fma_f32 v[118:119], v[118:119], s[26:27], v[246:247] op_sel:[0,0,0] op_sel_hi:[1,0,0]
    v_pk_fma_f32 v[120:121], v[120:121], s[26:27], v[246:247] op_sel:[0,0,1] op_sel_hi:[1,0,1]
    v_pk_fma_f32 v[122:123], v[122:123], s[26:27], v[246:247] op_sel:[0,0,1] op_sel_hi:[1,0,1]
    v_pk_fma_f32 v[124:125], v[124:125], s[26:27], v[246:247] op_sel:[0,0,1] op_sel_hi:[1,0,1]
    v_pk_fma_f32 v[126:127], v[126:127], s[26:27], v[246:247] op_sel:[0,0,1] op_sel_hi:[1,0,1]
    s_nop 1
    v_exp_f32 v96, v96
    v_exp_f32 v97, v97
    v_exp_f32 v98, v98
    v_cvt_pk_bf16_f32 v144, v96, v97
    v_exp_f32 v99, v99
    v_exp_f32 v100, v100
    v_cvt_pk_bf16_f32 v145, v98, v99
    v_exp_f32 v101, v101
    v_exp_f32 v102, v102
    v_cvt_pk_bf16_f32 v146, v100, v101
    v_exp_f32 v103, v103
    v_exp_f32 v104, v104
    v_cvt_pk_bf16_f32 v147, v102, v103
    v_exp_f32 v105, v105
    v_exp_f32 v106, v106
    v_cvt_pk_bf16_f32 v148, v104, v105
    v_exp_f32 v107, v107
    v_exp_f32 v108, v108
    v_cvt_pk_bf16_f32 v149, v106, v107
    v_exp_f32 v109, v109
    v_exp_f32 v110, v110
    v_cvt_pk_bf16_f32 v150, v108, v109
    v_exp_f32 v111, v111
    v_exp_f32 v112, v112
    v_cvt_pk_bf16_f32 v151, v110, v111
    v_exp_f32 v113, v113
    v_exp_f32 v114, v114
    v_cvt_pk_bf16_f32 v152, v112, v113
    v_exp_f32 v115, v115
    v_exp_f32 v116, v116
    v_cvt_pk_bf16_f32 v153, v114, v115
    v_exp_f32 v117, v117
    v_exp_f32 v118, v118
    v_cvt_pk_bf16_f32 v154, v116, v117
    v_exp_f32 v119, v119
    v_exp_f32 v120, v120
    v_cvt_pk_bf16_f32 v155, v118, v119
    v_exp_f32 v121, v121
    v_exp_f32 v122, v122
    v_cvt_pk_bf16_f32 v156, v120, v121
    v_exp_f32 v123, v123
    v_exp_f32 v124, v124
    v_cvt_pk_bf16_f32 v157, v122, v123
    v_exp_f32 v125, v125
    v_exp_f32 v126, v126
    v_cvt_pk_bf16_f32 v158, v124, v125
    v_exp_f32 v127, v127
    s_nop 0
    v_cvt_pk_bf16_f32 v159, v126, v127
    s_add_u32 s41, s41, 1
    s_cmp_eq_u32 s41, 16
    s_cbranch_scc1 L_tail
    s_waitcnt lgkmcnt(0)
    v_mfma_f32_16x16x32_bf16 a[224:227], a[240:243], v[144:147], a[224:227]
    v_mfma_f32_16x16x32_bf16 a[228:231], a[240:243], v[148:151], a[228:231]
    v_mfma_f32_16x16x32_bf16 a[232:235], a[240:243], v[152:155], a[232:235]
    v_mfma_f32_16x16x32_bf16 a[236:239], a[240:243], v[156:159], a[236:239]
    v_mfma_f32_16x16x32_bf16 v[0:3], a[192:195], v[144:147], v[0:3]
    v_mfma_f32_16x16x32_bf16 v[4:7], a[192:195], v[148:151], v[4:7]
    v_mfma_f32_16x16x32_bf16 a[0:3], a[192:195], v[152:155], a[0:3]
    v_mfma_f32_16x16x32_bf16 a[4:7], a[192:195], v[156:159], a[4:7]
    v_mfma_f32_16x16x32_bf16 v[8:11], a[196:199], v[144:147], v[8:11]
    v_mfma_f32_16x16x32_bf16 v[12:15], a[196:199], v[148:151], v[12:15]
    v_mfma_f32_16x16x32_bf16 a[8:11], a[196:199], v[152:155], a[8:11]
    v_mfma_f32_16x16x32_bf16 a[12:15], a[196:199], v[156:159], a[12:15]
    v_mfma_f32_16x16x32_bf16 v[16:19], a[200:203], v[144:147], v[16:19]
    v_mfma_f32_16x16x32_bf16 v[20:23], a[200:203], v[148:151], v[20:23]
    v_mfma_f32_16x16x32_bf16 a[16:19], a[200:203], v[152:155], a[16:19]
    v_mfma_f32_16x16x32_bf16 a[20:23], a[200:203], v[156:159], a[20:23]
    v_mfma_f32_16x16x32_bf16 v[24:27], a[204:207], v[144:147], v[24:27]
    v_mfma_f32_16x16x32_bf16 v[28:31], a[204:207], v[148:151], v[28:31]
    v_mfma_f32_16x16x32_bf16 a[24:27], a[204:207], v[152:155], a[24:27]
    v_mfma_f32_16x16x32_bf16 a[28:31], a[204:207], v[156:159], a[28:31]
    v_mfma_f32_16x16x32_bf16 v[32:35], a[208:211], v[144:147], v[32:35]
    v_mfma_f32_16x16x32_bf16 v[36:39], a[208:211], v[148:151], v[36:39]
    v_mfma_f32_16x16x32_bf16 a[32:35], a[208:211], v[152:155], a[32:35]
    v_mfma_f32_16x16x32_bf16 a[36:39], a[208:211], v[156:159], a[36:39]
    v_mfma_f32_16x16x32_bf16 v[40:43], a[212:215], v[144:147], v[40:43]
    v_mfma_f32_16x16x32_bf16 v[44:47], a[212:215], v[148:151], v[44:47]
    v_mfma_f32_16x16x32_bf16 a[40:43], a[212:215], v[152:155], a[40:43]
    v_mfma_f32_16x16x32_bf16 a[44:47], a[212:215], v[156:159], a[44:47]
    v_mfma_f32_16x16x32_bf16 v[48:51], a[216:219], v[144:147], v[48:51]
    v_mfma_f32_16x16x32_bf16 v[52:55], a[216:219], v[148:151], v[52:55]
    v_mfma_f32_16x16x32_bf16 a[48:51], a[216:219], v[152:155], a[48:51]
    v_mfma_f32_16x16x32_bf16 a[52:55], a[216:219], v[156:159], a[52:55]
    v_mfma_f32_16x16x32_bf16 v[56:59], a[220:223], v[144:147], v[56:59]
    v_mfma_f32_16x16x32_bf16 v[60:63], a[220:223], v[148:151], v[60:63]
    v_mfma_f32_16x16x32_bf16 a[56:59], a[220:223], v[152:155], a[56:59]
    v_mfma_f32_16x16x32_bf16 a[60:63], a[220:223], v[156:159], a[60:63]
    s_branch L_redo_blk
L_codeend:
.section .rodata,"a"
.p2align 6
.amdhsa_kernel standalone__mha_softmax__near_ridge_kernel
  .amdhsa_next_free_vgpr 508
  .amdhsa_next_free_sgpr 48
  .amdhsa_accum_offset 256
  .amdhsa_group_segment_fixed_size 0
  .amdhsa_kernarg_size 48
  .amdhsa_user_sgpr_count 2
  .amdhsa_user_sgpr_kernarg_segment_ptr 1
  .amdhsa_system_sgpr_workgroup_id_x 1
.end_amdhsa_kernel
```
